```python
import torch

def _softmax(x, axis=-1):
    return torch.softmax(x, dim=axis)
def _gelu(x):
    return torch.nn.functional.gelu(x, approximate="tanh")
def _silu(x):
    return torch.nn.functional.silu(x)
def _sigmoid(x):
    return torch.sigmoid(x)
def _layernorm(x, axis=-1, eps=1e-5):
    m = x.mean(dim=axis, keepdim=True)
    v = x.var(dim=axis, keepdim=True, unbiased=False)
    return (x - m) / torch.sqrt(v + eps)
def _scatter_add(tgt, idx, src, axis=0):
    return tgt.clone().index_add_(axis, idx, src)
def _segment_sum(src, seg, n):
    out = torch.zeros((n,) + src.shape[1:], dtype=src.dtype)
    return out.index_add_(0, seg, src)
def _pad(x, pw):
    flat = tuple(v for pair in reversed(pw) for v in pair)
    return torch.nn.functional.pad(x, flat)

kernel_name = 'interleave_layers__grouped_kv_mqa__dense_activation_silu__prompt'

def setup_inputs():

    _w = (lambda a: (lambda t: t.to(torch.bfloat16) if t.is_floating_point() else t)(torch.as_tensor(a)))
    def _A_setup():
        B, S, D, H = 1, 2048, 1024, 32
        Dh = D // H
        return {
            "x": _w((lambda *s: torch.randn(*s, dtype=torch.bfloat16) * 0.05)(B, S, D)),
            "wq": _w((lambda *s: torch.randn(*s, dtype=torch.bfloat16) * 0.05)(D, H * Dh)),
            "wk": _w((lambda *s: torch.randn(*s, dtype=torch.bfloat16) * 0.05)(D, Dh)),
            "wv": _w((lambda *s: torch.randn(*s, dtype=torch.bfloat16) * 0.05)(D, Dh)),
            "wo": _w((lambda *s: torch.randn(*s, dtype=torch.bfloat16) * 0.05)(H * Dh, D)),
        }
    _A_in = _A_setup()

    def _B_setup():
        B, S, D, F = 1, 2048, 1024, 3584
        return {
            "x": _w((lambda *s: torch.randn(*s, dtype=torch.bfloat16) * 0.05)(B, S, D)),
            "w1": _w((lambda *s: torch.randn(*s, dtype=torch.bfloat16) * 1.6)(D, F) * (D ** -0.5)),
            "w2": _w((lambda *s: torch.randn(*s, dtype=torch.bfloat16) * 1.6)(F, D) * (F ** -0.5)),
        }
    _B_in = _B_setup()

    return {
        "A_x": _A_in["x"],
        "A_wq": _A_in["wq"],
        "A_wk": _A_in["wk"],
        "A_wv": _A_in["wv"],
        "A_wo": _A_in["wo"],
        "B_x": _B_in["x"],
        "B_w1": _B_in["w1"],
        "B_w2": _B_in["w2"],
    }

def reference(A_x, A_wq, A_wk, A_wv, A_wo, B_x, B_w1, B_w2):
    def _A_ref(x, wq, wk, wv, wo):
        B, S, D = x.shape
        H = 32
        Dh = D // H
        q = (lambda x, *d: x.permute(*d))((x @ wq).reshape(B, S, H, Dh), 0, 2, 1, 3)
        k = x @ wk
        v = x @ wv
        scores = torch.einsum("bhqd,bkd->bhqk", q, k) * (Dh ** -0.5)
        p = _softmax(scores, axis=-1)
        o = torch.einsum("bhqk,bkd->bhqd", p, v)
        return (lambda x, *d: x.permute(*d))(o, 0, 2, 1, 3).reshape(B, S, H * Dh) @ wo

    def _B_ref(x, w1, w2):
        h = torch.einsum("bsd,df->bsf", x, w1)
        h = _silu(h)
        out = torch.einsum("bsf,fd->bsd", h, w2)
        return out

    x = A_x
    x = x + _A_ref(_layernorm(x, axis=-1), A_wq, A_wk, A_wv, A_wo)
    x = x + _B_ref(_layernorm(x, axis=-1), B_w1, B_w2)
    x = x + _A_ref(_layernorm(x, axis=-1), A_wq, A_wk, A_wv, A_wo)
    x = x + _B_ref(_layernorm(x, axis=-1), B_w1, B_w2)
    return x
```

```asm
; @launch grid=(256,1,1) block=(256,1,1) lds=163840
.amdgcn_target "amdgcn-amd-amdhsa--gfx950"
.text
.globl interleave_layers__grouped_kv_mqa__dense_activation_silu__prompt_kernel
.p2align 8
.type interleave_layers__grouped_kv_mqa__dense_activation_silu__prompt_kernel,@function
interleave_layers__grouped_kv_mqa__dense_activation_silu__prompt_kernel:
Lcode_start:
    s_cmp_ge_u32 s2, 256
    s_cbranch_scc1 L_main_kernel_end_1001
    s_load_dwordx2 s[4:5], s[0:1], 80
    s_load_dwordx2 s[6:7], s[0:1], 64
    s_load_dwordx4 s[48:51], s[0:1], 48
    s_load_dwordx2 s[8:9], s[0:1], 0
    s_load_dwordx2 s[96:97], s[0:1], 8
    s_load_dwordx4 s[36:39], s[0:1], 16
    s_load_dwordx2 s[100:101], s[0:1], 32
    v_lshrrev_b32 v1, 6, v0
    v_and_b32 v2, 63, v0
    v_readfirstlane_b32 s54, v1
    v_lshlrev_b32 v3, 4, v2
    v_add_u32 v4, 0x10000, v3
    v_add_u32 v242, 0x20000, v3
    s_and_b32 s52, s2, 7
    s_lshl_b32 s52, s52, 1
    s_lshr_b32 s32, s2, 7
    s_add_u32 s52, s52, s32
    s_lshr_b32 s53, s2, 3
    s_and_b32 s53, s53, 15
    s_lshl_b32 s55, s52, 2
    s_lshr_b32 s32, s53, 2
    s_add_u32 s82, s55, s32
    s_add_u32 s55, s55, s54
    s_mov_b32 s58, 0x07060302
    s_lshl_b32 s77, s52, 4
    s_add_u32 s77, s77, s53
    s_lshl_b32 s77, s77, 3
    s_add_u32 s77, s77, 835584
    s_cmp_eq_u32 s82, s55
    s_cselect_b32 s77, s77, 2146435072
    s_lshl_b32 s30, s54, 15
    s_lshl_b32 s29, s54, 19
    s_lshl_b32 s32, s53, 7
    s_add_u32 s29, s29, s32
    s_sub_u32 s30, s30, 0x8000
    s_cmp_eq_u32 s54, 0
    s_cselect_b32 s30, 0x20000, s30
    s_lshl_b32 s34, s55, 16
    s_add_u32 s34, s34, s32
    s_lshl_b32 s87, s54, 12
    s_add_u32 m0, s30, 0x7000
    s_lshl_b32 s84, s54, 13
    s_add_u32 s84, s84, 0x18000
    v_lshrrev_b32 v252, 3, v2
    v_lshlrev_b32 v252, 11, v252
    v_lshrrev_b32 v5, 2, v2
    v_and_b32 v5, 4, v5
    v_and_b32 v6, 7, v2
    v_xor_b32 v5, v5, v6
    v_lshl_add_u32 v252, v5, 4, v252
    s_mov_b32 s10, 4194304
    s_mov_b32 s11, 0x20000
    s_mov_b32 s98, 2097152
    s_mov_b32 s99, 0x20000
    s_waitcnt lgkmcnt(0)
    buffer_load_dwordx4 v252, s[8:11], s34 offen offset:0 nt lds
    s_add_u32 s34, s34, 15360
    buffer_load_dwordx4 v252, s[8:11], s34 offen offset:1024 nt lds
    s_add_u32 s34, s34, 15360
    buffer_load_dwordx4 v252, s[8:11], s34 offen offset:2048 nt lds
    s_add_u32 s34, s34, 15360
    buffer_load_dwordx4 v252, s[8:11], s34 offen offset:3072 nt lds
    v_mov_b32 v5, 48234496
    global_load_dwordx2 v[244:245], v5, s[4:5]
    s_getpc_b64 s[34:35]
Lpc0:
    s_sub_u32 s34, s34, Lpc0-Lcode_start
    s_subb_u32 s35, s35, 0
    s_lshr_b32 s32, s2, 3
    s_lshl_b32 s32, s32, 2
    s_add_u32 s32, s32, s54
    s_min_u32 s32, s32, ((Lcode_end-Lcode_start)>>10)-1
    s_lshl_b32 s32, s32, 10
    v_add_u32 v5, s32, v3
    global_load_dwordx4 v[140:143], v5, s[34:35]
    s_mov_b32 s20, s4
    s_mov_b32 s21, s5
    s_mov_b32 s22, 48496640
    s_mov_b32 s23, 0x20000
    s_add_u32 s16, s4, 48496640
    s_addc_u32 s17, s5, 0
    s_mov_b32 s18, 2097152
    s_mov_b32 s19, 0x20000
    s_lshr_b32 s32, s2, 1
    s_and_b32 s32, s32, 3
    s_lshl_b32 s32, s32, 2
    s_lshr_b32 s33, s2, 6
    s_add_u32 s32, s32, s33
    s_lshl_b32 s32, s32, 2
    s_add_u32 s32, s32, s54
    s_sub_u32 s32, s32, s55
    v_lshrrev_b32 v5, 5, v2
    v_mul_lo_u32 v5, v5, s32
    v_add_u32 v5, s55, v5
    v_and_b32 v6, 7, v2
    v_lshrrev_b32 v7, 2, v5
    v_cmp_gt_u32 vcc, 6, v6
    v_min_u32 v6, 6, v6
    v_bfe_u32 v28, v2, 3, 1
    v_cndmask_b32 v5, v7, v5, vcc
    v_lshlrev_b32 v5, 7, v5
    v_lshl_add_u32 v5, v6, 13, v5
    v_mul_u32_u24 v28, 53248, v28
    v_add_u32 v5, v5, v28
    v_bfe_u32 v6, v2, 4, 1
    v_lshl_add_u32 v5, v6, 20, v5
    s_mov_b32 s33, 786432
    buffer_load_dword v248, v5, s[16:19], s33 offen sc1
    s_bitcmp1_b32 s53, 0
    s_cselect_b32 s12, s38, s36
    s_cselect_b32 s13, s39, s37
    s_mov_b32 s14, 65536
    s_mov_b32 s15, 0x20000
    s_lshl_b32 s85, s54, 14
    v_and_b32 v5, 15, v2
    v_lshlrev_b32 v5, 11, v5
    s_lshl_b32 s32, s55, 15
    s_lshl_b32 s33, s53, 7
    s_add_u32 s33, s33, s32
    buffer_load_dword v248, v5, s[96:99], s33 offen
    s_lshr_b32 s33, s53, 1
    s_lshl_b32 s32, s55, 3
    s_add_u32 s33, s33, s32
    s_lshl_b32 s33, s33, 7
    buffer_load_dword v248, off, s[12:15], s33
    s_add_u32 m0, s84, 0
    s_add_u32 s60, s85, 0
    buffer_load_dwordx4 v3, s[12:15], s60 offen offset:0 lds
    buffer_load_dwordx4 v3, s[12:15], s60 offen offset:1024 lds
    buffer_load_dwordx4 v3, s[12:15], s60 offen offset:2048 lds
    buffer_load_dwordx4 v3, s[12:15], s60 offen offset:3072 lds
    s_lshr_b32 s32, s2, 1
    s_and_b32 s32, s32, 3
    s_lshl_b32 s32, s32, 2
    s_lshr_b32 s33, s2, 6
    s_add_u32 s32, s32, s33
    s_lshl_b32 s94, s32, 2
    s_add_u32 s94, s94, s54
    s_lshl_b32 s43, s33, 2
    s_add_u32 s43, s43, s54
    s_and_b32 s40, s53, 7
    s_and_b32 s32, s2, 1
    s_lshl_b32 s95, s32, 3
    s_add_u32 s95, s95, s40
    s_lshr_b32 s33, s2, 7
    s_cmp_eq_u32 s32, s33
    s_cselect_b32 s41, 1, 0
    s_mov_b32 s56, 0
    s_and_b32 s45, s40, 0
    s_and_b32 s76, s40, 7
    s_mov_b32 s68, 0xbfb8aa3b
    s_mov_b32 s69, 0xbfb8aa3b
    s_lshl_b32 s46, s95, 20
    s_add_u32 s46, s46, s87
    s_add_u32 s46, s46, 31916032
    s_lshl_b32 s47, s54, 16
    s_lshl_b32 s32, s53, 7
    s_add_u32 s47, s47, s32
    s_and_b32 s86, s52, 1
    s_lshl_b32 s86, s86, 2
    s_add_u32 s86, s86, s54
    v_lshlrev_b32 v249, 7, v2
    v_and_b32 v5, 15, v2
    v_lshlrev_b32 v5, 3, v5
    s_lshl_b32 s32, s55, 7
    v_add_u32 v250, s32, v5
    s_lshl_b32 s32, s82, 7
    v_add_u32 v251, s32, v5
    v_cmp_gt_u32 vcc, 16, v2
    s_nop 1
    v_cndmask_b32 v251, v251, v250, vcc
    s_lshl_b32 s32, s94, 7
    v_add_u32 v0, s32, v5
    s_and_b32 s33, s2, 1
    s_lshl_b32 s33, s33, 6
    s_add_u32 s33, s33, s32
    v_and_b32 v5, 56, v5
    v_add_u32 v1, s33, v5
    v_lshrrev_b32 v243, 4, v2
    v_lshlrev_b32 v243, 9, v243
    v_and_b32 v5, 15, v2
    v_lshl_add_u32 v243, v5, 4, v243
    v_lshrrev_b32 v172, 5, v2
    v_bfe_u32 v5, v2, 2, 2
    v_lshl_add_u32 v172, v172, 2, v5
    v_lshlrev_b32 v172, 7, v172
    v_bfe_u32 v5, v2, 3, 1
    v_lshl_add_u32 v172, v5, 6, v172
    v_bfe_u32 v5, v2, 4, 1
    v_lshl_add_u32 v172, v5, 5, v172
    v_and_b32 v5, 3, v2
    v_lshl_add_u32 v172, v5, 3, v172
    v_xor_b32 v173, 64, v172
    v_add_u32 v174, 0x10000, v172
    v_add_u32 v175, 0x10000, v173
    v_add_u32 v176, 0x20000, v172
    v_add_u32 v177, 0x20000, v173
    v_lshrrev_b32 v146, 2, v2
    v_lshlrev_b32 v146, 6, v146
    v_bfe_u32 v5, v2, 1, 1
    v_lshl_add_u32 v146, v5, 5, v146
    v_and_b32 v5, 1, v2
    v_lshl_add_u32 v146, v5, 3, v146
    v_add_u32 v146, s84, v146
    s_lshl_b32 s35, s55, 16
    s_lshl_b32 s32, s53, 12
    s_add_u32 s35, s35, s32
    s_lshl_b32 s34, s53, 14
    s_lshl_b32 s33, s55, 8
    s_add_u32 s34, s34, s33
    s_add_u32 s34, s34, 262144
    v_mov_b32 v24, 0
    v_mov_b32 v25, 0
    v_mov_b32 v26, 0
    v_mov_b32 v27, 0
    v_mov_b32 v136, 0x3f803f80
    v_mov_b32 v137, 0x3f803f80
    v_mov_b32 v138, 0x3f803f80
    v_mov_b32 v139, 0x3f803f80
    v_and_b32 v7, 31, v2
    v_lshlrev_b32 v7, 3, v7
    v_and_b32 v147, 15, v2
    v_lshlrev_b32 v147, 7, v147
    v_bfe_u32 v5, v2, 1, 1
    v_lshl_add_u32 v147, v5, 6, v147
    v_lshrrev_b32 v5, 4, v2
    v_lshl_add_u32 v147, v5, 3, v147
    s_add_u32 s33, s30, 0x7000
    v_add_u32 v147, s33, v147
    v_xor_b32 v148, 64, v147
    v_add_u32 v144, s30, v172
    v_add_u32 v145, s30, v173
    s_waitcnt vmcnt(9)
    ds_read_b64 v[8:9], v147 offset:0
    ds_read_b64 v[10:11], v147 offset:32
    ds_read_b64 v[12:13], v147 offset:2048
    ds_read_b64 v[14:15], v147 offset:2080
    ds_read_b64 v[16:17], v148 offset:0
    ds_read_b64 v[18:19], v148 offset:32
    ds_read_b64 v[20:21], v148 offset:2048
    ds_read_b64 v[22:23], v148 offset:2080
    s_waitcnt lgkmcnt(0)
    buffer_store_dwordx4 v[8:11], v243, s[20:23], s35 offen offset:0 sc1
    buffer_store_dwordx4 v[12:15], v243, s[20:23], s35 offen offset:256 sc1
    buffer_store_dwordx4 v[16:19], v243, s[20:23], s35 offen offset:2048 sc1
    buffer_store_dwordx4 v[20:23], v243, s[20:23], s35 offen offset:2304 sc1
    v_dot2_f32_bf16 v24, v8, v136, v24
    v_dot2_f32_bf16 v25, v8, v8, v25
    v_dot2_f32_bf16 v24, v9, v136, v24
    v_dot2_f32_bf16 v25, v9, v9, v25
    v_dot2_f32_bf16 v24, v10, v136, v24
    v_dot2_f32_bf16 v25, v10, v10, v25
    v_dot2_f32_bf16 v24, v11, v136, v24
    v_dot2_f32_bf16 v25, v11, v11, v25
    v_dot2_f32_bf16 v26, v12, v136, v26
    v_dot2_f32_bf16 v27, v12, v12, v27
    v_dot2_f32_bf16 v26, v13, v136, v26
    v_dot2_f32_bf16 v27, v13, v13, v27
    v_dot2_f32_bf16 v26, v14, v136, v26
    v_dot2_f32_bf16 v27, v14, v14, v27
    v_dot2_f32_bf16 v26, v15, v136, v26
    v_dot2_f32_bf16 v27, v15, v15, v27
    v_dot2_f32_bf16 v24, v16, v136, v24
    v_dot2_f32_bf16 v25, v16, v16, v25
    v_dot2_f32_bf16 v24, v17, v136, v24
    v_dot2_f32_bf16 v25, v17, v17, v25
    v_dot2_f32_bf16 v24, v18, v136, v24
    v_dot2_f32_bf16 v25, v18, v18, v25
    v_dot2_f32_bf16 v24, v19, v136, v24
    v_dot2_f32_bf16 v25, v19, v19, v25
    v_dot2_f32_bf16 v26, v20, v136, v26
    v_dot2_f32_bf16 v27, v20, v20, v27
    v_dot2_f32_bf16 v26, v21, v136, v26
    v_dot2_f32_bf16 v27, v21, v21, v27
    v_dot2_f32_bf16 v26, v22, v136, v26
    v_dot2_f32_bf16 v27, v22, v22, v27
    v_dot2_f32_bf16 v26, v23, v136, v26
    v_dot2_f32_bf16 v27, v23, v23, v27
    s_nop 2
    v_permlane16_swap_b32 v24, v26
    v_permlane16_swap_b32 v25, v27
    s_nop 0
    v_add_f32 v24, v24, v26
    v_add_f32 v25, v25, v27
    v_mov_b32 v26, v24
    v_mov_b32 v27, v25
    s_nop 1
    v_permlane32_swap_b32 v24, v26
    v_permlane32_swap_b32 v25, v27
    s_nop 0
    v_add_f32 v24, v24, v26
    v_add_f32 v25, v25, v27
    buffer_store_dwordx2 v[24:25], v7, s[16:19], s34 offen sc1
    s_waitcnt vmcnt(13)
    v_readfirstlane_b32 s74, v244
    v_readfirstlane_b32 s75, v245
    s_mul_i32 s74, s74, 0x9e3779b1
    s_add_u32 s74, s74, 0x7f4a7c15
    s_mul_i32 s75, s75, 0x85ebca6d
    s_add_u32 s75, s75, 0x165667b1
    v_mov_b32 v244, s74
    v_mov_b32 v245, s75
    v_mov_b32 v246, s74
    v_mov_b32 v247, s75
    v_and_b32 v28, 31, v2
    v_lshrrev_b32 v6, 5, v2
    v_lshlrev_b32 v7, 2, v6
    s_add_u32 m0, s84, 4096
    v_sub_u32 v28, v28, v7
    v_and_b32 v29, 15, v2
    v_lshrrev_b32 v7, 4, v2
    v_lshlrev_b32 v7, 2, v7
    v_sub_u32 v30, v29, v7
    v_lshlrev_b32 v6, 4, v6
    v_sub_u32 v29, v29, v6
    s_add_u32 s60, s85, 4096
    v_and_b32 v7, 4, v7
    v_sub_u32 v29, v29, v7
    v_mov_b32 v6, 0x3f80
    v_subrev_u32 v32, 0, v28
    v_cmp_gt_u32 vcc, 2, v32
    v_lshlrev_b32 v32, 4, v32
    v_lshlrev_b32 v32, v32, v6
    buffer_load_dwordx4 v3, s[12:15], s60 offen offset:0 lds
    v_cndmask_b32 v32, 0, v32, vcc
    v_subrev_u32 v33, 2, v28
    v_cmp_gt_u32 vcc, 2, v33
    v_lshlrev_b32 v33, 4, v33
    v_lshlrev_b32 v33, v33, v6
    v_cndmask_b32 v33, 0, v33, vcc
    v_subrev_u32 v34, 16, v28
    buffer_load_dwordx4 v3, s[12:15], s60 offen offset:1024 lds
    v_cmp_gt_u32 vcc, 2, v34
    v_lshlrev_b32 v34, 4, v34
    v_lshlrev_b32 v34, v34, v6
    v_cndmask_b32 v34, 0, v34, vcc
    v_subrev_u32 v35, 18, v28
    v_cmp_gt_u32 vcc, 2, v35
    v_lshlrev_b32 v35, 4, v35
    buffer_load_dwordx4 v3, s[12:15], s60 offen offset:2048 lds
    v_lshlrev_b32 v35, v35, v6
    v_cndmask_b32 v35, 0, v35, vcc
    v_accvgpr_write_b32 a244, v32
    v_accvgpr_write_b32 a245, v33
    v_accvgpr_write_b32 a246, v34
    v_accvgpr_write_b32 a247, v35
    v_subrev_u32 v32, 8, v28
    buffer_load_dwordx4 v3, s[12:15], s60 offen offset:3072 lds
    v_cmp_gt_u32 vcc, 2, v32
    v_lshlrev_b32 v32, 4, v32
    v_lshlrev_b32 v32, v32, v6
    v_cndmask_b32 v32, 0, v32, vcc
    v_subrev_u32 v33, 10, v28
    v_cmp_gt_u32 vcc, 2, v33
    v_lshlrev_b32 v33, 4, v33
    s_add_u32 m0, s30, 0
    v_lshlrev_b32 v33, v33, v6
    v_cndmask_b32 v33, 0, v33, vcc
    v_subrev_u32 v34, 24, v28
    v_cmp_gt_u32 vcc, 2, v34
    v_lshlrev_b32 v34, 4, v34
    v_lshlrev_b32 v34, v34, v6
    v_cndmask_b32 v34, 0, v34, vcc
    s_add_u32 s60, s29, 0
    v_subrev_u32 v35, 26, v28
    v_cmp_gt_u32 vcc, 2, v35
    v_lshlrev_b32 v35, 4, v35
    v_lshlrev_b32 v35, v35, v6
    v_cndmask_b32 v35, 0, v35, vcc
    v_accvgpr_write_b32 a248, v32
    v_accvgpr_write_b32 a249, v33
    buffer_load_dwordx4 v252, s[96:99], s60 offen offset:0 lds
    v_accvgpr_write_b32 a250, v34
    v_accvgpr_write_b32 a251, v35
    v_subrev_u32 v32, 0, v29
    v_cmp_gt_u32 vcc, 2, v32
    v_lshlrev_b32 v32, 4, v32
    v_lshlrev_b32 v32, v32, v6
    v_cndmask_b32 v32, 0, v32, vcc
    s_add_u32 s60, s29, 15360
    v_subrev_u32 v33, 2, v29
    v_cmp_gt_u32 vcc, 2, v33
    v_lshlrev_b32 v33, 4, v33
    v_lshlrev_b32 v33, v33, v6
    v_cndmask_b32 v33, 0, v33, vcc
    v_subrev_u32 v34, 8, v29
    v_cmp_gt_u32 vcc, 2, v34
    buffer_load_dwordx4 v252, s[96:99], s60 offen offset:1024 lds
    v_lshlrev_b32 v34, 4, v34
    v_lshlrev_b32 v34, v34, v6
    v_cndmask_b32 v34, 0, v34, vcc
    v_subrev_u32 v35, 10, v29
    v_cmp_gt_u32 vcc, 2, v35
    v_lshlrev_b32 v35, 4, v35
    v_lshlrev_b32 v35, v35, v6
    s_add_u32 s60, s29, 30720
    v_cndmask_b32 v35, 0, v35, vcc
    v_accvgpr_write_b32 a204, v32
    v_accvgpr_write_b32 a205, v33
    v_accvgpr_write_b32 a206, v34
    v_accvgpr_write_b32 a207, v35
    v_subrev_u32 v32, -16, v29
    buffer_load_dwordx4 v252, s[96:99], s60 offen offset:2048 lds
    v_cmp_gt_u32 vcc, 2, v32
    v_lshlrev_b32 v32, 4, v32
    v_lshlrev_b32 v32, v32, v6
    v_cndmask_b32 v32, 0, v32, vcc
    v_subrev_u32 v33, -14, v29
    v_cmp_gt_u32 vcc, 2, v33
    v_lshlrev_b32 v33, 4, v33
    s_add_u32 s60, s29, 46080
    v_lshlrev_b32 v33, v33, v6
    v_cndmask_b32 v33, 0, v33, vcc
    v_subrev_u32 v34, -8, v29
    v_cmp_gt_u32 vcc, 2, v34
    v_lshlrev_b32 v34, 4, v34
    v_lshlrev_b32 v34, v34, v6
    v_cndmask_b32 v34, 0, v34, vcc
    buffer_load_dwordx4 v252, s[96:99], s60 offen offset:3072 lds
    v_subrev_u32 v35, -6, v29
    v_cmp_gt_u32 vcc, 2, v35
    v_lshlrev_b32 v35, 4, v35
    v_lshlrev_b32 v35, v35, v6
    v_cndmask_b32 v35, 0, v35, vcc
    v_accvgpr_write_b32 a208, v32
    v_accvgpr_write_b32 a209, v33
    s_add_u32 m0, s30, 4096
    v_accvgpr_write_b32 a210, v34
    v_accvgpr_write_b32 a211, v35
    v_subrev_u32 v32, 0, v30
    v_cmp_gt_u32 vcc, 2, v32
    v_lshlrev_b32 v32, 4, v32
    v_lshlrev_b32 v32, v32, v6
    v_cndmask_b32 v32, 0, v32, vcc
    s_add_u32 s60, s29, 65536
    v_subrev_u32 v33, 2, v30
    v_cmp_gt_u32 vcc, 2, v33
    v_lshlrev_b32 v33, 4, v33
    v_lshlrev_b32 v33, v33, v6
    v_cndmask_b32 v33, 0, v33, vcc
    v_subrev_u32 v34, 16, v30
    v_cmp_gt_u32 vcc, 2, v34
    buffer_load_dwordx4 v252, s[96:99], s60 offen offset:0 lds
    v_lshlrev_b32 v34, 4, v34
    v_lshlrev_b32 v34, v34, v6
    v_cndmask_b32 v34, 0, v34, vcc
    v_subrev_u32 v35, 18, v30
    v_cmp_gt_u32 vcc, 2, v35
    v_lshlrev_b32 v35, 4, v35
    v_lshlrev_b32 v35, v35, v6
    s_add_u32 s60, s29, 80896
    v_cndmask_b32 v35, 0, v35, vcc
    v_accvgpr_write_b32 a212, v32
    v_accvgpr_write_b32 a213, v33
    v_accvgpr_write_b32 a214, v34
    v_accvgpr_write_b32 a215, v35
    v_subrev_u32 v32, -16, v30
    v_cmp_gt_u32 vcc, 2, v32
    buffer_load_dwordx4 v252, s[96:99], s60 offen offset:1024 lds
    v_lshlrev_b32 v32, 4, v32
    v_lshlrev_b32 v32, v32, v6
    v_cndmask_b32 v32, 0, v32, vcc
    v_subrev_u32 v33, -14, v30
    v_cmp_gt_u32 vcc, 2, v33
    v_lshlrev_b32 v33, 4, v33
    v_lshlrev_b32 v33, v33, v6
    s_add_u32 s60, s29, 96256
    v_cndmask_b32 v33, 0, v33, vcc
    v_subrev_u32 v34, 0, v30
    v_cmp_gt_u32 vcc, 2, v34
    v_lshlrev_b32 v34, 4, v34
    v_lshlrev_b32 v34, v34, v6
    v_cndmask_b32 v34, 0, v34, vcc
    v_subrev_u32 v35, 2, v30
    buffer_load_dwordx4 v252, s[96:99], s60 offen offset:2048 lds
    v_cmp_gt_u32 vcc, 2, v35
    v_lshlrev_b32 v35, 4, v35
    v_lshlrev_b32 v35, v35, v6
    v_cndmask_b32 v35, 0, v35, vcc
    v_accvgpr_write_b32 a216, v32
    v_accvgpr_write_b32 a217, v33
    v_accvgpr_write_b32 a218, v34
    s_add_u32 s60, s29, 111616
    v_accvgpr_write_b32 a219, v35
    v_mov_b32 v7, 0x3f803f80
    v_bfe_u32 v6, v2, 2, 1
    v_mul_lo_u32 v6, v6, v7
    v_sub_u32 v7, v7, v6
    s_nop 0
    v_accvgpr_write_b32 a252, v7
    buffer_load_dwordx4 v252, s[96:99], s60 offen offset:3072 lds
    v_accvgpr_write_b32 a253, v7
    v_accvgpr_write_b32 a254, v6
    v_accvgpr_write_b32 a255, v6
    s_and_b32 s32, s2, 7
    s_lshl_b32 s32, s32, 5
    s_lshr_b32 s33, s2, 3
    s_add_u32 s32, s32, s33
    s_lshl_b32 s34, s54, 4
    s_mov_b32 s65, 2146435072
    s_mov_b32 s36, s4
    s_mov_b32 s37, s5
    s_mov_b32 s38, 48496640
    s_mov_b32 s39, 0x20000
    v_bfe_u32 v28, v2, 2, 2
    v_lshlrev_b32 v28, 6, v28
    v_and_b32 v29, 3, v2
    v_lshl_add_u32 v28, v29, 3, v28
    v_add_u32 v28, s87, v28
    s_cmp_ge_u32 s32, 112
    s_cbranch_scc1 L_main_kernel_p2_1002
    s_mov_b32 s24, s48
    s_mov_b32 s25, s49
    s_mov_b32 s66, 7340032
    s_mov_b32 s62, 7168
    s_mul_i32 s33, s32, 9363
    s_lshr_b32 s33, s33, 16
    s_mul_i32 s35, s33, 7
    s_sub_u32 s35, s32, s35
    s_lshl_b32 s33, s33, 20
    s_lshl_b32 s35, s35, 11
    s_add_u32 s33, s33, s35
    s_mul_i32 s35, s54, 114688
    s_add_u32 s33, s33, s35
    s_add_u32 s33, s33, 31457280
    v_mul_u32_u24 v195, 14336, v2
    v_add_u32 v195, s33, v195
    s_lshl_b32 s65, s32, 9
    s_add_u32 s65, s65, 48300032
    v_lshrrev_b32 v29, 5, v2
    v_lshl_add_u32 v193, v29, 10, v28
    v_bfe_u32 v29, v2, 4, 1
    v_lshl_add_u32 v193, v29, 8, v193
    v_add_u32 v194, 512, v193
    s_branch L_main_kernel_pj_1003
L_main_kernel_p2_1002:
    s_mov_b32 s24, s50
    s_mov_b32 s25, s51
    s_cmp_ge_u32 s32, 224
    s_cselect_b32 s66, 0, 7340032
    s_cselect_b32 s38, 0, s38
    s_mov_b32 s62, 2048
    s_sub_u32 s35, s32, 112
    s_lshl_b32 s35, s35, 2
    s_add_u32 s35, s35, s54
    s_mul_i32 s32, s35, 4682
    s_lshr_b32 s32, s32, 16
    s_mul_i32 s34, s32, 14
    s_sub_u32 s34, s35, s34
    s_cmp_ge_u32 s34, 7
    s_cselect_b32 s33, 8, 0
    s_cselect_b32 s35, 7, 0
    s_sub_u32 s35, s34, s35
    s_lshl_b32 s35, s35, 3
    s_lshl_b32 s34, s34, 4
    v_add_u32 v29, s35, v2
    v_mul_u32_u24 v30, 37, v29
    v_lshrrev_b32 v30, 8, v30
    v_mul_u32_u24 v31, 7, v30
    v_sub_u32 v29, v29, v31
    s_lshr_b32 s35, s32, 2
    s_and_b32 s59, s35, 0
    v_subrev_u32 v30, s59, v30
    v_and_b32 v30, 7, v30
    s_and_b32 s59, s35, 7
    v_cmp_gt_u32 vcc, s59, v30
    v_add_u32 v31, 1, v30
    s_nop 0
    v_cndmask_b32 v31, v30, v31, vcc
    v_cmp_ne_u32 vcc, s59, v30
    s_nop 1
    v_cndmask_b32 v30, 0, v31, vcc
    v_mul_u32_u24 v31, 2, v30
    v_add_u32 v31, 5, v31
    v_mul_u32_u24 v32, 5, v30
    v_add_u32 v32, 14, v32
    v_cmp_gt_u32 vcc, 2, v29
    s_add_u32 s33, s33, s35
    s_lshl_b32 s33, s33, 20
    v_cndmask_b32 v31, v32, v31, vcc
    v_cmp_ne_u32 vcc, 0, v30
    s_and_b32 s35, s32, 3
    s_lshl_b32 s35, s35, 11
    v_cndmask_b32 v31, 0, v31, vcc
    v_add_u32 v31, v31, v29
    s_add_u32 s33, s33, s35
    s_add_u32 s33, s33, 31916032
    v_lshlrev_b32 v31, 13, v31
    v_add_u32 v195, s33, v31
    v_lshrrev_b32 v29, 4, v2
    v_lshl_add_u32 v193, v29, 8, v28
    v_add_u32 v194, 1024, v193
L_main_kernel_pj_1003:
    s_mov_b32 s26, s66
    s_mov_b32 s27, 0x20000
    v_lshrrev_b32 v192, 2, v2
    v_mul_lo_u32 v192, v192, s62
    v_and_b32 v29, 3, v2
    v_lshl_add_u32 v192, v29, 4, v192
    s_lshl_b32 s62, s62, 4
    s_mul_i32 s61, s34, s62
    s_lshl_b32 s32, s32, 6
    s_add_u32 s61, s61, s32
    s_lshl_b32 s67, s2, 3
    s_add_u32 s67, s67, 48238592
    s_mov_b32 s44, 0
    v_and_b32 v196, 15, v2
    v_lshlrev_b32 v196, 2, v196
    s_lshl_b32 s33, s54, 7
    s_add_u32 s33, s33, 0x4000
    v_add_u32 v196, s33, v196
    s_lshl_b32 s83, s55, 7
    s_lshl_b32 s32, s53, 3
    s_add_u32 s83, s83, s32
    s_add_u32 s33, s83, 786432
    s_waitcnt vmcnt(12)
    s_mov_b64 exec, 1
    buffer_store_dwordx2 v[244:245], off, s[16:19], s33
    s_mov_b64 exec, -1
    s_waitcnt vmcnt(8)
    s_add_u32 m0, s30, 8192
    ds_read_b64_tr_b16 a[128:129], v146 offset:0
    s_add_u32 s60, s29, 131072
    ds_read_b64_tr_b16 a[130:131], v146 offset:1024
    buffer_load_dwordx4 v252, s[96:99], s60 offen offset:0 lds
    ds_read_b64_tr_b16 a[132:133], v146 offset:16
    s_add_u32 s60, s29, 146432
    ds_read_b64_tr_b16 a[134:135], v146 offset:1040
    buffer_load_dwordx4 v252, s[96:99], s60 offen offset:1024 lds
    ds_read_b64_tr_b16 a[136:137], v146 offset:2048
    s_add_u32 s60, s29, 161792
    ds_read_b64_tr_b16 a[138:139], v146 offset:3072
    buffer_load_dwordx4 v252, s[96:99], s60 offen offset:2048 lds
    ds_read_b64_tr_b16 a[140:141], v146 offset:2064
    s_add_u32 s60, s29, 177152
    ds_read_b64_tr_b16 a[142:143], v146 offset:3088
    buffer_load_dwordx4 v252, s[96:99], s60 offen offset:3072 lds
    s_waitcnt lgkmcnt(4)
    ds_read_b64_tr_b16 a[144:145], v146 offset:4096
    s_add_u32 m0, s30, 12288
    ds_read_b64_tr_b16 a[146:147], v146 offset:5120
    s_add_u32 s60, s29, 196608
    ds_read_b64_tr_b16 a[148:149], v146 offset:4112
    buffer_load_dwordx4 v252, s[96:99], s60 offen offset:0 lds
    ds_read_b64_tr_b16 a[150:151], v146 offset:5136
    s_add_u32 s60, s29, 211968
    ds_read_b64_tr_b16 a[152:153], v146 offset:6144
    buffer_load_dwordx4 v252, s[96:99], s60 offen offset:1024 lds
    ds_read_b64_tr_b16 a[154:155], v146 offset:7168
    s_add_u32 s60, s29, 227328
    ds_read_b64_tr_b16 a[156:157], v146 offset:6160
    buffer_load_dwordx4 v252, s[96:99], s60 offen offset:2048 lds
    ds_read_b64_tr_b16 a[158:159], v146 offset:7184
    s_add_u32 s60, s29, 242688
    s_waitcnt lgkmcnt(4)
    buffer_load_dwordx4 v252, s[96:99], s60 offen offset:3072 lds
    s_waitcnt lgkmcnt(0)
    s_add_u32 m0, s84, 0
    s_add_u32 s60, s85, 8192
    buffer_load_dwordx4 v3, s[12:15], s60 offen offset:0 lds
    buffer_load_dwordx4 v3, s[12:15], s60 offen offset:1024 lds
    buffer_load_dwordx4 v3, s[12:15], s60 offen offset:2048 lds
    buffer_load_dwordx4 v3, s[12:15], s60 offen offset:3072 lds
    s_add_u32 m0, s84, 4096
    s_add_u32 s60, s85, 12288
    buffer_load_dwordx4 v3, s[12:15], s60 offen offset:0 lds
    buffer_load_dwordx4 v3, s[12:15], s60 offen offset:1024 lds
    buffer_load_dwordx4 v3, s[12:15], s60 offen offset:2048 lds
    buffer_load_dwordx4 v3, s[12:15], s60 offen offset:3072 lds
    s_add_u32 m0, s30, 16384
    s_add_u32 s60, s29, 262144
    buffer_load_dwordx4 v252, s[96:99], s60 offen offset:0 lds
    s_add_u32 s60, s29, 277504
    buffer_load_dwordx4 v252, s[96:99], s60 offen offset:1024 lds
    s_add_u32 s60, s29, 292864
    buffer_load_dwordx4 v252, s[96:99], s60 offen offset:2048 lds
    s_add_u32 s60, s29, 308224
    buffer_load_dwordx4 v252, s[96:99], s60 offen offset:3072 lds
    s_add_u32 m0, s30, 20480
    s_add_u32 s60, s29, 327680
    buffer_load_dwordx4 v252, s[96:99], s60 offen offset:0 lds
    s_add_u32 s60, s29, 343040
    buffer_load_dwordx4 v252, s[96:99], s60 offen offset:1024 lds
    s_add_u32 s60, s29, 358400
    buffer_load_dwordx4 v252, s[96:99], s60 offen offset:2048 lds
    s_add_u32 s60, s29, 373760
    buffer_load_dwordx4 v252, s[96:99], s60 offen offset:3072 lds
    s_mov_b32 s35, 786432
    buffer_load_dwordx2 v[240:241], v251, s[16:19], s35 offen sc1
    s_waitcnt vmcnt(17)
    ds_read_b64_tr_b16 v[204:205], v144 offset:0
    ds_read_b64_tr_b16 v[206:207], v144 offset:1024
    s_add_u32 m0, s30, 24576
    ds_read_b64_tr_b16 v[208:209], v145 offset:0
    ds_read_b64_tr_b16 v[210:211], v145 offset:1024
    ds_read_b64_tr_b16 v[212:213], v144 offset:2048
    ds_read_b64_tr_b16 v[214:215], v144 offset:3072
    ds_read_b64_tr_b16 v[216:217], v145 offset:2048
    s_add_u32 s60, s29, 393216
    ds_read_b64_tr_b16 v[218:219], v145 offset:3072
    s_waitcnt lgkmcnt(4)
    ds_read_b64_tr_b16 v[220:221], v144 offset:4096
    ds_read_b64_tr_b16 v[222:223], v144 offset:5120
    ds_read_b64_tr_b16 v[224:225], v145 offset:4096
    buffer_load_dwordx4 v252, s[96:99], s60 offen offset:0 lds
    ds_read_b64_tr_b16 v[226:227], v145 offset:5120
    ds_read_b64_tr_b16 v[228:229], v144 offset:6144
    ds_read_b64_tr_b16 v[230:231], v144 offset:7168
    ds_read_b64_tr_b16 v[232:233], v145 offset:6144
    ds_read_b64_tr_b16 v[234:235], v145 offset:7168
    s_add_u32 s60, s29, 408576
    s_waitcnt lgkmcnt(8)
    v_mfma_f32_32x32x16_bf16 v[24:39], v[136:139], v[204:207], 0
    v_mfma_f32_32x32x16_bf16 v[40:55], v[136:139], v[208:211], 0
    v_mfma_f32_32x32x16_bf16 v[24:39], v[136:139], v[212:215], v[24:39]
    v_mfma_f32_32x32x16_bf16 v[40:55], v[136:139], v[216:219], v[40:55]
    buffer_load_dwordx4 v252, s[96:99], s60 offen offset:1024 lds
    s_waitcnt lgkmcnt(4)
    ds_read_b64_tr_b16 v[204:205], v144 offset:8192
    ds_read_b64_tr_b16 v[206:207], v144 offset:9216
    ds_read_b64_tr_b16 v[208:209], v145 offset:8192
    ds_read_b64_tr_b16 v[210:211], v145 offset:9216
    s_add_u32 s60, s29, 423936
    ds_read_b64_tr_b16 v[212:213], v144 offset:10240
    ds_read_b64_tr_b16 v[214:215], v144 offset:11264
    ds_read_b64_tr_b16 v[216:217], v145 offset:10240
    ds_read_b64_tr_b16 v[218:219], v145 offset:11264
    s_waitcnt lgkmcnt(8)
    buffer_load_dwordx4 v252, s[96:99], s60 offen offset:2048 lds
    v_mfma_f32_32x32x16_bf16 v[24:39], v[136:139], v[220:223], v[24:39]
    v_mfma_f32_32x32x16_bf16 v[40:55], v[136:139], v[224:227], v[40:55]
    v_mfma_f32_32x32x16_bf16 v[24:39], v[136:139], v[228:231], v[24:39]
    v_mfma_f32_32x32x16_bf16 v[40:55], v[136:139], v[232:235], v[40:55]
    s_waitcnt lgkmcnt(4)
    s_add_u32 s60, s29, 439296
    ds_read_b64_tr_b16 v[220:221], v144 offset:12288
    ds_read_b64_tr_b16 v[222:223], v144 offset:13312
    ds_read_b64_tr_b16 v[224:225], v145 offset:12288
    ds_read_b64_tr_b16 v[226:227], v145 offset:13312
    ds_read_b64_tr_b16 v[228:229], v144 offset:14336
    buffer_load_dwordx4 v252, s[96:99], s60 offen offset:3072 lds
    ds_read_b64_tr_b16 v[230:231], v144 offset:15360
    ds_read_b64_tr_b16 v[232:233], v145 offset:14336
    ds_read_b64_tr_b16 v[234:235], v145 offset:15360
    s_waitcnt lgkmcnt(8)
    v_mfma_f32_32x32x16_bf16 v[24:39], v[136:139], v[204:207], v[24:39]
    v_mfma_f32_32x32x16_bf16 v[40:55], v[136:139], v[208:211], v[40:55]
    s_add_u32 m0, s30, 28672
    v_mfma_f32_32x32x16_bf16 v[24:39], v[136:139], v[212:215], v[24:39]
    v_mfma_f32_32x32x16_bf16 v[40:55], v[136:139], v[216:219], v[40:55]
    s_waitcnt lgkmcnt(0)
    v_mfma_f32_32x32x16_bf16 v[24:39], v[136:139], v[220:223], v[24:39]
    v_mfma_f32_32x32x16_bf16 v[40:55], v[136:139], v[224:227], v[40:55]
    s_add_u32 s60, s29, 458752
    v_mfma_f32_32x32x16_bf16 v[24:39], v[136:139], v[228:231], v[24:39]
    v_mfma_f32_32x32x16_bf16 v[40:55], v[136:139], v[232:235], v[40:55]
    s_waitcnt vmcnt(13)
    ds_read_b64_tr_b16 a[160:161], v146 offset:0
    ds_read_b64_tr_b16 a[162:163], v146 offset:1024
    buffer_load_dwordx4 v252, s[96:99], s60 offen offset:0 lds
    ds_read_b64_tr_b16 a[164:165], v146 offset:16
    ds_read_b64_tr_b16 a[166:167], v146 offset:1040
    ds_read_b64_tr_b16 a[168:169], v146 offset:2048
    ds_read_b64_tr_b16 a[170:171], v146 offset:3072
    ds_read_b64_tr_b16 a[172:173], v146 offset:2064
    s_add_u32 s60, s29, 474112
    ds_read_b64_tr_b16 a[174:175], v146 offset:3088
    s_waitcnt lgkmcnt(4)
    ds_read_b64_tr_b16 a[176:177], v146 offset:4096
    ds_read_b64_tr_b16 a[178:179], v146 offset:5120
    ds_read_b64_tr_b16 a[180:181], v146 offset:4112
    buffer_load_dwordx4 v252, s[96:99], s60 offen offset:1024 lds
    ds_read_b64_tr_b16 a[182:183], v146 offset:5136
    ds_read_b64_tr_b16 a[184:185], v146 offset:6144
    ds_read_b64_tr_b16 a[186:187], v146 offset:7168
    ds_read_b64_tr_b16 a[188:189], v146 offset:6160
    ds_read_b64_tr_b16 a[190:191], v146 offset:7184
    s_add_u32 s60, s29, 489472
    s_waitcnt lgkmcnt(4)
    s_waitcnt lgkmcnt(0)
    v_mfma_f32_16x16x32_bf16 v[120:123], a[128:131], v[136:139], 0
    v_mfma_f32_16x16x32_bf16 v[124:127], a[132:135], v[136:139], 0
    v_mfma_f32_16x16x32_bf16 v[120:123], a[136:139], v[136:139], v[120:123]
    buffer_load_dwordx4 v252, s[96:99], s60 offen offset:2048 lds
    v_mfma_f32_16x16x32_bf16 v[124:127], a[140:143], v[136:139], v[124:127]
    v_mfma_f32_16x16x32_bf16 v[120:123], a[144:147], v[136:139], v[120:123]
    v_mfma_f32_16x16x32_bf16 v[124:127], a[148:151], v[136:139], v[124:127]
    v_mfma_f32_16x16x32_bf16 v[120:123], a[152:155], v[136:139], v[120:123]
    v_mfma_f32_16x16x32_bf16 v[124:127], a[156:159], v[136:139], v[124:127]
    s_add_u32 s60, s29, 504832
    v_mfma_f32_16x16x32_bf16 v[120:123], a[160:163], v[136:139], v[120:123]
    v_mfma_f32_16x16x32_bf16 v[124:127], a[164:167], v[136:139], v[124:127]
    v_mfma_f32_16x16x32_bf16 v[120:123], a[168:171], v[136:139], v[120:123]
    v_mfma_f32_16x16x32_bf16 v[124:127], a[172:175], v[136:139], v[124:127]
    v_mfma_f32_16x16x32_bf16 v[120:123], a[176:179], v[136:139], v[120:123]
    buffer_load_dwordx4 v252, s[96:99], s60 offen offset:3072 lds
    v_mfma_f32_16x16x32_bf16 v[124:127], a[180:183], v[136:139], v[124:127]
    v_mfma_f32_16x16x32_bf16 v[120:123], a[184:187], v[136:139], v[120:123]
    v_mfma_f32_16x16x32_bf16 v[124:127], a[188:191], v[136:139], v[124:127]
    s_waitcnt vmcnt(8)
    v_cmp_ne_u64 vcc, s[74:75], v[240:241]
    s_cmp_lg_u64 vcc, 0
    s_cbranch_scc1 L_main_kernel_spin_1008
L_main_kernel_ok_1007:
    v_lshrrev_b32 v7, 5, v2
    v_lshlrev_b32 v7, 17, v7
    v_and_b32 v88, 31, v2
    v_lshl_add_u32 v7, v88, 3, v7
    s_lshl_b32 s33, s55, 8
    s_add_u32 s33, s33, 262144
    buffer_load_dwordx2 v[88:89], v7, s[16:19], s33 offen sc1
    s_add_u32 s33, s33, 16384
    buffer_load_dwordx2 v[90:91], v7, s[16:19], s33 offen sc1
    s_add_u32 s33, s33, 16384
    buffer_load_dwordx2 v[92:93], v7, s[16:19], s33 offen sc1
    s_add_u32 s33, s33, 16384
    buffer_load_dwordx2 v[94:95], v7, s[16:19], s33 offen sc1
    s_add_u32 s33, s33, 16384
    buffer_load_dwordx2 v[96:97], v7, s[16:19], s33 offen sc1
    s_add_u32 s33, s33, 16384
    buffer_load_dwordx2 v[98:99], v7, s[16:19], s33 offen sc1
    s_add_u32 s33, s33, 16384
    buffer_load_dwordx2 v[100:101], v7, s[16:19], s33 offen sc1
    s_add_u32 s33, s33, 16384
    buffer_load_dwordx2 v[102:103], v7, s[16:19], s33 offen sc1
    s_waitcnt vmcnt(8)
    s_lshl_b32 s28, s82, 16
    ds_read_b64_tr_b16 v[204:205], v144 offset:16384
    ds_read_b64_tr_b16 v[206:207], v144 offset:17408
    s_lshl_b32 s33, s54, 14
    ds_read_b64_tr_b16 v[208:209], v145 offset:16384
    ds_read_b64_tr_b16 v[210:211], v145 offset:17408
    s_add_u32 s28, s28, s33
    ds_read_b64_tr_b16 v[212:213], v144 offset:18432
    ds_read_b64_tr_b16 v[214:215], v144 offset:19456
    ds_read_b64_tr_b16 v[216:217], v145 offset:18432
    s_and_b32 s33, s53, 2
    ds_read_b64_tr_b16 v[218:219], v145 offset:19456
    s_waitcnt lgkmcnt(4)
    s_lshl_b32 s33, s33, 7
    ds_read_b64_tr_b16 v[220:221], v144 offset:20480
    ds_read_b64_tr_b16 v[222:223], v144 offset:21504
    s_add_u32 s28, s28, s33
    ds_read_b64_tr_b16 v[224:225], v145 offset:20480
    ds_read_b64_tr_b16 v[226:227], v145 offset:21504
    buffer_load_dwordx4 a[64:67], v243, s[20:23], s28 offen offset:0 sc1
    ds_read_b64_tr_b16 v[228:229], v144 offset:22528
    ds_read_b64_tr_b16 v[230:231], v144 offset:23552
    buffer_load_dwordx4 a[68:71], v243, s[20:23], s28 offen offset:2048 sc1
    ds_read_b64_tr_b16 v[232:233], v145 offset:22528
    ds_read_b64_tr_b16 v[234:235], v145 offset:23552
    s_add_u32 s28, s28, 4096
    s_waitcnt lgkmcnt(8)
    v_mfma_f32_32x32x16_bf16 v[24:39], v[136:139], v[204:207], v[24:39]
    buffer_load_dwordx4 a[72:75], v243, s[20:23], s28 offen offset:0 sc1
    v_mfma_f32_32x32x16_bf16 v[40:55], v[136:139], v[208:211], v[40:55]
    v_mfma_f32_32x32x16_bf16 v[24:39], v[136:139], v[212:215], v[24:39]
    v_mfma_f32_32x32x16_bf16 v[40:55], v[136:139], v[216:219], v[40:55]
    buffer_load_dwordx4 a[76:79], v243, s[20:23], s28 offen offset:2048 sc1
    s_waitcnt lgkmcnt(4)
    ds_read_b64_tr_b16 v[204:205], v144 offset:24576
    s_add_u32 s28, s28, 4096
    ds_read_b64_tr_b16 v[206:207], v144 offset:25600
    ds_read_b64_tr_b16 v[208:209], v145 offset:24576
    buffer_load_dwordx4 a[80:83], v243, s[20:23], s28 offen offset:0 sc1
    ds_read_b64_tr_b16 v[210:211], v145 offset:25600
    ds_read_b64_tr_b16 v[212:213], v144 offset:26624
    buffer_load_dwordx4 a[84:87], v243, s[20:23], s28 offen offset:2048 sc1
    ds_read_b64_tr_b16 v[214:215], v144 offset:27648
    ds_read_b64_tr_b16 v[216:217], v145 offset:26624
    s_add_u32 s28, s28, 4096
    ds_read_b64_tr_b16 v[218:219], v145 offset:27648
    s_waitcnt lgkmcnt(8)
    buffer_load_dwordx4 a[88:91], v243, s[20:23], s28 offen offset:0 sc1
    v_mfma_f32_32x32x16_bf16 v[24:39], v[136:139], v[220:223], v[24:39]
    v_mfma_f32_32x32x16_bf16 v[40:55], v[136:139], v[224:227], v[40:55]
    v_mfma_f32_32x32x16_bf16 v[24:39], v[136:139], v[228:231], v[24:39]
    buffer_load_dwordx4 a[92:95], v243, s[20:23], s28 offen offset:2048 sc1
    v_mfma_f32_32x32x16_bf16 v[40:55], v[136:139], v[232:235], v[40:55]
    s_waitcnt lgkmcnt(4)
    s_add_u32 s28, s28, 4096
    ds_read_b64_tr_b16 v[220:221], v144 offset:28672
    ds_read_b64_tr_b16 v[222:223], v144 offset:29696
    s_lshl_b32 s28, s55, 16
    ds_read_b64_tr_b16 v[224:225], v145 offset:28672
    ds_read_b64_tr_b16 v[226:227], v145 offset:29696
    buffer_load_dwordx4 a[0:3], v3, s[20:23], s28 offen offset:0 sc1
    ds_read_b64_tr_b16 v[228:229], v144 offset:30720
    ds_read_b64_tr_b16 v[230:231], v144 offset:31744
    buffer_load_dwordx4 a[4:7], v3, s[20:23], s28 offen offset:1024 sc1
    ds_read_b64_tr_b16 v[232:233], v145 offset:30720
    ds_read_b64_tr_b16 v[234:235], v145 offset:31744
    buffer_load_dwordx4 a[8:11], v3, s[20:23], s28 offen offset:2048 sc1
    s_waitcnt lgkmcnt(8)
    v_mfma_f32_32x32x16_bf16 v[24:39], v[136:139], v[204:207], v[24:39]
    buffer_load_dwordx4 a[12:15], v3, s[20:23], s28 offen offset:3072 sc1
    v_mfma_f32_32x32x16_bf16 v[40:55], v[136:139], v[208:211], v[40:55]
    v_mfma_f32_32x32x16_bf16 v[24:39], v[136:139], v[212:215], v[24:39]
    v_mfma_f32_32x32x16_bf16 v[40:55], v[136:139], v[216:219], v[40:55]
    s_add_u32 s28, s28, 4096
    s_waitcnt lgkmcnt(0)
    v_mfma_f32_32x32x16_bf16 v[24:39], v[136:139], v[220:223], v[24:39]
    buffer_load_dwordx4 a[16:19], v3, s[20:23], s28 offen offset:0 sc1
    v_mfma_f32_32x32x16_bf16 v[40:55], v[136:139], v[224:227], v[40:55]
    v_mfma_f32_32x32x16_bf16 v[24:39], v[136:139], v[228:231], v[24:39]
    buffer_load_dwordx4 a[20:23], v3, s[20:23], s28 offen offset:1024 sc1
    v_mfma_f32_32x32x16_bf16 v[40:55], v[136:139], v[232:235], v[40:55]
    s_mov_b64 exec, 1
    s_add_u32 s59, s83, 839680
    buffer_store_dwordx2 v[244:245], off, s[16:19], s59 sc1
    s_mov_b64 exec, -1
    v_and_b32 v5, 31, v2
    v_lshlrev_b32 v5, 2, v5
    v_add_u32 v6, s84, v5
    v_add_u32 v5, 0x18000, v5
    v_cmp_gt_u32 s[88:89], 32, v2
    v_add_u32 v149, s84, v3
    s_nop 6
    ds_write_b32 v6, v24 offset:6144
    ds_write_b32 v6, v40 offset:6272
    ds_write_b128 v149, v[120:123] offset:4096
    ds_write_b128 v149, v[124:127] offset:5120
    s_waitcnt lgkmcnt(0)
    s_barrier
    ds_read_b32 v8, v5 offset:6144
    ds_read_b32 v9, v5 offset:14336
    ds_read_b32 v10, v5 offset:22528
    ds_read_b32 v11, v5 offset:30720
    ds_read_b32 v12, v5 offset:6272
    ds_read_b32 v13, v5 offset:14464
    ds_read_b32 v14, v5 offset:22656
    ds_read_b32 v15, v5 offset:30848
    s_waitcnt lgkmcnt(4)
    ds_read_b128 v[108:111], v4 offset:36864
    ds_read_b128 v[112:115], v4 offset:37888
    ds_read_b128 v[116:119], v4 offset:45056
    ds_read_b128 v[120:123], v4 offset:46080
    ds_read_b128 v[124:127], v4 offset:53248
    ds_read_b128 v[128:131], v4 offset:54272
    ds_read_b128 v[132:135], v4 offset:61440
    ds_read_b128 v[136:139], v4 offset:62464
    s_waitcnt lgkmcnt(8)
    v_add_f32 v8, v8, v9
    v_add_f32 v8, v8, v10
    v_add_f32 v8, v8, v11
    v_cndmask_b32 v8, 0, v8, s[88:89]
    v_and_b32 v9, 0xffff0000, v8
    v_sub_f32 v9, v8, v9
    v_and_b32 v10, 0xffff0000, v9
    v_sub_f32 v10, v9, v10
    v_perm_b32 v20, v9, v8, s58
    v_perm_b32 v21, v9, v8, s58
    v_perm_b32 v22, v8, v10, s58
    v_mov_b32 v23, 0
    v_add_f32 v12, v12, v13
    v_add_f32 v12, v12, v14
    v_add_f32 v12, v12, v15
    v_cndmask_b32 v12, 0, v12, s[88:89]
    v_and_b32 v13, 0xffff0000, v12
    v_sub_f32 v13, v12, v13
    v_and_b32 v14, 0xffff0000, v13
    v_sub_f32 v14, v13, v14
    v_perm_b32 v24, v13, v12, s58
    v_perm_b32 v25, v13, v12, s58
    v_perm_b32 v26, v12, v14, s58
    v_mov_b32 v27, 0
    v_accvgpr_write_b32 a192, v20
    v_accvgpr_write_b32 a193, v21
    v_accvgpr_write_b32 a194, v22
    v_accvgpr_write_b32 a195, v23
    v_accvgpr_write_b32 a196, v24
    v_accvgpr_write_b32 a197, v25
    v_accvgpr_write_b32 a198, v26
    v_accvgpr_write_b32 a199, v27
    s_waitcnt lgkmcnt(0)
    v_pk_add_f32 v[108:109], v[108:109], v[116:117]
    v_pk_add_f32 v[110:111], v[110:111], v[118:119]
    v_pk_add_f32 v[112:113], v[112:113], v[120:121]
    v_pk_add_f32 v[114:115], v[114:115], v[122:123]
    v_pk_add_f32 v[108:109], v[108:109], v[124:125]
    v_pk_add_f32 v[110:111], v[110:111], v[126:127]
    v_pk_add_f32 v[112:113], v[112:113], v[128:129]
    v_pk_add_f32 v[114:115], v[114:115], v[130:131]
    v_pk_add_f32 v[108:109], v[108:109], v[132:133]
    v_pk_add_f32 v[110:111], v[110:111], v[134:135]
    v_pk_add_f32 v[112:113], v[112:113], v[136:137]
    v_pk_add_f32 v[114:115], v[114:115], v[138:139]
    v_accvgpr_write_b32 a200, v108
    v_accvgpr_write_b32 a201, v109
    v_accvgpr_write_b32 a202, v110
    v_accvgpr_write_b32 a203, v111
    v_accvgpr_write_b32 a220, v112
    v_accvgpr_write_b32 a221, v113
    v_accvgpr_write_b32 a222, v114
    v_accvgpr_write_b32 a223, v115
    s_branch L_main_kernel_kvm_1006
L_main_kernel_layer_1005:
    v_lshrrev_b32 v7, 5, v2
    v_lshlrev_b32 v7, 17, v7
    v_and_b32 v88, 31, v2
    v_lshl_add_u32 v7, v88, 3, v7
    s_lshl_b32 s33, s55, 8
    s_add_u32 s33, s33, 262144
    buffer_load_dwordx2 v[88:89], v7, s[16:19], s33 offen sc1
    s_add_u32 s33, s33, 16384
    buffer_load_dwordx2 v[90:91], v7, s[16:19], s33 offen sc1
    s_add_u32 s33, s33, 16384
    buffer_load_dwordx2 v[92:93], v7, s[16:19], s33 offen sc1
    s_add_u32 s33, s33, 16384
    buffer_load_dwordx2 v[94:95], v7, s[16:19], s33 offen sc1
    s_add_u32 s33, s33, 16384
    buffer_load_dwordx2 v[96:97], v7, s[16:19], s33 offen sc1
    s_add_u32 s33, s33, 16384
    buffer_load_dwordx2 v[98:99], v7, s[16:19], s33 offen sc1
    s_add_u32 s33, s33, 16384
    buffer_load_dwordx2 v[100:101], v7, s[16:19], s33 offen sc1
    s_add_u32 s33, s33, 16384
    buffer_load_dwordx2 v[102:103], v7, s[16:19], s33 offen sc1
    s_lshl_b32 s28, s82, 16
    s_lshl_b32 s33, s54, 14
    s_add_u32 s28, s28, s33
    s_and_b32 s33, s53, 2
    s_lshl_b32 s33, s33, 7
    s_add_u32 s28, s28, s33
    buffer_load_dwordx4 a[64:67], v243, s[20:23], s28 offen offset:0 sc1
    buffer_load_dwordx4 a[68:71], v243, s[20:23], s28 offen offset:2048 sc1
    s_add_u32 s28, s28, 4096
    buffer_load_dwordx4 a[72:75], v243, s[20:23], s28 offen offset:0 sc1
    buffer_load_dwordx4 a[76:79], v243, s[20:23], s28 offen offset:2048 sc1
    s_add_u32 s28, s28, 4096
    buffer_load_dwordx4 a[80:83], v243, s[20:23], s28 offen offset:0 sc1
    buffer_load_dwordx4 a[84:87], v243, s[20:23], s28 offen offset:2048 sc1
    s_add_u32 s28, s28, 4096
    buffer_load_dwordx4 a[88:91], v243, s[20:23], s28 offen offset:0 sc1
    buffer_load_dwordx4 a[92:95], v243, s[20:23], s28 offen offset:2048 sc1
    s_add_u32 s28, s28, 4096
    s_lshl_b32 s28, s55, 16
    buffer_load_dwordx4 a[0:3], v3, s[20:23], s28 offen offset:0 sc1
    buffer_load_dwordx4 a[4:7], v3, s[20:23], s28 offen offset:1024 sc1
    buffer_load_dwordx4 a[8:11], v3, s[20:23], s28 offen offset:2048 sc1
    buffer_load_dwordx4 a[12:15], v3, s[20:23], s28 offen offset:3072 sc1
    s_add_u32 s28, s28, 4096
    buffer_load_dwordx4 a[16:19], v3, s[20:23], s28 offen offset:0 sc1
    buffer_load_dwordx4 a[20:23], v3, s[20:23], s28 offen offset:1024 sc1
    s_mov_b64 exec, 1
    s_add_u32 s59, s83, 839680
    buffer_store_dwordx4 v[244:247], off, s[16:19], s59 sc1
    s_mov_b64 exec, -1
    s_barrier
L_main_kernel_kvm_1006:
    v_lshrrev_b32 v172, 5, v2
    v_bfe_u32 v7, v2, 2, 2
    v_lshl_add_u32 v172, v172, 2, v7
    v_lshlrev_b32 v172, 7, v172
    v_bfe_u32 v7, v2, 3, 1
    v_lshl_add_u32 v172, v7, 6, v172
    v_bfe_u32 v7, v2, 4, 1
    v_lshl_add_u32 v172, v7, 5, v172
    v_and_b32 v7, 3, v2
    v_lshl_add_u32 v172, v7, 3, v172
    v_xor_b32 v173, 64, v172
    v_add_u32 v174, 0x10000, v172
    v_add_u32 v175, 0x10000, v173
    v_add_u32 v176, 0x20000, v172
    v_add_u32 v177, 0x20000, v173
    v_add_u32 v7, s84, v3
    s_waitcnt vmcnt(15)
    v_add_f32 v88, v88, v90
    v_add_f32 v89, v89, v91
    buffer_load_dwordx4 a[24:27], v3, s[20:23], s28 offen offset:2048 sc1
    v_add_f32 v88, v88, v92
    v_add_f32 v89, v89, v93
    v_add_f32 v88, v88, v94
    v_add_f32 v89, v89, v95
    v_add_f32 v88, v88, v96
    buffer_load_dwordx4 a[28:31], v3, s[20:23], s28 offen offset:3072 sc1
    v_add_f32 v89, v89, v97
    v_add_f32 v88, v88, v98
    v_add_f32 v89, v89, v99
    v_add_f32 v88, v88, v100
    s_add_u32 s28, s28, 4096
    v_add_f32 v89, v89, v101
    v_add_f32 v88, v88, v102
    v_add_f32 v89, v89, v103
    v_mov_b32 v90, v88
    buffer_load_dwordx4 a[32:35], v3, s[20:23], s28 offen offset:0 sc1
    v_mov_b32 v91, v89
    s_nop 1
    v_permlane32_swap_b32 v88, v90
    v_permlane32_swap_b32 v89, v91
    s_nop 0
    buffer_load_dwordx4 a[36:39], v3, s[20:23], s28 offen offset:1024 sc1
    v_add_f32 v88, v88, v90
    v_add_f32 v89, v89, v91
    v_mul_f32 v5, 0xba800000, v88
    v_mul_f32 v89, 0x3a800000, v89
    buffer_load_dwordx4 a[40:43], v3, s[20:23], s28 offen offset:2048 sc1
    v_fma_f32 v89, -v5, v5, v89
    v_max_f32 v89, 0, v89
    v_add_f32 v89, 0x3727c5ac, v89
    v_rsq_f32 v6, v89
    s_nop 0
    buffer_load_dwordx4 a[44:47], v3, s[20:23], s28 offen offset:3072 sc1
    v_and_b32 v88, 0xffff0000, v5
    v_sub_f32 v88, v5, v88
    v_and_b32 v89, 0xffff0000, v88
    v_sub_f32 v89, v88, v89
    s_add_u32 s28, s28, 4096
    v_perm_b32 v104, v5, v5, s58
    v_perm_b32 v105, v88, v88, s58
    v_perm_b32 v106, v89, v5, s58
    v_mov_b32 v107, 0
    buffer_load_dwordx4 a[48:51], v3, s[20:23], s28 offen offset:0 sc1
    s_waitcnt vmcnt(20)
    v_mfma_f32_16x16x32_bf16 v[40:43], a[128:131], a[64:67], 0
    v_mfma_f32_16x16x32_bf16 v[44:47], a[132:135], a[64:67], 0
    v_mfma_f32_16x16x32_bf16 v[40:43], a[136:139], a[68:71], v[40:43]
    v_mfma_f32_16x16x32_bf16 v[44:47], a[140:143], a[68:71], v[44:47]
    buffer_load_dwordx4 a[52:55], v3, s[20:23], s28 offen offset:1024 sc1
    s_waitcnt vmcnt(19)
    v_mfma_f32_16x16x32_bf16 v[40:43], a[144:147], a[72:75], v[40:43]
    v_mfma_f32_16x16x32_bf16 v[44:47], a[148:151], a[72:75], v[44:47]
    v_mfma_f32_16x16x32_bf16 v[40:43], a[152:155], a[76:79], v[40:43]
    buffer_load_dwordx4 a[56:59], v3, s[20:23], s28 offen offset:2048 sc1
    v_mfma_f32_16x16x32_bf16 v[44:47], a[156:159], a[76:79], v[44:47]
    s_waitcnt vmcnt(18)
    v_mfma_f32_16x16x32_bf16 v[40:43], a[160:163], a[80:83], v[40:43]
    v_mfma_f32_16x16x32_bf16 v[44:47], a[164:167], a[80:83], v[44:47]
    buffer_load_dwordx4 a[60:63], v3, s[20:23], s28 offen offset:3072 sc1
    v_mfma_f32_16x16x32_bf16 v[40:43], a[168:171], a[84:87], v[40:43]
    v_mfma_f32_16x16x32_bf16 v[44:47], a[172:175], a[84:87], v[44:47]
    s_waitcnt vmcnt(17)
    v_mfma_f32_16x16x32_bf16 v[40:43], a[176:179], a[88:91], v[40:43]
    v_mfma_f32_16x16x32_bf16 v[44:47], a[180:183], a[88:91], v[44:47]
    s_add_u32 s28, s28, 4096
    v_mfma_f32_16x16x32_bf16 v[40:43], a[184:187], a[92:95], v[40:43]
    v_mfma_f32_16x16x32_bf16 v[44:47], a[188:191], a[92:95], v[44:47]
    s_nop 7
    ds_write_b128 v7, v[40:43] offset:0
    ds_write_b128 v7, v[44:47] offset:1024
    s_waitcnt lgkmcnt(0)
    s_barrier
    s_cmp_lg_u32 s82, s55
    s_cbranch_scc1 L_main_kernel_qgo_1004
    v_add_u32 v7, 0x18000, v3
    ds_read_b128 v[108:111], v7 offset:0
    ds_read_b128 v[112:115], v7 offset:1024
    ds_read_b128 v[116:119], v7 offset:8192
    ds_read_b128 v[120:123], v7 offset:9216
    ds_read_b128 v[124:127], v7 offset:16384
    ds_read_b128 v[128:131], v7 offset:17408
    ds_read_b128 v[132:135], v7 offset:24576
    ds_read_b128 v[136:139], v7 offset:25600
    v_mov_b32 v140, v5
    v_mov_b32 v141, v5
    v_mov_b32 v142, v6
    v_mov_b32 v143, v6
    s_bitcmp1_b32 s53, 1
    s_cselect_b64 s[34:35], -1, 0
    v_permlane16_swap_b32 v140, v141
    v_permlane16_swap_b32 v142, v143
    s_cselect_b32 s32, 1, 0
    v_accvgpr_read_b32 v40, a200
    v_accvgpr_read_b32 v41, a201
    v_accvgpr_read_b32 v42, a202
    v_accvgpr_read_b32 v43, a203
    v_accvgpr_read_b32 v44, a220
    v_accvgpr_read_b32 v45, a221
    v_accvgpr_read_b32 v46, a222
    v_accvgpr_read_b32 v47, a223
    v_cndmask_b32 v140, v140, v141, s[34:35]
    v_cndmask_b32 v142, v142, v143, s[34:35]
    s_lshl_b32 s35, s55, 12
    s_waitcnt lgkmcnt(0)
    v_fma_f32 v40, v40, v140, v108
    v_fma_f32 v41, v41, v140, v109
    v_fma_f32 v42, v42, v140, v110
    v_fma_f32 v43, v43, v140, v111
    v_fma_f32 v44, v44, v140, v112
    v_fma_f32 v45, v45, v140, v113
    v_fma_f32 v46, v46, v140, v114
    v_fma_f32 v47, v47, v140, v115
    v_pk_add_f32 v[40:41], v[40:41], v[116:117]
    v_pk_add_f32 v[42:43], v[42:43], v[118:119]
    v_pk_add_f32 v[44:45], v[44:45], v[120:121]
    v_pk_add_f32 v[46:47], v[46:47], v[122:123]
    v_pk_add_f32 v[40:41], v[40:41], v[124:125]
    v_pk_add_f32 v[42:43], v[42:43], v[126:127]
    v_pk_add_f32 v[44:45], v[44:45], v[128:129]
    v_pk_add_f32 v[46:47], v[46:47], v[130:131]
    v_pk_add_f32 v[40:41], v[40:41], v[132:133]
    v_pk_add_f32 v[42:43], v[42:43], v[134:135]
    v_pk_add_f32 v[44:45], v[44:45], v[136:137]
    v_pk_add_f32 v[46:47], v[46:47], v[138:139]
    v_mul_f32 v40, v40, v142
    v_mul_f32 v41, v41, v142
    v_mul_f32 v42, v42, v142
    v_mul_f32 v43, v43, v142
    v_mul_f32 v44, v44, v142
    v_mul_f32 v45, v45, v142
    v_mul_f32 v46, v46, v142
    v_mul_f32 v47, v47, v142
    v_cvt_pk_bf16_f32 v108, v40, v41
    v_cvt_pk_bf16_f32 v109, v42, v43
    v_cvt_pk_bf16_f32 v110, v44, v45
    v_cvt_pk_bf16_f32 v111, v46, v47
    s_bitcmp1_b32 s53, 0
    s_cbranch_scc1 L_main_kernel_kvV_1011
    s_lshl_b32 s32, s32, 8
    s_add_u32 s35, s35, s32
    buffer_store_dwordx4 v[108:111], v243, s[16:19], s35 offen sc1
    s_branch L_main_kernel_qgo_1004
L_main_kernel_kvV_1011:
    v_and_b32 v7, 15, v2
    v_lshlrev_b32 v7, 6, v7
    v_lshrrev_b32 v140, 5, v2
    v_lshl_add_u32 v7, v140, 5, v7
    v_bfe_u32 v141, v2, 4, 1
    v_lshl_add_u32 v7, v141, 3, v7
    v_add_u32 v7, 0x18800, v7
    ds_write2_b64 v7, v[108:109], v[110:111] offset0:0 offset1:2
    v_lshlrev_b32 v140, 9, v140
    v_lshl_add_u32 v140, v141, 5, v140
    v_bfe_u32 v141, v2, 2, 2
    v_lshl_add_u32 v140, v141, 6, v140
    v_and_b32 v141, 3, v2
    v_lshl_add_u32 v140, v141, 3, v140
    v_add_u32 v140, 0x18800, v140
    s_lshl_b32 s32, s32, 10
    s_add_u32 s35, s35, s32
    s_waitcnt lgkmcnt(0)
    ds_read_b64_tr_b16 v[112:113], v140
    ds_read_b64_tr_b16 v[114:115], v140 offset:256
    s_waitcnt lgkmcnt(0)
    buffer_store_dwordx4 v[112:115], v3, s[16:19], s35 offen offset:2048 sc1
L_main_kernel_qgo_1004:
    ds_read_b64_tr_b16 v[56:57], v176 offset:0
    ds_read_b64_tr_b16 v[58:59], v176 offset:2048
    ds_read_b64_tr_b16 v[60:61], v177 offset:0
    ds_read_b64_tr_b16 v[62:63], v177 offset:2048
    ds_read_b64_tr_b16 v[64:65], v176 offset:1024
    ds_read_b64_tr_b16 v[66:67], v176 offset:3072
    ds_read_b64_tr_b16 v[68:69], v177 offset:1024
    ds_read_b64_tr_b16 v[70:71], v177 offset:3072
    ds_read_b64_tr_b16 v[72:73], v176 offset:4096
    ds_read_b64_tr_b16 v[74:75], v176 offset:6144
    ds_read_b64_tr_b16 v[76:77], v177 offset:4096
    ds_read_b64_tr_b16 v[78:79], v177 offset:6144
    ds_read_b64_tr_b16 v[80:81], v176 offset:5120
    ds_read_b64_tr_b16 v[82:83], v176 offset:7168
    s_waitcnt vmcnt(15)
    s_waitcnt lgkmcnt(12)
    v_mfma_f32_32x32x16_bf16 v[8:23], v[56:59], a[0:3], 0
    ds_read_b64_tr_b16 v[84:85], v177 offset:5120
    ds_read_b64_tr_b16 v[86:87], v177 offset:7168
    s_waitcnt lgkmcnt(12)
    v_mfma_f32_32x32x16_bf16 v[24:39], v[60:63], a[0:3], 0
    ds_read_b64_tr_b16 v[56:57], v176 offset:8192
    ds_read_b64_tr_b16 v[58:59], v176 offset:10240
    buffer_load_dwordx4 a[0:3], v3, s[20:23], s28 offen offset:0 sc1
    s_waitcnt vmcnt(15)
    s_waitcnt lgkmcnt(12)
    v_mfma_f32_32x32x16_bf16 v[8:23], v[64:67], a[4:7], v[8:23]
    ds_read_b64_tr_b16 v[60:61], v177 offset:8192
    ds_read_b64_tr_b16 v[62:63], v177 offset:10240
    s_waitcnt lgkmcnt(12)
    v_mfma_f32_32x32x16_bf16 v[24:39], v[68:71], a[4:7], v[24:39]
    ds_read_b64_tr_b16 v[64:65], v176 offset:9216
    ds_read_b64_tr_b16 v[66:67], v176 offset:11264
    buffer_load_dwordx4 a[4:7], v3, s[20:23], s28 offen offset:1024 sc1
    s_waitcnt vmcnt(15)
    s_waitcnt lgkmcnt(12)
    v_mfma_f32_32x32x16_bf16 v[8:23], v[72:75], a[8:11], v[8:23]
    ds_read_b64_tr_b16 v[68:69], v177 offset:9216
    ds_read_b64_tr_b16 v[70:71], v177 offset:11264
    s_waitcnt lgkmcnt(12)
    v_mfma_f32_32x32x16_bf16 v[24:39], v[76:79], a[8:11], v[24:39]
    ds_read_b64_tr_b16 v[72:73], v176 offset:12288
    ds_read_b64_tr_b16 v[74:75], v176 offset:14336
    buffer_load_dwordx4 a[8:11], v3, s[20:23], s28 offen offset:2048 sc1
    s_waitcnt vmcnt(15)
    s_waitcnt lgkmcnt(12)
    v_mfma_f32_32x32x16_bf16 v[8:23], v[80:83], a[12:15], v[8:23]
    ds_read_b64_tr_b16 v[76:77], v177 offset:12288
    ds_read_b64_tr_b16 v[78:79], v177 offset:14336
    s_waitcnt lgkmcnt(12)
    v_mfma_f32_32x32x16_bf16 v[24:39], v[84:87], a[12:15], v[24:39]
    ds_read_b64_tr_b16 v[80:81], v176 offset:13312
    ds_read_b64_tr_b16 v[82:83], v176 offset:15360
    buffer_load_dwordx4 a[12:15], v3, s[20:23], s28 offen offset:3072 sc1
    s_add_u32 s28, s28, 4096
    s_waitcnt vmcnt(15)
    s_waitcnt lgkmcnt(12)
    v_mfma_f32_32x32x16_bf16 v[8:23], v[56:59], a[16:19], v[8:23]
    ds_read_b64_tr_b16 v[84:85], v177 offset:13312
    ds_read_b64_tr_b16 v[86:87], v177 offset:15360
    s_waitcnt lgkmcnt(12)
    v_mfma_f32_32x32x16_bf16 v[24:39], v[60:63], a[16:19], v[24:39]
    ds_read_b64_tr_b16 v[56:57], v176 offset:16384
    ds_read_b64_tr_b16 v[58:59], v176 offset:18432
    buffer_load_dwordx4 a[16:19], v3, s[20:23], s28 offen offset:0 sc1
    s_waitcnt vmcnt(15)
    s_waitcnt lgkmcnt(12)
    v_mfma_f32_32x32x16_bf16 v[8:23], v[64:67], a[20:23], v[8:23]
    ds_read_b64_tr_b16 v[60:61], v177 offset:16384
    ds_read_b64_tr_b16 v[62:63], v177 offset:18432
    s_waitcnt lgkmcnt(12)
    v_mfma_f32_32x32x16_bf16 v[24:39], v[68:71], a[20:23], v[24:39]
    ds_read_b64_tr_b16 v[64:65], v176 offset:17408
    ds_read_b64_tr_b16 v[66:67], v176 offset:19456
    buffer_load_dwordx4 a[20:23], v3, s[20:23], s28 offen offset:1024 sc1
    s_waitcnt vmcnt(15)
    s_waitcnt lgkmcnt(12)
    v_mfma_f32_32x32x16_bf16 v[8:23], v[72:75], a[24:27], v[8:23]
    ds_read_b64_tr_b16 v[68:69], v177 offset:17408
    ds_read_b64_tr_b16 v[70:71], v177 offset:19456
    s_waitcnt lgkmcnt(12)
    v_mfma_f32_32x32x16_bf16 v[24:39], v[76:79], a[24:27], v[24:39]
    ds_read_b64_tr_b16 v[72:73], v176 offset:20480
    ds_read_b64_tr_b16 v[74:75], v176 offset:22528
    buffer_load_dwordx4 a[24:27], v3, s[20:23], s28 offen offset:2048 sc1
    s_waitcnt vmcnt(15)
    s_waitcnt lgkmcnt(12)
    v_mfma_f32_32x32x16_bf16 v[8:23], v[80:83], a[28:31], v[8:23]
    ds_read_b64_tr_b16 v[76:77], v177 offset:20480
    ds_read_b64_tr_b16 v[78:79], v177 offset:22528
    s_waitcnt lgkmcnt(12)
    v_mfma_f32_32x32x16_bf16 v[24:39], v[84:87], a[28:31], v[24:39]
    ds_read_b64_tr_b16 v[80:81], v176 offset:21504
    ds_read_b64_tr_b16 v[82:83], v176 offset:23552
    buffer_load_dwordx4 a[28:31], v3, s[20:23], s28 offen offset:3072 sc1
    s_add_u32 s28, s28, 4096
    s_waitcnt vmcnt(15)
    s_waitcnt lgkmcnt(12)
    v_mfma_f32_32x32x16_bf16 v[8:23], v[56:59], a[32:35], v[8:23]
    ds_read_b64_tr_b16 v[84:85], v177 offset:21504
    ds_read_b64_tr_b16 v[86:87], v177 offset:23552
    s_waitcnt lgkmcnt(12)
    v_mfma_f32_32x32x16_bf16 v[24:39], v[60:63], a[32:35], v[24:39]
    ds_read_b64_tr_b16 v[56:57], v176 offset:24576
    ds_read_b64_tr_b16 v[58:59], v176 offset:26624
    buffer_load_dwordx4 a[32:35], v3, s[20:23], s28 offen offset:0 sc1
    s_waitcnt vmcnt(15)
    s_waitcnt lgkmcnt(12)
    v_mfma_f32_32x32x16_bf16 v[8:23], v[64:67], a[36:39], v[8:23]
    ds_read_b64_tr_b16 v[60:61], v177 offset:24576
    ds_read_b64_tr_b16 v[62:63], v177 offset:26624
    s_waitcnt lgkmcnt(12)
    v_mfma_f32_32x32x16_bf16 v[24:39], v[68:71], a[36:39], v[24:39]
    ds_read_b64_tr_b16 v[64:65], v176 offset:25600
    ds_read_b64_tr_b16 v[66:67], v176 offset:27648
    buffer_load_dwordx4 a[36:39], v3, s[20:23], s28 offen offset:1024 sc1
    s_waitcnt vmcnt(10)
    s_mov_b64 exec, 1
    buffer_store_dwordx2 v[244:245], off, s[16:19], s77
    s_add_u32 s32, s77, 53248
    buffer_store_dwordx2 v[244:245], off, s[16:19], s32 sc1
    s_mov_b64 exec, -1
    s_waitcnt vmcnt(15)
    s_waitcnt lgkmcnt(12)
    v_mfma_f32_32x32x16_bf16 v[8:23], v[72:75], a[40:43], v[8:23]
    ds_read_b64_tr_b16 v[68:69], v177 offset:25600
    ds_read_b64_tr_b16 v[70:71], v177 offset:27648
    s_waitcnt lgkmcnt(12)
    v_mfma_f32_32x32x16_bf16 v[24:39], v[76:79], a[40:43], v[24:39]
    ds_read_b64_tr_b16 v[72:73], v176 offset:28672
    ds_read_b64_tr_b16 v[74:75], v176 offset:30720
    buffer_load_dwordx4 a[40:43], v3, s[20:23], s28 offen offset:2048 sc1
    s_waitcnt vmcnt(15)
    s_waitcnt lgkmcnt(12)
    v_mfma_f32_32x32x16_bf16 v[8:23], v[80:83], a[44:47], v[8:23]
    ds_read_b64_tr_b16 v[76:77], v177 offset:28672
    ds_read_b64_tr_b16 v[78:79], v177 offset:30720
    s_waitcnt lgkmcnt(12)
    v_mfma_f32_32x32x16_bf16 v[24:39], v[84:87], a[44:47], v[24:39]
    ds_read_b64_tr_b16 v[80:81], v176 offset:29696
    ds_read_b64_tr_b16 v[82:83], v176 offset:31744
    buffer_load_dwordx4 a[44:47], v3, s[20:23], s28 offen offset:3072 sc1
    s_add_u32 s28, s28, 4096
    s_waitcnt vmcnt(15)
    s_waitcnt lgkmcnt(12)
    v_mfma_f32_32x32x16_bf16 v[8:23], v[56:59], a[48:51], v[8:23]
    ds_read_b64_tr_b16 v[84:85], v177 offset:29696
    ds_read_b64_tr_b16 v[86:87], v177 offset:31744
    s_waitcnt lgkmcnt(12)
    v_mfma_f32_32x32x16_bf16 v[24:39], v[60:63], a[48:51], v[24:39]
    ds_read_b64_tr_b16 v[56:57], v172 offset:0
    ds_read_b64_tr_b16 v[58:59], v172 offset:2048
    buffer_load_dwordx4 a[48:51], v3, s[20:23], s28 offen offset:0 sc1
    s_waitcnt vmcnt(15)
    s_waitcnt lgkmcnt(12)
    v_mfma_f32_32x32x16_bf16 v[8:23], v[64:67], a[52:55], v[8:23]
    ds_read_b64_tr_b16 v[60:61], v173 offset:0
    ds_read_b64_tr_b16 v[62:63], v173 offset:2048
    s_waitcnt lgkmcnt(12)
    v_mfma_f32_32x32x16_bf16 v[24:39], v[68:71], a[52:55], v[24:39]
    ds_read_b64_tr_b16 v[64:65], v172 offset:1024
    ds_read_b64_tr_b16 v[66:67], v172 offset:3072
    buffer_load_dwordx4 a[52:55], v3, s[20:23], s28 offen offset:1024 sc1
    s_waitcnt vmcnt(15)
    s_waitcnt lgkmcnt(12)
    v_mfma_f32_32x32x16_bf16 v[8:23], v[72:75], a[56:59], v[8:23]
    ds_read_b64_tr_b16 v[68:69], v173 offset:1024
    ds_read_b64_tr_b16 v[70:71], v173 offset:3072
    s_waitcnt lgkmcnt(12)
    v_mfma_f32_32x32x16_bf16 v[24:39], v[76:79], a[56:59], v[24:39]
    ds_read_b64_tr_b16 v[72:73], v172 offset:4096
    ds_read_b64_tr_b16 v[74:75], v172 offset:6144
    buffer_load_dwordx4 a[56:59], v3, s[20:23], s28 offen offset:2048 sc1
    s_waitcnt vmcnt(15)
    s_waitcnt lgkmcnt(12)
    v_mfma_f32_32x32x16_bf16 v[8:23], v[80:83], a[60:63], v[8:23]
    ds_read_b64_tr_b16 v[76:77], v173 offset:4096
    ds_read_b64_tr_b16 v[78:79], v173 offset:6144
    s_waitcnt lgkmcnt(12)
    v_mfma_f32_32x32x16_bf16 v[24:39], v[84:87], a[60:63], v[24:39]
    ds_read_b64_tr_b16 v[80:81], v172 offset:5120
    ds_read_b64_tr_b16 v[82:83], v172 offset:7168
    buffer_load_dwordx4 a[60:63], v3, s[20:23], s28 offen offset:3072 sc1
    s_add_u32 s28, s28, 4096
    s_waitcnt vmcnt(15)
    s_waitcnt lgkmcnt(12)
    v_mfma_f32_32x32x16_bf16 v[8:23], v[56:59], a[0:3], v[8:23]
    ds_read_b64_tr_b16 v[84:85], v173 offset:5120
    ds_read_b64_tr_b16 v[86:87], v173 offset:7168
    s_waitcnt lgkmcnt(12)
    v_mfma_f32_32x32x16_bf16 v[24:39], v[60:63], a[0:3], v[24:39]
    ds_read_b64_tr_b16 v[56:57], v172 offset:8192
    ds_read_b64_tr_b16 v[58:59], v172 offset:10240
    buffer_load_dwordx4 a[0:3], v3, s[20:23], s28 offen offset:0 sc1
    s_waitcnt vmcnt(15)
    s_waitcnt lgkmcnt(12)
    v_mfma_f32_32x32x16_bf16 v[8:23], v[64:67], a[4:7], v[8:23]
    ds_read_b64_tr_b16 v[60:61], v173 offset:8192
    ds_read_b64_tr_b16 v[62:63], v173 offset:10240
    s_waitcnt lgkmcnt(12)
    v_mfma_f32_32x32x16_bf16 v[24:39], v[68:71], a[4:7], v[24:39]
    ds_read_b64_tr_b16 v[64:65], v172 offset:9216
    ds_read_b64_tr_b16 v[66:67], v172 offset:11264
    buffer_load_dwordx4 a[4:7], v3, s[20:23], s28 offen offset:1024 sc1
    s_waitcnt vmcnt(15)
    s_waitcnt lgkmcnt(12)
    v_mfma_f32_32x32x16_bf16 v[8:23], v[72:75], a[8:11], v[8:23]
    ds_read_b64_tr_b16 v[68:69], v173 offset:9216
    ds_read_b64_tr_b16 v[70:71], v173 offset:11264
    s_waitcnt lgkmcnt(12)
    v_mfma_f32_32x32x16_bf16 v[24:39], v[76:79], a[8:11], v[24:39]
    ds_read_b64_tr_b16 v[72:73], v172 offset:12288
    ds_read_b64_tr_b16 v[74:75], v172 offset:14336
    buffer_load_dwordx4 a[8:11], v3, s[20:23], s28 offen offset:2048 sc1
    s_waitcnt vmcnt(15)
    s_waitcnt lgkmcnt(12)
    v_mfma_f32_32x32x16_bf16 v[8:23], v[80:83], a[12:15], v[8:23]
    ds_read_b64_tr_b16 v[76:77], v173 offset:12288
    ds_read_b64_tr_b16 v[78:79], v173 offset:14336
    s_waitcnt lgkmcnt(12)
    v_mfma_f32_32x32x16_bf16 v[24:39], v[84:87], a[12:15], v[24:39]
    ds_read_b64_tr_b16 v[80:81], v172 offset:13312
    ds_read_b64_tr_b16 v[82:83], v172 offset:15360
    buffer_load_dwordx4 a[12:15], v3, s[20:23], s28 offen offset:3072 sc1
    s_add_u32 s28, s28, 4096
    s_waitcnt vmcnt(15)
    s_waitcnt lgkmcnt(12)
    v_mfma_f32_32x32x16_bf16 v[8:23], v[56:59], a[16:19], v[8:23]
    ds_read_b64_tr_b16 v[84:85], v173 offset:13312
    ds_read_b64_tr_b16 v[86:87], v173 offset:15360
    s_add_u32 s12, s16, 0
    s_addc_u32 s13, s17, 0
    s_waitcnt lgkmcnt(12)
    v_mfma_f32_32x32x16_bf16 v[24:39], v[60:63], a[16:19], v[24:39]
    ds_read_b64_tr_b16 v[56:57], v172 offset:16384
    ds_read_b64_tr_b16 v[58:59], v172 offset:18432
    buffer_load_dwordx4 a[16:19], v3, s[20:23], s28 offen offset:0 sc1
    s_waitcnt vmcnt(15)
    s_waitcnt lgkmcnt(12)
    v_mfma_f32_32x32x16_bf16 v[8:23], v[64:67], a[20:23], v[8:23]
    ds_read_b64_tr_b16 v[60:61], v173 offset:16384
    ds_read_b64_tr_b16 v[62:63], v173 offset:18432
    s_mov_b32 s14, 262144
    s_mov_b32 s15, 0x20000
    s_waitcnt lgkmcnt(12)
    v_mfma_f32_32x32x16_bf16 v[24:39], v[68:71], a[20:23], v[24:39]
    ds_read_b64_tr_b16 v[64:65], v172 offset:17408
    ds_read_b64_tr_b16 v[66:67], v172 offset:19456
    buffer_load_dwordx4 a[20:23], v3, s[20:23], s28 offen offset:1024 sc1
    s_waitcnt vmcnt(15)
    s_waitcnt lgkmcnt(12)
    v_mfma_f32_32x32x16_bf16 v[8:23], v[72:75], a[24:27], v[8:23]
    ds_read_b64_tr_b16 v[68:69], v173 offset:17408
    ds_read_b64_tr_b16 v[70:71], v173 offset:19456
    s_lshl_b32 s29, s54, 13
    s_add_u32 s80, s29, 0x18000
    s_waitcnt lgkmcnt(12)
    v_mfma_f32_32x32x16_bf16 v[24:39], v[76:79], a[24:27], v[24:39]
    ds_read_b64_tr_b16 v[72:73], v172 offset:20480
    ds_read_b64_tr_b16 v[74:75], v172 offset:22528
    buffer_load_dwordx4 a[24:27], v3, s[20:23], s28 offen offset:2048 sc1
    s_waitcnt vmcnt(15)
    s_waitcnt lgkmcnt(12)
    v_mfma_f32_32x32x16_bf16 v[8:23], v[80:83], a[28:31], v[8:23]
    ds_read_b64_tr_b16 v[76:77], v173 offset:20480
    ds_read_b64_tr_b16 v[78:79], v173 offset:22528
    s_add_u32 s30, s29, 0x28000
    s_mov_b32 s79, 0x20000
    s_waitcnt lgkmcnt(12)
    v_mfma_f32_32x32x16_bf16 v[24:39], v[84:87], a[28:31], v[24:39]
    ds_read_b64_tr_b16 v[80:81], v172 offset:21504
    ds_read_b64_tr_b16 v[82:83], v172 offset:23552
    buffer_load_dwordx4 a[28:31], v3, s[20:23], s28 offen offset:3072 sc1
    s_add_u32 s28, s28, 4096
    s_waitcnt vmcnt(15)
    s_waitcnt lgkmcnt(12)
    v_mfma_f32_32x32x16_bf16 v[8:23], v[56:59], a[32:35], v[8:23]
    ds_read_b64_tr_b16 v[84:85], v173 offset:21504
    ds_read_b64_tr_b16 v[86:87], v173 offset:23552
    s_and_b32 s32, s2, 7
    s_lshl_b32 s33, s32, 15
    s_waitcnt lgkmcnt(12)
    v_mfma_f32_32x32x16_bf16 v[24:39], v[60:63], a[32:35], v[24:39]
    ds_read_b64_tr_b16 v[56:57], v172 offset:24576
    ds_read_b64_tr_b16 v[58:59], v172 offset:26624
    buffer_load_dwordx4 a[32:35], v3, s[20:23], s28 offen offset:0 sc1
    s_waitcnt vmcnt(15)
    s_waitcnt lgkmcnt(12)
    v_mfma_f32_32x32x16_bf16 v[8:23], v[64:67], a[36:39], v[8:23]
    ds_read_b64_tr_b16 v[60:61], v173 offset:24576
    ds_read_b64_tr_b16 v[62:63], v173 offset:26624
    s_add_u32 s29, s29, s33
    s_mov_b32 s57, s29
    s_waitcnt lgkmcnt(12)
    v_mfma_f32_32x32x16_bf16 v[24:39], v[68:71], a[36:39], v[24:39]
    ds_read_b64_tr_b16 v[64:65], v172 offset:25600
    ds_read_b64_tr_b16 v[66:67], v172 offset:27648
    buffer_load_dwordx4 a[36:39], v3, s[20:23], s28 offen offset:1024 sc1
    s_waitcnt vmcnt(15)
    s_waitcnt lgkmcnt(12)
    v_mfma_f32_32x32x16_bf16 v[8:23], v[72:75], a[40:43], v[8:23]
    ds_read_b64_tr_b16 v[68:69], v173 offset:25600
    ds_read_b64_tr_b16 v[70:71], v173 offset:27648
    s_mov_b32 s81, 0
    s_lshl_b32 s33, s32, 8
    s_waitcnt lgkmcnt(12)
    v_mfma_f32_32x32x16_bf16 v[24:39], v[76:79], a[40:43], v[24:39]
    ds_read_b64_tr_b16 v[72:73], v172 offset:28672
    ds_read_b64_tr_b16 v[74:75], v172 offset:30720
    buffer_load_dwordx4 a[40:43], v3, s[20:23], s28 offen offset:2048 sc1
    s_waitcnt vmcnt(15)
    s_waitcnt lgkmcnt(12)
    v_mfma_f32_32x32x16_bf16 v[8:23], v[80:83], a[44:47], v[8:23]
    ds_read_b64_tr_b16 v[76:77], v173 offset:28672
    ds_read_b64_tr_b16 v[78:79], v173 offset:30720
    s_xor_b32 s78, s33, 256
    v_and_b32 v254, 31, v2
    s_waitcnt lgkmcnt(12)
    v_mfma_f32_32x32x16_bf16 v[24:39], v[84:87], a[44:47], v[24:39]
    ds_read_b64_tr_b16 v[80:81], v172 offset:29696
    ds_read_b64_tr_b16 v[82:83], v172 offset:31744
    buffer_load_dwordx4 a[44:47], v3, s[20:23], s28 offen offset:3072 sc1
    s_add_u32 s28, s28, 4096
    s_waitcnt vmcnt(15)
    s_waitcnt lgkmcnt(12)
    v_mfma_f32_32x32x16_bf16 v[8:23], v[56:59], a[48:51], v[8:23]
    ds_read_b64_tr_b16 v[84:85], v173 offset:29696
    ds_read_b64_tr_b16 v[86:87], v173 offset:31744
    v_lshlrev_b32 v254, 3, v254
    v_add_u32 v7, s33, v254
    s_waitcnt lgkmcnt(12)
    v_mfma_f32_32x32x16_bf16 v[24:39], v[60:63], a[48:51], v[24:39]
    ds_read_b64_tr_b16 v[56:57], v172 offset:32768
    ds_read_b64_tr_b16 v[58:59], v172 offset:34816
    buffer_load_dwordx4 a[48:51], v3, s[20:23], s28 offen offset:0 sc1
    s_waitcnt vmcnt(15)
    s_waitcnt lgkmcnt(12)
    v_mfma_f32_32x32x16_bf16 v[8:23], v[64:67], a[52:55], v[8:23]
    ds_read_b64_tr_b16 v[60:61], v173 offset:32768
    ds_read_b64_tr_b16 v[62:63], v173 offset:34816
    v_add_u32 v254, 888832, v254
    s_mov_b32 s35, 835584
    s_waitcnt lgkmcnt(12)
    v_mfma_f32_32x32x16_bf16 v[24:39], v[68:71], a[52:55], v[24:39]
    ds_read_b64_tr_b16 v[64:65], v172 offset:33792
    ds_read_b64_tr_b16 v[66:67], v172 offset:35840
    buffer_load_dwordx4 a[52:55], v3, s[20:23], s28 offen offset:1024 sc1
    s_waitcnt vmcnt(15)
    s_waitcnt lgkmcnt(12)
    v_mfma_f32_32x32x16_bf16 v[8:23], v[72:75], a[56:59], v[8:23]
    ds_read_b64_tr_b16 v[68:69], v173 offset:33792
    ds_read_b64_tr_b16 v[70:71], v173 offset:35840
    s_waitcnt lgkmcnt(12)
    v_mfma_f32_32x32x16_bf16 v[24:39], v[76:79], a[56:59], v[24:39]
    ds_read_b64_tr_b16 v[72:73], v172 offset:36864
    ds_read_b64_tr_b16 v[74:75], v172 offset:38912
    buffer_load_dwordx4 a[56:59], v3, s[20:23], s28 offen offset:2048 sc1
    s_waitcnt vmcnt(15)
    s_waitcnt lgkmcnt(12)
    v_mfma_f32_32x32x16_bf16 v[8:23], v[80:83], a[60:63], v[8:23]
    ds_read_b64_tr_b16 v[76:77], v173 offset:36864
    ds_read_b64_tr_b16 v[78:79], v173 offset:38912
    s_waitcnt lgkmcnt(12)
    v_mfma_f32_32x32x16_bf16 v[24:39], v[84:87], a[60:63], v[24:39]
    ds_read_b64_tr_b16 v[80:81], v172 offset:37888
    ds_read_b64_tr_b16 v[82:83], v172 offset:39936
    buffer_load_dwordx4 a[60:63], v3, s[20:23], s28 offen offset:3072 sc1
    s_add_u32 s28, s28, 4096
    s_waitcnt vmcnt(15)
    s_waitcnt lgkmcnt(12)
    v_mfma_f32_32x32x16_bf16 v[8:23], v[56:59], a[0:3], v[8:23]
    ds_read_b64_tr_b16 v[84:85], v173 offset:37888
    ds_read_b64_tr_b16 v[86:87], v173 offset:39936
    s_waitcnt lgkmcnt(12)
    v_mfma_f32_32x32x16_bf16 v[24:39], v[60:63], a[0:3], v[24:39]
    ds_read_b64_tr_b16 v[56:57], v172 offset:40960
    ds_read_b64_tr_b16 v[58:59], v172 offset:43008
    buffer_load_dwordx4 a[0:3], v3, s[20:23], s28 offen offset:0 sc1
    s_waitcnt vmcnt(15)
    s_waitcnt lgkmcnt(12)
    v_mfma_f32_32x32x16_bf16 v[8:23], v[64:67], a[4:7], v[8:23]
    ds_read_b64_tr_b16 v[60:61], v173 offset:40960
    ds_read_b64_tr_b16 v[62:63], v173 offset:43008
    s_waitcnt lgkmcnt(12)
    v_mfma_f32_32x32x16_bf16 v[24:39], v[68:71], a[4:7], v[24:39]
    ds_read_b64_tr_b16 v[64:65], v172 offset:41984
    ds_read_b64_tr_b16 v[66:67], v172 offset:44032
    buffer_load_dwordx4 a[4:7], v3, s[20:23], s28 offen offset:1024 sc1
    s_waitcnt vmcnt(15)
    s_waitcnt lgkmcnt(12)
    v_mfma_f32_32x32x16_bf16 v[8:23], v[72:75], a[8:11], v[8:23]
    ds_read_b64_tr_b16 v[68:69], v173 offset:41984
    ds_read_b64_tr_b16 v[70:71], v173 offset:44032
    s_waitcnt lgkmcnt(12)
    v_mfma_f32_32x32x16_bf16 v[24:39], v[76:79], a[8:11], v[24:39]
    ds_read_b64_tr_b16 v[72:73], v172 offset:45056
    ds_read_b64_tr_b16 v[74:75], v172 offset:47104
    buffer_load_dwordx4 a[8:11], v3, s[20:23], s28 offen offset:2048 sc1
    s_waitcnt vmcnt(15)
    s_waitcnt lgkmcnt(12)
    v_mfma_f32_32x32x16_bf16 v[8:23], v[80:83], a[12:15], v[8:23]
    ds_read_b64_tr_b16 v[76:77], v173 offset:45056
    ds_read_b64_tr_b16 v[78:79], v173 offset:47104
    s_waitcnt lgkmcnt(12)
    v_mfma_f32_32x32x16_bf16 v[24:39], v[84:87], a[12:15], v[24:39]
    ds_read_b64_tr_b16 v[80:81], v172 offset:46080
    ds_read_b64_tr_b16 v[82:83], v172 offset:48128
    buffer_load_dwordx4 a[12:15], v3, s[20:23], s28 offen offset:3072 sc1
    s_add_u32 s28, s28, 4096
    s_waitcnt vmcnt(15)
    s_waitcnt lgkmcnt(12)
    v_mfma_f32_32x32x16_bf16 v[8:23], v[56:59], a[16:19], v[8:23]
    ds_read_b64_tr_b16 v[84:85], v173 offset:46080
    ds_read_b64_tr_b16 v[86:87], v173 offset:48128
    s_waitcnt lgkmcnt(12)
    v_mfma_f32_32x32x16_bf16 v[24:39], v[60:63], a[16:19], v[24:39]
    ds_read_b64_tr_b16 v[56:57], v172 offset:49152
    ds_read_b64_tr_b16 v[58:59], v172 offset:51200
    buffer_load_dwordx4 a[16:19], v3, s[20:23], s28 offen offset:0 sc1
    s_waitcnt vmcnt(15)
    s_waitcnt lgkmcnt(12)
    v_mfma_f32_32x32x16_bf16 v[8:23], v[64:67], a[20:23], v[8:23]
    ds_read_b64_tr_b16 v[60:61], v173 offset:49152
    ds_read_b64_tr_b16 v[62:63], v173 offset:51200
    s_waitcnt lgkmcnt(12)
    v_mfma_f32_32x32x16_bf16 v[24:39], v[68:71], a[20:23], v[24:39]
    ds_read_b64_tr_b16 v[64:65], v172 offset:50176
    ds_read_b64_tr_b16 v[66:67], v172 offset:52224
    buffer_load_dwordx4 a[20:23], v3, s[20:23], s28 offen offset:1024 sc1
    s_waitcnt vmcnt(15)
    s_waitcnt lgkmcnt(12)
    v_mfma_f32_32x32x16_bf16 v[8:23], v[72:75], a[24:27], v[8:23]
    ds_read_b64_tr_b16 v[68:69], v173 offset:50176
    ds_read_b64_tr_b16 v[70:71], v173 offset:52224
    s_waitcnt lgkmcnt(12)
    v_mfma_f32_32x32x16_bf16 v[24:39], v[76:79], a[24:27], v[24:39]
    ds_read_b64_tr_b16 v[72:73], v172 offset:53248
    ds_read_b64_tr_b16 v[74:75], v172 offset:55296
    buffer_load_dwordx4 a[24:27], v3, s[20:23], s28 offen offset:2048 sc1
    s_waitcnt vmcnt(15)
    s_waitcnt lgkmcnt(12)
    v_mfma_f32_32x32x16_bf16 v[8:23], v[80:83], a[28:31], v[8:23]
    ds_read_b64_tr_b16 v[76:77], v173 offset:53248
    ds_read_b64_tr_b16 v[78:79], v173 offset:55296
    s_waitcnt lgkmcnt(12)
    v_mfma_f32_32x32x16_bf16 v[24:39], v[84:87], a[28:31], v[24:39]
    ds_read_b64_tr_b16 v[80:81], v172 offset:54272
    ds_read_b64_tr_b16 v[82:83], v172 offset:56320
    buffer_load_dwordx4 a[28:31], v3, s[20:23], s28 offen offset:3072 sc1
    s_add_u32 s28, s28, 4096
    s_waitcnt vmcnt(15)
    s_waitcnt lgkmcnt(12)
    v_mfma_f32_32x32x16_bf16 v[8:23], v[56:59], a[32:35], v[8:23]
    ds_read_b64_tr_b16 v[84:85], v173 offset:54272
    ds_read_b64_tr_b16 v[86:87], v173 offset:56320
    s_waitcnt lgkmcnt(12)
    v_mfma_f32_32x32x16_bf16 v[24:39], v[60:63], a[32:35], v[24:39]
    ds_read_b64_tr_b16 v[56:57], v172 offset:57344
    ds_read_b64_tr_b16 v[58:59], v172 offset:59392
    buffer_load_dwordx4 a[32:35], v3, s[20:23], s28 offen offset:0 sc1
    s_waitcnt vmcnt(15)
    s_waitcnt lgkmcnt(12)
    v_mfma_f32_32x32x16_bf16 v[8:23], v[64:67], a[36:39], v[8:23]
    ds_read_b64_tr_b16 v[60:61], v173 offset:57344
    ds_read_b64_tr_b16 v[62:63], v173 offset:59392
    s_waitcnt lgkmcnt(12)
    v_mfma_f32_32x32x16_bf16 v[24:39], v[68:71], a[36:39], v[24:39]
    ds_read_b64_tr_b16 v[64:65], v172 offset:58368
    ds_read_b64_tr_b16 v[66:67], v172 offset:60416
    buffer_load_dwordx4 a[36:39], v3, s[20:23], s28 offen offset:1024 sc1
    s_waitcnt vmcnt(15)
    s_waitcnt lgkmcnt(12)
    v_mfma_f32_32x32x16_bf16 v[8:23], v[72:75], a[40:43], v[8:23]
    ds_read_b64_tr_b16 v[68:69], v173 offset:58368
    ds_read_b64_tr_b16 v[70:71], v173 offset:60416
    s_waitcnt lgkmcnt(12)
    v_mfma_f32_32x32x16_bf16 v[24:39], v[76:79], a[40:43], v[24:39]
    ds_read_b64_tr_b16 v[72:73], v172 offset:61440
    ds_read_b64_tr_b16 v[74:75], v172 offset:63488
    buffer_load_dwordx4 a[40:43], v3, s[20:23], s28 offen offset:2048 sc1
    s_waitcnt vmcnt(15)
    s_waitcnt lgkmcnt(12)
    v_mfma_f32_32x32x16_bf16 v[8:23], v[80:83], a[44:47], v[8:23]
    ds_read_b64_tr_b16 v[76:77], v173 offset:61440
    ds_read_b64_tr_b16 v[78:79], v173 offset:63488
    s_waitcnt lgkmcnt(12)
    v_mfma_f32_32x32x16_bf16 v[24:39], v[84:87], a[44:47], v[24:39]
    ds_read_b64_tr_b16 v[80:81], v172 offset:62464
    ds_read_b64_tr_b16 v[82:83], v172 offset:64512
    buffer_load_dwordx4 a[44:47], v3, s[20:23], s28 offen offset:3072 sc1
    s_add_u32 s28, s28, 4096
    s_waitcnt vmcnt(15)
    s_waitcnt lgkmcnt(12)
    v_mfma_f32_32x32x16_bf16 v[8:23], v[56:59], a[48:51], v[8:23]
    ds_read_b64_tr_b16 v[84:85], v173 offset:62464
    ds_read_b64_tr_b16 v[86:87], v173 offset:64512
    s_waitcnt lgkmcnt(12)
    v_mfma_f32_32x32x16_bf16 v[24:39], v[60:63], a[48:51], v[24:39]
    ds_read_b64_tr_b16 v[56:57], v174 offset:0
    ds_read_b64_tr_b16 v[58:59], v174 offset:2048
    buffer_load_dwordx4 a[48:51], v3, s[20:23], s28 offen offset:0 sc1
    s_waitcnt vmcnt(15)
    s_waitcnt lgkmcnt(12)
    v_mfma_f32_32x32x16_bf16 v[8:23], v[64:67], a[52:55], v[8:23]
    ds_read_b64_tr_b16 v[60:61], v175 offset:0
    ds_read_b64_tr_b16 v[62:63], v175 offset:2048
    s_waitcnt lgkmcnt(12)
    v_mfma_f32_32x32x16_bf16 v[24:39], v[68:71], a[52:55], v[24:39]
    ds_read_b64_tr_b16 v[64:65], v174 offset:1024
    ds_read_b64_tr_b16 v[66:67], v174 offset:3072
    buffer_load_dwordx4 a[52:55], v3, s[20:23], s28 offen offset:1024 sc1
    s_waitcnt vmcnt(15)
    s_waitcnt lgkmcnt(12)
    v_mfma_f32_32x32x16_bf16 v[8:23], v[72:75], a[56:59], v[8:23]
    ds_read_b64_tr_b16 v[68:69], v175 offset:1024
    ds_read_b64_tr_b16 v[70:71], v175 offset:3072
    s_waitcnt lgkmcnt(12)
    v_mfma_f32_32x32x16_bf16 v[24:39], v[76:79], a[56:59], v[24:39]
    ds_read_b64_tr_b16 v[72:73], v174 offset:4096
    ds_read_b64_tr_b16 v[74:75], v174 offset:6144
    buffer_load_dwordx4 a[56:59], v3, s[20:23], s28 offen offset:2048 sc1
    s_waitcnt vmcnt(15)
    s_waitcnt lgkmcnt(12)
    v_mfma_f32_32x32x16_bf16 v[8:23], v[80:83], a[60:63], v[8:23]
    ds_read_b64_tr_b16 v[76:77], v175 offset:4096
    ds_read_b64_tr_b16 v[78:79], v175 offset:6144
    s_waitcnt lgkmcnt(12)
    v_mfma_f32_32x32x16_bf16 v[24:39], v[84:87], a[60:63], v[24:39]
    ds_read_b64_tr_b16 v[80:81], v174 offset:5120
    ds_read_b64_tr_b16 v[82:83], v174 offset:7168
    buffer_load_dwordx4 a[60:63], v3, s[20:23], s28 offen offset:3072 sc1
    s_add_u32 s28, s28, 4096
    s_waitcnt vmcnt(15)
    s_waitcnt lgkmcnt(12)
    v_mfma_f32_32x32x16_bf16 v[8:23], v[56:59], a[0:3], v[8:23]
    ds_read_b64_tr_b16 v[84:85], v175 offset:5120
    ds_read_b64_tr_b16 v[86:87], v175 offset:7168
    buffer_load_dwordx2 v[240:241], v7, s[16:19], s35 offen sc1
    s_waitcnt lgkmcnt(12)
    v_mfma_f32_32x32x16_bf16 v[24:39], v[60:63], a[0:3], v[24:39]
    ds_read_b64_tr_b16 v[56:57], v174 offset:8192
    ds_read_b64_tr_b16 v[58:59], v174 offset:10240
    s_waitcnt vmcnt(15)
    s_waitcnt lgkmcnt(12)
    v_mfma_f32_32x32x16_bf16 v[8:23], v[64:67], a[4:7], v[8:23]
    ds_read_b64_tr_b16 v[60:61], v175 offset:8192
    ds_read_b64_tr_b16 v[62:63], v175 offset:10240
    s_waitcnt lgkmcnt(12)
    v_mfma_f32_32x32x16_bf16 v[24:39], v[68:71], a[4:7], v[24:39]
    ds_read_b64_tr_b16 v[64:65], v174 offset:9216
    ds_read_b64_tr_b16 v[66:67], v174 offset:11264
    s_waitcnt vmcnt(14)
    s_waitcnt lgkmcnt(12)
    v_mfma_f32_32x32x16_bf16 v[8:23], v[72:75], a[8:11], v[8:23]
    ds_read_b64_tr_b16 v[68:69], v175 offset:9216
    ds_read_b64_tr_b16 v[70:71], v175 offset:11264
    s_waitcnt lgkmcnt(12)
    v_mfma_f32_32x32x16_bf16 v[24:39], v[76:79], a[8:11], v[24:39]
    ds_read_b64_tr_b16 v[72:73], v174 offset:12288
    ds_read_b64_tr_b16 v[74:75], v174 offset:14336
    s_waitcnt vmcnt(13)
    s_waitcnt lgkmcnt(12)
    v_mfma_f32_32x32x16_bf16 v[8:23], v[80:83], a[12:15], v[8:23]
    ds_read_b64_tr_b16 v[76:77], v175 offset:12288
    ds_read_b64_tr_b16 v[78:79], v175 offset:14336
    s_waitcnt lgkmcnt(12)
    v_mfma_f32_32x32x16_bf16 v[24:39], v[84:87], a[12:15], v[24:39]
    ds_read_b64_tr_b16 v[80:81], v174 offset:13312
    ds_read_b64_tr_b16 v[82:83], v174 offset:15360
    s_waitcnt vmcnt(12)
    s_waitcnt lgkmcnt(12)
    v_mfma_f32_32x32x16_bf16 v[8:23], v[56:59], a[16:19], v[8:23]
    ds_read_b64_tr_b16 v[84:85], v175 offset:13312
    ds_read_b64_tr_b16 v[86:87], v175 offset:15360
    s_waitcnt lgkmcnt(12)
    v_mfma_f32_32x32x16_bf16 v[24:39], v[60:63], a[16:19], v[24:39]
    ds_read_b64_tr_b16 v[56:57], v174 offset:16384
    ds_read_b64_tr_b16 v[58:59], v174 offset:18432
    s_waitcnt vmcnt(11)
    s_waitcnt lgkmcnt(12)
    v_mfma_f32_32x32x16_bf16 v[8:23], v[64:67], a[20:23], v[8:23]
    ds_read_b64_tr_b16 v[60:61], v175 offset:16384
    ds_read_b64_tr_b16 v[62:63], v175 offset:18432
    s_waitcnt lgkmcnt(12)
    v_mfma_f32_32x32x16_bf16 v[24:39], v[68:71], a[20:23], v[24:39]
    ds_read_b64_tr_b16 v[64:65], v174 offset:17408
    ds_read_b64_tr_b16 v[66:67], v174 offset:19456
    s_waitcnt vmcnt(10)
    s_waitcnt lgkmcnt(12)
    v_mfma_f32_32x32x16_bf16 v[8:23], v[72:75], a[24:27], v[8:23]
    ds_read_b64_tr_b16 v[68:69], v175 offset:17408
    ds_read_b64_tr_b16 v[70:71], v175 offset:19456
    s_waitcnt lgkmcnt(12)
    v_mfma_f32_32x32x16_bf16 v[24:39], v[76:79], a[24:27], v[24:39]
    ds_read_b64_tr_b16 v[72:73], v174 offset:20480
    ds_read_b64_tr_b16 v[74:75], v174 offset:22528
    s_waitcnt vmcnt(9)
    s_waitcnt lgkmcnt(12)
    v_mfma_f32_32x32x16_bf16 v[8:23], v[80:83], a[28:31], v[8:23]
    ds_read_b64_tr_b16 v[76:77], v175 offset:20480
    ds_read_b64_tr_b16 v[78:79], v175 offset:22528
    s_waitcnt vmcnt(0)
    v_cmp_ne_u64 vcc, s[74:75], v[240:241]
    s_cmp_lg_u64 vcc, 0
    s_cbranch_scc1 L_main_kernel_spin_1013
L_main_kernel_ok_1012:
    s_waitcnt lgkmcnt(12)
    v_mfma_f32_32x32x16_bf16 v[24:39], v[84:87], a[28:31], v[24:39]
    ds_read_b64_tr_b16 v[80:81], v174 offset:21504
    ds_read_b64_tr_b16 v[82:83], v174 offset:23552
    s_add_u32 m0, s80, 0
    s_nop 0
    buffer_load_dwordx4 v3, s[12:15], s29 offen offset:0 sc1 lds
    s_waitcnt vmcnt(9)
    s_waitcnt lgkmcnt(12)
    v_mfma_f32_32x32x16_bf16 v[8:23], v[56:59], a[32:35], v[8:23]
    ds_read_b64_tr_b16 v[84:85], v175 offset:21504
    ds_read_b64_tr_b16 v[86:87], v175 offset:23552
    s_waitcnt lgkmcnt(12)
    v_mfma_f32_32x32x16_bf16 v[24:39], v[60:63], a[32:35], v[24:39]
    ds_read_b64_tr_b16 v[56:57], v174 offset:24576
    ds_read_b64_tr_b16 v[58:59], v174 offset:26624
    buffer_load_dwordx4 v3, s[12:15], s29 offen offset:1024 sc1 lds
    s_waitcnt vmcnt(9)
    s_waitcnt lgkmcnt(12)
    v_mfma_f32_32x32x16_bf16 v[8:23], v[64:67], a[36:39], v[8:23]
    ds_read_b64_tr_b16 v[60:61], v175 offset:24576
    ds_read_b64_tr_b16 v[62:63], v175 offset:26624
    s_waitcnt lgkmcnt(12)
    v_mfma_f32_32x32x16_bf16 v[24:39], v[68:71], a[36:39], v[24:39]
    ds_read_b64_tr_b16 v[64:65], v174 offset:25600
    ds_read_b64_tr_b16 v[66:67], v174 offset:27648
    buffer_load_dwordx4 v3, s[12:15], s29 offen offset:2048 sc1 lds
    s_waitcnt vmcnt(9)
    s_waitcnt lgkmcnt(12)
    v_mfma_f32_32x32x16_bf16 v[8:23], v[72:75], a[40:43], v[8:23]
    ds_read_b64_tr_b16 v[68:69], v175 offset:25600
    ds_read_b64_tr_b16 v[70:71], v175 offset:27648
    s_waitcnt lgkmcnt(12)
    v_mfma_f32_32x32x16_bf16 v[24:39], v[76:79], a[40:43], v[24:39]
    ds_read_b64_tr_b16 v[72:73], v174 offset:28672
    ds_read_b64_tr_b16 v[74:75], v174 offset:30720
    buffer_load_dwordx4 v3, s[12:15], s29 offen offset:3072 sc1 lds
    s_add_u32 s29, s29, 4096
    s_waitcnt vmcnt(9)
    s_waitcnt lgkmcnt(12)
    v_mfma_f32_32x32x16_bf16 v[8:23], v[80:83], a[44:47], v[8:23]
    ds_read_b64_tr_b16 v[76:77], v175 offset:28672
    ds_read_b64_tr_b16 v[78:79], v175 offset:30720
    s_waitcnt lgkmcnt(12)
    v_mfma_f32_32x32x16_bf16 v[24:39], v[84:87], a[44:47], v[24:39]
    ds_read_b64_tr_b16 v[80:81], v174 offset:29696
    ds_read_b64_tr_b16 v[82:83], v174 offset:31744
    s_add_u32 m0, s80, 4096
    s_nop 0
    buffer_load_dwordx4 v3, s[12:15], s29 offen offset:0 sc1 lds
    s_add_u32 s80, s80, 0x8000
    s_waitcnt vmcnt(9)
    s_waitcnt lgkmcnt(12)
    v_mfma_f32_32x32x16_bf16 v[8:23], v[56:59], a[48:51], v[8:23]
    ds_read_b64_tr_b16 v[84:85], v175 offset:29696
    ds_read_b64_tr_b16 v[86:87], v175 offset:31744
    s_waitcnt lgkmcnt(12)
    v_mfma_f32_32x32x16_bf16 v[24:39], v[60:63], a[48:51], v[24:39]
    buffer_load_dwordx4 v3, s[12:15], s29 offen offset:1024 sc1 lds
    s_sub_u32 s60, s80, 0x18000
    s_waitcnt vmcnt(9)
    s_waitcnt lgkmcnt(10)
    v_mfma_f32_32x32x16_bf16 v[8:23], v[64:67], a[52:55], v[8:23]
    s_waitcnt lgkmcnt(8)
    v_mfma_f32_32x32x16_bf16 v[24:39], v[68:71], a[52:55], v[24:39]
    s_cmp_ge_u32 s80, s30
    s_nop 0
    buffer_load_dwordx4 v3, s[12:15], s29 offen offset:2048 sc1 lds
    s_cselect_b32 s80, s60, s80
    s_waitcnt vmcnt(9)
    s_waitcnt lgkmcnt(6)
    v_mfma_f32_32x32x16_bf16 v[8:23], v[72:75], a[56:59], v[8:23]
    s_waitcnt lgkmcnt(4)
    v_mfma_f32_32x32x16_bf16 v[24:39], v[76:79], a[56:59], v[24:39]
    s_add_u32 s81, s81, 0x8000
    s_nop 0
    buffer_load_dwordx4 v3, s[12:15], s29 offen offset:3072 sc1 lds
    s_and_b32 s81, s81, 0x3ffff
    s_xor_b32 s29, s81, s57
    s_waitcnt vmcnt(9)
    s_waitcnt lgkmcnt(2)
    v_mfma_f32_32x32x16_bf16 v[8:23], v[80:83], a[60:63], v[8:23]
    s_waitcnt lgkmcnt(0)
    v_mfma_f32_32x32x16_bf16 v[24:39], v[84:87], a[60:63], v[24:39]
    v_mfma_f32_32x32x16_bf16 v[8:23], a[192:195], v[104:107], v[8:23]
    v_mfma_f32_32x32x16_bf16 v[24:39], a[196:199], v[104:107], v[24:39]
    buffer_load_dwordx2 v[240:241], v254, s[16:19], s78 offen sc1
    v_mul_f32 v6, 0x3e8293ee, v6
    v_mov_b32 v7, v6
    v_mov_b64 v[200:201], 0
    v_mov_b64 v[202:203], 0
    v_mov_b64 v[204:205], 0
    v_mov_b64 v[206:207], 0
    v_mov_b64 v[208:209], 0
    v_mov_b64 v[210:211], 0
    v_mov_b64 v[212:213], 0
    v_mov_b64 v[214:215], 0
    v_mov_b64 v[216:217], 0
    v_mov_b64 v[218:219], 0
    v_mov_b64 v[220:221], 0
    v_mov_b64 v[222:223], 0
    v_mov_b64 v[224:225], 0
    v_mov_b64 v[226:227], 0
    v_mov_b64 v[228:229], 0
    v_mov_b64 v[230:231], 0
    v_mov_b64 v[232:233], 0
    v_mov_b64 v[234:235], 0
    v_mov_b64 v[236:237], 0
    v_mov_b64 v[238:239], 0
    v_mov_b64 v[80:81], 0
    v_mov_b64 v[82:83], 0
    v_mov_b64 v[84:85], 0
    v_mov_b64 v[86:87], 0
    v_pk_mul_f32 v[8:9], v[8:9], v[6:7]
    v_pk_mul_f32 v[10:11], v[10:11], v[6:7]
    v_pk_mul_f32 v[12:13], v[12:13], v[6:7]
    v_pk_mul_f32 v[14:15], v[14:15], v[6:7]
    v_pk_mul_f32 v[16:17], v[16:17], v[6:7]
    v_pk_mul_f32 v[18:19], v[18:19], v[6:7]
    v_pk_mul_f32 v[20:21], v[20:21], v[6:7]
    v_pk_mul_f32 v[22:23], v[22:23], v[6:7]
    v_pk_mul_f32 v[24:25], v[24:25], v[6:7]
    v_pk_mul_f32 v[26:27], v[26:27], v[6:7]
    v_pk_mul_f32 v[28:29], v[28:29], v[6:7]
    v_pk_mul_f32 v[30:31], v[30:31], v[6:7]
    v_pk_mul_f32 v[32:33], v[32:33], v[6:7]
    v_pk_mul_f32 v[34:35], v[34:35], v[6:7]
    v_pk_mul_f32 v[36:37], v[36:37], v[6:7]
    v_pk_mul_f32 v[38:39], v[38:39], v[6:7]
    v_cvt_pk_bf16_f32 v112, v8, v9
    v_cvt_pk_bf16_f32 v113, v10, v11
    v_cvt_pk_bf16_f32 v114, v12, v13
    v_cvt_pk_bf16_f32 v115, v14, v15
    v_cvt_pk_bf16_f32 v116, v16, v17
    v_cvt_pk_bf16_f32 v117, v18, v19
    v_cvt_pk_bf16_f32 v118, v20, v21
    v_cvt_pk_bf16_f32 v119, v22, v23
    v_cvt_pk_bf16_f32 v120, v24, v25
    v_cvt_pk_bf16_f32 v121, v26, v27
    v_cvt_pk_bf16_f32 v122, v28, v29
    v_cvt_pk_bf16_f32 v123, v30, v31
    v_cvt_pk_bf16_f32 v124, v32, v33
    v_cvt_pk_bf16_f32 v125, v34, v35
    v_cvt_pk_bf16_f32 v126, v36, v37
    v_cvt_pk_bf16_f32 v127, v38, v39
    v_add_u32 v104, 0x18000, v3
    v_mov_b32 v105, v242
    v_lshlrev_b32 v110, 11, v2
    v_mov_b32 v111, 0xdddddddd
    s_waitcnt vmcnt(1)
    s_barrier
    ds_read_b128 v[56:59], v104 offset:0
    ds_read_b128 v[60:63], v104 offset:1024
    ds_read_b128 v[72:75], v104 offset:2048
    ds_read_b128 v[76:79], v104 offset:3072
    s_waitcnt vmcnt(0)
    v_cmp_ne_u64 vcc, s[74:75], v[240:241]
    s_cmp_lg_u64 vcc, 0
    s_cbranch_scc1 L_main_kernel_spin_1017
L_main_kernel_ok_1016:
    s_cmp_lg_u32 s56, 0
    s_cbranch_scc1 L_main_kernel_nopack_1015
    s_add_u32 m0, s87, 0
    s_nop 0
    buffer_load_dwordx4 v192, s[24:27], s61 offen nt lds
    s_add_u32 s61, s61, s62
    s_add_u32 m0, s87, 1024
    s_nop 0
    buffer_load_dwordx4 v192, s[24:27], s61 offen nt lds
    s_add_u32 s61, s61, s62
    s_add_u32 m0, s87, 2048
    s_nop 0
    buffer_load_dwordx4 v192, s[24:27], s61 offen nt lds
    s_add_u32 s61, s61, s62
    s_add_u32 m0, s87, 3072
    s_nop 0
    buffer_load_dwordx4 v192, s[24:27], s61 offen nt lds
    s_add_u32 s61, s61, s62
    v_mov_b32 v9, 0x3f803f80
    v_accvgpr_write_b32 a0, 0
    v_accvgpr_write_b32 a1, 0
    v_accvgpr_write_b32 a2, 0
    v_accvgpr_write_b32 a3, 0
    v_accvgpr_write_b32 a4, 0
    v_accvgpr_write_b32 a5, 0
    v_accvgpr_write_b32 a6, 0
    v_accvgpr_write_b32 a7, 0
    v_accvgpr_write_b32 a8, v9
    v_accvgpr_write_b32 a9, v9
    v_accvgpr_write_b32 a10, v9
    v_accvgpr_write_b32 a11, v9
L_main_kernel_nopack_1015:
    s_add_u32 m0, s80, 0
    s_nop 0
    buffer_load_dwordx4 v3, s[12:15], s29 offen offset:0 sc1 lds
    buffer_load_dwordx4 v3, s[12:15], s29 offen offset:1024 sc1 lds
    s_waitcnt lgkmcnt(0)
    v_mfma_f32_32x32x16_bf16 v[160:175], v[56:59], v[112:115], 0
    v_mfma_f32_32x32x16_bf16 v[160:175], v[60:63], v[116:119], v[160:175]
    v_mfma_f32_32x32x16_bf16 v[176:191], v[56:59], v[120:123], 0
    v_mfma_f32_32x32x16_bf16 v[176:191], v[60:63], v[124:127], v[176:191]
    s_nop 9
    v_max3_f32 v6, v160, v161, v162
    v_max3_f32 v6, v6, v163, v164
    v_max3_f32 v6, v6, v165, v166
    v_max3_f32 v6, v6, v167, v168
    v_max3_f32 v6, v6, v169, v170
    v_max3_f32 v6, v6, v171, v172
    v_max3_f32 v6, v6, v173, v174
    v_max_f32 v6, v6, v175
    v_mov_b32 v7, v6
    s_nop 1
    v_permlane32_swap_b32 v6, v7
    s_nop 0
    v_max_f32 v6, v6, v7
    v_sub_f32 v6, 0, v6
    v_mov_b32 v7, v6
    v_mov_b64 v[128:129], v[6:7]
    v_mov_b64 v[130:131], v[6:7]
    v_mov_b64 v[132:133], v[6:7]
    v_mov_b64 v[134:135], v[6:7]
    v_mov_b64 v[136:137], v[6:7]
    v_mov_b64 v[138:139], v[6:7]
    v_mov_b64 v[140:141], v[6:7]
    v_mov_b64 v[142:143], v[6:7]
    v_pk_add_f32 v[160:161], v[160:161], v[6:7]
    v_pk_add_f32 v[162:163], v[162:163], v[6:7]
    v_pk_add_f32 v[164:165], v[164:165], v[6:7]
    v_pk_add_f32 v[166:167], v[166:167], v[6:7]
    v_pk_add_f32 v[168:169], v[168:169], v[6:7]
    v_pk_add_f32 v[170:171], v[170:171], v[6:7]
    v_pk_add_f32 v[172:173], v[172:173], v[6:7]
    v_pk_add_f32 v[174:175], v[174:175], v[6:7]
    v_max3_f32 v6, v176, v177, v178
    v_max3_f32 v6, v6, v179, v180
    v_max3_f32 v6, v6, v181, v182
    v_max3_f32 v6, v6, v183, v184
    v_max3_f32 v6, v6, v185, v186
    v_max3_f32 v6, v6, v187, v188
    v_max3_f32 v6, v6, v189, v190
    v_max_f32 v6, v6, v191
    v_mov_b32 v7, v6
    s_nop 1
    v_permlane32_swap_b32 v6, v7
    s_nop 0
    v_max_f32 v6, v6, v7
    v_sub_f32 v6, 0, v6
    v_mov_b32 v7, v6
    v_mov_b64 v[144:145], v[6:7]
    v_mov_b64 v[146:147], v[6:7]
    v_mov_b64 v[148:149], v[6:7]
    v_mov_b64 v[150:151], v[6:7]
    v_mov_b64 v[152:153], v[6:7]
    v_mov_b64 v[154:155], v[6:7]
    v_mov_b64 v[156:157], v[6:7]
    v_mov_b64 v[158:159], v[6:7]
    v_mov_b64 v[184:185], 0
    v_mov_b64 v[186:187], 0
    v_mov_b64 v[188:189], 0
    v_mov_b64 v[190:191], 0
    s_mov_b32 s31, 8
    s_mov_b32 s88, -1
    s_lshl_b32 s92, s53, 7
    s_lshl_b32 s32, s86, 18
    s_add_u32 s92, s92, s32
    s_cmp_lg_u32 s56, 0
    s_cbranch_scc1 L_main_kernel_aN_1020
L_main_kernel_aP_1019:
    v_exp_f32 v160, v160
    v_exp_f32 v161, v161
    v_smfmac_f32_32x32x32_bf16 v[216:231], v[84:87], v[184:191], v111
    ds_read_b128 v[64:67], v104 offset:4096
    v_exp_f32 v162, v162
    v_exp_f32 v163, v163
    v_exp_f32 v164, v164
    v_smfmac_f32_16x16x64_bf16 v[236:239], a[252:255], v[184:191], v111
    ds_read_b128 v[68:71], v104 offset:5120
    v_exp_f32 v165, v165
    v_mfma_f32_32x32x16_bf16 v[176:191], v[56:59], v[120:123], v[144:159]
    s_add_u32 s79, s79, 0x8000
    v_exp_f32 v166, v166
    v_exp_f32 v167, v167
    v_exp_f32 v168, v168
    v_mfma_f32_32x32x16_bf16 v[176:191], v[60:63], v[124:127], v[176:191]
    s_cmp_ge_u32 s79, 0x28000
    v_exp_f32 v169, v169
    v_exp_f32 v170, v170
    v_exp_f32 v171, v171
    v_smfmac_f32_32x32x32_bf16 v[200:215], v[72:75], v[160:167], v111
    buffer_load_dwordx4 v3, s[12:15], s29 offen offset:2048 sc1 lds
    v_exp_f32 v172, v172
    v_exp_f32 v173, v173
    v_exp_f32 v174, v174
    v_smfmac_f32_16x16x64_bf16 v[232:235], a[252:255], v[160:167], v111
    s_waitcnt lgkmcnt(0)
    s_cselect_b32 s79, 0x10000, s79
    v_exp_f32 v175, v175
    v_readlane_b32 s63, v195, s44
    v_exp_f32 v176, v176
    v_exp_f32 v177, v177
    v_smfmac_f32_32x32x32_bf16 v[200:215], v[76:79], v[168:175], v111
    ds_read_b128 v[80:83], v104 offset:6144
    v_exp_f32 v178, v178
    v_exp_f32 v179, v179
    v_exp_f32 v180, v180
    v_smfmac_f32_16x16x64_bf16 v[232:235], a[252:255], v[168:175], v111
    ds_read_b128 v[84:87], v104 offset:7168
    v_exp_f32 v181, v181
    v_mfma_f32_32x32x16_bf16 v[160:175], v[64:67], v[112:115], v[128:143]
    s_add_u32 s44, s44, 1
    v_exp_f32 v182, v182
    v_exp_f32 v183, v183
    v_exp_f32 v184, v184
    v_mfma_f32_32x32x16_bf16 v[160:175], v[68:71], v[116:119], v[160:175]
    s_nop 0
    v_exp_f32 v185, v185
    v_exp_f32 v186, v186
    v_exp_f32 v187, v187
    v_smfmac_f32_32x32x32_bf16 v[216:231], v[72:75], v[176:183], v111
    buffer_load_dwordx4 v3, s[12:15], s29 offen offset:3072 sc1 lds
    v_exp_f32 v188, v188
    v_exp_f32 v189, v189
    v_exp_f32 v190, v190
    v_smfmac_f32_16x16x64_bf16 v[236:239], a[252:255], v[176:183], v111
    s_waitcnt lgkmcnt(0)
    s_add_u32 s29, s29, 4096
    v_exp_f32 v191, v191
    v_readlane_b32 s64, v195, s44
    v_exp_f32 v160, v160
    v_exp_f32 v161, v161
    v_smfmac_f32_32x32x32_bf16 v[216:231], v[76:79], v[184:191], v111
    ds_read_b128 v[56:59], v104 offset:8192
    v_exp_f32 v162, v162
    v_exp_f32 v163, v163
    v_exp_f32 v164, v164
    v_smfmac_f32_16x16x64_bf16 v[236:239], a[252:255], v[184:191], v111
    ds_read_b128 v[60:63], v104 offset:9216
    v_exp_f32 v165, v165
    v_mfma_f32_32x32x16_bf16 v[176:191], v[64:67], v[120:123], v[144:159]
    s_add_u32 s44, s44, 1
    v_exp_f32 v166, v166
    v_exp_f32 v167, v167
    v_exp_f32 v168, v168
    v_mfma_f32_32x32x16_bf16 v[176:191], v[68:71], v[124:127], v[176:191]
    s_add_u32 m0, s80, 4096
    v_exp_f32 v169, v169
    v_exp_f32 v170, v170
    v_exp_f32 v171, v171
    v_smfmac_f32_32x32x32_bf16 v[200:215], v[80:83], v[160:167], v111
    buffer_load_dwordx4 v3, s[12:15], s29 offen offset:0 sc1 lds
    v_exp_f32 v172, v172
    v_exp_f32 v173, v173
    v_exp_f32 v174, v174
    v_smfmac_f32_16x16x64_bf16 v[232:235], a[252:255], v[160:167], v111
    s_waitcnt lgkmcnt(0)
    s_add_u32 s80, s80, 0x8000
    v_exp_f32 v175, v175
    v_exp_f32 v176, v176
    v_exp_f32 v177, v177
    v_smfmac_f32_32x32x32_bf16 v[200:215], v[84:87], v[168:175], v111
    ds_read_b128 v[72:75], v104 offset:10240
    v_exp_f32 v178, v178
    v_exp_f32 v179, v179
    v_exp_f32 v180, v180
    v_smfmac_f32_16x16x64_bf16 v[232:235], a[252:255], v[168:175], v111
    ds_read_b128 v[76:79], v104 offset:11264
    v_exp_f32 v181, v181
    v_mfma_f32_32x32x16_bf16 v[160:175], v[56:59], v[112:115], v[128:143]
    v_exp_f32 v182, v182
    v_exp_f32 v183, v183
    v_exp_f32 v184, v184
    v_mfma_f32_32x32x16_bf16 v[160:175], v[60:63], v[116:119], v[160:175]
    s_sub_u32 s60, s80, 0x18000
    v_exp_f32 v185, v185
    v_exp_f32 v186, v186
    v_exp_f32 v187, v187
    v_smfmac_f32_32x32x32_bf16 v[216:231], v[80:83], v[176:183], v111
    buffer_load_dwordx4 v3, s[12:15], s29 offen offset:1024 sc1 lds
    v_exp_f32 v188, v188
    v_exp_f32 v189, v189
    v_exp_f32 v190, v190
    v_smfmac_f32_16x16x64_bf16 v[236:239], a[252:255], v[176:183], v111
    s_waitcnt lgkmcnt(0)
    v_exp_f32 v191, v191
    v_exp_f32 v160, v160
    v_exp_f32 v161, v161
    v_smfmac_f32_32x32x32_bf16 v[216:231], v[84:87], v[184:191], v111
    ds_read_b128 v[64:67], v104 offset:12288
    v_exp_f32 v162, v162
    v_exp_f32 v163, v163
    v_exp_f32 v164, v164
    v_smfmac_f32_16x16x64_bf16 v[236:239], a[252:255], v[184:191], v111
    ds_read_b128 v[68:71], v104 offset:13312
    v_exp_f32 v165, v165
    v_mfma_f32_32x32x16_bf16 v[176:191], v[56:59], v[120:123], v[144:159]
    s_cmp_ge_u32 s80, s30
    v_exp_f32 v166, v166
    v_exp_f32 v167, v167
    v_exp_f32 v168, v168
    v_mfma_f32_32x32x16_bf16 v[176:191], v[60:63], v[124:127], v[176:191]
    s_cselect_b32 s80, s60, s80
    v_exp_f32 v169, v169
    v_exp_f32 v170, v170
    v_exp_f32 v171, v171
    v_smfmac_f32_32x32x32_bf16 v[200:215], v[72:75], v[160:167], v111
    buffer_load_dwordx4 v3, s[12:15], s29 offen offset:2048 sc1 lds
    v_exp_f32 v172, v172
    v_exp_f32 v173, v173
    v_exp_f32 v174, v174
    v_smfmac_f32_16x16x64_bf16 v[232:235], a[252:255], v[160:167], v111
    s_waitcnt lgkmcnt(0)
    v_exp_f32 v175, v175
    v_exp_f32 v176, v176
    v_exp_f32 v177, v177
    v_smfmac_f32_32x32x32_bf16 v[200:215], v[76:79], v[168:175], v111
    ds_read_b128 v[80:83], v104 offset:14336
    v_exp_f32 v178, v178
    v_exp_f32 v179, v179
    v_exp_f32 v180, v180
    v_smfmac_f32_16x16x64_bf16 v[232:235], a[252:255], v[168:175], v111
    ds_read_b128 v[84:87], v104 offset:15360
    v_exp_f32 v181, v181
    v_mfma_f32_32x32x16_bf16 v[160:175], v[64:67], v[112:115], v[128:143]
    s_add_u32 s81, s81, 0x8000
    v_exp_f32 v182, v182
    v_exp_f32 v183, v183
    v_exp_f32 v184, v184
    v_mfma_f32_32x32x16_bf16 v[160:175], v[68:71], v[116:119], v[160:175]
    s_and_b32 s81, s81, 0x3ffff
    v_exp_f32 v185, v185
    v_exp_f32 v186, v186
    v_exp_f32 v187, v187
    v_smfmac_f32_32x32x32_bf16 v[216:231], v[72:75], v[176:183], v111
    buffer_load_dwordx4 v3, s[12:15], s29 offen offset:3072 sc1 lds
    v_exp_f32 v188, v188
    v_exp_f32 v189, v189
    v_exp_f32 v190, v190
    v_smfmac_f32_16x16x64_bf16 v[236:239], a[252:255], v[176:183], v111
    s_waitcnt vmcnt(8) lgkmcnt(0)
    s_xor_b32 s29, s81, s57
    v_exp_f32 v191, v191
    v_exp_f32 v160, v160
    v_exp_f32 v161, v161
    v_smfmac_f32_32x32x32_bf16 v[216:231], v[76:79], v[184:191], v111
    ds_read_b128 v[56:59], v104 offset:16384
    ds_read_b64_tr_b16 v[88:89], v193 offset:0
    ds_read_b64_tr_b16 v[90:91], v194 offset:0
    v_exp_f32 v162, v162
    v_exp_f32 v163, v163
    v_exp_f32 v164, v164
    v_smfmac_f32_16x16x64_bf16 v[236:239], a[252:255], v[184:191], v111
    ds_read_b128 v[60:63], v104 offset:17408
    ds_read_b64_tr_b16 v[92:93], v193 offset:32
    ds_read_b64_tr_b16 v[94:95], v194 offset:32
    v_exp_f32 v165, v165
    v_mfma_f32_32x32x16_bf16 v[176:191], v[64:67], v[120:123], v[144:159]
    s_lshr_b32 s78, s29, 15
    v_exp_f32 v166, v166
    v_exp_f32 v167, v167
    v_exp_f32 v168, v168
    v_mfma_f32_32x32x16_bf16 v[176:191], v[68:71], v[124:127], v[176:191]
    s_lshl_b32 s78, s78, 8
    v_exp_f32 v169, v169
    v_exp_f32 v170, v170
    v_exp_f32 v171, v171
    v_smfmac_f32_32x32x32_bf16 v[200:215], v[80:83], v[160:167], v111
    buffer_load_dwordx2 v[108:109], v254, s[16:19], s78 offen sc1
    v_exp_f32 v172, v172
    v_exp_f32 v173, v173
    v_exp_f32 v174, v174
    v_smfmac_f32_16x16x64_bf16 v[232:235], a[252:255], v[160:167], v111
    s_waitcnt lgkmcnt(0)
    v_exp_f32 v175, v175
    v_exp_f32 v176, v176
    v_exp_f32 v177, v177
    v_smfmac_f32_32x32x32_bf16 v[200:215], v[84:87], v[168:175], v111
    ds_read_b128 v[72:75], v104 offset:18432
    v_exp_f32 v178, v178
    v_exp_f32 v179, v179
    v_exp_f32 v180, v180
    v_smfmac_f32_16x16x64_bf16 v[232:235], a[252:255], v[168:175], v111
    ds_read_b128 v[76:79], v104 offset:19456
    v_exp_f32 v181, v181
    v_mfma_f32_32x32x16_bf16 v[160:175], v[56:59], v[112:115], v[128:143]
    ds_read_b64_tr_b16 v[96:97], v193 offset:2048
    ds_read_b64_tr_b16 v[98:99], v194 offset:2048
    v_exp_f32 v182, v182
    v_exp_f32 v183, v183
    v_exp_f32 v184, v184
    v_mfma_f32_32x32x16_bf16 v[160:175], v[60:63], v[116:119], v[160:175]
    ds_read_b64_tr_b16 v[100:101], v193 offset:2080
    ds_read_b64_tr_b16 v[102:103], v194 offset:2080
    v_exp_f32 v185, v185
    v_exp_f32 v186, v186
    v_exp_f32 v187, v187
    v_smfmac_f32_32x32x32_bf16 v[216:231], v[80:83], v[176:183], v111
    buffer_store_dwordx4 v[88:91], v3, s[36:39], s63 offen offset:0 sc1
    v_exp_f32 v188, v188
    v_exp_f32 v189, v189
    v_exp_f32 v190, v190
    v_smfmac_f32_16x16x64_bf16 v[236:239], a[252:255], v[176:183], v111
    s_waitcnt lgkmcnt(0)
    v_exp_f32 v191, v191
    v_mfma_f32_16x16x32_bf16 a[0:3], a[8:11], v[88:91], a[0:3]
    v_exp_f32 v160, v160
    v_exp_f32 v161, v161
    v_smfmac_f32_32x32x32_bf16 v[216:231], v[84:87], v[184:191], v111
    ds_read_b128 v[64:67], v104 offset:20480
    v_exp_f32 v162, v162
    v_exp_f32 v163, v163
    v_exp_f32 v164, v164
    v_smfmac_f32_16x16x64_bf16 v[236:239], a[252:255], v[184:191], v111
    ds_read_b128 v[68:71], v104 offset:21504
    v_exp_f32 v165, v165
    v_mfma_f32_32x32x16_bf16 v[176:191], v[56:59], v[120:123], v[144:159]
    s_cmp_gt_u32 s31, 5
    v_exp_f32 v166, v166
    v_exp_f32 v167, v167
    v_exp_f32 v168, v168
    v_mfma_f32_32x32x16_bf16 v[176:191], v[60:63], v[124:127], v[176:191]
    s_cselect_b32 s26, s66, 0
    v_exp_f32 v169, v169
    v_exp_f32 v170, v170
    v_exp_f32 v171, v171
    v_smfmac_f32_32x32x32_bf16 v[200:215], v[72:75], v[160:167], v111
    buffer_store_dwordx4 v[92:95], v3, s[36:39], s63 offen offset:1024 sc1
    v_exp_f32 v172, v172
    v_exp_f32 v173, v173
    v_exp_f32 v174, v174
    v_smfmac_f32_16x16x64_bf16 v[232:235], a[252:255], v[160:167], v111
    s_waitcnt lgkmcnt(0)
    v_exp_f32 v175, v175
    v_mfma_f32_16x16x32_bf16 a[4:7], a[8:11], v[92:95], a[4:7]
    v_exp_f32 v176, v176
    v_exp_f32 v177, v177
    v_smfmac_f32_32x32x32_bf16 v[200:215], v[76:79], v[168:175], v111
    ds_read_b128 v[80:83], v104 offset:22528
    v_exp_f32 v178, v178
    v_exp_f32 v179, v179
    v_exp_f32 v180, v180
    v_smfmac_f32_16x16x64_bf16 v[232:235], a[252:255], v[168:175], v111
    ds_read_b128 v[84:87], v104 offset:23552
    v_exp_f32 v181, v181
    v_mfma_f32_32x32x16_bf16 v[160:175], v[64:67], v[112:115], v[128:143]
    buffer_store_dwordx4 v[96:99], v3, s[36:39], s64 offen offset:0 sc1
    v_exp_f32 v182, v182
    v_exp_f32 v183, v183
    v_exp_f32 v184, v184
    v_mfma_f32_32x32x16_bf16 v[160:175], v[68:71], v[116:119], v[160:175]
    s_nop 0
    v_exp_f32 v185, v185
    v_exp_f32 v186, v186
    v_exp_f32 v187, v187
    v_smfmac_f32_32x32x32_bf16 v[216:231], v[72:75], v[176:183], v111
    buffer_store_dwordx4 v[100:103], v3, s[36:39], s64 offen offset:1024 sc1
    v_exp_f32 v188, v188
    v_exp_f32 v189, v189
    v_exp_f32 v190, v190
    v_smfmac_f32_16x16x64_bf16 v[236:239], a[252:255], v[176:183], v111
    s_waitcnt lgkmcnt(0)
    v_exp_f32 v191, v191
    v_mfma_f32_16x16x32_bf16 a[0:3], a[8:11], v[96:99], a[0:3]
    v_exp_f32 v160, v160
    v_exp_f32 v161, v161
    v_smfmac_f32_32x32x32_bf16 v[216:231], v[76:79], v[184:191], v111
    ds_read_b128 v[56:59], v104 offset:24576
    v_exp_f32 v162, v162
    v_exp_f32 v163, v163
    v_exp_f32 v164, v164
    v_smfmac_f32_16x16x64_bf16 v[236:239], a[252:255], v[184:191], v111
    ds_read_b128 v[60:63], v104 offset:25600
    v_exp_f32 v165, v165
    v_mfma_f32_32x32x16_bf16 v[176:191], v[64:67], v[120:123], v[144:159]
    v_exp_f32 v166, v166
    v_exp_f32 v167, v167
    v_exp_f32 v168, v168
    v_mfma_f32_32x32x16_bf16 v[176:191], v[68:71], v[124:127], v[176:191]
    s_add_u32 m0, s87, 0
    v_exp_f32 v169, v169
    v_exp_f32 v170, v170
    v_exp_f32 v171, v171
    v_smfmac_f32_32x32x32_bf16 v[200:215], v[80:83], v[160:167], v111
    buffer_load_dwordx4 v192, s[24:27], s61 offen nt lds
    v_exp_f32 v172, v172
    v_exp_f32 v173, v173
    v_exp_f32 v174, v174
    v_smfmac_f32_16x16x64_bf16 v[232:235], a[252:255], v[160:167], v111
    s_waitcnt lgkmcnt(0)
    s_add_u32 s61, s61, s62
    v_exp_f32 v175, v175
    v_mfma_f32_16x16x32_bf16 a[4:7], a[8:11], v[100:103], a[4:7]
    v_exp_f32 v176, v176
    v_exp_f32 v177, v177
    v_smfmac_f32_32x32x32_bf16 v[200:215], v[84:87], v[168:175], v111
    ds_read_b128 v[72:75], v104 offset:26624
    v_exp_f32 v178, v178
    v_exp_f32 v179, v179
    v_exp_f32 v180, v180
    v_smfmac_f32_16x16x64_bf16 v[232:235], a[252:255], v[168:175], v111
    ds_read_b128 v[76:79], v104 offset:27648
    v_exp_f32 v181, v181
    v_mfma_f32_32x32x16_bf16 v[160:175], v[56:59], v[112:115], v[128:143]
    v_exp_f32 v182, v182
    v_exp_f32 v183, v183
    v_exp_f32 v184, v184
    v_mfma_f32_32x32x16_bf16 v[160:175], v[60:63], v[116:119], v[160:175]
    s_add_u32 m0, s87, 1024
    v_exp_f32 v185, v185
    v_exp_f32 v186, v186
    v_exp_f32 v187, v187
    v_smfmac_f32_32x32x32_bf16 v[216:231], v[80:83], v[176:183], v111
    buffer_load_dwordx4 v192, s[24:27], s61 offen nt lds
    v_exp_f32 v188, v188
    v_exp_f32 v189, v189
    v_exp_f32 v190, v190
    v_smfmac_f32_16x16x64_bf16 v[236:239], a[252:255], v[176:183], v111
    s_waitcnt lgkmcnt(0)
    s_add_u32 s61, s61, s62
    v_exp_f32 v191, v191
    v_exp_f32 v160, v160
    v_exp_f32 v161, v161
    v_smfmac_f32_32x32x32_bf16 v[216:231], v[84:87], v[184:191], v111
    ds_read_b128 v[64:67], v104 offset:28672
    v_exp_f32 v162, v162
    v_exp_f32 v163, v163
    v_exp_f32 v164, v164
    v_smfmac_f32_16x16x64_bf16 v[236:239], a[252:255], v[184:191], v111
    ds_read_b128 v[68:71], v104 offset:29696
    v_exp_f32 v165, v165
    v_mfma_f32_32x32x16_bf16 v[176:191], v[56:59], v[120:123], v[144:159]
    ds_write_b32 v196, a0
    ds_write_b32 v196, a4 offset:64
    v_exp_f32 v166, v166
    v_exp_f32 v167, v167
    v_exp_f32 v168, v168
    v_mfma_f32_32x32x16_bf16 v[176:191], v[60:63], v[124:127], v[176:191]
    s_add_u32 m0, s87, 2048
    v_exp_f32 v169, v169
    v_exp_f32 v170, v170
    v_exp_f32 v171, v171
    v_smfmac_f32_32x32x32_bf16 v[200:215], v[72:75], v[160:167], v111
    buffer_load_dwordx4 v192, s[24:27], s61 offen nt lds
    v_exp_f32 v172, v172
    v_exp_f32 v173, v173
    v_exp_f32 v174, v174
    v_smfmac_f32_16x16x64_bf16 v[232:235], a[252:255], v[160:167], v111
    s_waitcnt vmcnt(7) lgkmcnt(0)
    s_add_u32 s61, s61, s62
    v_exp_f32 v175, v175
    v_cmp_ne_u64 vcc, s[74:75], v[108:109]
    v_exp_f32 v176, v176
    v_exp_f32 v177, v177
    v_smfmac_f32_32x32x32_bf16 v[200:215], v[76:79], v[168:175], v111
    ds_read_b128 v[80:83], v104 offset:30720
    v_exp_f32 v178, v178
    v_exp_f32 v179, v179
    v_exp_f32 v180, v180
    v_smfmac_f32_16x16x64_bf16 v[232:235], a[252:255], v[168:175], v111
    ds_read_b128 v[84:87], v104 offset:31744
    s_add_u32 m0, s87, 3072
    v_exp_f32 v181, v181
    v_mfma_f32_32x32x16_bf16 v[160:175], v[64:67], v[112:115], v[128:143]
    s_cmp_lg_u64 vcc, 0
    v_exp_f32 v182, v182
    v_exp_f32 v183, v183
    v_exp_f32 v184, v184
    v_mfma_f32_32x32x16_bf16 v[160:175], v[68:71], v[116:119], v[160:175]
    s_cbranch_scc1 L_main_kernel_spin_1022
L_main_kernel_ok_1021:
    v_exp_f32 v185, v185
    v_exp_f32 v186, v186
    v_exp_f32 v187, v187
    v_smfmac_f32_32x32x32_bf16 v[216:231], v[72:75], v[176:183], v111
    buffer_load_dwordx4 v192, s[24:27], s61 offen nt lds
    v_exp_f32 v188, v188
    v_exp_f32 v189, v189
    v_exp_f32 v190, v190
    v_smfmac_f32_16x16x64_bf16 v[236:239], a[252:255], v[176:183], v111
    s_waitcnt lgkmcnt(0)
    s_barrier
    v_exp_f32 v191, v191
    v_exp_f32 v160, v160
    v_exp_f32 v161, v161
    v_smfmac_f32_32x32x32_bf16 v[216:231], v[76:79], v[184:191], v111
    ds_read_b128 v[56:59], v105 offset:0
    v_exp_f32 v162, v162
    v_exp_f32 v163, v163
    v_exp_f32 v164, v164
    v_smfmac_f32_16x16x64_bf16 v[236:239], a[252:255], v[184:191], v111
    ds_read_b128 v[60:63], v105 offset:1024
    v_exp_f32 v165, v165
    v_mfma_f32_32x32x16_bf16 v[176:191], v[64:67], v[120:123], v[144:159]
    s_sub_u32 s31, s31, 1
    v_exp_f32 v166, v166
    v_exp_f32 v167, v167
    v_exp_f32 v168, v168
    v_mfma_f32_32x32x16_bf16 v[176:191], v[68:71], v[124:127], v[176:191]
    s_mov_b32 m0, s80
    v_exp_f32 v169, v169
    v_exp_f32 v170, v170
    v_exp_f32 v171, v171
    v_smfmac_f32_32x32x32_bf16 v[200:215], v[80:83], v[160:167], v111
    buffer_load_dwordx4 v3, s[12:15], s29 offen offset:0 sc1 lds
    v_exp_f32 v172, v172
    v_exp_f32 v173, v173
    v_exp_f32 v174, v174
    v_smfmac_f32_16x16x64_bf16 v[232:235], a[252:255], v[160:167], v111
    s_waitcnt lgkmcnt(0)
    s_add_u32 s61, s61, s62
    v_exp_f32 v175, v175
    v_exp_f32 v176, v176
    v_exp_f32 v177, v177
    v_smfmac_f32_32x32x32_bf16 v[200:215], v[84:87], v[168:175], v111
    ds_read_b128 v[72:75], v105 offset:2048
    v_exp_f32 v178, v178
    v_exp_f32 v179, v179
    v_exp_f32 v180, v180
    v_smfmac_f32_16x16x64_bf16 v[232:235], a[252:255], v[168:175], v111
    ds_read_b128 v[76:79], v105 offset:3072
    v_exp_f32 v181, v181
    v_mfma_f32_32x32x16_bf16 v[160:175], v[56:59], v[112:115], v[128:143]
    v_exp_f32 v182, v182
    v_exp_f32 v183, v183
    v_exp_f32 v184, v184
    v_mfma_f32_32x32x16_bf16 v[160:175], v[60:63], v[116:119], v[160:175]
    s_nop 0
    v_exp_f32 v185, v185
    v_exp_f32 v186, v186
    v_exp_f32 v187, v187
    v_smfmac_f32_32x32x32_bf16 v[216:231], v[80:83], v[176:183], v111
    buffer_load_dwordx4 v3, s[12:15], s29 offen offset:1024 sc1 lds
    v_exp_f32 v188, v188
    v_exp_f32 v189, v189
    v_exp_f32 v190, v190
    v_smfmac_f32_16x16x64_bf16 v[236:239], a[252:255], v[176:183], v111
    s_waitcnt lgkmcnt(0)
    s_cmp_gt_u32 s31, 4
    v_exp_f32 v191, v191
    v_mov_b32 v104, v105
    v_add_u32 v105, s79, v3
    s_cbranch_scc1 L_main_kernel_aP_1019
    s_mov_b32 s24, s100
    s_mov_b32 s25, s101
    s_mov_b32 s26, 2097152
    s_mov_b32 s27, 0x20000
    s_cmp_lg_u32 s54, 0
    s_cbranch_scc1 L_main_kernel_aN_1020
    s_mov_b32 s88, 3
    v_and_b32 v8, 31, v2
    v_lshlrev_b32 v12, 4, v8
    v_lshlrev_b32 v8, 2, v8
    ds_read_b32 v16, v8 offset:16384
    ds_read_b32 v17, v8 offset:16512
    ds_read_b32 v18, v8 offset:16640
    ds_read_b32 v19, v8 offset:16768
    s_waitcnt lgkmcnt(0)
    v_add_f32 v16, v16, v17
    v_add_f32 v16, v16, v18
    v_add_f32 v16, v16, v19
    v_and_b32 v17, 0xffff0000, v16
    v_sub_f32 v17, v16, v17
    v_and_b32 v18, 0xffff0000, v17
    v_sub_f32 v18, v17, v18
    v_perm_b32 v8, v17, v16, s58
    v_perm_b32 v9, v17, v16, s58
    v_perm_b32 v10, v16, v18, s58
    v_mov_b32 v11, 0
    buffer_store_dwordx4 v[8:11], v12, s[20:23], s65 offen sc1
L_main_kernel_aN_1020:
    v_exp_f32 v160, v160
    v_exp_f32 v161, v161
    v_smfmac_f32_32x32x32_bf16 v[216:231], v[84:87], v[184:191], v111
    ds_read_b128 v[64:67], v104 offset:4096
    v_exp_f32 v162, v162
    v_exp_f32 v163, v163
    v_exp_f32 v164, v164
    v_smfmac_f32_16x16x64_bf16 v[236:239], a[252:255], v[184:191], v111
    ds_read_b128 v[68:71], v104 offset:5120
    v_exp_f32 v165, v165
    v_mfma_f32_32x32x16_bf16 v[176:191], v[56:59], v[120:123], v[144:159]
    s_add_u32 s79, s79, 0x8000
    v_exp_f32 v166, v166
    v_exp_f32 v167, v167
    v_exp_f32 v168, v168
    v_mfma_f32_32x32x16_bf16 v[176:191], v[60:63], v[124:127], v[176:191]
    s_cmp_ge_u32 s79, 0x28000
    v_exp_f32 v169, v169
    v_exp_f32 v170, v170
    v_exp_f32 v171, v171
    v_smfmac_f32_32x32x32_bf16 v[200:215], v[72:75], v[160:167], v111
    buffer_load_dwordx4 v3, s[12:15], s29 offen offset:2048 sc1 lds
    v_exp_f32 v172, v172
    v_exp_f32 v173, v173
    v_exp_f32 v174, v174
    v_smfmac_f32_16x16x64_bf16 v[232:235], a[252:255], v[160:167], v111
    s_waitcnt lgkmcnt(0)
    s_cselect_b32 s79, 0x10000, s79
    v_exp_f32 v175, v175
    v_exp_f32 v176, v176
    v_exp_f32 v177, v177
    v_smfmac_f32_32x32x32_bf16 v[200:215], v[76:79], v[168:175], v111
    ds_read_b128 v[80:83], v104 offset:6144
    v_exp_f32 v178, v178
    v_exp_f32 v179, v179
    v_exp_f32 v180, v180
    v_smfmac_f32_16x16x64_bf16 v[232:235], a[252:255], v[168:175], v111
    ds_read_b128 v[84:87], v104 offset:7168
    v_exp_f32 v181, v181
    v_mfma_f32_32x32x16_bf16 v[160:175], v[64:67], v[112:115], v[128:143]
    v_exp_f32 v182, v182
    v_exp_f32 v183, v183
    v_exp_f32 v184, v184
    v_mfma_f32_32x32x16_bf16 v[160:175], v[68:71], v[116:119], v[160:175]
    s_nop 0
    v_exp_f32 v185, v185
    v_exp_f32 v186, v186
    v_exp_f32 v187, v187
    v_smfmac_f32_32x32x32_bf16 v[216:231], v[72:75], v[176:183], v111
    buffer_load_dwordx4 v3, s[12:15], s29 offen offset:3072 sc1 lds
    v_exp_f32 v188, v188
    v_exp_f32 v189, v189
    v_exp_f32 v190, v190
    v_smfmac_f32_16x16x64_bf16 v[236:239], a[252:255], v[176:183], v111
    s_waitcnt lgkmcnt(0)
    s_add_u32 s29, s29, 4096
    v_exp_f32 v191, v191
    v_exp_f32 v160, v160
    v_exp_f32 v161, v161
    v_smfmac_f32_32x32x32_bf16 v[216:231], v[76:79], v[184:191], v111
    ds_read_b128 v[56:59], v104 offset:8192
    v_exp_f32 v162, v162
    v_exp_f32 v163, v163
    v_exp_f32 v164, v164
    v_smfmac_f32_16x16x64_bf16 v[236:239], a[252:255], v[184:191], v111
    ds_read_b128 v[60:63], v104 offset:9216
    v_exp_f32 v165, v165
    v_mfma_f32_32x32x16_bf16 v[176:191], v[64:67], v[120:123], v[144:159]
    v_exp_f32 v166, v166
    v_exp_f32 v167, v167
    v_exp_f32 v168, v168
    v_mfma_f32_32x32x16_bf16 v[176:191], v[68:71], v[124:127], v[176:191]
    s_add_u32 m0, s80, 4096
    v_exp_f32 v169, v169
    v_exp_f32 v170, v170
    v_exp_f32 v171, v171
    v_smfmac_f32_32x32x32_bf16 v[200:215], v[80:83], v[160:167], v111
    buffer_load_dwordx4 v3, s[12:15], s29 offen offset:0 sc1 lds
    v_exp_f32 v172, v172
    v_exp_f32 v173, v173
    v_exp_f32 v174, v174
    v_smfmac_f32_16x16x64_bf16 v[232:235], a[252:255], v[160:167], v111
    s_waitcnt lgkmcnt(0)
    s_add_u32 s80, s80, 0x8000
    v_exp_f32 v175, v175
    v_exp_f32 v176, v176
    v_exp_f32 v177, v177
    v_smfmac_f32_32x32x32_bf16 v[200:215], v[84:87], v[168:175], v111
    ds_read_b128 v[72:75], v104 offset:10240
    v_exp_f32 v178, v178
    v_exp_f32 v179, v179
    v_exp_f32 v180, v180
    v_smfmac_f32_16x16x64_bf16 v[232:235], a[252:255], v[168:175], v111
    ds_read_b128 v[76:79], v104 offset:11264
    v_exp_f32 v181, v181
    v_mfma_f32_32x32x16_bf16 v[160:175], v[56:59], v[112:115], v[128:143]
    v_exp_f32 v182, v182
    v_exp_f32 v183, v183
    v_exp_f32 v184, v184
    v_mfma_f32_32x32x16_bf16 v[160:175], v[60:63], v[116:119], v[160:175]
    s_sub_u32 s60, s80, 0x18000
    v_exp_f32 v185, v185
    v_exp_f32 v186, v186
    v_exp_f32 v187, v187
    v_smfmac_f32_32x32x32_bf16 v[216:231], v[80:83], v[176:183], v111
    buffer_load_dwordx4 v3, s[12:15], s29 offen offset:1024 sc1 lds
    v_exp_f32 v188, v188
    v_exp_f32 v189, v189
    v_exp_f32 v190, v190
    v_smfmac_f32_16x16x64_bf16 v[236:239], a[252:255], v[176:183], v111
    s_waitcnt lgkmcnt(0)
    v_exp_f32 v191, v191
    v_exp_f32 v160, v160
    v_exp_f32 v161, v161
    v_smfmac_f32_32x32x32_bf16 v[216:231], v[84:87], v[184:191], v111
    ds_read_b128 v[64:67], v104 offset:12288
    v_exp_f32 v162, v162
    v_exp_f32 v163, v163
    v_exp_f32 v164, v164
    v_smfmac_f32_16x16x64_bf16 v[236:239], a[252:255], v[184:191], v111
    ds_read_b128 v[68:71], v104 offset:13312
    v_exp_f32 v165, v165
    v_mfma_f32_32x32x16_bf16 v[176:191], v[56:59], v[120:123], v[144:159]
    s_cmp_ge_u32 s80, s30
    v_exp_f32 v166, v166
    v_exp_f32 v167, v167
    v_exp_f32 v168, v168
    v_mfma_f32_32x32x16_bf16 v[176:191], v[60:63], v[124:127], v[176:191]
    s_cselect_b32 s80, s60, s80
    v_exp_f32 v169, v169
    v_exp_f32 v170, v170
    v_exp_f32 v171, v171
    v_smfmac_f32_32x32x32_bf16 v[200:215], v[72:75], v[160:167], v111
    buffer_load_dwordx4 v3, s[12:15], s29 offen offset:2048 sc1 lds
    v_exp_f32 v172, v172
    v_exp_f32 v173, v173
    v_exp_f32 v174, v174
    v_smfmac_f32_16x16x64_bf16 v[232:235], a[252:255], v[160:167], v111
    s_waitcnt lgkmcnt(0)
    v_exp_f32 v175, v175
    v_exp_f32 v176, v176
    v_exp_f32 v177, v177
    v_smfmac_f32_32x32x32_bf16 v[200:215], v[76:79], v[168:175], v111
    ds_read_b128 v[80:83], v104 offset:14336
    v_exp_f32 v178, v178
    v_exp_f32 v179, v179
    v_exp_f32 v180, v180
    v_smfmac_f32_16x16x64_bf16 v[232:235], a[252:255], v[168:175], v111
    ds_read_b128 v[84:87], v104 offset:15360
    v_exp_f32 v181, v181
    v_mfma_f32_32x32x16_bf16 v[160:175], v[64:67], v[112:115], v[128:143]
    s_add_u32 s81, s81, 0x8000
    v_exp_f32 v182, v182
    v_exp_f32 v183, v183
    v_exp_f32 v184, v184
    v_mfma_f32_32x32x16_bf16 v[160:175], v[68:71], v[116:119], v[160:175]
    s_and_b32 s81, s81, 0x3ffff
    v_exp_f32 v185, v185
    v_exp_f32 v186, v186
    v_exp_f32 v187, v187
    v_smfmac_f32_32x32x32_bf16 v[216:231], v[72:75], v[176:183], v111
    buffer_load_dwordx4 v3, s[12:15], s29 offen offset:3072 sc1 lds
    v_exp_f32 v188, v188
    v_exp_f32 v189, v189
    v_exp_f32 v190, v190
    v_smfmac_f32_16x16x64_bf16 v[236:239], a[252:255], v[176:183], v111
    s_waitcnt lgkmcnt(0)
    s_xor_b32 s29, s81, s57
    v_exp_f32 v191, v191
    v_exp_f32 v160, v160
    v_exp_f32 v161, v161
    v_smfmac_f32_32x32x32_bf16 v[216:231], v[76:79], v[184:191], v111
    ds_read_b128 v[56:59], v104 offset:16384
    v_exp_f32 v162, v162
    v_exp_f32 v163, v163
    v_exp_f32 v164, v164
    v_smfmac_f32_16x16x64_bf16 v[236:239], a[252:255], v[184:191], v111
    ds_read_b128 v[60:63], v104 offset:17408
    v_exp_f32 v165, v165
    v_mfma_f32_32x32x16_bf16 v[176:191], v[64:67], v[120:123], v[144:159]
    s_lshr_b32 s78, s29, 15
    v_exp_f32 v166, v166
    v_exp_f32 v167, v167
    v_exp_f32 v168, v168
    v_mfma_f32_32x32x16_bf16 v[176:191], v[68:71], v[124:127], v[176:191]
    s_lshl_b32 s78, s78, 8
    v_exp_f32 v169, v169
    v_exp_f32 v170, v170
    v_exp_f32 v171, v171
    v_smfmac_f32_32x32x32_bf16 v[200:215], v[80:83], v[160:167], v111
    buffer_load_dwordx2 v[108:109], v254, s[16:19], s78 offen sc1
    v_exp_f32 v172, v172
    v_exp_f32 v173, v173
    v_exp_f32 v174, v174
    v_smfmac_f32_16x16x64_bf16 v[232:235], a[252:255], v[160:167], v111
    s_waitcnt lgkmcnt(0)
    v_exp_f32 v175, v175
    v_exp_f32 v176, v176
    v_exp_f32 v177, v177
    v_smfmac_f32_32x32x32_bf16 v[200:215], v[84:87], v[168:175], v111
    ds_read_b128 v[72:75], v104 offset:18432
    v_exp_f32 v178, v178
    v_exp_f32 v179, v179
    v_exp_f32 v180, v180
    v_smfmac_f32_16x16x64_bf16 v[232:235], a[252:255], v[168:175], v111
    ds_read_b128 v[76:79], v104 offset:19456
    v_exp_f32 v181, v181
    v_mfma_f32_32x32x16_bf16 v[160:175], v[56:59], v[112:115], v[128:143]
    s_cmp_le_u32 s31, 3
    v_exp_f32 v182, v182
    v_exp_f32 v183, v183
    v_exp_f32 v184, v184
    v_mfma_f32_32x32x16_bf16 v[160:175], v[60:63], v[116:119], v[160:175]
    s_cselect_b32 s33, s92, 2146435072
    v_exp_f32 v185, v185
    v_exp_f32 v186, v186
    v_exp_f32 v187, v187
    v_smfmac_f32_32x32x32_bf16 v[216:231], v[80:83], v[176:183], v111
    buffer_load_dword v248, v110, s[24:27], s33 offen
    v_exp_f32 v188, v188
    v_exp_f32 v189, v189
    v_exp_f32 v190, v190
    v_smfmac_f32_16x16x64_bf16 v[236:239], a[252:255], v[176:183], v111
    s_waitcnt lgkmcnt(0)
    s_cselect_b32 s32, 131072, 0
    v_exp_f32 v191, v191
    v_exp_f32 v160, v160
    v_exp_f32 v161, v161
    v_smfmac_f32_32x32x32_bf16 v[216:231], v[84:87], v[184:191], v111
    ds_read_b128 v[64:67], v104 offset:20480
    v_exp_f32 v162, v162
    v_exp_f32 v163, v163
    v_exp_f32 v164, v164
    v_smfmac_f32_16x16x64_bf16 v[236:239], a[252:255], v[184:191], v111
    ds_read_b128 v[68:71], v104 offset:21504
    v_exp_f32 v165, v165
    v_mfma_f32_32x32x16_bf16 v[176:191], v[56:59], v[120:123], v[144:159]
    s_add_u32 s92, s92, s32
    v_exp_f32 v166, v166
    v_exp_f32 v167, v167
    v_exp_f32 v168, v168
    v_mfma_f32_32x32x16_bf16 v[176:191], v[60:63], v[124:127], v[176:191]
    s_nop 0
    v_exp_f32 v169, v169
    v_exp_f32 v170, v170
    v_exp_f32 v171, v171
    v_smfmac_f32_32x32x32_bf16 v[200:215], v[72:75], v[160:167], v111
    s_nop 0
    v_exp_f32 v172, v172
    v_exp_f32 v173, v173
    v_exp_f32 v174, v174
    v_smfmac_f32_16x16x64_bf16 v[232:235], a[252:255], v[160:167], v111
    s_waitcnt lgkmcnt(0)
    v_exp_f32 v175, v175
    v_exp_f32 v176, v176
    v_exp_f32 v177, v177
    v_smfmac_f32_32x32x32_bf16 v[200:215], v[76:79], v[168:175], v111
    ds_read_b128 v[80:83], v104 offset:22528
    v_exp_f32 v178, v178
    v_exp_f32 v179, v179
    v_exp_f32 v180, v180
    v_smfmac_f32_16x16x64_bf16 v[232:235], a[252:255], v[168:175], v111
    ds_read_b128 v[84:87], v104 offset:23552
    v_exp_f32 v181, v181
    v_mfma_f32_32x32x16_bf16 v[160:175], v[64:67], v[112:115], v[128:143]
    v_exp_f32 v182, v182
    v_exp_f32 v183, v183
    v_exp_f32 v184, v184
    v_mfma_f32_32x32x16_bf16 v[160:175], v[68:71], v[116:119], v[160:175]
    s_nop 0
    v_exp_f32 v185, v185
    v_exp_f32 v186, v186
    v_exp_f32 v187, v187
    v_smfmac_f32_32x32x32_bf16 v[216:231], v[72:75], v[176:183], v111
    s_nop 0
    v_exp_f32 v188, v188
    v_exp_f32 v189, v189
    v_exp_f32 v190, v190
    v_smfmac_f32_16x16x64_bf16 v[236:239], a[252:255], v[176:183], v111
    s_waitcnt lgkmcnt(0)
    v_exp_f32 v191, v191
    v_exp_f32 v160, v160
    v_exp_f32 v161, v161
    v_smfmac_f32_32x32x32_bf16 v[216:231], v[76:79], v[184:191], v111
    ds_read_b128 v[56:59], v104 offset:24576
    v_exp_f32 v162, v162
    v_exp_f32 v163, v163
    v_exp_f32 v164, v164
    v_smfmac_f32_16x16x64_bf16 v[236:239], a[252:255], v[184:191], v111
    ds_read_b128 v[60:63], v104 offset:25600
    v_exp_f32 v165, v165
    v_mfma_f32_32x32x16_bf16 v[176:191], v[64:67], v[120:123], v[144:159]
    v_exp_f32 v166, v166
    v_exp_f32 v167, v167
    v_exp_f32 v168, v168
    v_mfma_f32_32x32x16_bf16 v[176:191], v[68:71], v[124:127], v[176:191]
    s_nop 0
    v_exp_f32 v169, v169
    v_exp_f32 v170, v170
    v_exp_f32 v171, v171
    v_smfmac_f32_32x32x32_bf16 v[200:215], v[80:83], v[160:167], v111
    s_nop 0
    v_exp_f32 v172, v172
    v_exp_f32 v173, v173
    v_exp_f32 v174, v174
    v_smfmac_f32_16x16x64_bf16 v[232:235], a[252:255], v[160:167], v111
    s_waitcnt lgkmcnt(0)
    v_exp_f32 v175, v175
    v_exp_f32 v176, v176
    v_exp_f32 v177, v177
    v_smfmac_f32_32x32x32_bf16 v[200:215], v[84:87], v[168:175], v111
    ds_read_b128 v[72:75], v104 offset:26624
    v_exp_f32 v178, v178
    v_exp_f32 v179, v179
    v_exp_f32 v180, v180
    v_smfmac_f32_16x16x64_bf16 v[232:235], a[252:255], v[168:175], v111
    ds_read_b128 v[76:79], v104 offset:27648
    v_exp_f32 v181, v181
    v_mfma_f32_32x32x16_bf16 v[160:175], v[56:59], v[112:115], v[128:143]
    v_exp_f32 v182, v182
    v_exp_f32 v183, v183
    v_exp_f32 v184, v184
    v_mfma_f32_32x32x16_bf16 v[160:175], v[60:63], v[116:119], v[160:175]
    s_nop 0
    v_exp_f32 v185, v185
    v_exp_f32 v186, v186
    v_exp_f32 v187, v187
    v_smfmac_f32_32x32x32_bf16 v[216:231], v[80:83], v[176:183], v111
    s_nop 0
    v_exp_f32 v188, v188
    v_exp_f32 v189, v189
    v_exp_f32 v190, v190
    v_smfmac_f32_16x16x64_bf16 v[236:239], a[252:255], v[176:183], v111
    s_waitcnt lgkmcnt(0)
    v_exp_f32 v191, v191
    v_exp_f32 v160, v160
    v_exp_f32 v161, v161
    v_smfmac_f32_32x32x32_bf16 v[216:231], v[84:87], v[184:191], v111
    ds_read_b128 v[64:67], v104 offset:28672
    v_exp_f32 v162, v162
    v_exp_f32 v163, v163
    v_exp_f32 v164, v164
    v_smfmac_f32_16x16x64_bf16 v[236:239], a[252:255], v[184:191], v111
    ds_read_b128 v[68:71], v104 offset:29696
    v_exp_f32 v165, v165
    v_mfma_f32_32x32x16_bf16 v[176:191], v[56:59], v[120:123], v[144:159]
    v_exp_f32 v166, v166
    v_exp_f32 v167, v167
    v_exp_f32 v168, v168
    v_mfma_f32_32x32x16_bf16 v[176:191], v[60:63], v[124:127], v[176:191]
    s_nop 0
    v_exp_f32 v169, v169
    v_exp_f32 v170, v170
    v_exp_f32 v171, v171
    v_smfmac_f32_32x32x32_bf16 v[200:215], v[72:75], v[160:167], v111
    s_nop 0
    v_exp_f32 v172, v172
    v_exp_f32 v173, v173
    v_exp_f32 v174, v174
    v_smfmac_f32_16x16x64_bf16 v[232:235], a[252:255], v[160:167], v111
    s_waitcnt vmcnt(1) lgkmcnt(0)
    v_exp_f32 v175, v175
    v_cmp_ne_u64 vcc, s[74:75], v[108:109]
    v_exp_f32 v176, v176
    v_exp_f32 v177, v177
    v_smfmac_f32_32x32x32_bf16 v[200:215], v[76:79], v[168:175], v111
    ds_read_b128 v[80:83], v104 offset:30720
    v_exp_f32 v178, v178
    v_exp_f32 v179, v179
    v_exp_f32 v180, v180
    v_smfmac_f32_16x16x64_bf16 v[232:235], a[252:255], v[168:175], v111
    ds_read_b128 v[84:87], v104 offset:31744
    v_exp_f32 v181, v181
    v_mfma_f32_32x32x16_bf16 v[160:175], v[64:67], v[112:115], v[128:143]
    s_cmp_lg_u64 vcc, 0
    v_exp_f32 v182, v182
    v_exp_f32 v183, v183
    v_exp_f32 v184, v184
    v_mfma_f32_32x32x16_bf16 v[160:175], v[68:71], v[116:119], v[160:175]
    s_cbranch_scc1 L_main_kernel_spin_1025
L_main_kernel_ok_1024:
    v_exp_f32 v185, v185
    v_exp_f32 v186, v186
    v_exp_f32 v187, v187
    v_smfmac_f32_32x32x32_bf16 v[216:231], v[72:75], v[176:183], v111
    s_nop 0
    v_exp_f32 v188, v188
    v_exp_f32 v189, v189
    v_exp_f32 v190, v190
    v_smfmac_f32_16x16x64_bf16 v[236:239], a[252:255], v[176:183], v111
    s_waitcnt lgkmcnt(0)
    s_barrier
    v_exp_f32 v191, v191
    v_exp_f32 v160, v160
    v_exp_f32 v161, v161
    v_smfmac_f32_32x32x32_bf16 v[216:231], v[76:79], v[184:191], v111
    ds_read_b128 v[56:59], v105 offset:0
    v_exp_f32 v162, v162
    v_exp_f32 v163, v163
    v_exp_f32 v164, v164
    v_smfmac_f32_16x16x64_bf16 v[236:239], a[252:255], v[184:191], v111
    ds_read_b128 v[60:63], v105 offset:1024
    v_exp_f32 v165, v165
    v_mfma_f32_32x32x16_bf16 v[176:191], v[64:67], v[120:123], v[144:159]
    s_sub_u32 s31, s31, 1
    v_exp_f32 v166, v166
    v_exp_f32 v167, v167
    v_exp_f32 v168, v168
    v_mfma_f32_32x32x16_bf16 v[176:191], v[68:71], v[124:127], v[176:191]
    s_mov_b32 m0, s80
    v_exp_f32 v169, v169
    v_exp_f32 v170, v170
    v_exp_f32 v171, v171
    v_smfmac_f32_32x32x32_bf16 v[200:215], v[80:83], v[160:167], v111
    buffer_load_dwordx4 v3, s[12:15], s29 offen offset:0 sc1 lds
    v_exp_f32 v172, v172
    v_exp_f32 v173, v173
    v_exp_f32 v174, v174
    v_smfmac_f32_16x16x64_bf16 v[232:235], a[252:255], v[160:167], v111
    s_waitcnt lgkmcnt(0)
    v_exp_f32 v175, v175
    v_exp_f32 v176, v176
    v_exp_f32 v177, v177
    v_smfmac_f32_32x32x32_bf16 v[200:215], v[84:87], v[168:175], v111
    ds_read_b128 v[72:75], v105 offset:2048
    v_exp_f32 v178, v178
    v_exp_f32 v179, v179
    v_exp_f32 v180, v180
    v_smfmac_f32_16x16x64_bf16 v[232:235], a[252:255], v[168:175], v111
    ds_read_b128 v[76:79], v105 offset:3072
    v_exp_f32 v181, v181
    v_mfma_f32_32x32x16_bf16 v[160:175], v[56:59], v[112:115], v[128:143]
    s_cmp_eq_u32 s31, s88
    v_exp_f32 v182, v182
    v_exp_f32 v183, v183
    v_exp_f32 v184, v184
    v_mfma_f32_32x32x16_bf16 v[160:175], v[60:63], v[116:119], v[160:175]
    s_cbranch_scc1 L_main_kernel_spec_1027
L_main_kernel_bk_1028:
    v_exp_f32 v185, v185
    v_exp_f32 v186, v186
    v_exp_f32 v187, v187
    v_smfmac_f32_32x32x32_bf16 v[216:231], v[80:83], v[176:183], v111
    buffer_load_dwordx4 v3, s[12:15], s29 offen offset:1024 sc1 lds
    v_exp_f32 v188, v188
    v_exp_f32 v189, v189
    v_exp_f32 v190, v190
    v_smfmac_f32_16x16x64_bf16 v[236:239], a[252:255], v[176:183], v111
    s_waitcnt lgkmcnt(0)
    s_cmp_gt_u32 s31, 1
    v_exp_f32 v191, v191
    v_mov_b32 v104, v105
    v_add_u32 v105, s79, v3
    s_cbranch_scc1 L_main_kernel_aN_1020
    s_lshl_b32 s85, s55, 16
    s_lshl_b32 s32, s53, 12
    s_add_u32 s85, s85, s32
    s_mov_b32 s89, 48238592
    s_add_u32 s93, s85, 4194304
    s_add_u32 s57, s85, 12582912
    s_lshl_b32 s32, s53, 7
    s_lshl_b32 s29, s54, 19
    s_add_u32 s29, s29, s32
    s_lshl_b32 s30, s54, 14
    s_lshl_b32 s81, s54, 18
    s_add_u32 s81, s81, s32
    s_lshl_b32 s80, s54, 13
    v_mov_b64 v[50:51], 0
    v_mov_b32 v52, 0x71800000
    v_mov_b64 v[192:193], -1
    v_mov_b64 v[194:195], -1
    v_exp_f32 v160, v160
    v_exp_f32 v161, v161
    v_smfmac_f32_32x32x32_bf16 v[216:231], v[84:87], v[184:191], v111
    v_exp_f32 v162, v162
    v_exp_f32 v163, v163
    v_exp_f32 v164, v164
    v_smfmac_f32_16x16x64_bf16 v[236:239], a[252:255], v[184:191], v111
    ds_read_b128 v[64:67], v104 offset:4096
    ds_read_b128 v[68:71], v104 offset:5120
    v_exp_f32 v165, v165
    v_mfma_f32_32x32x16_bf16 v[176:191], v[56:59], v[120:123], v[144:159]
    buffer_load_dwordx4 v[16:19], v3, s[20:23], s89 offen sc1
    v_exp_f32 v166, v166
    v_exp_f32 v167, v167
    v_exp_f32 v168, v168
    v_mfma_f32_32x32x16_bf16 v[176:191], v[60:63], v[124:127], v[176:191]
    s_nop 0
    v_exp_f32 v169, v169
    v_exp_f32 v170, v170
    v_exp_f32 v171, v171
    v_smfmac_f32_32x32x32_bf16 v[200:215], v[72:75], v[160:167], v111
    buffer_load_dwordx4 v[20:23], v3, s[20:23], s89 offen offset:1024 sc1
    v_exp_f32 v172, v172
    v_exp_f32 v173, v173
    v_exp_f32 v174, v174
    v_smfmac_f32_16x16x64_bf16 v[232:235], a[252:255], v[160:167], v111
    buffer_store_dwordx4 v[192:195], v3, s[20:23], s57 offen offset:0 sc1
    s_waitcnt lgkmcnt(0)
    v_exp_f32 v175, v175
    v_exp_f32 v176, v176
    v_exp_f32 v177, v177
    v_smfmac_f32_32x32x32_bf16 v[200:215], v[76:79], v[168:175], v111
    ds_read_b128 v[80:83], v104 offset:6144
    ds_read_b128 v[84:87], v104 offset:7168
    v_exp_f32 v178, v178
    v_exp_f32 v179, v179
    v_exp_f32 v180, v180
    v_smfmac_f32_16x16x64_bf16 v[232:235], a[252:255], v[168:175], v111
    ds_read_b128 v[56:59], v104 offset:8192
    ds_read_b128 v[60:63], v104 offset:9216
    v_exp_f32 v181, v181
    v_mfma_f32_32x32x16_bf16 v[160:175], v[64:67], v[112:115], v[128:143]
    buffer_store_dwordx4 v[192:195], v3, s[20:23], s57 offen offset:1024 sc1
    v_exp_f32 v182, v182
    v_exp_f32 v183, v183
    v_exp_f32 v184, v184
    v_mfma_f32_32x32x16_bf16 v[160:175], v[68:71], v[116:119], v[160:175]
    s_nop 0
    v_exp_f32 v185, v185
    v_exp_f32 v186, v186
    v_exp_f32 v187, v187
    v_smfmac_f32_32x32x32_bf16 v[216:231], v[72:75], v[176:183], v111
    buffer_store_dwordx4 v[192:195], v3, s[20:23], s57 offen offset:2048 sc1
    v_exp_f32 v188, v188
    v_exp_f32 v189, v189
    v_exp_f32 v190, v190
    v_smfmac_f32_16x16x64_bf16 v[236:239], a[252:255], v[176:183], v111
    buffer_store_dwordx4 v[192:195], v3, s[20:23], s57 offen offset:3072 sc1
    s_waitcnt lgkmcnt(0)
    v_exp_f32 v191, v191
    v_exp_f32 v160, v160
    v_exp_f32 v161, v161
    v_smfmac_f32_32x32x32_bf16 v[216:231], v[76:79], v[184:191], v111
    ds_read_b128 v[72:75], v104 offset:10240
    ds_read_b128 v[76:79], v104 offset:11264
    v_exp_f32 v162, v162
    v_exp_f32 v163, v163
    v_exp_f32 v164, v164
    v_smfmac_f32_16x16x64_bf16 v[236:239], a[252:255], v[184:191], v111
    ds_read_b128 v[64:67], v104 offset:12288
    ds_read_b128 v[68:71], v104 offset:13312
    v_exp_f32 v165, v165
    v_mfma_f32_32x32x16_bf16 v[176:191], v[56:59], v[112:115], v[128:143]
    s_add_u32 m0, s30, 0
    s_add_u32 s60, s29, 0
    buffer_load_dwordx4 v252, s[24:27], s60 offen offset:0 lds
    v_exp_f32 v166, v166
    v_exp_f32 v167, v167
    v_exp_f32 v168, v168
    v_mfma_f32_32x32x16_bf16 v[176:191], v[60:63], v[116:119], v[176:191]
    s_add_u32 s60, s29, 15360
    v_exp_f32 v169, v169
    v_exp_f32 v170, v170
    v_exp_f32 v171, v171
    v_smfmac_f32_32x32x32_bf16 v[200:215], v[80:83], v[160:167], v111
    buffer_load_dwordx4 v252, s[24:27], s60 offen offset:1024 lds
    v_exp_f32 v172, v172
    v_exp_f32 v173, v173
    v_exp_f32 v174, v174
    v_smfmac_f32_16x16x64_bf16 v[232:235], a[252:255], v[160:167], v111
    s_add_u32 s60, s29, 30720
    buffer_load_dwordx4 v252, s[24:27], s60 offen offset:2048 lds
    s_waitcnt lgkmcnt(0)
    v_exp_f32 v175, v175
    v_exp_f32 v176, v176
    v_exp_f32 v177, v177
    v_smfmac_f32_32x32x32_bf16 v[200:215], v[84:87], v[168:175], v111
    ds_read_b128 v[80:83], v104 offset:14336
    ds_read_b128 v[84:87], v104 offset:15360
    v_exp_f32 v178, v178
    v_exp_f32 v179, v179
    v_exp_f32 v180, v180
    v_smfmac_f32_16x16x64_bf16 v[232:235], a[252:255], v[168:175], v111
    ds_read_b128 v[56:59], v104 offset:16384
    ds_read_b128 v[60:63], v104 offset:17408
    v_exp_f32 v181, v181
    v_mfma_f32_32x32x16_bf16 v[160:175], v[64:67], v[112:115], v[128:143]
    s_add_u32 s60, s29, 46080
    buffer_load_dwordx4 v252, s[24:27], s60 offen offset:3072 lds
    v_exp_f32 v182, v182
    v_exp_f32 v183, v183
    v_exp_f32 v184, v184
    v_mfma_f32_32x32x16_bf16 v[160:175], v[68:71], v[116:119], v[160:175]
    s_add_u32 m0, s30, 4096
    s_add_u32 s60, s29, 131072
    v_exp_f32 v185, v185
    v_exp_f32 v186, v186
    v_exp_f32 v187, v187
    v_smfmac_f32_32x32x32_bf16 v[200:215], v[72:75], v[176:183], v111
    buffer_load_dwordx4 v252, s[24:27], s60 offen offset:0 lds
    v_exp_f32 v188, v188
    v_exp_f32 v189, v189
    v_exp_f32 v190, v190
    v_smfmac_f32_16x16x64_bf16 v[232:235], a[252:255], v[176:183], v111
    s_add_u32 s60, s29, 146432
    buffer_load_dwordx4 v252, s[24:27], s60 offen offset:1024 lds
    s_waitcnt lgkmcnt(0)
    v_exp_f32 v191, v191
    v_exp_f32 v160, v160
    v_exp_f32 v161, v161
    v_smfmac_f32_32x32x32_bf16 v[200:215], v[76:79], v[184:191], v111
    ds_read_b128 v[72:75], v104 offset:18432
    ds_read_b128 v[76:79], v104 offset:19456
    v_exp_f32 v162, v162
    v_exp_f32 v163, v163
    v_exp_f32 v164, v164
    v_smfmac_f32_16x16x64_bf16 v[232:235], a[252:255], v[184:191], v111
    ds_read_b128 v[64:67], v104 offset:20480
    ds_read_b128 v[68:71], v104 offset:21504
    v_exp_f32 v165, v165
    v_mfma_f32_32x32x16_bf16 v[176:191], v[56:59], v[112:115], v[128:143]
    s_add_u32 s60, s29, 161792
    buffer_load_dwordx4 v252, s[24:27], s60 offen offset:2048 lds
    v_exp_f32 v166, v166
    v_exp_f32 v167, v167
    v_exp_f32 v168, v168
    v_mfma_f32_32x32x16_bf16 v[176:191], v[60:63], v[116:119], v[176:191]
    s_add_u32 s60, s29, 177152
    v_exp_f32 v169, v169
    v_exp_f32 v170, v170
    v_exp_f32 v171, v171
    v_smfmac_f32_32x32x32_bf16 v[200:215], v[80:83], v[160:167], v111
    buffer_load_dwordx4 v252, s[24:27], s60 offen offset:3072 lds
    v_exp_f32 v172, v172
    v_exp_f32 v173, v173
    v_exp_f32 v174, v174
    v_smfmac_f32_16x16x64_bf16 v[232:235], a[252:255], v[160:167], v111
    s_add_u32 m0, s30, 8192
    s_add_u32 s60, s29, 262144
    buffer_load_dwordx4 v252, s[24:27], s60 offen offset:0 lds
    s_waitcnt lgkmcnt(0)
    v_exp_f32 v175, v175
    v_exp_f32 v176, v176
    v_exp_f32 v177, v177
    v_smfmac_f32_32x32x32_bf16 v[200:215], v[84:87], v[168:175], v111
    ds_read_b128 v[80:83], v104 offset:22528
    ds_read_b128 v[84:87], v104 offset:23552
    v_exp_f32 v178, v178
    v_exp_f32 v179, v179
    v_exp_f32 v180, v180
    v_smfmac_f32_16x16x64_bf16 v[232:235], a[252:255], v[168:175], v111
    ds_read_b128 v[56:59], v104 offset:24576
    ds_read_b128 v[60:63], v104 offset:25600
    v_exp_f32 v181, v181
    v_mfma_f32_32x32x16_bf16 v[160:175], v[64:67], v[112:115], v[128:143]
    s_add_u32 s60, s29, 277504
    buffer_load_dwordx4 v252, s[24:27], s60 offen offset:1024 lds
    v_exp_f32 v182, v182
    v_exp_f32 v183, v183
    v_exp_f32 v184, v184
    v_mfma_f32_32x32x16_bf16 v[160:175], v[68:71], v[116:119], v[160:175]
    s_add_u32 s60, s29, 292864
    v_exp_f32 v185, v185
    v_exp_f32 v186, v186
    v_exp_f32 v187, v187
    v_smfmac_f32_32x32x32_bf16 v[200:215], v[72:75], v[176:183], v111
    buffer_load_dwordx4 v252, s[24:27], s60 offen offset:2048 lds
    v_exp_f32 v188, v188
    v_exp_f32 v189, v189
    v_exp_f32 v190, v190
    v_smfmac_f32_16x16x64_bf16 v[232:235], a[252:255], v[176:183], v111
    s_add_u32 s60, s29, 308224
    buffer_load_dwordx4 v252, s[24:27], s60 offen offset:3072 lds
    s_waitcnt lgkmcnt(0)
    v_exp_f32 v191, v191
    s_waitcnt vmcnt(16)
    v_cmp_ne_u64 vcc, s[74:75], v[16:17]
    v_cmp_ne_u64 s[34:35], s[74:75], v[18:19]
    s_or_b64 vcc, vcc, s[34:35]
    v_cmp_ne_u64 s[34:35], s[74:75], v[20:21]
    s_or_b64 vcc, vcc, s[34:35]
    v_cmp_ne_u64 s[34:35], s[74:75], v[22:23]
    s_or_b64 vcc, vcc, s[34:35]
    s_cmp_lg_u64 vcc, 0
    s_cbranch_scc1 L_main_kernel_spin_1036
L_main_kernel_ok_1035:
    v_exp_f32 v160, v160
    v_exp_f32 v161, v161
    v_smfmac_f32_32x32x32_bf16 v[200:215], v[76:79], v[184:191], v111
    ds_read_b128 v[72:75], v104 offset:26624
    ds_read_b128 v[76:79], v104 offset:27648
    v_exp_f32 v162, v162
    v_exp_f32 v163, v163
    v_exp_f32 v164, v164
    v_smfmac_f32_16x16x64_bf16 v[232:235], a[252:255], v[184:191], v111
    ds_read_b128 v[64:67], v104 offset:28672
    ds_read_b128 v[68:71], v104 offset:29696
    v_exp_f32 v165, v165
    v_mfma_f32_32x32x16_bf16 v[176:191], v[56:59], v[112:115], v[128:143]
    s_add_u32 m0, s30, 12288
    s_add_u32 s60, s29, 393216
    buffer_load_dwordx4 v252, s[24:27], s60 offen offset:0 lds
    v_exp_f32 v166, v166
    v_exp_f32 v167, v167
    v_exp_f32 v168, v168
    v_mfma_f32_32x32x16_bf16 v[176:191], v[60:63], v[116:119], v[176:191]
    s_add_u32 s60, s29, 408576
    v_exp_f32 v169, v169
    v_exp_f32 v170, v170
    v_exp_f32 v171, v171
    v_smfmac_f32_32x32x32_bf16 v[200:215], v[80:83], v[160:167], v111
    buffer_load_dwordx4 v252, s[24:27], s60 offen offset:1024 lds
    v_exp_f32 v172, v172
    v_exp_f32 v173, v173
    v_exp_f32 v174, v174
    v_smfmac_f32_16x16x64_bf16 v[232:235], a[252:255], v[160:167], v111
    s_add_u32 s60, s29, 423936
    buffer_load_dwordx4 v252, s[24:27], s60 offen offset:2048 lds
    s_waitcnt lgkmcnt(0)
    v_exp_f32 v175, v175
    v_exp_f32 v176, v176
    v_exp_f32 v177, v177
    v_smfmac_f32_32x32x32_bf16 v[200:215], v[84:87], v[168:175], v111
    ds_read_b128 v[80:83], v104 offset:30720
    ds_read_b128 v[84:87], v104 offset:31744
    v_exp_f32 v178, v178
    v_exp_f32 v179, v179
    v_exp_f32 v180, v180
    v_smfmac_f32_16x16x64_bf16 v[232:235], a[252:255], v[168:175], v111
    ds_read_b128 v[56:59], v104 offset:4096
    ds_read_b128 v[60:63], v104 offset:5120
    v_exp_f32 v181, v181
    v_mfma_f32_32x32x16_bf16 v[160:175], v[64:67], v[112:115], v[128:143]
    s_add_u32 s60, s29, 439296
    buffer_load_dwordx4 v252, s[24:27], s60 offen offset:3072 lds
    v_exp_f32 v182, v182
    v_exp_f32 v183, v183
    v_exp_f32 v184, v184
    v_mfma_f32_32x32x16_bf16 v[160:175], v[68:71], v[116:119], v[160:175]
    s_add_u32 m0, s80, 65536
    s_add_u32 s60, s81, 65536
    v_exp_f32 v185, v185
    v_exp_f32 v186, v186
    v_exp_f32 v187, v187
    v_smfmac_f32_32x32x32_bf16 v[200:215], v[72:75], v[176:183], v111
    buffer_load_dwordx4 v252, s[24:27], s60 offen offset:0 lds
    v_exp_f32 v188, v188
    v_exp_f32 v189, v189
    v_exp_f32 v190, v190
    v_smfmac_f32_16x16x64_bf16 v[232:235], a[252:255], v[176:183], v111
    s_add_u32 s60, s81, 80896
    buffer_load_dwordx4 v252, s[24:27], s60 offen offset:1024 lds
    s_waitcnt lgkmcnt(0)
    v_exp_f32 v191, v191
    v_exp_f32 v160, v160
    v_exp_f32 v161, v161
    v_smfmac_f32_32x32x32_bf16 v[200:215], v[76:79], v[184:191], v111
    ds_read_b128 v[72:75], v104 offset:6144
    ds_read_b128 v[76:79], v104 offset:7168
    v_exp_f32 v162, v162
    v_exp_f32 v163, v163
    v_exp_f32 v164, v164
    v_smfmac_f32_16x16x64_bf16 v[232:235], a[252:255], v[184:191], v111
    ds_read_b128 v[64:67], v104 offset:8192
    ds_read_b128 v[68:71], v104 offset:9216
    v_exp_f32 v165, v165
    v_mfma_f32_32x32x16_bf16 v[176:191], v[56:59], v[120:123], v[144:159]
    s_add_u32 s60, s81, 96256
    buffer_load_dwordx4 v252, s[24:27], s60 offen offset:2048 lds
    v_exp_f32 v166, v166
    v_exp_f32 v167, v167
    v_exp_f32 v168, v168
    v_mfma_f32_32x32x16_bf16 v[176:191], v[60:63], v[124:127], v[176:191]
    s_add_u32 s60, s81, 111616
    v_exp_f32 v169, v169
    v_exp_f32 v170, v170
    v_exp_f32 v171, v171
    v_smfmac_f32_32x32x32_bf16 v[200:215], v[80:83], v[160:167], v111
    buffer_load_dwordx4 v252, s[24:27], s60 offen offset:3072 lds
    v_exp_f32 v172, v172
    v_exp_f32 v173, v173
    v_exp_f32 v174, v174
    v_smfmac_f32_16x16x64_bf16 v[232:235], a[252:255], v[160:167], v111
    s_add_u32 m0, s80, 69632
    s_add_u32 s60, s81, 196608
    buffer_load_dwordx4 v252, s[24:27], s60 offen offset:0 lds
    s_waitcnt lgkmcnt(0)
    v_exp_f32 v175, v175
    v_exp_f32 v176, v176
    v_exp_f32 v177, v177
    v_smfmac_f32_32x32x32_bf16 v[200:215], v[84:87], v[168:175], v111
    ds_read_b128 v[80:83], v104 offset:10240
    ds_read_b128 v[84:87], v104 offset:11264
    v_exp_f32 v178, v178
    v_exp_f32 v179, v179
    v_exp_f32 v180, v180
    v_smfmac_f32_16x16x64_bf16 v[232:235], a[252:255], v[168:175], v111
    ds_read_b128 v[56:59], v104 offset:12288
    ds_read_b128 v[60:63], v104 offset:13312
    v_exp_f32 v181, v181
    v_mfma_f32_32x32x16_bf16 v[160:175], v[64:67], v[120:123], v[144:159]
    s_add_u32 s60, s81, 211968
    buffer_load_dwordx4 v252, s[24:27], s60 offen offset:1024 lds
    v_exp_f32 v182, v182
    v_exp_f32 v183, v183
    v_exp_f32 v184, v184
    v_mfma_f32_32x32x16_bf16 v[160:175], v[68:71], v[124:127], v[160:175]
    s_add_u32 s60, s81, 227328
    v_exp_f32 v185, v185
    v_exp_f32 v186, v186
    v_exp_f32 v187, v187
    v_smfmac_f32_32x32x32_bf16 v[216:231], v[72:75], v[176:183], v111
    buffer_load_dwordx4 v252, s[24:27], s60 offen offset:2048 lds
    v_exp_f32 v188, v188
    v_exp_f32 v189, v189
    v_exp_f32 v190, v190
    v_smfmac_f32_16x16x64_bf16 v[236:239], a[252:255], v[176:183], v111
    s_add_u32 s60, s81, 242688
    buffer_load_dwordx4 v252, s[24:27], s60 offen offset:3072 lds
    s_waitcnt lgkmcnt(0)
    v_exp_f32 v191, v191
    v_mov_b32 v48, v232
    v_mov_b32 v49, 0
    v_pk_fma_f32 v[48:49], v[200:201], v[50:51], v[48:49]
    v_pk_fma_f32 v[48:49], v[202:203], v[50:51], v[48:49]
    v_pk_fma_f32 v[48:49], v[204:205], v[50:51], v[48:49]
    v_pk_fma_f32 v[48:49], v[206:207], v[50:51], v[48:49]
    v_pk_fma_f32 v[48:49], v[208:209], v[50:51], v[48:49]
    v_pk_fma_f32 v[48:49], v[210:211], v[50:51], v[48:49]
    v_pk_fma_f32 v[48:49], v[212:213], v[50:51], v[48:49]
    v_pk_fma_f32 v[48:49], v[214:215], v[50:51], v[48:49]
    v_add_f32 v48, v48, v49
    v_cmp_nle_f32 vcc, v48, v52
    s_cmp_lg_u64 vcc, 0
    s_cbranch_scc1 L_main_kernel_slow_1030
L_main_kernel_fin_1029:
    v_rcp_f32 v48, v232
    s_nop 0
    v_mov_b32 v49, v48
    v_pk_mul_f32 v[200:201], v[200:201], v[48:49]
    v_pk_mul_f32 v[202:203], v[202:203], v[48:49]
    v_pk_mul_f32 v[204:205], v[204:205], v[48:49]
    v_pk_mul_f32 v[206:207], v[206:207], v[48:49]
    v_cvt_pk_bf16_f32 v88, v200, v201
    v_cvt_pk_bf16_f32 v89, v202, v203
    v_cvt_pk_bf16_f32 v90, v204, v205
    v_cvt_pk_bf16_f32 v91, v206, v207
    buffer_store_dwordx4 v[88:91], v3, s[20:23], s93 offen offset:0 sc1
    v_pk_mul_f32 v[208:209], v[208:209], v[48:49]
    v_pk_mul_f32 v[210:211], v[210:211], v[48:49]
    v_pk_mul_f32 v[212:213], v[212:213], v[48:49]
    v_pk_mul_f32 v[214:215], v[214:215], v[48:49]
    v_cvt_pk_bf16_f32 v92, v208, v209
    v_cvt_pk_bf16_f32 v93, v210, v211
    v_cvt_pk_bf16_f32 v94, v212, v213
    v_cvt_pk_bf16_f32 v95, v214, v215
    buffer_store_dwordx4 v[92:95], v3, s[20:23], s93 offen offset:1024 sc1
    v_exp_f32 v160, v160
    v_exp_f32 v161, v161
    v_smfmac_f32_32x32x32_bf16 v[216:231], v[76:79], v[184:191], v111
    ds_read_b128 v[72:75], v104 offset:14336
    ds_read_b128 v[76:79], v104 offset:15360
    v_exp_f32 v162, v162
    v_exp_f32 v163, v163
    v_exp_f32 v164, v164
    v_smfmac_f32_16x16x64_bf16 v[236:239], a[252:255], v[184:191], v111
    ds_read_b128 v[64:67], v104 offset:16384
    ds_read_b128 v[68:71], v104 offset:17408
    v_exp_f32 v165, v165
    v_mfma_f32_32x32x16_bf16 v[176:191], v[56:59], v[120:123], v[144:159]
    s_add_u32 m0, s80, 98304
    s_add_u32 s60, s81, 1114112
    buffer_load_dwordx4 v252, s[24:27], s60 offen offset:0 lds
    v_exp_f32 v166, v166
    v_exp_f32 v167, v167
    v_exp_f32 v168, v168
    v_mfma_f32_32x32x16_bf16 v[176:191], v[60:63], v[124:127], v[176:191]
    s_add_u32 s60, s81, 1129472
    v_exp_f32 v169, v169
    v_exp_f32 v170, v170
    v_exp_f32 v171, v171
    v_smfmac_f32_32x32x32_bf16 v[216:231], v[80:83], v[160:167], v111
    buffer_load_dwordx4 v252, s[24:27], s60 offen offset:1024 lds
    v_exp_f32 v172, v172
    v_exp_f32 v173, v173
    v_exp_f32 v174, v174
    v_smfmac_f32_16x16x64_bf16 v[236:239], a[252:255], v[160:167], v111
    s_add_u32 s60, s81, 1144832
    buffer_load_dwordx4 v252, s[24:27], s60 offen offset:2048 lds
    s_waitcnt lgkmcnt(0)
    v_exp_f32 v175, v175
    v_exp_f32 v176, v176
    v_exp_f32 v177, v177
    v_smfmac_f32_32x32x32_bf16 v[216:231], v[84:87], v[168:175], v111
    ds_read_b128 v[80:83], v104 offset:18432
    ds_read_b128 v[84:87], v104 offset:19456
    v_exp_f32 v178, v178
    v_exp_f32 v179, v179
    v_exp_f32 v180, v180
    v_smfmac_f32_16x16x64_bf16 v[236:239], a[252:255], v[168:175], v111
    ds_read_b128 v[56:59], v104 offset:20480
    ds_read_b128 v[60:63], v104 offset:21504
    v_exp_f32 v181, v181
    v_mfma_f32_32x32x16_bf16 v[160:175], v[64:67], v[120:123], v[144:159]
    s_add_u32 s60, s81, 1160192
    buffer_load_dwordx4 v252, s[24:27], s60 offen offset:3072 lds
    v_exp_f32 v182, v182
    v_exp_f32 v183, v183
    v_exp_f32 v184, v184
    v_mfma_f32_32x32x16_bf16 v[160:175], v[68:71], v[124:127], v[160:175]
    s_add_u32 m0, s80, 102400
    s_add_u32 s60, s81, 1245184
    v_exp_f32 v185, v185
    v_exp_f32 v186, v186
    v_exp_f32 v187, v187
    v_smfmac_f32_32x32x32_bf16 v[216:231], v[72:75], v[176:183], v111
    buffer_load_dwordx4 v252, s[24:27], s60 offen offset:0 lds
    v_exp_f32 v188, v188
    v_exp_f32 v189, v189
    v_exp_f32 v190, v190
    v_smfmac_f32_16x16x64_bf16 v[236:239], a[252:255], v[176:183], v111
    s_add_u32 s60, s81, 1260544
    buffer_load_dwordx4 v252, s[24:27], s60 offen offset:1024 lds
    s_waitcnt lgkmcnt(0)
    v_exp_f32 v191, v191
    v_exp_f32 v160, v160
    v_exp_f32 v161, v161
    v_smfmac_f32_32x32x32_bf16 v[216:231], v[76:79], v[184:191], v111
    ds_read_b128 v[72:75], v104 offset:22528
    ds_read_b128 v[76:79], v104 offset:23552
    v_exp_f32 v162, v162
    v_exp_f32 v163, v163
    v_exp_f32 v164, v164
    v_smfmac_f32_16x16x64_bf16 v[236:239], a[252:255], v[184:191], v111
    ds_read_b128 v[64:67], v104 offset:24576
    ds_read_b128 v[68:71], v104 offset:25600
    v_exp_f32 v165, v165
    v_mfma_f32_32x32x16_bf16 v[176:191], v[56:59], v[120:123], v[144:159]
    s_add_u32 s60, s81, 1275904
    buffer_load_dwordx4 v252, s[24:27], s60 offen offset:2048 lds
    v_exp_f32 v166, v166
    v_exp_f32 v167, v167
    v_exp_f32 v168, v168
    v_mfma_f32_32x32x16_bf16 v[176:191], v[60:63], v[124:127], v[176:191]
    s_add_u32 s60, s81, 1291264
    v_exp_f32 v169, v169
    v_exp_f32 v170, v170
    v_exp_f32 v171, v171
    v_smfmac_f32_32x32x32_bf16 v[216:231], v[80:83], v[160:167], v111
    buffer_load_dwordx4 v252, s[24:27], s60 offen offset:3072 lds
    v_exp_f32 v172, v172
    v_exp_f32 v173, v173
    v_exp_f32 v174, v174
    v_smfmac_f32_16x16x64_bf16 v[236:239], a[252:255], v[160:167], v111
    buffer_load_dwordx4 a[228:231], v3, s[20:23], s85 offen offset:0 sc1
    s_waitcnt lgkmcnt(0)
    v_exp_f32 v175, v175
    s_lshl_b32 s83, s55, 7
    s_lshl_b32 s32, s53, 3
    s_add_u32 s83, s83, s32
    s_add_u32 s33, s83, 794624
    s_waitcnt vmcnt(9)
    s_mov_b64 exec, 1
    buffer_store_dwordx2 v[244:245], off, s[16:19], s33
    s_mov_b64 exec, -1
    v_exp_f32 v176, v176
    v_exp_f32 v177, v177
    v_smfmac_f32_32x32x32_bf16 v[216:231], v[84:87], v[168:175], v111
    ds_read_b128 v[80:83], v104 offset:26624
    ds_read_b128 v[84:87], v104 offset:27648
    v_exp_f32 v178, v178
    v_exp_f32 v179, v179
    v_exp_f32 v180, v180
    v_smfmac_f32_16x16x64_bf16 v[236:239], a[252:255], v[168:175], v111
    ds_read_b128 v[56:59], v104 offset:28672
    ds_read_b128 v[60:63], v104 offset:29696
    v_exp_f32 v181, v181
    v_mfma_f32_32x32x16_bf16 v[160:175], v[64:67], v[120:123], v[144:159]
    buffer_load_dwordx4 a[232:235], v3, s[20:23], s85 offen offset:1024 sc1
    v_exp_f32 v182, v182
    v_exp_f32 v183, v183
    v_exp_f32 v184, v184
    v_mfma_f32_32x32x16_bf16 v[160:175], v[68:71], v[124:127], v[160:175]
    s_nop 0
    v_exp_f32 v185, v185
    v_exp_f32 v186, v186
    v_exp_f32 v187, v187
    v_smfmac_f32_32x32x32_bf16 v[216:231], v[72:75], v[176:183], v111
    buffer_load_dwordx4 a[236:239], v3, s[20:23], s85 offen offset:2048 sc1
    v_exp_f32 v188, v188
    v_exp_f32 v189, v189
    v_exp_f32 v190, v190
    v_smfmac_f32_16x16x64_bf16 v[236:239], a[252:255], v[176:183], v111
    buffer_load_dwordx4 a[240:243], v3, s[20:23], s85 offen offset:3072 sc1
    s_waitcnt lgkmcnt(0)
    v_exp_f32 v191, v191
    v_exp_f32 v160, v160
    v_exp_f32 v161, v161
    v_smfmac_f32_32x32x32_bf16 v[216:231], v[76:79], v[184:191], v111
    ds_read_b128 v[72:75], v104 offset:30720
    ds_read_b128 v[76:79], v104 offset:31744
    v_exp_f32 v162, v162
    v_exp_f32 v163, v163
    v_exp_f32 v164, v164
    v_smfmac_f32_16x16x64_bf16 v[236:239], a[252:255], v[184:191], v111
    v_exp_f32 v165, v165
    v_mfma_f32_32x32x16_bf16 v[176:191], v[56:59], v[120:123], v[144:159]
    v_exp_f32 v166, v166
    v_exp_f32 v167, v167
    v_exp_f32 v168, v168
    v_mfma_f32_32x32x16_bf16 v[176:191], v[60:63], v[124:127], v[176:191]
    s_nop 0
    v_exp_f32 v169, v169
    v_exp_f32 v170, v170
    v_exp_f32 v171, v171
    v_smfmac_f32_32x32x32_bf16 v[216:231], v[80:83], v[160:167], v111
    s_nop 0
    v_exp_f32 v172, v172
    v_exp_f32 v173, v173
    v_exp_f32 v174, v174
    v_smfmac_f32_16x16x64_bf16 v[236:239], a[252:255], v[160:167], v111
    s_waitcnt lgkmcnt(0)
    v_exp_f32 v175, v175
    v_exp_f32 v176, v176
    v_exp_f32 v177, v177
    v_smfmac_f32_32x32x32_bf16 v[216:231], v[84:87], v[168:175], v111
    v_exp_f32 v178, v178
    v_exp_f32 v179, v179
    v_exp_f32 v180, v180
    v_smfmac_f32_16x16x64_bf16 v[236:239], a[252:255], v[168:175], v111
    v_exp_f32 v181, v181
    v_exp_f32 v182, v182
    v_exp_f32 v183, v183
    v_exp_f32 v184, v184
    s_nop 0
    v_exp_f32 v185, v185
    v_exp_f32 v186, v186
    v_exp_f32 v187, v187
    v_smfmac_f32_32x32x32_bf16 v[216:231], v[72:75], v[176:183], v111
    s_nop 0
    v_exp_f32 v188, v188
    v_exp_f32 v189, v189
    v_exp_f32 v190, v190
    v_smfmac_f32_16x16x64_bf16 v[236:239], a[252:255], v[176:183], v111
    s_mov_b32 s35, 794624
    buffer_load_dwordx2 v[240:241], v250, s[16:19], s35 offen sc1
    v_exp_f32 v191, v191
    s_nop 1
    v_smfmac_f32_32x32x32_bf16 v[216:231], v[76:79], v[184:191], v111
    v_smfmac_f32_16x16x64_bf16 v[236:239], a[252:255], v[184:191], v111
    s_nop 11
    v_mov_b32 v48, v236
    v_mov_b32 v49, 0
    v_pk_fma_f32 v[48:49], v[216:217], v[50:51], v[48:49]
    v_pk_fma_f32 v[48:49], v[218:219], v[50:51], v[48:49]
    v_pk_fma_f32 v[48:49], v[220:221], v[50:51], v[48:49]
    v_pk_fma_f32 v[48:49], v[222:223], v[50:51], v[48:49]
    v_pk_fma_f32 v[48:49], v[224:225], v[50:51], v[48:49]
    v_pk_fma_f32 v[48:49], v[226:227], v[50:51], v[48:49]
    v_pk_fma_f32 v[48:49], v[228:229], v[50:51], v[48:49]
    v_pk_fma_f32 v[48:49], v[230:231], v[50:51], v[48:49]
    v_add_f32 v48, v48, v49
    v_cmp_nle_f32 vcc, v48, v52
    s_cmp_lg_u64 vcc, 0
    s_cbranch_scc1 L_main_kernel_slow_1033
L_main_kernel_fin_1032:
    v_rcp_f32 v48, v236
    s_nop 0
    v_mov_b32 v49, v48
    v_pk_mul_f32 v[216:217], v[216:217], v[48:49]
    v_pk_mul_f32 v[218:219], v[218:219], v[48:49]
    v_pk_mul_f32 v[220:221], v[220:221], v[48:49]
    v_pk_mul_f32 v[222:223], v[222:223], v[48:49]
    v_cvt_pk_bf16_f32 v96, v216, v217
    v_cvt_pk_bf16_f32 v97, v218, v219
    v_cvt_pk_bf16_f32 v98, v220, v221
    v_cvt_pk_bf16_f32 v99, v222, v223
    buffer_store_dwordx4 v[96:99], v3, s[20:23], s93 offen offset:2048 sc1
    v_pk_mul_f32 v[224:225], v[224:225], v[48:49]
    v_pk_mul_f32 v[226:227], v[226:227], v[48:49]
    v_pk_mul_f32 v[228:229], v[228:229], v[48:49]
    v_pk_mul_f32 v[230:231], v[230:231], v[48:49]
    v_cvt_pk_bf16_f32 v100, v224, v225
    v_cvt_pk_bf16_f32 v101, v226, v227
    v_cvt_pk_bf16_f32 v102, v228, v229
    v_cvt_pk_bf16_f32 v103, v230, v231
    buffer_store_dwordx4 v[100:103], v3, s[20:23], s93 offen offset:3072 sc1
    s_waitcnt vmcnt(2)
    v_cmp_ne_u64 vcc, s[74:75], v[240:241]
    s_cmp_lg_u64 vcc, 0
    s_cbranch_scc1 L_main_kernel_spin_1039
L_main_kernel_ok_1038:
    s_lshl_b32 s28, s55, 16
    s_add_u32 s28, s28, 4194304
    buffer_load_dwordx4 a[0:3], v3, s[20:23], s28 offen offset:0 sc1
    buffer_load_dwordx4 a[4:7], v3, s[20:23], s28 offen offset:1024 sc1
    s_add_u32 s28, s28, 4096
    buffer_load_dwordx4 a[8:11], v3, s[20:23], s28 offen offset:0 sc1
    buffer_load_dwordx4 a[12:15], v3, s[20:23], s28 offen offset:1024 sc1
    s_add_u32 s28, s28, 4096
    buffer_load_dwordx4 a[16:19], v3, s[20:23], s28 offen offset:0 sc1
    buffer_load_dwordx4 a[20:23], v3, s[20:23], s28 offen offset:1024 sc1
    s_add_u32 s28, s28, 4096
    buffer_load_dwordx4 a[24:27], v3, s[20:23], s28 offen offset:0 sc1
    buffer_load_dwordx4 a[28:31], v3, s[20:23], s28 offen offset:1024 sc1
    s_add_u32 s28, s28, 4096
    s_mov_b64 exec, 1
    s_add_u32 s59, s83, 847872
    buffer_store_dwordx2 v[244:245], off, s[16:19], s59 sc1
    s_mov_b64 exec, -1
    v_lshrrev_b32 v108, 5, v2
    v_bfe_u32 v5, v2, 2, 2
    v_lshl_add_u32 v108, v108, 2, v5
    v_lshlrev_b32 v108, 7, v108
    v_bfe_u32 v5, v2, 3, 1
    v_lshl_add_u32 v108, v5, 6, v108
    v_bfe_u32 v5, v2, 4, 1
    v_lshl_add_u32 v108, v5, 5, v108
    v_and_b32 v5, 3, v2
    v_lshl_add_u32 v108, v5, 3, v108
    v_xor_b32 v109, 64, v108
    v_add_u32 v110, 0x10000, v108
    v_add_u32 v111, 0x10000, v109
    v_add_u32 v112, 0x20000, v108
    v_add_u32 v113, 0x20000, v109
    s_barrier
    ds_read_b64_tr_b16 v[40:41], v108 offset:0
    ds_read_b64_tr_b16 v[42:43], v108 offset:1024
    ds_read_b64_tr_b16 v[44:45], v109 offset:0
    ds_read_b64_tr_b16 v[46:47], v109 offset:1024
    ds_read_b64_tr_b16 v[48:49], v108 offset:2048
    ds_read_b64_tr_b16 v[50:51], v108 offset:3072
    ds_read_b64_tr_b16 v[52:53], v109 offset:2048
    ds_read_b64_tr_b16 v[54:55], v109 offset:3072
    ds_read_b64_tr_b16 v[56:57], v108 offset:4096
    ds_read_b64_tr_b16 v[58:59], v108 offset:5120
    ds_read_b64_tr_b16 v[60:61], v109 offset:4096
    ds_read_b64_tr_b16 v[62:63], v109 offset:5120
    ds_read_b64_tr_b16 v[64:65], v108 offset:6144
    ds_read_b64_tr_b16 v[66:67], v108 offset:7168
    s_waitcnt vmcnt(8)
    s_waitcnt lgkmcnt(12)
    v_mfma_f32_32x32x16_bf16 v[8:23], v[40:43], a[0:3], 0
    ds_read_b64_tr_b16 v[68:69], v109 offset:6144
    ds_read_b64_tr_b16 v[70:71], v109 offset:7168
    buffer_load_dwordx4 a[32:35], v3, s[20:23], s28 offen offset:0 sc1
    s_waitcnt lgkmcnt(12)
    v_mfma_f32_32x32x16_bf16 v[24:39], v[44:47], a[0:3], 0
    ds_read_b64_tr_b16 v[40:41], v108 offset:8192
    ds_read_b64_tr_b16 v[42:43], v108 offset:9216
    buffer_load_dwordx4 a[36:39], v3, s[20:23], s28 offen offset:1024 sc1
    s_add_u32 s28, s28, 4096
    s_waitcnt vmcnt(9)
    s_waitcnt lgkmcnt(12)
    v_mfma_f32_32x32x16_bf16 v[8:23], v[48:51], a[4:7], v[8:23]
    ds_read_b64_tr_b16 v[44:45], v109 offset:8192
    ds_read_b64_tr_b16 v[46:47], v109 offset:9216
    buffer_load_dwordx4 a[40:43], v3, s[20:23], s28 offen offset:0 sc1
    s_waitcnt lgkmcnt(12)
    v_mfma_f32_32x32x16_bf16 v[24:39], v[52:55], a[4:7], v[24:39]
    ds_read_b64_tr_b16 v[48:49], v108 offset:10240
    ds_read_b64_tr_b16 v[50:51], v108 offset:11264
    buffer_load_dwordx4 a[44:47], v3, s[20:23], s28 offen offset:1024 sc1
    s_add_u32 s28, s28, 4096
    s_waitcnt vmcnt(10)
    s_waitcnt lgkmcnt(12)
    v_mfma_f32_32x32x16_bf16 v[8:23], v[56:59], a[8:11], v[8:23]
    ds_read_b64_tr_b16 v[52:53], v109 offset:10240
    ds_read_b64_tr_b16 v[54:55], v109 offset:11264
    buffer_load_dwordx4 a[48:51], v3, s[20:23], s28 offen offset:0 sc1
    s_waitcnt lgkmcnt(12)
    v_mfma_f32_32x32x16_bf16 v[24:39], v[60:63], a[8:11], v[24:39]
    ds_read_b64_tr_b16 v[56:57], v108 offset:12288
    ds_read_b64_tr_b16 v[58:59], v108 offset:13312
    buffer_load_dwordx4 a[52:55], v3, s[20:23], s28 offen offset:1024 sc1
    s_add_u32 s28, s28, 4096
    s_waitcnt vmcnt(11)
    s_waitcnt lgkmcnt(12)
    v_mfma_f32_32x32x16_bf16 v[8:23], v[64:67], a[12:15], v[8:23]
    ds_read_b64_tr_b16 v[60:61], v109 offset:12288
    ds_read_b64_tr_b16 v[62:63], v109 offset:13312
    buffer_load_dwordx4 a[56:59], v3, s[20:23], s28 offen offset:0 sc1
    s_waitcnt lgkmcnt(12)
    v_mfma_f32_32x32x16_bf16 v[24:39], v[68:71], a[12:15], v[24:39]
    ds_read_b64_tr_b16 v[64:65], v108 offset:14336
    ds_read_b64_tr_b16 v[66:67], v108 offset:15360
    buffer_load_dwordx4 a[60:63], v3, s[20:23], s28 offen offset:1024 sc1
    s_add_u32 s28, s28, 4096
    s_waitcnt vmcnt(12)
    s_waitcnt lgkmcnt(12)
    v_mfma_f32_32x32x16_bf16 v[8:23], v[40:43], a[16:19], v[8:23]
    ds_read_b64_tr_b16 v[68:69], v109 offset:14336
    ds_read_b64_tr_b16 v[70:71], v109 offset:15360
    buffer_load_dwordx4 a[0:3], v3, s[20:23], s28 offen offset:0 sc1
    s_waitcnt lgkmcnt(12)
    v_mfma_f32_32x32x16_bf16 v[24:39], v[44:47], a[16:19], v[24:39]
    ds_read_b64_tr_b16 v[40:41], v108 offset:16384
    ds_read_b64_tr_b16 v[42:43], v108 offset:17408
    buffer_load_dwordx4 a[4:7], v3, s[20:23], s28 offen offset:1024 sc1
    s_add_u32 s28, s28, 4096
    s_waitcnt vmcnt(13)
    s_waitcnt lgkmcnt(12)
    v_mfma_f32_32x32x16_bf16 v[8:23], v[48:51], a[20:23], v[8:23]
    ds_read_b64_tr_b16 v[44:45], v109 offset:16384
    ds_read_b64_tr_b16 v[46:47], v109 offset:17408
    buffer_load_dwordx4 a[8:11], v3, s[20:23], s28 offen offset:0 sc1
    s_waitcnt lgkmcnt(12)
    v_mfma_f32_32x32x16_bf16 v[24:39], v[52:55], a[20:23], v[24:39]
    ds_read_b64_tr_b16 v[48:49], v108 offset:18432
    ds_read_b64_tr_b16 v[50:51], v108 offset:19456
    buffer_load_dwordx4 a[12:15], v3, s[20:23], s28 offen offset:1024 sc1
    s_add_u32 s28, s28, 4096
    s_waitcnt vmcnt(14)
    s_waitcnt lgkmcnt(12)
    v_mfma_f32_32x32x16_bf16 v[8:23], v[56:59], a[24:27], v[8:23]
    ds_read_b64_tr_b16 v[52:53], v109 offset:18432
    ds_read_b64_tr_b16 v[54:55], v109 offset:19456
    buffer_load_dwordx4 a[16:19], v3, s[20:23], s28 offen offset:0 sc1
    s_waitcnt lgkmcnt(12)
    v_mfma_f32_32x32x16_bf16 v[24:39], v[60:63], a[24:27], v[24:39]
    ds_read_b64_tr_b16 v[56:57], v108 offset:20480
    ds_read_b64_tr_b16 v[58:59], v108 offset:21504
    buffer_load_dwordx4 a[20:23], v3, s[20:23], s28 offen offset:1024 sc1
    s_add_u32 s28, s28, 4096
    s_waitcnt vmcnt(15)
    s_waitcnt lgkmcnt(12)
    v_mfma_f32_32x32x16_bf16 v[8:23], v[64:67], a[28:31], v[8:23]
    ds_read_b64_tr_b16 v[60:61], v109 offset:20480
    ds_read_b64_tr_b16 v[62:63], v109 offset:21504
    buffer_load_dwordx4 a[24:27], v3, s[20:23], s28 offen offset:0 sc1
    s_waitcnt lgkmcnt(12)
    v_mfma_f32_32x32x16_bf16 v[24:39], v[68:71], a[28:31], v[24:39]
    ds_read_b64_tr_b16 v[64:65], v108 offset:22528
    ds_read_b64_tr_b16 v[66:67], v108 offset:23552
    buffer_load_dwordx4 a[28:31], v3, s[20:23], s28 offen offset:1024 sc1
    s_add_u32 s28, s28, 4096
    s_waitcnt vmcnt(15)
    s_waitcnt lgkmcnt(12)
    v_mfma_f32_32x32x16_bf16 v[8:23], v[40:43], a[32:35], v[8:23]
    ds_read_b64_tr_b16 v[68:69], v109 offset:22528
    ds_read_b64_tr_b16 v[70:71], v109 offset:23552
    s_waitcnt lgkmcnt(12)
    v_mfma_f32_32x32x16_bf16 v[24:39], v[44:47], a[32:35], v[24:39]
    ds_read_b64_tr_b16 v[40:41], v108 offset:24576
    ds_read_b64_tr_b16 v[42:43], v108 offset:25600
    buffer_load_dwordx4 a[32:35], v3, s[20:23], s28 offen offset:0 sc1
    s_waitcnt vmcnt(15)
    s_waitcnt lgkmcnt(12)
    v_mfma_f32_32x32x16_bf16 v[8:23], v[48:51], a[36:39], v[8:23]
    ds_read_b64_tr_b16 v[44:45], v109 offset:24576
    ds_read_b64_tr_b16 v[46:47], v109 offset:25600
    s_waitcnt lgkmcnt(12)
    v_mfma_f32_32x32x16_bf16 v[24:39], v[52:55], a[36:39], v[24:39]
    ds_read_b64_tr_b16 v[48:49], v108 offset:26624
    ds_read_b64_tr_b16 v[50:51], v108 offset:27648
    buffer_load_dwordx4 a[36:39], v3, s[20:23], s28 offen offset:1024 sc1
    s_add_u32 s28, s28, 4096
    s_waitcnt vmcnt(15)
    s_waitcnt lgkmcnt(12)
    v_mfma_f32_32x32x16_bf16 v[8:23], v[56:59], a[40:43], v[8:23]
    ds_read_b64_tr_b16 v[52:53], v109 offset:26624
    ds_read_b64_tr_b16 v[54:55], v109 offset:27648
    s_waitcnt lgkmcnt(12)
    v_mfma_f32_32x32x16_bf16 v[24:39], v[60:63], a[40:43], v[24:39]
    ds_read_b64_tr_b16 v[56:57], v108 offset:28672
    ds_read_b64_tr_b16 v[58:59], v108 offset:29696
    buffer_load_dwordx4 a[40:43], v3, s[20:23], s28 offen offset:0 sc1
    s_waitcnt vmcnt(15)
    s_waitcnt lgkmcnt(12)
    v_mfma_f32_32x32x16_bf16 v[8:23], v[64:67], a[44:47], v[8:23]
    ds_read_b64_tr_b16 v[60:61], v109 offset:28672
    ds_read_b64_tr_b16 v[62:63], v109 offset:29696
    s_waitcnt lgkmcnt(12)
    v_mfma_f32_32x32x16_bf16 v[24:39], v[68:71], a[44:47], v[24:39]
    ds_read_b64_tr_b16 v[64:65], v108 offset:30720
    ds_read_b64_tr_b16 v[66:67], v108 offset:31744
    buffer_load_dwordx4 a[44:47], v3, s[20:23], s28 offen offset:1024 sc1
    s_add_u32 s28, s28, 4096
    s_waitcnt vmcnt(15)
    s_waitcnt lgkmcnt(12)
    v_mfma_f32_32x32x16_bf16 v[8:23], v[40:43], a[48:51], v[8:23]
    ds_read_b64_tr_b16 v[68:69], v109 offset:30720
    ds_read_b64_tr_b16 v[70:71], v109 offset:31744
    s_lshl_b32 s83, s55, 7
    s_lshl_b32 s32, s53, 3
    s_add_u32 s83, s83, s32
    s_add_u32 s33, s83, 827392
    s_waitcnt vmcnt(29)
    s_mov_b64 exec, 1
    buffer_store_dwordx2 v[244:245], off, s[16:19], s33
    s_mov_b64 exec, -1
    s_waitcnt lgkmcnt(12)
    v_mfma_f32_32x32x16_bf16 v[24:39], v[44:47], a[48:51], v[24:39]
    ds_read_b64_tr_b16 v[40:41], v108 offset:32768
    ds_read_b64_tr_b16 v[42:43], v108 offset:33792
    buffer_load_dwordx4 a[48:51], v3, s[20:23], s28 offen offset:0 sc1
    s_waitcnt vmcnt(15)
    s_waitcnt lgkmcnt(12)
    v_mfma_f32_32x32x16_bf16 v[8:23], v[48:51], a[52:55], v[8:23]
    ds_read_b64_tr_b16 v[44:45], v109 offset:32768
    ds_read_b64_tr_b16 v[46:47], v109 offset:33792
    s_waitcnt lgkmcnt(12)
    v_mfma_f32_32x32x16_bf16 v[24:39], v[52:55], a[52:55], v[24:39]
    ds_read_b64_tr_b16 v[48:49], v108 offset:34816
    ds_read_b64_tr_b16 v[50:51], v108 offset:35840
    buffer_load_dwordx4 a[52:55], v3, s[20:23], s28 offen offset:1024 sc1
    s_add_u32 s28, s28, 4096
    s_waitcnt vmcnt(15)
    s_waitcnt lgkmcnt(12)
    v_mfma_f32_32x32x16_bf16 v[8:23], v[56:59], a[56:59], v[8:23]
    ds_read_b64_tr_b16 v[52:53], v109 offset:34816
    ds_read_b64_tr_b16 v[54:55], v109 offset:35840
    s_waitcnt lgkmcnt(12)
    v_mfma_f32_32x32x16_bf16 v[24:39], v[60:63], a[56:59], v[24:39]
    ds_read_b64_tr_b16 v[56:57], v108 offset:36864
    ds_read_b64_tr_b16 v[58:59], v108 offset:37888
    buffer_load_dwordx4 a[56:59], v3, s[20:23], s28 offen offset:0 sc1
    s_waitcnt vmcnt(15)
    s_waitcnt lgkmcnt(12)
    v_mfma_f32_32x32x16_bf16 v[8:23], v[64:67], a[60:63], v[8:23]
    ds_read_b64_tr_b16 v[60:61], v109 offset:36864
    ds_read_b64_tr_b16 v[62:63], v109 offset:37888
    s_waitcnt lgkmcnt(12)
    v_mfma_f32_32x32x16_bf16 v[24:39], v[68:71], a[60:63], v[24:39]
    ds_read_b64_tr_b16 v[64:65], v108 offset:38912
    ds_read_b64_tr_b16 v[66:67], v108 offset:39936
    buffer_load_dwordx4 a[60:63], v3, s[20:23], s28 offen offset:1024 sc1
    s_add_u32 s28, s28, 4096
    s_waitcnt vmcnt(15)
    s_waitcnt lgkmcnt(12)
    v_mfma_f32_32x32x16_bf16 v[8:23], v[40:43], a[0:3], v[8:23]
    ds_read_b64_tr_b16 v[68:69], v109 offset:38912
    ds_read_b64_tr_b16 v[70:71], v109 offset:39936
    s_mov_b32 s35, 827392
    buffer_load_dwordx2 v[240:241], v250, s[16:19], s35 offen sc1
    s_waitcnt lgkmcnt(12)
    v_mfma_f32_32x32x16_bf16 v[24:39], v[44:47], a[0:3], v[24:39]
    ds_read_b64_tr_b16 v[40:41], v108 offset:40960
    ds_read_b64_tr_b16 v[42:43], v108 offset:41984
    s_waitcnt vmcnt(15)
    s_waitcnt lgkmcnt(12)
    v_mfma_f32_32x32x16_bf16 v[8:23], v[48:51], a[4:7], v[8:23]
    ds_read_b64_tr_b16 v[44:45], v109 offset:40960
    ds_read_b64_tr_b16 v[46:47], v109 offset:41984
    s_add_u32 m0, s87, 131072
    s_add_u32 s60, s46, 131072
    buffer_load_dwordx4 v3, s[20:23], s60 offen offset:0 lds
    s_waitcnt lgkmcnt(12)
    v_mfma_f32_32x32x16_bf16 v[24:39], v[52:55], a[4:7], v[24:39]
    ds_read_b64_tr_b16 v[48:49], v108 offset:43008
    ds_read_b64_tr_b16 v[50:51], v108 offset:44032
    buffer_load_dwordx4 v3, s[20:23], s60 offen offset:1024 lds
    s_waitcnt vmcnt(16)
    s_waitcnt lgkmcnt(12)
    v_mfma_f32_32x32x16_bf16 v[8:23], v[56:59], a[8:11], v[8:23]
    ds_read_b64_tr_b16 v[52:53], v109 offset:43008
    ds_read_b64_tr_b16 v[54:55], v109 offset:44032
    buffer_load_dwordx4 v3, s[20:23], s60 offen offset:2048 lds
    s_waitcnt lgkmcnt(12)
    v_mfma_f32_32x32x16_bf16 v[24:39], v[60:63], a[8:11], v[24:39]
    ds_read_b64_tr_b16 v[56:57], v108 offset:45056
    ds_read_b64_tr_b16 v[58:59], v108 offset:46080
    buffer_load_dwordx4 v3, s[20:23], s60 offen offset:3072 lds
    s_waitcnt vmcnt(17)
    s_waitcnt lgkmcnt(12)
    v_mfma_f32_32x32x16_bf16 v[8:23], v[64:67], a[12:15], v[8:23]
    ds_read_b64_tr_b16 v[60:61], v109 offset:45056
    ds_read_b64_tr_b16 v[62:63], v109 offset:46080
    s_add_u32 m0, s87, 147456
    s_add_u32 s60, s46, 147456
    buffer_load_dwordx4 v3, s[20:23], s60 offen offset:0 lds
    s_waitcnt lgkmcnt(12)
    v_mfma_f32_32x32x16_bf16 v[24:39], v[68:71], a[12:15], v[24:39]
    ds_read_b64_tr_b16 v[64:65], v108 offset:47104
    ds_read_b64_tr_b16 v[66:67], v108 offset:48128
    v_mfma_f32_32x32x16_bf16 v[8:23], a[244:247], a[228:231], v[8:23]
    v_mfma_f32_32x32x16_bf16 v[24:39], a[244:247], a[236:239], v[24:39]
    buffer_load_dwordx4 v3, s[20:23], s60 offen offset:1024 lds
    s_waitcnt vmcnt(18)
    s_waitcnt lgkmcnt(12)
    v_mfma_f32_32x32x16_bf16 v[8:23], v[40:43], a[16:19], v[8:23]
    ds_read_b64_tr_b16 v[68:69], v109 offset:47104
    ds_read_b64_tr_b16 v[70:71], v109 offset:48128
    v_mfma_f32_32x32x16_bf16 v[8:23], a[248:251], a[232:235], v[8:23]
    v_mfma_f32_32x32x16_bf16 v[24:39], a[248:251], a[240:243], v[24:39]
    buffer_load_dwordx4 v3, s[20:23], s60 offen offset:2048 lds
    s_waitcnt lgkmcnt(12)
    v_mfma_f32_32x32x16_bf16 v[24:39], v[44:47], a[16:19], v[24:39]
    ds_read_b64_tr_b16 v[40:41], v108 offset:49152
    ds_read_b64_tr_b16 v[42:43], v108 offset:50176
    buffer_load_dwordx4 v3, s[20:23], s60 offen offset:3072 lds
    s_waitcnt vmcnt(19)
    s_waitcnt lgkmcnt(12)
    v_mfma_f32_32x32x16_bf16 v[8:23], v[48:51], a[20:23], v[8:23]
    ds_read_b64_tr_b16 v[44:45], v109 offset:49152
    ds_read_b64_tr_b16 v[46:47], v109 offset:50176
    s_waitcnt vmcnt(8)
    v_cmp_ne_u64 vcc, s[74:75], v[240:241]
    s_cmp_lg_u64 vcc, 0
    s_cbranch_scc1 L_main_kernel_spin_1043
L_main_kernel_ok_1042:
    s_waitcnt lgkmcnt(12)
    v_mfma_f32_32x32x16_bf16 v[24:39], v[52:55], a[20:23], v[24:39]
    ds_read_b64_tr_b16 v[48:49], v108 offset:51200
    ds_read_b64_tr_b16 v[50:51], v108 offset:52224
    s_lshl_b32 s28, s55, 16
    s_add_u32 s28, s28, 4196352
    buffer_load_dwordx4 a[0:3], v3, s[20:23], s28 offen offset:0 sc1
    s_waitcnt vmcnt(19)
    s_waitcnt lgkmcnt(12)
    v_mfma_f32_32x32x16_bf16 v[8:23], v[56:59], a[24:27], v[8:23]
    ds_read_b64_tr_b16 v[52:53], v109 offset:51200
    ds_read_b64_tr_b16 v[54:55], v109 offset:52224
    buffer_load_dwordx4 a[4:7], v3, s[20:23], s28 offen offset:1024 sc1
    s_add_u32 s28, s28, 4096
    s_waitcnt lgkmcnt(12)
    v_mfma_f32_32x32x16_bf16 v[24:39], v[60:63], a[24:27], v[24:39]
    ds_read_b64_tr_b16 v[56:57], v108 offset:53248
    ds_read_b64_tr_b16 v[58:59], v108 offset:54272
    buffer_load_dwordx4 a[8:11], v3, s[20:23], s28 offen offset:0 sc1
    s_waitcnt vmcnt(20)
    s_waitcnt lgkmcnt(12)
    v_mfma_f32_32x32x16_bf16 v[8:23], v[64:67], a[28:31], v[8:23]
    ds_read_b64_tr_b16 v[60:61], v109 offset:53248
    ds_read_b64_tr_b16 v[62:63], v109 offset:54272
    buffer_load_dwordx4 a[12:15], v3, s[20:23], s28 offen offset:1024 sc1
    s_add_u32 s28, s28, 4096
    s_waitcnt lgkmcnt(12)
    v_mfma_f32_32x32x16_bf16 v[24:39], v[68:71], a[28:31], v[24:39]
    ds_read_b64_tr_b16 v[64:65], v108 offset:55296
    ds_read_b64_tr_b16 v[66:67], v108 offset:56320
    buffer_load_dwordx4 a[16:19], v3, s[20:23], s28 offen offset:0 sc1
    s_waitcnt vmcnt(21)
    s_waitcnt lgkmcnt(12)
    v_mfma_f32_32x32x16_bf16 v[8:23], v[40:43], a[32:35], v[8:23]
    ds_read_b64_tr_b16 v[68:69], v109 offset:55296
    ds_read_b64_tr_b16 v[70:71], v109 offset:56320
    buffer_load_dwordx4 a[20:23], v3, s[20:23], s28 offen offset:1024 sc1
    s_add_u32 s28, s28, 4096
    s_waitcnt lgkmcnt(12)
    v_mfma_f32_32x32x16_bf16 v[24:39], v[44:47], a[32:35], v[24:39]
    ds_read_b64_tr_b16 v[40:41], v108 offset:57344
    ds_read_b64_tr_b16 v[42:43], v108 offset:58368
    buffer_load_dwordx4 a[24:27], v3, s[20:23], s28 offen offset:0 sc1
    s_waitcnt vmcnt(22)
    s_waitcnt lgkmcnt(12)
    v_mfma_f32_32x32x16_bf16 v[8:23], v[48:51], a[36:39], v[8:23]
    ds_read_b64_tr_b16 v[44:45], v109 offset:57344
    ds_read_b64_tr_b16 v[46:47], v109 offset:58368
    buffer_load_dwordx4 a[28:31], v3, s[20:23], s28 offen offset:1024 sc1
    s_add_u32 s28, s28, 4096
    s_waitcnt lgkmcnt(12)
    v_mfma_f32_32x32x16_bf16 v[24:39], v[52:55], a[36:39], v[24:39]
    ds_read_b64_tr_b16 v[48:49], v108 offset:59392
    ds_read_b64_tr_b16 v[50:51], v108 offset:60416
    buffer_load_dwordx4 a[32:35], v3, s[20:23], s28 offen offset:0 sc1
    s_waitcnt vmcnt(23)
    s_waitcnt lgkmcnt(12)
    v_mfma_f32_32x32x16_bf16 v[8:23], v[56:59], a[40:43], v[8:23]
    ds_read_b64_tr_b16 v[52:53], v109 offset:59392
    ds_read_b64_tr_b16 v[54:55], v109 offset:60416
    buffer_load_dwordx4 a[36:39], v3, s[20:23], s28 offen offset:1024 sc1
    s_add_u32 s28, s28, 4096
    s_waitcnt lgkmcnt(12)
    v_mfma_f32_32x32x16_bf16 v[24:39], v[60:63], a[40:43], v[24:39]
    ds_read_b64_tr_b16 v[56:57], v108 offset:61440
    ds_read_b64_tr_b16 v[58:59], v108 offset:62464
    buffer_load_dwordx4 a[40:43], v3, s[20:23], s28 offen offset:0 sc1
    s_waitcnt vmcnt(24)
    s_waitcnt lgkmcnt(12)
    v_mfma_f32_32x32x16_bf16 v[8:23], v[64:67], a[44:47], v[8:23]
    ds_read_b64_tr_b16 v[60:61], v109 offset:61440
    ds_read_b64_tr_b16 v[62:63], v109 offset:62464
    s_waitcnt lgkmcnt(12)
    v_mfma_f32_32x32x16_bf16 v[24:39], v[68:71], a[44:47], v[24:39]
    ds_read_b64_tr_b16 v[64:65], v108 offset:63488
    ds_read_b64_tr_b16 v[66:67], v108 offset:64512
    buffer_load_dwordx4 a[44:47], v3, s[20:23], s28 offen offset:1024 sc1
    s_add_u32 s28, s28, 4096
    s_waitcnt vmcnt(24)
    s_waitcnt lgkmcnt(12)
    v_mfma_f32_32x32x16_bf16 v[8:23], v[40:43], a[48:51], v[8:23]
    ds_read_b64_tr_b16 v[68:69], v109 offset:63488
    ds_read_b64_tr_b16 v[70:71], v109 offset:64512
    s_waitcnt lgkmcnt(12)
    v_mfma_f32_32x32x16_bf16 v[24:39], v[44:47], a[48:51], v[24:39]
    ds_read_b64_tr_b16 v[40:41], v110 offset:0
    ds_read_b64_tr_b16 v[42:43], v110 offset:1024
    buffer_load_dwordx4 a[48:51], v3, s[20:23], s28 offen offset:0 sc1
    s_waitcnt vmcnt(24)
    s_waitcnt lgkmcnt(12)
    v_mfma_f32_32x32x16_bf16 v[8:23], v[48:51], a[52:55], v[8:23]
    ds_read_b64_tr_b16 v[44:45], v111 offset:0
    ds_read_b64_tr_b16 v[46:47], v111 offset:1024
    s_waitcnt lgkmcnt(12)
    v_mfma_f32_32x32x16_bf16 v[24:39], v[52:55], a[52:55], v[24:39]
    ds_read_b64_tr_b16 v[48:49], v110 offset:2048
    ds_read_b64_tr_b16 v[50:51], v110 offset:3072
    buffer_load_dwordx4 a[52:55], v3, s[20:23], s28 offen offset:1024 sc1
    s_add_u32 s28, s28, 4096
    s_waitcnt vmcnt(24)
    s_waitcnt lgkmcnt(12)
    v_mfma_f32_32x32x16_bf16 v[8:23], v[56:59], a[56:59], v[8:23]
    ds_read_b64_tr_b16 v[52:53], v111 offset:2048
    ds_read_b64_tr_b16 v[54:55], v111 offset:3072
    s_waitcnt lgkmcnt(12)
    v_mfma_f32_32x32x16_bf16 v[24:39], v[60:63], a[56:59], v[24:39]
    ds_read_b64_tr_b16 v[56:57], v110 offset:4096
    ds_read_b64_tr_b16 v[58:59], v110 offset:5120
    buffer_load_dwordx4 a[56:59], v3, s[20:23], s28 offen offset:0 sc1
    s_waitcnt vmcnt(24)
    s_waitcnt lgkmcnt(12)
    v_mfma_f32_32x32x16_bf16 v[8:23], v[64:67], a[60:63], v[8:23]
    ds_read_b64_tr_b16 v[60:61], v111 offset:4096
    ds_read_b64_tr_b16 v[62:63], v111 offset:5120
    s_waitcnt lgkmcnt(12)
    v_mfma_f32_32x32x16_bf16 v[24:39], v[68:71], a[60:63], v[24:39]
    ds_read_b64_tr_b16 v[64:65], v110 offset:6144
    ds_read_b64_tr_b16 v[66:67], v110 offset:7168
    buffer_load_dwordx4 a[60:63], v3, s[20:23], s28 offen offset:1024 sc1
    s_add_u32 s28, s28, 4096
    s_waitcnt vmcnt(15)
    s_waitcnt lgkmcnt(12)
    v_mfma_f32_32x32x16_bf16 v[8:23], v[40:43], a[0:3], v[8:23]
    ds_read_b64_tr_b16 v[68:69], v111 offset:6144
    ds_read_b64_tr_b16 v[70:71], v111 offset:7168
    s_waitcnt lgkmcnt(12)
    v_mfma_f32_32x32x16_bf16 v[24:39], v[44:47], a[0:3], v[24:39]
    ds_read_b64_tr_b16 v[40:41], v110 offset:8192
    ds_read_b64_tr_b16 v[42:43], v110 offset:9216
    buffer_load_dwordx4 a[0:3], v3, s[20:23], s28 offen offset:0 sc1
    s_waitcnt vmcnt(15)
    s_waitcnt lgkmcnt(12)
    v_mfma_f32_32x32x16_bf16 v[8:23], v[48:51], a[4:7], v[8:23]
    ds_read_b64_tr_b16 v[44:45], v111 offset:8192
    ds_read_b64_tr_b16 v[46:47], v111 offset:9216
    s_waitcnt lgkmcnt(12)
    v_mfma_f32_32x32x16_bf16 v[24:39], v[52:55], a[4:7], v[24:39]
    ds_read_b64_tr_b16 v[48:49], v110 offset:10240
    ds_read_b64_tr_b16 v[50:51], v110 offset:11264
    buffer_load_dwordx4 a[4:7], v3, s[20:23], s28 offen offset:1024 sc1
    s_add_u32 s28, s28, 4096
    s_waitcnt vmcnt(15)
    s_waitcnt lgkmcnt(12)
    v_mfma_f32_32x32x16_bf16 v[8:23], v[56:59], a[8:11], v[8:23]
    ds_read_b64_tr_b16 v[52:53], v111 offset:10240
    ds_read_b64_tr_b16 v[54:55], v111 offset:11264
    s_waitcnt lgkmcnt(12)
    v_mfma_f32_32x32x16_bf16 v[24:39], v[60:63], a[8:11], v[24:39]
    ds_read_b64_tr_b16 v[56:57], v110 offset:12288
    ds_read_b64_tr_b16 v[58:59], v110 offset:13312
    buffer_load_dwordx4 a[8:11], v3, s[20:23], s28 offen offset:0 sc1
    s_waitcnt vmcnt(15)
    s_waitcnt lgkmcnt(12)
    v_mfma_f32_32x32x16_bf16 v[8:23], v[64:67], a[12:15], v[8:23]
    ds_read_b64_tr_b16 v[60:61], v111 offset:12288
    ds_read_b64_tr_b16 v[62:63], v111 offset:13312
    s_waitcnt lgkmcnt(12)
    v_mfma_f32_32x32x16_bf16 v[24:39], v[68:71], a[12:15], v[24:39]
    ds_read_b64_tr_b16 v[64:65], v110 offset:14336
    ds_read_b64_tr_b16 v[66:67], v110 offset:15360
    buffer_load_dwordx4 a[12:15], v3, s[20:23], s28 offen offset:1024 sc1
    s_add_u32 s28, s28, 4096
    s_waitcnt vmcnt(15)
    s_waitcnt lgkmcnt(12)
    v_mfma_f32_32x32x16_bf16 v[8:23], v[40:43], a[16:19], v[8:23]
    ds_read_b64_tr_b16 v[68:69], v111 offset:14336
    ds_read_b64_tr_b16 v[70:71], v111 offset:15360
    s_waitcnt lgkmcnt(12)
    v_mfma_f32_32x32x16_bf16 v[24:39], v[44:47], a[16:19], v[24:39]
    ds_read_b64_tr_b16 v[40:41], v110 offset:16384
    ds_read_b64_tr_b16 v[42:43], v110 offset:17408
    buffer_load_dwordx4 a[16:19], v3, s[20:23], s28 offen offset:0 sc1
    s_waitcnt vmcnt(15)
    s_waitcnt lgkmcnt(12)
    v_mfma_f32_32x32x16_bf16 v[8:23], v[48:51], a[20:23], v[8:23]
    ds_read_b64_tr_b16 v[44:45], v111 offset:16384
    ds_read_b64_tr_b16 v[46:47], v111 offset:17408
    s_waitcnt lgkmcnt(12)
    v_mfma_f32_32x32x16_bf16 v[24:39], v[52:55], a[20:23], v[24:39]
    ds_read_b64_tr_b16 v[48:49], v110 offset:18432
    ds_read_b64_tr_b16 v[50:51], v110 offset:19456
    buffer_load_dwordx4 a[20:23], v3, s[20:23], s28 offen offset:1024 sc1
    s_add_u32 s28, s28, 4096
    s_waitcnt vmcnt(15)
    s_waitcnt lgkmcnt(12)
    v_mfma_f32_32x32x16_bf16 v[8:23], v[56:59], a[24:27], v[8:23]
    ds_read_b64_tr_b16 v[52:53], v111 offset:18432
    ds_read_b64_tr_b16 v[54:55], v111 offset:19456
    s_waitcnt lgkmcnt(12)
    v_mfma_f32_32x32x16_bf16 v[24:39], v[60:63], a[24:27], v[24:39]
    ds_read_b64_tr_b16 v[56:57], v110 offset:20480
    ds_read_b64_tr_b16 v[58:59], v110 offset:21504
    buffer_load_dwordx4 a[24:27], v3, s[20:23], s28 offen offset:0 sc1
    s_waitcnt vmcnt(15)
    s_waitcnt lgkmcnt(12)
    v_mfma_f32_32x32x16_bf16 v[8:23], v[64:67], a[28:31], v[8:23]
    ds_read_b64_tr_b16 v[60:61], v111 offset:20480
    ds_read_b64_tr_b16 v[62:63], v111 offset:21504
    s_waitcnt lgkmcnt(12)
    v_mfma_f32_32x32x16_bf16 v[24:39], v[68:71], a[28:31], v[24:39]
    ds_read_b64_tr_b16 v[64:65], v110 offset:22528
    ds_read_b64_tr_b16 v[66:67], v110 offset:23552
    buffer_load_dwordx4 a[28:31], v3, s[20:23], s28 offen offset:1024 sc1
    s_add_u32 s28, s28, 4096
    s_waitcnt vmcnt(15)
    s_waitcnt lgkmcnt(12)
    v_mfma_f32_32x32x16_bf16 v[8:23], v[40:43], a[32:35], v[8:23]
    ds_read_b64_tr_b16 v[68:69], v111 offset:22528
    ds_read_b64_tr_b16 v[70:71], v111 offset:23552
    s_waitcnt lgkmcnt(12)
    v_mfma_f32_32x32x16_bf16 v[24:39], v[44:47], a[32:35], v[24:39]
    ds_read_b64_tr_b16 v[40:41], v110 offset:24576
    ds_read_b64_tr_b16 v[42:43], v110 offset:25600
    buffer_load_dwordx4 a[32:35], v3, s[20:23], s28 offen offset:0 sc1
    s_waitcnt vmcnt(15)
    s_waitcnt lgkmcnt(12)
    v_mfma_f32_32x32x16_bf16 v[8:23], v[48:51], a[36:39], v[8:23]
    ds_read_b64_tr_b16 v[44:45], v111 offset:24576
    ds_read_b64_tr_b16 v[46:47], v111 offset:25600
    s_waitcnt lgkmcnt(12)
    v_mfma_f32_32x32x16_bf16 v[24:39], v[52:55], a[36:39], v[24:39]
    ds_read_b64_tr_b16 v[48:49], v110 offset:26624
    ds_read_b64_tr_b16 v[50:51], v110 offset:27648
    buffer_load_dwordx4 a[36:39], v3, s[20:23], s28 offen offset:1024 sc1
    s_add_u32 s28, s28, 4096
    s_waitcnt vmcnt(15)
    s_waitcnt lgkmcnt(12)
    v_mfma_f32_32x32x16_bf16 v[8:23], v[56:59], a[40:43], v[8:23]
    ds_read_b64_tr_b16 v[52:53], v111 offset:26624
    ds_read_b64_tr_b16 v[54:55], v111 offset:27648
    s_waitcnt lgkmcnt(12)
    v_mfma_f32_32x32x16_bf16 v[24:39], v[60:63], a[40:43], v[24:39]
    ds_read_b64_tr_b16 v[56:57], v110 offset:28672
    ds_read_b64_tr_b16 v[58:59], v110 offset:29696
    buffer_load_dwordx4 a[40:43], v3, s[20:23], s28 offen offset:0 sc1
    s_waitcnt vmcnt(15)
    s_waitcnt lgkmcnt(12)
    v_mfma_f32_32x32x16_bf16 v[8:23], v[64:67], a[44:47], v[8:23]
    ds_read_b64_tr_b16 v[60:61], v111 offset:28672
    ds_read_b64_tr_b16 v[62:63], v111 offset:29696
    s_waitcnt lgkmcnt(12)
    v_mfma_f32_32x32x16_bf16 v[24:39], v[68:71], a[44:47], v[24:39]
    ds_read_b64_tr_b16 v[64:65], v110 offset:30720
    ds_read_b64_tr_b16 v[66:67], v110 offset:31744
    buffer_load_dwordx4 a[44:47], v3, s[20:23], s28 offen offset:1024 sc1
    s_add_u32 s28, s28, 4096
    s_waitcnt vmcnt(15)
    s_waitcnt lgkmcnt(12)
    v_mfma_f32_32x32x16_bf16 v[8:23], v[40:43], a[48:51], v[8:23]
    ds_read_b64_tr_b16 v[68:69], v111 offset:30720
    ds_read_b64_tr_b16 v[70:71], v111 offset:31744
    s_waitcnt lgkmcnt(12)
    v_mfma_f32_32x32x16_bf16 v[24:39], v[44:47], a[48:51], v[24:39]
    ds_read_b64_tr_b16 v[40:41], v110 offset:32768
    ds_read_b64_tr_b16 v[42:43], v110 offset:33792
    buffer_load_dwordx4 a[48:51], v3, s[20:23], s28 offen offset:0 sc1
    s_waitcnt vmcnt(15)
    s_waitcnt lgkmcnt(12)
    v_mfma_f32_32x32x16_bf16 v[8:23], v[48:51], a[52:55], v[8:23]
    ds_read_b64_tr_b16 v[44:45], v111 offset:32768
    ds_read_b64_tr_b16 v[46:47], v111 offset:33792
    s_waitcnt lgkmcnt(12)
    v_mfma_f32_32x32x16_bf16 v[24:39], v[52:55], a[52:55], v[24:39]
    ds_read_b64_tr_b16 v[48:49], v110 offset:34816
    ds_read_b64_tr_b16 v[50:51], v110 offset:35840
    buffer_load_dwordx4 a[52:55], v3, s[20:23], s28 offen offset:1024 sc1
    s_add_u32 s28, s28, 4096
    s_waitcnt vmcnt(15)
    s_waitcnt lgkmcnt(12)
    v_mfma_f32_32x32x16_bf16 v[8:23], v[56:59], a[56:59], v[8:23]
    ds_read_b64_tr_b16 v[52:53], v111 offset:34816
    ds_read_b64_tr_b16 v[54:55], v111 offset:35840
    s_waitcnt lgkmcnt(12)
    v_mfma_f32_32x32x16_bf16 v[24:39], v[60:63], a[56:59], v[24:39]
    ds_read_b64_tr_b16 v[56:57], v110 offset:36864
    ds_read_b64_tr_b16 v[58:59], v110 offset:37888
    buffer_load_dwordx4 a[56:59], v3, s[20:23], s28 offen offset:0 sc1
    s_waitcnt vmcnt(15)
    s_waitcnt lgkmcnt(12)
    v_mfma_f32_32x32x16_bf16 v[8:23], v[64:67], a[60:63], v[8:23]
    ds_read_b64_tr_b16 v[60:61], v111 offset:36864
    ds_read_b64_tr_b16 v[62:63], v111 offset:37888
    s_waitcnt lgkmcnt(12)
    v_mfma_f32_32x32x16_bf16 v[24:39], v[68:71], a[60:63], v[24:39]
    ds_read_b64_tr_b16 v[64:65], v110 offset:38912
    ds_read_b64_tr_b16 v[66:67], v110 offset:39936
    buffer_load_dwordx4 a[60:63], v3, s[20:23], s28 offen offset:1024 sc1
    s_add_u32 s28, s28, 4096
    s_waitcnt vmcnt(15)
    s_waitcnt lgkmcnt(12)
    v_mfma_f32_32x32x16_bf16 v[8:23], v[40:43], a[0:3], v[8:23]
    ds_read_b64_tr_b16 v[68:69], v111 offset:38912
    ds_read_b64_tr_b16 v[70:71], v111 offset:39936
    s_waitcnt lgkmcnt(12)
    v_mfma_f32_32x32x16_bf16 v[24:39], v[44:47], a[0:3], v[24:39]
    ds_read_b64_tr_b16 v[40:41], v110 offset:40960
    ds_read_b64_tr_b16 v[42:43], v110 offset:41984
    s_waitcnt vmcnt(14)
    s_waitcnt lgkmcnt(12)
    v_mfma_f32_32x32x16_bf16 v[8:23], v[48:51], a[4:7], v[8:23]
    ds_read_b64_tr_b16 v[44:45], v111 offset:40960
    ds_read_b64_tr_b16 v[46:47], v111 offset:41984
    s_mov_b64 exec, 1
    s_add_u32 s59, s83, 880640
    buffer_store_dwordx2 v[244:245], off, s[16:19], s59 sc1
    s_mov_b64 exec, -1
    s_waitcnt lgkmcnt(12)
    v_mfma_f32_32x32x16_bf16 v[24:39], v[52:55], a[4:7], v[24:39]
    ds_read_b64_tr_b16 v[48:49], v110 offset:43008
    ds_read_b64_tr_b16 v[50:51], v110 offset:44032
    s_waitcnt vmcnt(14)
    s_waitcnt lgkmcnt(12)
    v_mfma_f32_32x32x16_bf16 v[8:23], v[56:59], a[8:11], v[8:23]
    ds_read_b64_tr_b16 v[52:53], v111 offset:43008
    ds_read_b64_tr_b16 v[54:55], v111 offset:44032
    s_waitcnt lgkmcnt(12)
    v_mfma_f32_32x32x16_bf16 v[24:39], v[60:63], a[8:11], v[24:39]
    ds_read_b64_tr_b16 v[56:57], v110 offset:45056
    ds_read_b64_tr_b16 v[58:59], v110 offset:46080
    s_waitcnt vmcnt(13)
    s_waitcnt lgkmcnt(12)
    v_mfma_f32_32x32x16_bf16 v[8:23], v[64:67], a[12:15], v[8:23]
    ds_read_b64_tr_b16 v[60:61], v111 offset:45056
    ds_read_b64_tr_b16 v[62:63], v111 offset:46080
    s_waitcnt lgkmcnt(12)
    v_mfma_f32_32x32x16_bf16 v[24:39], v[68:71], a[12:15], v[24:39]
    ds_read_b64_tr_b16 v[64:65], v110 offset:47104
    ds_read_b64_tr_b16 v[66:67], v110 offset:48128
    s_waitcnt vmcnt(12)
    s_waitcnt lgkmcnt(12)
    v_mfma_f32_32x32x16_bf16 v[8:23], v[40:43], a[16:19], v[8:23]
    ds_read_b64_tr_b16 v[68:69], v111 offset:47104
    ds_read_b64_tr_b16 v[70:71], v111 offset:48128
    s_waitcnt lgkmcnt(12)
    v_mfma_f32_32x32x16_bf16 v[24:39], v[44:47], a[16:19], v[24:39]
    ds_read_b64_tr_b16 v[40:41], v110 offset:49152
    ds_read_b64_tr_b16 v[42:43], v110 offset:50176
    s_waitcnt vmcnt(11)
    s_waitcnt lgkmcnt(12)
    v_mfma_f32_32x32x16_bf16 v[8:23], v[48:51], a[20:23], v[8:23]
    ds_read_b64_tr_b16 v[44:45], v111 offset:49152
    ds_read_b64_tr_b16 v[46:47], v111 offset:50176
    s_waitcnt lgkmcnt(12)
    v_mfma_f32_32x32x16_bf16 v[24:39], v[52:55], a[20:23], v[24:39]
    ds_read_b64_tr_b16 v[48:49], v110 offset:51200
    ds_read_b64_tr_b16 v[50:51], v110 offset:52224
    s_waitcnt vmcnt(10)
    s_waitcnt lgkmcnt(12)
    v_mfma_f32_32x32x16_bf16 v[8:23], v[56:59], a[24:27], v[8:23]
    ds_read_b64_tr_b16 v[52:53], v111 offset:51200
    ds_read_b64_tr_b16 v[54:55], v111 offset:52224
    s_waitcnt lgkmcnt(12)
    v_mfma_f32_32x32x16_bf16 v[24:39], v[60:63], a[24:27], v[24:39]
    ds_read_b64_tr_b16 v[56:57], v110 offset:53248
    ds_read_b64_tr_b16 v[58:59], v110 offset:54272
    s_waitcnt vmcnt(9)
    s_waitcnt lgkmcnt(12)
    v_mfma_f32_32x32x16_bf16 v[8:23], v[64:67], a[28:31], v[8:23]
    ds_read_b64_tr_b16 v[60:61], v111 offset:53248
    ds_read_b64_tr_b16 v[62:63], v111 offset:54272
    s_waitcnt lgkmcnt(12)
    v_mfma_f32_32x32x16_bf16 v[24:39], v[68:71], a[28:31], v[24:39]
    ds_read_b64_tr_b16 v[64:65], v110 offset:55296
    ds_read_b64_tr_b16 v[66:67], v110 offset:56320
    s_waitcnt vmcnt(8)
    s_waitcnt lgkmcnt(12)
    v_mfma_f32_32x32x16_bf16 v[8:23], v[40:43], a[32:35], v[8:23]
    ds_read_b64_tr_b16 v[68:69], v111 offset:55296
    ds_read_b64_tr_b16 v[70:71], v111 offset:56320
    s_waitcnt lgkmcnt(12)
    v_mfma_f32_32x32x16_bf16 v[24:39], v[44:47], a[32:35], v[24:39]
    ds_read_b64_tr_b16 v[40:41], v110 offset:57344
    ds_read_b64_tr_b16 v[42:43], v110 offset:58368
    s_waitcnt vmcnt(7)
    s_waitcnt lgkmcnt(12)
    v_mfma_f32_32x32x16_bf16 v[8:23], v[48:51], a[36:39], v[8:23]
    ds_read_b64_tr_b16 v[44:45], v111 offset:57344
    ds_read_b64_tr_b16 v[46:47], v111 offset:58368
    s_waitcnt lgkmcnt(12)
    v_mfma_f32_32x32x16_bf16 v[24:39], v[52:55], a[36:39], v[24:39]
    ds_read_b64_tr_b16 v[48:49], v110 offset:59392
    ds_read_b64_tr_b16 v[50:51], v110 offset:60416
    s_waitcnt vmcnt(6)
    s_waitcnt lgkmcnt(12)
    v_mfma_f32_32x32x16_bf16 v[8:23], v[56:59], a[40:43], v[8:23]
    ds_read_b64_tr_b16 v[52:53], v111 offset:59392
    ds_read_b64_tr_b16 v[54:55], v111 offset:60416
    s_waitcnt lgkmcnt(12)
    v_mfma_f32_32x32x16_bf16 v[24:39], v[60:63], a[40:43], v[24:39]
    ds_read_b64_tr_b16 v[56:57], v110 offset:61440
    ds_read_b64_tr_b16 v[58:59], v110 offset:62464
    s_waitcnt vmcnt(5)
    s_waitcnt lgkmcnt(12)
    v_mfma_f32_32x32x16_bf16 v[8:23], v[64:67], a[44:47], v[8:23]
    ds_read_b64_tr_b16 v[60:61], v111 offset:61440
    ds_read_b64_tr_b16 v[62:63], v111 offset:62464
    s_waitcnt lgkmcnt(12)
    v_mfma_f32_32x32x16_bf16 v[24:39], v[68:71], a[44:47], v[24:39]
    ds_read_b64_tr_b16 v[64:65], v110 offset:63488
    ds_read_b64_tr_b16 v[66:67], v110 offset:64512
    s_waitcnt vmcnt(4)
    s_waitcnt lgkmcnt(12)
    v_mfma_f32_32x32x16_bf16 v[8:23], v[40:43], a[48:51], v[8:23]
    ds_read_b64_tr_b16 v[68:69], v111 offset:63488
    ds_read_b64_tr_b16 v[70:71], v111 offset:64512
    s_waitcnt lgkmcnt(12)
    v_mfma_f32_32x32x16_bf16 v[24:39], v[44:47], a[48:51], v[24:39]
    s_waitcnt vmcnt(3)
    s_waitcnt lgkmcnt(10)
    v_mfma_f32_32x32x16_bf16 v[8:23], v[48:51], a[52:55], v[8:23]
    s_waitcnt lgkmcnt(8)
    v_mfma_f32_32x32x16_bf16 v[24:39], v[52:55], a[52:55], v[24:39]
    s_waitcnt vmcnt(2)
    s_waitcnt lgkmcnt(6)
    v_mfma_f32_32x32x16_bf16 v[8:23], v[56:59], a[56:59], v[8:23]
    s_waitcnt lgkmcnt(4)
    v_mfma_f32_32x32x16_bf16 v[24:39], v[60:63], a[56:59], v[24:39]
    s_waitcnt vmcnt(1)
    s_waitcnt lgkmcnt(2)
    v_mfma_f32_32x32x16_bf16 v[8:23], v[64:67], a[60:63], v[8:23]
    s_waitcnt lgkmcnt(0)
    v_mfma_f32_32x32x16_bf16 v[24:39], v[68:71], a[60:63], v[24:39]
    v_mov_b32 v88, 0
    v_mov_b32 v89, 0
    v_mov_b32 v90, 0x3f803f80
    v_and_b32 v5, 31, v2
    v_lshlrev_b32 v5, 3, v5
    s_lshl_b32 s35, s55, 16
    s_lshl_b32 s33, s53, 12
    s_add_u32 s35, s35, s33
    s_add_u32 s35, s35, 8388608
    s_lshl_b32 s34, s53, 14
    s_lshl_b32 s33, s55, 8
    s_add_u32 s34, s34, s33
    s_add_u32 s34, s34, 524288
    v_cvt_pk_bf16_f32 v72, v8, v9
    v_cvt_pk_bf16_f32 v73, v10, v11
    v_cvt_pk_bf16_f32 v74, v12, v13
    v_cvt_pk_bf16_f32 v75, v14, v15
    v_cvt_pk_bf16_f32 v76, v16, v17
    v_cvt_pk_bf16_f32 v77, v18, v19
    v_cvt_pk_bf16_f32 v78, v20, v21
    v_cvt_pk_bf16_f32 v79, v22, v23
    v_cvt_pk_bf16_f32 v80, v24, v25
    v_cvt_pk_bf16_f32 v81, v26, v27
    v_cvt_pk_bf16_f32 v82, v28, v29
    v_cvt_pk_bf16_f32 v83, v30, v31
    v_cvt_pk_bf16_f32 v84, v32, v33
    v_cvt_pk_bf16_f32 v85, v34, v35
    v_cvt_pk_bf16_f32 v86, v36, v37
    v_cvt_pk_bf16_f32 v87, v38, v39
    buffer_store_dwordx4 v[72:75], v3, s[20:23], s35 offen offset:0 sc1
    buffer_store_dwordx4 v[76:79], v3, s[20:23], s35 offen offset:1024 sc1
    buffer_store_dwordx4 v[80:83], v3, s[20:23], s35 offen offset:2048 sc1
    buffer_store_dwordx4 v[84:87], v3, s[20:23], s35 offen offset:3072 sc1
    v_dot2_f32_bf16 v88, v72, v90, v88
    v_dot2_f32_bf16 v89, v72, v72, v89
    v_dot2_f32_bf16 v88, v73, v90, v88
    v_dot2_f32_bf16 v89, v73, v73, v89
    v_dot2_f32_bf16 v88, v74, v90, v88
    v_dot2_f32_bf16 v89, v74, v74, v89
    v_dot2_f32_bf16 v88, v75, v90, v88
    v_dot2_f32_bf16 v89, v75, v75, v89
    v_dot2_f32_bf16 v88, v76, v90, v88
    v_dot2_f32_bf16 v89, v76, v76, v89
    v_dot2_f32_bf16 v88, v77, v90, v88
    v_dot2_f32_bf16 v89, v77, v77, v89
    v_dot2_f32_bf16 v88, v78, v90, v88
    v_dot2_f32_bf16 v89, v78, v78, v89
    v_dot2_f32_bf16 v88, v79, v90, v88
    v_dot2_f32_bf16 v89, v79, v79, v89
    v_dot2_f32_bf16 v88, v80, v90, v88
    v_dot2_f32_bf16 v89, v80, v80, v89
    v_dot2_f32_bf16 v88, v81, v90, v88
    v_dot2_f32_bf16 v89, v81, v81, v89
    v_dot2_f32_bf16 v88, v82, v90, v88
    v_dot2_f32_bf16 v89, v82, v82, v89
    v_dot2_f32_bf16 v88, v83, v90, v88
    v_dot2_f32_bf16 v89, v83, v83, v89
    v_dot2_f32_bf16 v88, v84, v90, v88
    v_dot2_f32_bf16 v89, v84, v84, v89
    v_dot2_f32_bf16 v88, v85, v90, v88
    v_dot2_f32_bf16 v89, v85, v85, v89
    v_dot2_f32_bf16 v88, v86, v90, v88
    v_dot2_f32_bf16 v89, v86, v86, v89
    v_dot2_f32_bf16 v88, v87, v90, v88
    v_dot2_f32_bf16 v89, v87, v87, v89
    s_nop 2
    v_mov_b32 v91, v88
    v_mov_b32 v92, v89
    s_nop 1
    v_permlane32_swap_b32 v88, v91
    v_permlane32_swap_b32 v89, v92
    s_nop 0
    v_add_f32 v88, v88, v91
    v_add_f32 v89, v89, v92
    buffer_store_dwordx2 v[88:89], v5, s[16:19], s34 offen sc1
    s_barrier
    s_mul_i32 s30, s54, 7168
    s_lshl_b32 s29, s95, 20
    s_add_u32 s29, s29, s30
    s_add_u32 s29, s29, 31457280
    s_lshl_b32 s33, s94, 16
    s_add_u32 s33, s33, 8388608
    s_add_u32 s8, s4, s33
    s_addc_u32 s9, s5, 0
    s_mov_b32 s10, 65536
    s_mov_b32 s11, 0x20000
    s_mov_b32 s28, 0
    v_and_b32 v237, 0x1ff, v3
    s_add_u32 m0, s30, 0
    s_nop 0
    buffer_load_dwordx4 v3, s[20:23], s29 offen offset:0 lds
    buffer_load_dwordx4 v3, s[20:23], s29 offen offset:1024 lds
    buffer_load_dwordx4 v3, s[20:23], s29 offen offset:2048 lds
    buffer_load_dwordx4 v3, s[20:23], s29 offen offset:3072 lds
    s_add_u32 m0, s30, 4096
    s_add_u32 s60, s29, 4096
    buffer_load_dwordx4 v3, s[20:23], s60 offen offset:0 lds
    buffer_load_dwordx4 v3, s[20:23], s60 offen offset:1024 lds
    buffer_load_dwordx4 v3, s[20:23], s60 offen offset:2048 lds
    s_add_u32 s29, s29, 28672
    s_add_u32 m0, s30, 28672
    s_nop 0
    buffer_load_dwordx4 v3, s[20:23], s29 offen offset:0 lds
    buffer_load_dwordx4 v3, s[20:23], s29 offen offset:1024 lds
    buffer_load_dwordx4 v3, s[20:23], s29 offen offset:2048 lds
    buffer_load_dwordx4 v3, s[20:23], s29 offen offset:3072 lds
    s_add_u32 m0, s30, 32768
    s_add_u32 s60, s29, 4096
    buffer_load_dwordx4 v3, s[20:23], s60 offen offset:0 lds
    s_lshl_b32 s83, s55, 7
    s_lshl_b32 s32, s53, 3
    s_add_u32 s83, s83, s32
    s_add_u32 s33, s83, 802816
    s_waitcnt vmcnt(12)
    s_mov_b64 exec, 1
    buffer_store_dwordx2 v[244:245], off, s[16:19], s33
    s_add_u32 s32, s33, 53248
    buffer_store_dwordx2 v[244:245], off, s[16:19], s32 sc1
    s_mov_b64 exec, -1
    buffer_load_dwordx4 v3, s[20:23], s60 offen offset:1024 lds
    buffer_load_dwordx4 v3, s[20:23], s60 offen offset:2048 lds
    s_add_u32 s29, s29, 28672
    s_mul_i32 s34, s95, 3584
    s_add_u32 s34, s34, 48300032
    buffer_load_dwordx4 a[64:67], v3, s[20:23], s34 offen offset:0
    buffer_load_dwordx4 a[68:71], v3, s[20:23], s34 offen offset:1024
    buffer_load_dwordx4 a[72:75], v3, s[20:23], s34 offen offset:2048
    buffer_load_dwordx4 a[76:79], v237, s[20:23], s34 offen offset:3072
    s_add_u32 m0, s87, 114688
    s_add_u32 s60, s46, 114688
    buffer_load_dwordx4 v3, s[20:23], s60 offen offset:0 lds
    s_cmp_lg_u32 s41, 0
    s_cselect_b32 s35, 0, 53248
    s_add_u32 s35, s35, 802816
    buffer_load_dwordx2 v[240:241], v0, s[16:19], s35 offen sc1
    buffer_load_dwordx4 v3, s[20:23], s60 offen offset:1024 lds
    buffer_load_dwordx4 v3, s[20:23], s60 offen offset:2048 lds
    buffer_load_dwordx4 v3, s[20:23], s60 offen offset:3072 lds
    s_add_u32 m0, s30, 57344
    s_nop 0
    buffer_load_dwordx4 v3, s[20:23], s29 offen offset:0 lds
    buffer_load_dwordx4 v3, s[20:23], s29 offen offset:1024 lds
    s_waitcnt vmcnt(5)
    v_cmp_ne_u64 vcc, s[74:75], v[240:241]
    s_cmp_lg_u64 vcc, 0
    s_cbranch_scc1 L_main_kernel_spin_1047
L_main_kernel_ok_1046:
    buffer_load_dwordx4 a[0:3], v243, s[8:11], s28 offen offset:0 sc1
    buffer_load_dwordx4 a[4:7], v243, s[8:11], s28 offen offset:256 sc1
    buffer_load_dwordx4 a[8:11], v243, s[8:11], s28 offen offset:2048 sc1
    buffer_load_dwordx4 a[12:15], v243, s[8:11], s28 offen offset:2304 sc1
    s_add_u32 s28, s28, 4096
    buffer_load_dwordx4 a[16:19], v243, s[8:11], s28 offen offset:0 sc1
    buffer_load_dwordx4 a[20:23], v243, s[8:11], s28 offen offset:256 sc1
    s_waitcnt vmcnt(15)
    s_barrier
    ds_read_b128 v[120:123], v3 offset:0
    ds_read_b128 v[124:127], v3 offset:1024
    ds_read_b128 v[128:131], v3 offset:2048
    ds_read_b128 v[132:135], v3 offset:3072
    ds_read_b128 v[136:139], v3 offset:4096
    ds_read_b128 v[140:143], v3 offset:5120
    ds_read_b128 v[144:147], v3 offset:6144
    s_waitcnt lgkmcnt(6)
    s_waitcnt vmcnt(4)
    v_mfma_f32_16x16x32_bf16 v[8:11], v[120:123], a[0:3], 0
    ds_read_b128 v[148:151], v3 offset:7168
    v_mfma_f32_16x16x32_bf16 v[16:19], v[120:123], a[4:7], 0
    s_waitcnt lgkmcnt(6)
    buffer_load_dwordx4 a[24:27], v243, s[8:11], s28 offen offset:2048 sc1
    v_mfma_f32_16x16x32_bf16 v[12:15], v[124:127], a[0:3], 0
    ds_read_b128 v[120:123], v3 offset:8192
    v_mfma_f32_16x16x32_bf16 v[20:23], v[124:127], a[4:7], 0
    s_waitcnt lgkmcnt(6)
    buffer_load_dwordx4 a[28:31], v243, s[8:11], s28 offen offset:2304 sc1
    s_add_u32 s28, s28, 4096
    buffer_load_dwordx4 v3, s[20:23], s29 offen offset:2048 lds
    v_mfma_f32_16x16x32_bf16 v[24:27], v[128:131], a[0:3], 0
    ds_read_b128 v[124:127], v3 offset:9216
    v_mfma_f32_16x16x32_bf16 v[32:35], v[128:131], a[4:7], 0
    s_waitcnt lgkmcnt(6)
    v_mfma_f32_16x16x32_bf16 v[28:31], v[132:135], a[0:3], 0
    ds_read_b128 v[128:131], v3 offset:10240
    v_mfma_f32_16x16x32_bf16 v[36:39], v[132:135], a[4:7], 0
    s_waitcnt lgkmcnt(6)
    v_mfma_f32_16x16x32_bf16 v[40:43], v[136:139], a[0:3], 0
    ds_read_b128 v[132:135], v3 offset:11264
    v_mfma_f32_16x16x32_bf16 v[48:51], v[136:139], a[4:7], 0
    s_waitcnt lgkmcnt(6)
    v_mfma_f32_16x16x32_bf16 v[44:47], v[140:143], a[0:3], 0
    ds_read_b128 v[136:139], v3 offset:12288
    v_mfma_f32_16x16x32_bf16 v[52:55], v[140:143], a[4:7], 0
    s_waitcnt lgkmcnt(6)
    buffer_load_dwordx4 v3, s[20:23], s29 offen offset:3072 lds
    v_mfma_f32_16x16x32_bf16 v[56:59], v[144:147], a[0:3], 0
    ds_read_b128 v[140:143], v3 offset:13312
    v_mfma_f32_16x16x32_bf16 v[64:67], v[144:147], a[4:7], 0
    s_waitcnt lgkmcnt(6)
    v_mfma_f32_16x16x32_bf16 v[60:63], v[148:151], a[0:3], 0
    ds_read_b128 v[144:147], v3 offset:14336
    v_mfma_f32_16x16x32_bf16 v[68:71], v[148:151], a[4:7], 0
    s_waitcnt lgkmcnt(6)
    v_mfma_f32_16x16x32_bf16 v[72:75], v[120:123], a[0:3], 0
    ds_read_b128 v[148:151], v3 offset:15360
    v_mfma_f32_16x16x32_bf16 v[80:83], v[120:123], a[4:7], 0
    s_waitcnt lgkmcnt(6)
    v_mfma_f32_16x16x32_bf16 v[76:79], v[124:127], a[0:3], 0
    ds_read_b128 v[120:123], v3 offset:16384
    v_mfma_f32_16x16x32_bf16 v[84:87], v[124:127], a[4:7], 0
    s_waitcnt lgkmcnt(6)
    s_add_u32 m0, s30, 61440
    s_add_u32 s60, s29, 4096
    buffer_load_dwordx4 v3, s[20:23], s60 offen offset:0 lds
    v_mfma_f32_16x16x32_bf16 v[88:91], v[128:131], a[0:3], 0
    ds_read_b128 v[124:127], v3 offset:17408
    v_mfma_f32_16x16x32_bf16 v[96:99], v[128:131], a[4:7], 0
    s_waitcnt lgkmcnt(6)
    v_mfma_f32_16x16x32_bf16 v[92:95], v[132:135], a[0:3], 0
    ds_read_b128 v[128:131], v3 offset:18432
    v_mfma_f32_16x16x32_bf16 v[100:103], v[132:135], a[4:7], 0
    s_waitcnt lgkmcnt(6)
    v_mfma_f32_16x16x32_bf16 v[104:107], v[136:139], a[0:3], 0
    ds_read_b128 v[132:135], v3 offset:19456
    v_mfma_f32_16x16x32_bf16 v[112:115], v[136:139], a[4:7], 0
    s_waitcnt lgkmcnt(6)
    v_lshrrev_b32 v7, 5, v2
    v_lshlrev_b32 v7, 17, v7
    v_mfma_f32_16x16x32_bf16 v[108:111], v[140:143], a[0:3], 0
    ds_read_b128 v[136:139], v3 offset:20480
    v_mfma_f32_16x16x32_bf16 v[116:119], v[140:143], a[4:7], 0
    s_waitcnt lgkmcnt(6)
    s_waitcnt vmcnt(7)
    buffer_load_dwordx4 v3, s[20:23], s60 offen offset:1024 lds
    v_and_b32 v152, 31, v2
    v_lshl_add_u32 v7, v152, 3, v7
    v_mfma_f32_16x16x32_bf16 v[8:11], v[144:147], a[8:11], v[8:11]
    ds_read_b128 v[140:143], v3 offset:21504
    v_mfma_f32_16x16x32_bf16 v[16:19], v[144:147], a[12:15], v[16:19]
    s_waitcnt lgkmcnt(6)
    buffer_load_dwordx4 a[0:3], v243, s[8:11], s28 offen offset:0 sc1
    s_lshl_b32 s33, s94, 8
    s_add_u32 s33, s33, 524288
    v_mfma_f32_16x16x32_bf16 v[12:15], v[148:151], a[8:11], v[12:15]
    ds_read_b128 v[144:147], v3 offset:22528
    v_mfma_f32_16x16x32_bf16 v[20:23], v[148:151], a[12:15], v[20:23]
    s_waitcnt lgkmcnt(6)
    buffer_load_dwordx2 v[152:153], v7, s[16:19], s33 offen sc1
    s_add_u32 s33, s33, 16384
    v_mfma_f32_16x16x32_bf16 v[24:27], v[120:123], a[8:11], v[24:27]
    ds_read_b128 v[148:151], v3 offset:23552
    v_mfma_f32_16x16x32_bf16 v[32:35], v[120:123], a[12:15], v[32:35]
    s_waitcnt lgkmcnt(6)
    buffer_load_dwordx4 a[4:7], v243, s[8:11], s28 offen offset:256 sc1
    buffer_load_dwordx2 v[154:155], v7, s[16:19], s33 offen sc1
    s_add_u32 s33, s33, 16384
    v_mfma_f32_16x16x32_bf16 v[28:31], v[124:127], a[8:11], v[28:31]
    ds_read_b128 v[120:123], v3 offset:24576
    v_mfma_f32_16x16x32_bf16 v[36:39], v[124:127], a[12:15], v[36:39]
    s_waitcnt lgkmcnt(6)
    buffer_load_dwordx4 v3, s[20:23], s60 offen offset:2048 lds
    s_add_u32 s29, s29, 28672
    buffer_load_dwordx2 v[156:157], v7, s[16:19], s33 offen sc1
    s_add_u32 s33, s33, 16384
    v_mfma_f32_16x16x32_bf16 v[40:43], v[128:131], a[8:11], v[40:43]
    ds_read_b128 v[124:127], v3 offset:25600
    v_mfma_f32_16x16x32_bf16 v[48:51], v[128:131], a[12:15], v[48:51]
    s_waitcnt lgkmcnt(6)
    buffer_load_dwordx2 v[158:159], v7, s[16:19], s33 offen sc1
    s_add_u32 s33, s33, 16384
    v_mfma_f32_16x16x32_bf16 v[44:47], v[132:135], a[8:11], v[44:47]
    ds_read_b128 v[128:131], v3 offset:26624
    v_mfma_f32_16x16x32_bf16 v[52:55], v[132:135], a[12:15], v[52:55]
    s_waitcnt lgkmcnt(6)
    buffer_load_dwordx2 v[160:161], v7, s[16:19], s33 offen sc1
    s_add_u32 s33, s33, 16384
    v_mfma_f32_16x16x32_bf16 v[56:59], v[136:139], a[8:11], v[56:59]
    ds_read_b128 v[132:135], v3 offset:27648
    v_mfma_f32_16x16x32_bf16 v[64:67], v[136:139], a[12:15], v[64:67]
    s_waitcnt lgkmcnt(6)
    buffer_load_dwordx2 v[162:163], v7, s[16:19], s33 offen sc1
    s_add_u32 s33, s33, 16384
    s_waitcnt vmcnt(23)
    s_barrier
    v_mfma_f32_16x16x32_bf16 v[60:63], v[140:143], a[8:11], v[60:63]
    ds_read_b128 v[136:139], v3 offset:28672
    v_mfma_f32_16x16x32_bf16 v[68:71], v[140:143], a[12:15], v[68:71]
    s_waitcnt lgkmcnt(6)
    s_add_u32 m0, s30, 86016
    s_nop 0
    buffer_load_dwordx4 v3, s[20:23], s29 offen offset:0 lds
    buffer_load_dwordx2 v[164:165], v7, s[16:19], s33 offen sc1
    s_add_u32 s33, s33, 16384
    v_mfma_f32_16x16x32_bf16 v[72:75], v[144:147], a[8:11], v[72:75]
    ds_read_b128 v[140:143], v3 offset:29696
    v_mfma_f32_16x16x32_bf16 v[80:83], v[144:147], a[12:15], v[80:83]
    s_waitcnt lgkmcnt(6)
    buffer_load_dwordx2 v[166:167], v7, s[16:19], s33 offen sc1
    v_mfma_f32_16x16x32_bf16 v[76:79], v[148:151], a[8:11], v[76:79]
    ds_read_b128 v[144:147], v3 offset:30720
    v_mfma_f32_16x16x32_bf16 v[84:87], v[148:151], a[12:15], v[84:87]
    s_waitcnt lgkmcnt(6)
    v_mfma_f32_16x16x32_bf16 v[88:91], v[120:123], a[8:11], v[88:91]
    ds_read_b128 v[148:151], v3 offset:31744
    v_mfma_f32_16x16x32_bf16 v[96:99], v[120:123], a[12:15], v[96:99]
    s_waitcnt lgkmcnt(6)
    v_mfma_f32_16x16x32_bf16 v[92:95], v[124:127], a[8:11], v[92:95]
    ds_read_b128 v[120:123], v3 offset:32768
    v_mfma_f32_16x16x32_bf16 v[100:103], v[124:127], a[12:15], v[100:103]
    s_waitcnt lgkmcnt(6)
    buffer_load_dwordx4 v3, s[20:23], s29 offen offset:1024 lds
    v_mfma_f32_16x16x32_bf16 v[104:107], v[128:131], a[8:11], v[104:107]
    ds_read_b128 v[124:127], v3 offset:33792
    v_mfma_f32_16x16x32_bf16 v[112:115], v[128:131], a[12:15], v[112:115]
    s_waitcnt lgkmcnt(6)
    v_mfma_f32_16x16x32_bf16 v[108:111], v[132:135], a[8:11], v[108:111]
    ds_read_b128 v[128:131], v3 offset:34816
    v_mfma_f32_16x16x32_bf16 v[116:119], v[132:135], a[12:15], v[116:119]
    s_waitcnt lgkmcnt(6)
    s_waitcnt vmcnt(19)
    v_mfma_f32_16x16x32_bf16 v[8:11], v[136:139], a[16:19], v[8:11]
    ds_read_b128 v[132:135], v3 offset:35840
    v_mfma_f32_16x16x32_bf16 v[16:19], v[136:139], a[20:23], v[16:19]
    s_waitcnt lgkmcnt(6)
    buffer_load_dwordx4 a[8:11], v243, s[8:11], s28 offen offset:2048 sc1
    v_mfma_f32_16x16x32_bf16 v[12:15], v[140:143], a[16:19], v[12:15]
    ds_read_b128 v[136:139], v3 offset:36864
    v_mfma_f32_16x16x32_bf16 v[20:23], v[140:143], a[20:23], v[20:23]
    s_waitcnt lgkmcnt(6)
    buffer_load_dwordx4 v3, s[20:23], s29 offen offset:2048 lds
    v_mfma_f32_16x16x32_bf16 v[24:27], v[144:147], a[16:19], v[24:27]
    ds_read_b128 v[140:143], v3 offset:37888
    v_mfma_f32_16x16x32_bf16 v[32:35], v[144:147], a[20:23], v[32:35]
    s_waitcnt lgkmcnt(6)
    buffer_load_dwordx4 a[12:15], v243, s[8:11], s28 offen offset:2304 sc1
    s_add_u32 s28, s28, 4096
    v_mfma_f32_16x16x32_bf16 v[28:31], v[148:151], a[16:19], v[28:31]
    ds_read_b128 v[144:147], v3 offset:38912
    v_mfma_f32_16x16x32_bf16 v[36:39], v[148:151], a[20:23], v[36:39]
    s_waitcnt lgkmcnt(6)
    v_mfma_f32_16x16x32_bf16 v[40:43], v[120:123], a[16:19], v[40:43]
    ds_read_b128 v[148:151], v3 offset:39936
    v_mfma_f32_16x16x32_bf16 v[48:51], v[120:123], a[20:23], v[48:51]
    s_waitcnt lgkmcnt(6)
    v_mfma_f32_16x16x32_bf16 v[44:47], v[124:127], a[16:19], v[44:47]
    ds_read_b128 v[120:123], v3 offset:40960
    v_mfma_f32_16x16x32_bf16 v[52:55], v[124:127], a[20:23], v[52:55]
    s_waitcnt lgkmcnt(6)
    buffer_load_dwordx4 v3, s[20:23], s29 offen offset:3072 lds
    v_mfma_f32_16x16x32_bf16 v[56:59], v[128:131], a[16:19], v[56:59]
    ds_read_b128 v[124:127], v3 offset:41984
    v_mfma_f32_16x16x32_bf16 v[64:67], v[128:131], a[20:23], v[64:67]
    s_waitcnt lgkmcnt(6)
    v_mfma_f32_16x16x32_bf16 v[60:63], v[132:135], a[16:19], v[60:63]
    ds_read_b128 v[128:131], v3 offset:43008
    v_mfma_f32_16x16x32_bf16 v[68:71], v[132:135], a[20:23], v[68:71]
    s_waitcnt lgkmcnt(6)
    v_mfma_f32_16x16x32_bf16 v[72:75], v[136:139], a[16:19], v[72:75]
    ds_read_b128 v[132:135], v3 offset:44032
    v_mfma_f32_16x16x32_bf16 v[80:83], v[136:139], a[20:23], v[80:83]
    s_waitcnt lgkmcnt(6)
    v_mfma_f32_16x16x32_bf16 v[76:79], v[140:143], a[16:19], v[76:79]
    ds_read_b128 v[136:139], v3 offset:45056
    v_mfma_f32_16x16x32_bf16 v[84:87], v[140:143], a[20:23], v[84:87]
    s_waitcnt lgkmcnt(6)
    s_add_u32 m0, s30, 90112
    s_add_u32 s60, s29, 4096
    buffer_load_dwordx4 v3, s[20:23], s60 offen offset:0 lds
    v_mfma_f32_16x16x32_bf16 v[88:91], v[144:147], a[16:19], v[88:91]
    ds_read_b128 v[140:143], v3 offset:46080
    v_mfma_f32_16x16x32_bf16 v[96:99], v[144:147], a[20:23], v[96:99]
    s_waitcnt lgkmcnt(6)
    v_mfma_f32_16x16x32_bf16 v[92:95], v[148:151], a[16:19], v[92:95]
    ds_read_b128 v[144:147], v3 offset:47104
    v_mfma_f32_16x16x32_bf16 v[100:103], v[148:151], a[20:23], v[100:103]
    s_waitcnt lgkmcnt(6)
    v_mfma_f32_16x16x32_bf16 v[104:107], v[120:123], a[16:19], v[104:107]
    ds_read_b128 v[148:151], v3 offset:48128
    v_mfma_f32_16x16x32_bf16 v[112:115], v[120:123], a[20:23], v[112:115]
    s_waitcnt lgkmcnt(6)
    v_mfma_f32_16x16x32_bf16 v[108:111], v[124:127], a[16:19], v[108:111]
    ds_read_b128 v[120:123], v3 offset:49152
    v_mfma_f32_16x16x32_bf16 v[116:119], v[124:127], a[20:23], v[116:119]
    s_waitcnt lgkmcnt(6)
    s_waitcnt vmcnt(22)
    buffer_load_dwordx4 v3, s[20:23], s60 offen offset:1024 lds
    v_mfma_f32_16x16x32_bf16 v[8:11], v[128:131], a[24:27], v[8:11]
    ds_read_b128 v[124:127], v3 offset:50176
    v_mfma_f32_16x16x32_bf16 v[16:19], v[128:131], a[28:31], v[16:19]
    s_waitcnt lgkmcnt(6)
    buffer_load_dwordx4 a[16:19], v243, s[8:11], s28 offen offset:0 sc1
    v_mfma_f32_16x16x32_bf16 v[12:15], v[132:135], a[24:27], v[12:15]
    ds_read_b128 v[128:131], v3 offset:51200
    v_mfma_f32_16x16x32_bf16 v[20:23], v[132:135], a[28:31], v[20:23]
    s_waitcnt lgkmcnt(6)
    v_mfma_f32_16x16x32_bf16 v[24:27], v[136:139], a[24:27], v[24:27]
    ds_read_b128 v[132:135], v3 offset:52224
    v_mfma_f32_16x16x32_bf16 v[32:35], v[136:139], a[28:31], v[32:35]
    s_waitcnt lgkmcnt(6)
    buffer_load_dwordx4 a[20:23], v243, s[8:11], s28 offen offset:256 sc1
    v_mfma_f32_16x16x32_bf16 v[28:31], v[140:143], a[24:27], v[28:31]
    ds_read_b128 v[136:139], v3 offset:53248
    v_mfma_f32_16x16x32_bf16 v[36:39], v[140:143], a[28:31], v[36:39]
    s_waitcnt lgkmcnt(6)
    buffer_load_dwordx4 v3, s[20:23], s60 offen offset:2048 lds
    s_add_u32 s29, s29, 28672
    v_mfma_f32_16x16x32_bf16 v[40:43], v[144:147], a[24:27], v[40:43]
    ds_read_b128 v[140:143], v3 offset:54272
    v_mfma_f32_16x16x32_bf16 v[48:51], v[144:147], a[28:31], v[48:51]
    s_waitcnt lgkmcnt(6)
    v_mfma_f32_16x16x32_bf16 v[44:47], v[148:151], a[24:27], v[44:47]
    ds_read_b128 v[144:147], v3 offset:55296
    v_mfma_f32_16x16x32_bf16 v[52:55], v[148:151], a[28:31], v[52:55]
    s_waitcnt lgkmcnt(6)
    v_mfma_f32_16x16x32_bf16 v[56:59], v[120:123], a[24:27], v[56:59]
    ds_read_b128 v[148:151], v3 offset:56320
    v_mfma_f32_16x16x32_bf16 v[64:67], v[120:123], a[28:31], v[64:67]
    s_waitcnt lgkmcnt(6)
    s_waitcnt vmcnt(17)
    s_barrier
    v_mfma_f32_16x16x32_bf16 v[60:63], v[124:127], a[24:27], v[60:63]
    ds_read_b128 v[120:123], v3 offset:57344
    v_mfma_f32_16x16x32_bf16 v[68:71], v[124:127], a[28:31], v[68:71]
    s_waitcnt lgkmcnt(6)
    s_add_u32 m0, s30, 0
    s_nop 0
    buffer_load_dwordx4 v3, s[20:23], s29 offen offset:0 lds
    v_mfma_f32_16x16x32_bf16 v[72:75], v[128:131], a[24:27], v[72:75]
    ds_read_b128 v[124:127], v3 offset:58368
    v_mfma_f32_16x16x32_bf16 v[80:83], v[128:131], a[28:31], v[80:83]
    s_waitcnt lgkmcnt(6)
    v_mfma_f32_16x16x32_bf16 v[76:79], v[132:135], a[24:27], v[76:79]
    ds_read_b128 v[128:131], v3 offset:59392
    v_mfma_f32_16x16x32_bf16 v[84:87], v[132:135], a[28:31], v[84:87]
    s_waitcnt lgkmcnt(6)
    v_mfma_f32_16x16x32_bf16 v[88:91], v[136:139], a[24:27], v[88:91]
    ds_read_b128 v[132:135], v3 offset:60416
    v_mfma_f32_16x16x32_bf16 v[96:99], v[136:139], a[28:31], v[96:99]
    s_waitcnt lgkmcnt(6)
    s_waitcnt vmcnt(11)
    v_add_f32 v152, v152, v154
    v_add_f32 v153, v153, v155
    v_mfma_f32_16x16x32_bf16 v[92:95], v[140:143], a[24:27], v[92:95]
    ds_read_b128 v[136:139], v3 offset:61440
    v_mfma_f32_16x16x32_bf16 v[100:103], v[140:143], a[28:31], v[100:103]
    s_waitcnt lgkmcnt(6)
    buffer_load_dwordx4 v3, s[20:23], s29 offen offset:1024 lds
    v_add_f32 v152, v152, v156
    v_add_f32 v153, v153, v157
    v_mfma_f32_16x16x32_bf16 v[104:107], v[144:147], a[24:27], v[104:107]
    ds_read_b128 v[140:143], v3 offset:62464
    v_mfma_f32_16x16x32_bf16 v[112:115], v[144:147], a[28:31], v[112:115]
    s_waitcnt lgkmcnt(6)
    v_add_f32 v152, v152, v158
    v_mfma_f32_16x16x32_bf16 v[108:111], v[148:151], a[24:27], v[108:111]
    ds_read_b128 v[144:147], v3 offset:63488
    v_mfma_f32_16x16x32_bf16 v[116:119], v[148:151], a[28:31], v[116:119]
    s_waitcnt lgkmcnt(6)
    s_waitcnt vmcnt(21)
    v_add_f32 v153, v153, v159
    v_add_f32 v152, v152, v160
    v_mfma_f32_16x16x32_bf16 v[8:11], v[120:123], a[0:3], v[8:11]
    ds_read_b128 v[148:151], v3 offset:64512
    v_mfma_f32_16x16x32_bf16 v[16:19], v[120:123], a[4:7], v[16:19]
    s_waitcnt lgkmcnt(6)
    buffer_load_dwordx4 a[24:27], v243, s[8:11], s28 offen offset:2048 sc1
    v_add_f32 v153, v153, v161
    v_mfma_f32_16x16x32_bf16 v[12:15], v[124:127], a[0:3], v[12:15]
    ds_read_b128 v[120:123], v4 offset:0
    v_mfma_f32_16x16x32_bf16 v[20:23], v[124:127], a[4:7], v[20:23]
    s_waitcnt lgkmcnt(6)
    buffer_load_dwordx4 v3, s[20:23], s29 offen offset:2048 lds
    v_add_f32 v152, v152, v162
    v_add_f32 v153, v153, v163
    v_mfma_f32_16x16x32_bf16 v[24:27], v[128:131], a[0:3], v[24:27]
    ds_read_b128 v[124:127], v4 offset:1024
    v_mfma_f32_16x16x32_bf16 v[32:35], v[128:131], a[4:7], v[32:35]
    s_waitcnt lgkmcnt(6)
    buffer_load_dwordx4 a[28:31], v243, s[8:11], s28 offen offset:2304 sc1
    s_add_u32 s28, s28, 4096
    v_add_f32 v152, v152, v164
    v_mfma_f32_16x16x32_bf16 v[28:31], v[132:135], a[0:3], v[28:31]
    ds_read_b128 v[128:131], v4 offset:2048
    v_mfma_f32_16x16x32_bf16 v[36:39], v[132:135], a[4:7], v[36:39]
    s_waitcnt lgkmcnt(6)
    v_add_f32 v153, v153, v165
    v_add_f32 v152, v152, v166
    v_mfma_f32_16x16x32_bf16 v[40:43], v[136:139], a[0:3], v[40:43]
    ds_read_b128 v[132:135], v4 offset:3072
    v_mfma_f32_16x16x32_bf16 v[48:51], v[136:139], a[4:7], v[48:51]
    s_waitcnt lgkmcnt(6)
    v_add_f32 v153, v153, v167
    v_mov_b32 v154, v152
    v_mfma_f32_16x16x32_bf16 v[44:47], v[140:143], a[0:3], v[44:47]
    ds_read_b128 v[136:139], v4 offset:4096
    v_mfma_f32_16x16x32_bf16 v[52:55], v[140:143], a[4:7], v[52:55]
    s_waitcnt lgkmcnt(6)
    buffer_load_dwordx4 v3, s[20:23], s29 offen offset:3072 lds
    v_mov_b32 v155, v153
    v_mfma_f32_16x16x32_bf16 v[56:59], v[144:147], a[0:3], v[56:59]
    ds_read_b128 v[140:143], v4 offset:5120
    v_mfma_f32_16x16x32_bf16 v[64:67], v[144:147], a[4:7], v[64:67]
    s_waitcnt lgkmcnt(6)
    s_nop 1
    v_permlane32_swap_b32 v152, v154
    v_mfma_f32_16x16x32_bf16 v[60:63], v[148:151], a[0:3], v[60:63]
    ds_read_b128 v[144:147], v4 offset:6144
    v_mfma_f32_16x16x32_bf16 v[68:71], v[148:151], a[4:7], v[68:71]
    s_waitcnt lgkmcnt(6)
    v_permlane32_swap_b32 v153, v155
    v_mfma_f32_16x16x32_bf16 v[72:75], v[120:123], a[0:3], v[72:75]
    ds_read_b128 v[148:151], v4 offset:7168
    v_mfma_f32_16x16x32_bf16 v[80:83], v[120:123], a[4:7], v[80:83]
    s_waitcnt lgkmcnt(6)
    s_nop 0
    v_add_f32 v152, v152, v154
    v_mfma_f32_16x16x32_bf16 v[76:79], v[124:127], a[0:3], v[76:79]
    ds_read_b128 v[120:123], v4 offset:8192
    v_mfma_f32_16x16x32_bf16 v[84:87], v[124:127], a[4:7], v[84:87]
    s_waitcnt lgkmcnt(6)
    s_add_u32 m0, s30, 4096
    s_add_u32 s60, s29, 4096
    buffer_load_dwordx4 v3, s[20:23], s60 offen offset:0 lds
    v_add_f32 v153, v153, v155
    v_mfma_f32_16x16x32_bf16 v[88:91], v[128:131], a[0:3], v[88:91]
    ds_read_b128 v[124:127], v4 offset:9216
    v_mfma_f32_16x16x32_bf16 v[96:99], v[128:131], a[4:7], v[96:99]
    s_waitcnt lgkmcnt(6)
    v_mul_f32 v5, 0xba800000, v152
    v_mul_f32 v153, 0x3a800000, v153
    v_mfma_f32_16x16x32_bf16 v[92:95], v[132:135], a[0:3], v[92:95]
    ds_read_b128 v[128:131], v4 offset:10240
    v_mfma_f32_16x16x32_bf16 v[100:103], v[132:135], a[4:7], v[100:103]
    s_waitcnt lgkmcnt(6)
    v_fma_f32 v153, -v5, v5, v153
    v_max_f32 v153, 0, v153
    v_mfma_f32_16x16x32_bf16 v[104:107], v[136:139], a[0:3], v[104:107]
    ds_read_b128 v[132:135], v4 offset:11264
    v_mfma_f32_16x16x32_bf16 v[112:115], v[136:139], a[4:7], v[112:115]
    s_waitcnt lgkmcnt(6)
    v_add_f32 v153, 0x3727c5ac, v153
    v_mfma_f32_16x16x32_bf16 v[108:111], v[140:143], a[0:3], v[108:111]
    ds_read_b128 v[136:139], v4 offset:12288
    v_mfma_f32_16x16x32_bf16 v[116:119], v[140:143], a[4:7], v[116:119]
    s_waitcnt lgkmcnt(6)
    s_waitcnt vmcnt(13)
    buffer_load_dwordx4 v3, s[20:23], s60 offen offset:1024 lds
    v_rsq_f32 v232, v153
    s_nop 0
    v_mfma_f32_16x16x32_bf16 v[8:11], v[144:147], a[8:11], v[8:11]
    ds_read_b128 v[140:143], v4 offset:13312
    v_mfma_f32_16x16x32_bf16 v[16:19], v[144:147], a[12:15], v[16:19]
    s_waitcnt lgkmcnt(6)
    buffer_load_dwordx4 a[0:3], v243, s[8:11], s28 offen offset:0 sc1
    v_mul_f32 v232, 0xbfb8aa3b, v232
    v_mfma_f32_16x16x32_bf16 v[12:15], v[148:151], a[8:11], v[12:15]
    ds_read_b128 v[144:147], v4 offset:14336
    v_mfma_f32_16x16x32_bf16 v[20:23], v[148:151], a[12:15], v[20:23]
    s_waitcnt lgkmcnt(6)
    v_mov_b32 v7, v5
    v_mov_b32 v234, v232
    v_mfma_f32_16x16x32_bf16 v[24:27], v[120:123], a[8:11], v[24:27]
    ds_read_b128 v[148:151], v4 offset:15360
    v_mfma_f32_16x16x32_bf16 v[32:35], v[120:123], a[12:15], v[32:35]
    s_waitcnt lgkmcnt(6)
    buffer_load_dwordx4 a[4:7], v243, s[8:11], s28 offen offset:256 sc1
    s_nop 1
    v_mfma_f32_16x16x32_bf16 v[28:31], v[124:127], a[8:11], v[28:31]
    ds_read_b128 v[120:123], v4 offset:16384
    v_mfma_f32_16x16x32_bf16 v[36:39], v[124:127], a[12:15], v[36:39]
    s_waitcnt lgkmcnt(6)
    buffer_load_dwordx4 v3, s[20:23], s60 offen offset:2048 lds
    s_add_u32 s29, s29, 28672
    v_permlane16_swap_b32 v5, v7
    v_permlane16_swap_b32 v232, v234
    v_mfma_f32_16x16x32_bf16 v[40:43], v[128:131], a[8:11], v[40:43]
    ds_read_b128 v[124:127], v4 offset:17408
    v_mfma_f32_16x16x32_bf16 v[48:51], v[128:131], a[12:15], v[48:51]
    s_waitcnt lgkmcnt(6)
    s_nop 0
    v_mov_b32 v233, v232
    v_mfma_f32_16x16x32_bf16 v[44:47], v[132:135], a[8:11], v[44:47]
    ds_read_b128 v[128:131], v4 offset:18432
    v_mfma_f32_16x16x32_bf16 v[52:55], v[132:135], a[12:15], v[52:55]
    s_waitcnt lgkmcnt(6)
    v_mov_b32 v235, v234
    v_mfma_f32_16x16x32_bf16 v[56:59], v[136:139], a[8:11], v[56:59]
    ds_read_b128 v[132:135], v4 offset:19456
    v_mfma_f32_16x16x32_bf16 v[64:67], v[136:139], a[12:15], v[64:67]
    s_waitcnt lgkmcnt(6)
    v_and_b32 v152, 0xffff0000, v5
    v_sub_f32 v152, v5, v152
    s_waitcnt vmcnt(11)
    s_barrier
    v_mfma_f32_16x16x32_bf16 v[60:63], v[140:143], a[8:11], v[60:63]
    ds_read_b128 v[136:139], v4 offset:20480
    v_mfma_f32_16x16x32_bf16 v[68:71], v[140:143], a[12:15], v[68:71]
    s_waitcnt lgkmcnt(6)
    s_add_u32 m0, s30, 28672
    s_nop 0
    buffer_load_dwordx4 v3, s[20:23], s29 offen offset:0 lds
    v_and_b32 v153, 0xffff0000, v152
    v_mfma_f32_16x16x32_bf16 v[72:75], v[144:147], a[8:11], v[72:75]
    ds_read_b128 v[140:143], v4 offset:21504
    v_mfma_f32_16x16x32_bf16 v[80:83], v[144:147], a[12:15], v[80:83]
    s_waitcnt lgkmcnt(6)
    v_sub_f32 v153, v152, v153
    v_perm_b32 v168, v5, v5, s58
    v_mfma_f32_16x16x32_bf16 v[76:79], v[148:151], a[8:11], v[76:79]
    ds_read_b128 v[144:147], v4 offset:22528
    v_mfma_f32_16x16x32_bf16 v[84:87], v[148:151], a[12:15], v[84:87]
    s_waitcnt lgkmcnt(6)
    v_perm_b32 v169, v152, v152, s58
    v_mfma_f32_16x16x32_bf16 v[88:91], v[120:123], a[8:11], v[88:91]
    ds_read_b128 v[148:151], v4 offset:23552
    v_mfma_f32_16x16x32_bf16 v[96:99], v[120:123], a[12:15], v[96:99]
    s_waitcnt lgkmcnt(6)
    v_perm_b32 v170, v153, v5, s58
    v_mov_b32 v171, 0
    v_mfma_f32_16x16x32_bf16 v[92:95], v[124:127], a[8:11], v[92:95]
    ds_read_b128 v[120:123], v4 offset:24576
    v_mfma_f32_16x16x32_bf16 v[100:103], v[124:127], a[12:15], v[100:103]
    s_waitcnt lgkmcnt(6)
    buffer_load_dwordx4 v3, s[20:23], s29 offen offset:1024 lds
    v_and_b32 v152, 0xffff0000, v7
    v_sub_f32 v152, v7, v152
    v_mfma_f32_16x16x32_bf16 v[104:107], v[128:131], a[8:11], v[104:107]
    ds_read_b128 v[124:127], v4 offset:25600
    v_mfma_f32_16x16x32_bf16 v[112:115], v[128:131], a[12:15], v[112:115]
    s_waitcnt lgkmcnt(6)
    v_and_b32 v153, 0xffff0000, v152
    v_mfma_f32_16x16x32_bf16 v[108:111], v[132:135], a[8:11], v[108:111]
    ds_read_b128 v[128:131], v4 offset:26624
    v_mfma_f32_16x16x32_bf16 v[116:119], v[132:135], a[12:15], v[116:119]
    s_waitcnt lgkmcnt(6)
    s_waitcnt vmcnt(14)
    v_sub_f32 v153, v152, v153
    v_perm_b32 v172, v7, v7, s58
    v_mfma_f32_16x16x32_bf16 v[8:11], v[136:139], a[16:19], v[8:11]
    ds_read_b128 v[132:135], v4 offset:27648
    v_mfma_f32_16x16x32_bf16 v[16:19], v[136:139], a[20:23], v[16:19]
    s_waitcnt lgkmcnt(6)
    buffer_load_dwordx4 a[8:11], v243, s[8:11], s28 offen offset:2048 sc1
    v_perm_b32 v173, v152, v152, s58
    v_mfma_f32_16x16x32_bf16 v[12:15], v[140:143], a[16:19], v[12:15]
    ds_read_b128 v[136:139], v4 offset:28672
    v_mfma_f32_16x16x32_bf16 v[20:23], v[140:143], a[20:23], v[20:23]
    s_waitcnt lgkmcnt(6)
    buffer_load_dwordx4 v3, s[20:23], s29 offen offset:2048 lds
    v_perm_b32 v174, v153, v7, s58
    v_mov_b32 v175, 0
    v_mfma_f32_16x16x32_bf16 v[24:27], v[144:147], a[16:19], v[24:27]
    ds_read_b128 v[140:143], v4 offset:29696
    v_mfma_f32_16x16x32_bf16 v[32:35], v[144:147], a[20:23], v[32:35]
    s_waitcnt lgkmcnt(6)
    buffer_load_dwordx4 a[12:15], v243, s[8:11], s28 offen offset:2304 sc1
    s_add_u32 s28, s28, 4096
    v_lshrrev_b32 v7, 4, v2
    v_mfma_f32_16x16x32_bf16 v[28:31], v[148:151], a[16:19], v[28:31]
    ds_read_b128 v[144:147], v4 offset:30720
    v_mfma_f32_16x16x32_bf16 v[36:39], v[148:151], a[20:23], v[36:39]
    s_waitcnt lgkmcnt(6)
    v_cmp_eq_u32 vcc, 0, v7
    v_mov_b32 v179, 0
    v_mfma_f32_16x16x32_bf16 v[40:43], v[120:123], a[16:19], v[40:43]
    ds_read_b128 v[148:151], v4 offset:31744
    v_mfma_f32_16x16x32_bf16 v[48:51], v[120:123], a[20:23], v[48:51]
    s_waitcnt lgkmcnt(6)
    v_mov_b32 v183, 0
    v_cndmask_b32 v176, 0, v168, vcc
    v_mfma_f32_16x16x32_bf16 v[44:47], v[124:127], a[16:19], v[44:47]
    ds_read_b128 v[120:123], v4 offset:32768
    v_mfma_f32_16x16x32_bf16 v[52:55], v[124:127], a[20:23], v[52:55]
    s_waitcnt lgkmcnt(6)
    buffer_load_dwordx4 v3, s[20:23], s29 offen offset:3072 lds
    v_cndmask_b32 v177, 0, v169, vcc
    v_mfma_f32_16x16x32_bf16 v[56:59], v[128:131], a[16:19], v[56:59]
    ds_read_b128 v[124:127], v4 offset:33792
    v_mfma_f32_16x16x32_bf16 v[64:67], v[128:131], a[20:23], v[64:67]
    s_waitcnt lgkmcnt(6)
    v_cndmask_b32 v178, 0, v170, vcc
    v_cndmask_b32 v180, 0, v172, vcc
    v_mfma_f32_16x16x32_bf16 v[60:63], v[132:135], a[16:19], v[60:63]
    ds_read_b128 v[128:131], v4 offset:34816
    v_mfma_f32_16x16x32_bf16 v[68:71], v[132:135], a[20:23], v[68:71]
    s_waitcnt lgkmcnt(6)
    v_cndmask_b32 v181, 0, v173, vcc
    v_mfma_f32_16x16x32_bf16 v[72:75], v[136:139], a[16:19], v[72:75]
    ds_read_b128 v[132:135], v4 offset:35840
    v_mfma_f32_16x16x32_bf16 v[80:83], v[136:139], a[20:23], v[80:83]
    s_waitcnt lgkmcnt(6)
    v_cndmask_b32 v182, 0, v174, vcc
    v_cmp_eq_u32 vcc, 1, v7
    v_mfma_f32_16x16x32_bf16 v[76:79], v[140:143], a[16:19], v[76:79]
    ds_read_b128 v[136:139], v4 offset:36864
    v_mfma_f32_16x16x32_bf16 v[84:87], v[140:143], a[20:23], v[84:87]
    s_waitcnt lgkmcnt(6)
    s_add_u32 m0, s30, 32768
    s_add_u32 s60, s29, 4096
    buffer_load_dwordx4 v3, s[20:23], s60 offen offset:0 lds
    v_mov_b32 v187, 0
    v_mfma_f32_16x16x32_bf16 v[88:91], v[144:147], a[16:19], v[88:91]
    ds_read_b128 v[140:143], v4 offset:37888
    v_mfma_f32_16x16x32_bf16 v[96:99], v[144:147], a[20:23], v[96:99]
    s_waitcnt lgkmcnt(6)
    v_mov_b32 v191, 0
    v_cndmask_b32 v184, 0, v168, vcc
    v_mfma_f32_16x16x32_bf16 v[92:95], v[148:151], a[16:19], v[92:95]
    ds_read_b128 v[144:147], v4 offset:38912
    v_mfma_f32_16x16x32_bf16 v[100:103], v[148:151], a[20:23], v[100:103]
    s_waitcnt lgkmcnt(6)
    v_cndmask_b32 v185, 0, v169, vcc
    v_cndmask_b32 v186, 0, v170, vcc
    v_mfma_f32_16x16x32_bf16 v[104:107], v[120:123], a[16:19], v[104:107]
    ds_read_b128 v[148:151], v4 offset:39936
    v_mfma_f32_16x16x32_bf16 v[112:115], v[120:123], a[20:23], v[112:115]
    s_waitcnt lgkmcnt(6)
    v_cndmask_b32 v188, 0, v172, vcc
    v_mfma_f32_16x16x32_bf16 v[108:111], v[124:127], a[16:19], v[108:111]
    ds_read_b128 v[120:123], v4 offset:40960
    v_mfma_f32_16x16x32_bf16 v[116:119], v[124:127], a[20:23], v[116:119]
    s_waitcnt lgkmcnt(6)
    s_waitcnt vmcnt(13)
    buffer_load_dwordx4 v3, s[20:23], s60 offen offset:1024 lds
    v_cndmask_b32 v189, 0, v173, vcc
    v_cndmask_b32 v190, 0, v174, vcc
    v_mfma_f32_16x16x32_bf16 v[8:11], v[128:131], a[24:27], v[8:11]
    ds_read_b128 v[124:127], v4 offset:41984
    v_mfma_f32_16x16x32_bf16 v[16:19], v[128:131], a[28:31], v[16:19]
    s_waitcnt lgkmcnt(6)
    buffer_load_dwordx4 a[16:19], v243, s[8:11], s28 offen offset:0 sc1
    v_cmp_eq_u32 vcc, 2, v7
    v_mfma_f32_16x16x32_bf16 v[12:15], v[132:135], a[24:27], v[12:15]
    ds_read_b128 v[128:131], v4 offset:43008
    v_mfma_f32_16x16x32_bf16 v[20:23], v[132:135], a[28:31], v[20:23]
    s_waitcnt lgkmcnt(6)
    v_mov_b32 v195, 0
    v_mov_b32 v199, 0
    v_mfma_f32_16x16x32_bf16 v[24:27], v[136:139], a[24:27], v[24:27]
    ds_read_b128 v[132:135], v4 offset:44032
    v_mfma_f32_16x16x32_bf16 v[32:35], v[136:139], a[28:31], v[32:35]
    s_waitcnt lgkmcnt(6)
    buffer_load_dwordx4 a[20:23], v243, s[8:11], s28 offen offset:256 sc1
    v_cndmask_b32 v192, 0, v168, vcc
    v_mfma_f32_16x16x32_bf16 v[28:31], v[140:143], a[24:27], v[28:31]
    ds_read_b128 v[136:139], v4 offset:45056
    v_mfma_f32_16x16x32_bf16 v[36:39], v[140:143], a[28:31], v[36:39]
    s_waitcnt lgkmcnt(6)
    buffer_load_dwordx4 v3, s[20:23], s60 offen offset:2048 lds
    s_add_u32 s29, s29, 28672
    v_cndmask_b32 v193, 0, v169, vcc
    v_cndmask_b32 v194, 0, v170, vcc
    v_mfma_f32_16x16x32_bf16 v[40:43], v[144:147], a[24:27], v[40:43]
    ds_read_b128 v[140:143], v4 offset:46080
    v_mfma_f32_16x16x32_bf16 v[48:51], v[144:147], a[28:31], v[48:51]
    s_waitcnt lgkmcnt(6)
    v_cndmask_b32 v196, 0, v172, vcc
    v_cndmask_b32 v197, 0, v173, vcc
    v_mfma_f32_16x16x32_bf16 v[44:47], v[148:151], a[24:27], v[44:47]
    ds_read_b128 v[144:147], v4 offset:47104
    v_mfma_f32_16x16x32_bf16 v[52:55], v[148:151], a[28:31], v[52:55]
    s_waitcnt lgkmcnt(6)
    v_cndmask_b32 v198, 0, v174, vcc
    v_mfma_f32_16x16x32_bf16 v[56:59], v[120:123], a[24:27], v[56:59]
    ds_read_b128 v[148:151], v4 offset:48128
    v_mfma_f32_16x16x32_bf16 v[64:67], v[120:123], a[28:31], v[64:67]
    s_waitcnt lgkmcnt(6)
    v_cmp_eq_u32 vcc, 3, v7
    v_mov_b32 v203, 0
    s_waitcnt vmcnt(11)
    s_barrier
    v_mfma_f32_16x16x32_bf16 v[60:63], v[124:127], a[24:27], v[60:63]
    ds_read_b128 v[120:123], v3 offset:0
    v_mfma_f32_16x16x32_bf16 v[68:71], v[124:127], a[28:31], v[68:71]
    s_waitcnt lgkmcnt(6)
    s_add_u32 m0, s30, 57344
    s_nop 0
    buffer_load_dwordx4 v3, s[20:23], s29 offen offset:0 lds
    v_mov_b32 v207, 0
    v_mfma_f32_16x16x32_bf16 v[72:75], v[128:131], a[24:27], v[72:75]
    ds_read_b128 v[124:127], v3 offset:1024
    v_mfma_f32_16x16x32_bf16 v[80:83], v[128:131], a[28:31], v[80:83]
    s_waitcnt lgkmcnt(6)
    v_cndmask_b32 v200, 0, v168, vcc
    v_cndmask_b32 v201, 0, v169, vcc
    v_mfma_f32_16x16x32_bf16 v[76:79], v[132:135], a[24:27], v[76:79]
    ds_read_b128 v[128:131], v3 offset:2048
    v_mfma_f32_16x16x32_bf16 v[84:87], v[132:135], a[28:31], v[84:87]
    s_waitcnt lgkmcnt(6)
    v_cndmask_b32 v202, 0, v170, vcc
    v_mfma_f32_16x16x32_bf16 v[88:91], v[136:139], a[24:27], v[88:91]
    ds_read_b128 v[132:135], v3 offset:3072
    v_mfma_f32_16x16x32_bf16 v[96:99], v[136:139], a[28:31], v[96:99]
    s_waitcnt lgkmcnt(6)
    v_cndmask_b32 v204, 0, v172, vcc
    v_cndmask_b32 v205, 0, v173, vcc
    v_mfma_f32_16x16x32_bf16 v[92:95], v[140:143], a[24:27], v[92:95]
    ds_read_b128 v[136:139], v3 offset:4096
    v_mfma_f32_16x16x32_bf16 v[100:103], v[140:143], a[28:31], v[100:103]
    s_waitcnt lgkmcnt(6)
    buffer_load_dwordx4 v3, s[20:23], s29 offen offset:1024 lds
    v_cndmask_b32 v206, 0, v174, vcc
    v_mfma_f32_16x16x32_bf16 v[104:107], v[144:147], a[24:27], v[104:107]
    ds_read_b128 v[140:143], v3 offset:5120
    v_mfma_f32_16x16x32_bf16 v[112:115], v[144:147], a[28:31], v[112:115]
    s_waitcnt lgkmcnt(6)
    v_mfma_f32_16x16x32_bf16 v[108:111], v[148:151], a[24:27], v[108:111]
    ds_read_b128 v[144:147], v3 offset:6144
    v_mfma_f32_16x16x32_bf16 v[116:119], v[148:151], a[28:31], v[116:119]
    s_waitcnt lgkmcnt(6)
    s_waitcnt vmcnt(14)
    v_mfma_f32_16x16x32_bf16 v[8:11], a[64:67], v[176:179], v[8:11]
    v_mfma_f32_16x16x32_bf16 v[16:19], a[64:67], v[180:183], v[16:19]
    v_mfma_f32_16x16x32_bf16 v[12:15], a[64:67], v[184:187], v[12:15]
    v_mfma_f32_16x16x32_bf16 v[20:23], a[64:67], v[188:191], v[20:23]
    v_mfma_f32_16x16x32_bf16 v[24:27], a[64:67], v[192:195], v[24:27]
    v_mfma_f32_16x16x32_bf16 v[32:35], a[64:67], v[196:199], v[32:35]
    v_mfma_f32_16x16x32_bf16 v[28:31], a[64:67], v[200:203], v[28:31]
    v_mfma_f32_16x16x32_bf16 v[36:39], a[64:67], v[204:207], v[36:39]
    v_mfma_f32_16x16x32_bf16 v[40:43], a[68:71], v[176:179], v[40:43]
    v_mfma_f32_16x16x32_bf16 v[48:51], a[68:71], v[180:183], v[48:51]
    v_mfma_f32_16x16x32_bf16 v[44:47], a[68:71], v[184:187], v[44:47]
    v_mfma_f32_16x16x32_bf16 v[52:55], a[68:71], v[188:191], v[52:55]
    v_mfma_f32_16x16x32_bf16 v[56:59], a[68:71], v[192:195], v[56:59]
    v_mfma_f32_16x16x32_bf16 v[64:67], a[68:71], v[196:199], v[64:67]
    v_mfma_f32_16x16x32_bf16 v[60:63], a[68:71], v[200:203], v[60:63]
    v_mfma_f32_16x16x32_bf16 v[68:71], a[68:71], v[204:207], v[68:71]
    v_mfma_f32_16x16x32_bf16 v[72:75], a[72:75], v[176:179], v[72:75]
    v_mfma_f32_16x16x32_bf16 v[80:83], a[72:75], v[180:183], v[80:83]
    v_mfma_f32_16x16x32_bf16 v[76:79], a[72:75], v[184:187], v[76:79]
    v_mfma_f32_16x16x32_bf16 v[84:87], a[72:75], v[188:191], v[84:87]
    v_mfma_f32_16x16x32_bf16 v[88:91], a[72:75], v[192:195], v[88:91]
    v_mfma_f32_16x16x32_bf16 v[96:99], a[72:75], v[196:199], v[96:99]
    v_mfma_f32_16x16x32_bf16 v[92:95], a[72:75], v[200:203], v[92:95]
    v_mfma_f32_16x16x32_bf16 v[100:103], a[72:75], v[204:207], v[100:103]
    v_mfma_f32_16x16x32_bf16 v[104:107], a[76:79], v[176:179], v[104:107]
    v_mfma_f32_16x16x32_bf16 v[112:115], a[76:79], v[180:183], v[112:115]
    v_mfma_f32_16x16x32_bf16 v[108:111], a[76:79], v[184:187], v[108:111]
    v_mfma_f32_16x16x32_bf16 v[116:119], a[76:79], v[188:191], v[116:119]
    s_mov_b32 s31, 2
L_main_kernel_loop_1049:
    v_mfma_f32_16x16x32_bf16 v[8:11], v[120:123], a[0:3], v[8:11]
    ds_read_b128 v[148:151], v3 offset:7168
    v_mfma_f32_16x16x32_bf16 v[16:19], v[120:123], a[4:7], v[16:19]
    s_waitcnt lgkmcnt(6)
    buffer_load_dwordx4 a[24:27], v243, s[8:11], s28 offen offset:2048 sc1
    v_mfma_f32_16x16x32_bf16 v[12:15], v[124:127], a[0:3], v[12:15]
    ds_read_b128 v[120:123], v3 offset:8192
    v_mfma_f32_16x16x32_bf16 v[20:23], v[124:127], a[4:7], v[20:23]
    s_waitcnt lgkmcnt(6)
    buffer_load_dwordx4 v3, s[20:23], s29 offen offset:2048 lds
    v_mfma_f32_16x16x32_bf16 v[24:27], v[128:131], a[0:3], v[24:27]
    ds_read_b128 v[124:127], v3 offset:9216
    v_mfma_f32_16x16x32_bf16 v[32:35], v[128:131], a[4:7], v[32:35]
    s_waitcnt lgkmcnt(6)
    buffer_load_dwordx4 a[28:31], v243, s[8:11], s28 offen offset:2304 sc1
    s_add_u32 s28, s28, 4096
    v_mfma_f32_16x16x32_bf16 v[28:31], v[132:135], a[0:3], v[28:31]
    ds_read_b128 v[128:131], v3 offset:10240
    v_mfma_f32_16x16x32_bf16 v[36:39], v[132:135], a[4:7], v[36:39]
    s_waitcnt lgkmcnt(6)
    v_mfma_f32_16x16x32_bf16 v[40:43], v[136:139], a[0:3], v[40:43]
    ds_read_b128 v[132:135], v3 offset:11264
    v_mfma_f32_16x16x32_bf16 v[48:51], v[136:139], a[4:7], v[48:51]
    s_waitcnt lgkmcnt(6)
    v_mfma_f32_16x16x32_bf16 v[44:47], v[140:143], a[0:3], v[44:47]
    ds_read_b128 v[136:139], v3 offset:12288
    v_mfma_f32_16x16x32_bf16 v[52:55], v[140:143], a[4:7], v[52:55]
    s_waitcnt lgkmcnt(6)
    buffer_load_dwordx4 v3, s[20:23], s29 offen offset:3072 lds
    v_mfma_f32_16x16x32_bf16 v[56:59], v[144:147], a[0:3], v[56:59]
    ds_read_b128 v[140:143], v3 offset:13312
    v_mfma_f32_16x16x32_bf16 v[64:67], v[144:147], a[4:7], v[64:67]
    s_waitcnt lgkmcnt(6)
    v_mfma_f32_16x16x32_bf16 v[60:63], v[148:151], a[0:3], v[60:63]
    ds_read_b128 v[144:147], v3 offset:14336
    v_mfma_f32_16x16x32_bf16 v[68:71], v[148:151], a[4:7], v[68:71]
    s_waitcnt lgkmcnt(6)
    v_mfma_f32_16x16x32_bf16 v[72:75], v[120:123], a[0:3], v[72:75]
    ds_read_b128 v[148:151], v3 offset:15360
    v_mfma_f32_16x16x32_bf16 v[80:83], v[120:123], a[4:7], v[80:83]
    s_waitcnt lgkmcnt(6)
    v_mfma_f32_16x16x32_bf16 v[76:79], v[124:127], a[0:3], v[76:79]
    ds_read_b128 v[120:123], v3 offset:16384
    v_mfma_f32_16x16x32_bf16 v[84:87], v[124:127], a[4:7], v[84:87]
    s_waitcnt lgkmcnt(6)
    s_add_u32 m0, s30, 61440
    s_add_u32 s60, s29, 4096
    buffer_load_dwordx4 v3, s[20:23], s60 offen offset:0 lds
    v_mfma_f32_16x16x32_bf16 v[88:91], v[128:131], a[0:3], v[88:91]
    ds_read_b128 v[124:127], v3 offset:17408
    v_mfma_f32_16x16x32_bf16 v[96:99], v[128:131], a[4:7], v[96:99]
    s_waitcnt lgkmcnt(6)
    v_mfma_f32_16x16x32_bf16 v[92:95], v[132:135], a[0:3], v[92:95]
    ds_read_b128 v[128:131], v3 offset:18432
    v_mfma_f32_16x16x32_bf16 v[100:103], v[132:135], a[4:7], v[100:103]
    s_waitcnt lgkmcnt(6)
    v_mfma_f32_16x16x32_bf16 v[104:107], v[136:139], a[0:3], v[104:107]
    ds_read_b128 v[132:135], v3 offset:19456
    v_mfma_f32_16x16x32_bf16 v[112:115], v[136:139], a[4:7], v[112:115]
    s_waitcnt lgkmcnt(6)
    v_mfma_f32_16x16x32_bf16 v[108:111], v[140:143], a[0:3], v[108:111]
    ds_read_b128 v[136:139], v3 offset:20480
    v_mfma_f32_16x16x32_bf16 v[116:119], v[140:143], a[4:7], v[116:119]
    s_waitcnt lgkmcnt(6)
    s_waitcnt vmcnt(13)
    buffer_load_dwordx4 v3, s[20:23], s60 offen offset:1024 lds
    v_mfma_f32_16x16x32_bf16 v[8:11], v[144:147], a[8:11], v[8:11]
    ds_read_b128 v[140:143], v3 offset:21504
    v_mfma_f32_16x16x32_bf16 v[16:19], v[144:147], a[12:15], v[16:19]
    s_waitcnt lgkmcnt(6)
    buffer_load_dwordx4 a[0:3], v243, s[8:11], s28 offen offset:0 sc1
    v_mfma_f32_16x16x32_bf16 v[12:15], v[148:151], a[8:11], v[12:15]
    ds_read_b128 v[144:147], v3 offset:22528
    v_mfma_f32_16x16x32_bf16 v[20:23], v[148:151], a[12:15], v[20:23]
    s_waitcnt lgkmcnt(6)
    v_mfma_f32_16x16x32_bf16 v[24:27], v[120:123], a[8:11], v[24:27]
    ds_read_b128 v[148:151], v3 offset:23552
    v_mfma_f32_16x16x32_bf16 v[32:35], v[120:123], a[12:15], v[32:35]
    s_waitcnt lgkmcnt(6)
    buffer_load_dwordx4 a[4:7], v243, s[8:11], s28 offen offset:256 sc1
    v_mfma_f32_16x16x32_bf16 v[28:31], v[124:127], a[8:11], v[28:31]
    ds_read_b128 v[120:123], v3 offset:24576
    v_mfma_f32_16x16x32_bf16 v[36:39], v[124:127], a[12:15], v[36:39]
    s_waitcnt lgkmcnt(6)
    buffer_load_dwordx4 v3, s[20:23], s60 offen offset:2048 lds
    s_add_u32 s29, s29, 28672
    v_mfma_f32_16x16x32_bf16 v[40:43], v[128:131], a[8:11], v[40:43]
    ds_read_b128 v[124:127], v3 offset:25600
    v_mfma_f32_16x16x32_bf16 v[48:51], v[128:131], a[12:15], v[48:51]
    s_waitcnt lgkmcnt(6)
    v_mfma_f32_16x16x32_bf16 v[44:47], v[132:135], a[8:11], v[44:47]
    ds_read_b128 v[128:131], v3 offset:26624
    v_mfma_f32_16x16x32_bf16 v[52:55], v[132:135], a[12:15], v[52:55]
    s_waitcnt lgkmcnt(6)
    v_mfma_f32_16x16x32_bf16 v[56:59], v[136:139], a[8:11], v[56:59]
    ds_read_b128 v[132:135], v3 offset:27648
    v_mfma_f32_16x16x32_bf16 v[64:67], v[136:139], a[12:15], v[64:67]
    s_waitcnt lgkmcnt(6)
    s_waitcnt vmcnt(11)
    s_barrier
    v_mfma_f32_16x16x32_bf16 v[60:63], v[140:143], a[8:11], v[60:63]
    ds_read_b128 v[136:139], v3 offset:28672
    v_mfma_f32_16x16x32_bf16 v[68:71], v[140:143], a[12:15], v[68:71]
    s_waitcnt lgkmcnt(6)
    s_add_u32 m0, s30, 86016
    s_nop 0
    buffer_load_dwordx4 v3, s[20:23], s29 offen offset:0 lds
    v_mfma_f32_16x16x32_bf16 v[72:75], v[144:147], a[8:11], v[72:75]
    ds_read_b128 v[140:143], v3 offset:29696
    v_mfma_f32_16x16x32_bf16 v[80:83], v[144:147], a[12:15], v[80:83]
    s_waitcnt lgkmcnt(6)
    v_mfma_f32_16x16x32_bf16 v[76:79], v[148:151], a[8:11], v[76:79]
    ds_read_b128 v[144:147], v3 offset:30720
    v_mfma_f32_16x16x32_bf16 v[84:87], v[148:151], a[12:15], v[84:87]
    s_waitcnt lgkmcnt(6)
    v_mfma_f32_16x16x32_bf16 v[88:91], v[120:123], a[8:11], v[88:91]
    ds_read_b128 v[148:151], v3 offset:31744
    v_mfma_f32_16x16x32_bf16 v[96:99], v[120:123], a[12:15], v[96:99]
    s_waitcnt lgkmcnt(6)
    v_mfma_f32_16x16x32_bf16 v[92:95], v[124:127], a[8:11], v[92:95]
    ds_read_b128 v[120:123], v3 offset:32768
    v_mfma_f32_16x16x32_bf16 v[100:103], v[124:127], a[12:15], v[100:103]
    s_waitcnt lgkmcnt(6)
    buffer_load_dwordx4 v3, s[20:23], s29 offen offset:1024 lds
    v_mfma_f32_16x16x32_bf16 v[104:107], v[128:131], a[8:11], v[104:107]
    ds_read_b128 v[124:127], v3 offset:33792
    v_mfma_f32_16x16x32_bf16 v[112:115], v[128:131], a[12:15], v[112:115]
    s_waitcnt lgkmcnt(6)
    v_mfma_f32_16x16x32_bf16 v[108:111], v[132:135], a[8:11], v[108:111]
    ds_read_b128 v[128:131], v3 offset:34816
    v_mfma_f32_16x16x32_bf16 v[116:119], v[132:135], a[12:15], v[116:119]
    s_waitcnt lgkmcnt(6)
    s_waitcnt vmcnt(14)
    v_mfma_f32_16x16x32_bf16 v[8:11], v[136:139], a[16:19], v[8:11]
    ds_read_b128 v[132:135], v3 offset:35840
    v_mfma_f32_16x16x32_bf16 v[16:19], v[136:139], a[20:23], v[16:19]
    s_waitcnt lgkmcnt(6)
    buffer_load_dwordx4 a[8:11], v243, s[8:11], s28 offen offset:2048 sc1
    v_mfma_f32_16x16x32_bf16 v[12:15], v[140:143], a[16:19], v[12:15]
    ds_read_b128 v[136:139], v3 offset:36864
    v_mfma_f32_16x16x32_bf16 v[20:23], v[140:143], a[20:23], v[20:23]
    s_waitcnt lgkmcnt(6)
    buffer_load_dwordx4 v3, s[20:23], s29 offen offset:2048 lds
    v_mfma_f32_16x16x32_bf16 v[24:27], v[144:147], a[16:19], v[24:27]
    ds_read_b128 v[140:143], v3 offset:37888
    v_mfma_f32_16x16x32_bf16 v[32:35], v[144:147], a[20:23], v[32:35]
    s_waitcnt lgkmcnt(6)
    buffer_load_dwordx4 a[12:15], v243, s[8:11], s28 offen offset:2304 sc1
    s_add_u32 s28, s28, 4096
    v_mfma_f32_16x16x32_bf16 v[28:31], v[148:151], a[16:19], v[28:31]
    ds_read_b128 v[144:147], v3 offset:38912
    v_mfma_f32_16x16x32_bf16 v[36:39], v[148:151], a[20:23], v[36:39]
    s_waitcnt lgkmcnt(6)
    v_mfma_f32_16x16x32_bf16 v[40:43], v[120:123], a[16:19], v[40:43]
    ds_read_b128 v[148:151], v3 offset:39936
    v_mfma_f32_16x16x32_bf16 v[48:51], v[120:123], a[20:23], v[48:51]
    s_waitcnt lgkmcnt(6)
    v_mfma_f32_16x16x32_bf16 v[44:47], v[124:127], a[16:19], v[44:47]
    ds_read_b128 v[120:123], v3 offset:40960
    v_mfma_f32_16x16x32_bf16 v[52:55], v[124:127], a[20:23], v[52:55]
    s_waitcnt lgkmcnt(6)
    buffer_load_dwordx4 v3, s[20:23], s29 offen offset:3072 lds
    v_mfma_f32_16x16x32_bf16 v[56:59], v[128:131], a[16:19], v[56:59]
    ds_read_b128 v[124:127], v3 offset:41984
    v_mfma_f32_16x16x32_bf16 v[64:67], v[128:131], a[20:23], v[64:67]
    s_waitcnt lgkmcnt(6)
    v_mfma_f32_16x16x32_bf16 v[60:63], v[132:135], a[16:19], v[60:63]
    ds_read_b128 v[128:131], v3 offset:43008
    v_mfma_f32_16x16x32_bf16 v[68:71], v[132:135], a[20:23], v[68:71]
    s_waitcnt lgkmcnt(6)
    v_mfma_f32_16x16x32_bf16 v[72:75], v[136:139], a[16:19], v[72:75]
    ds_read_b128 v[132:135], v3 offset:44032
    v_mfma_f32_16x16x32_bf16 v[80:83], v[136:139], a[20:23], v[80:83]
    s_waitcnt lgkmcnt(6)
    v_mfma_f32_16x16x32_bf16 v[76:79], v[140:143], a[16:19], v[76:79]
    ds_read_b128 v[136:139], v3 offset:45056
    v_mfma_f32_16x16x32_bf16 v[84:87], v[140:143], a[20:23], v[84:87]
    s_waitcnt lgkmcnt(6)
    s_add_u32 m0, s30, 90112
    s_add_u32 s60, s29, 4096
    buffer_load_dwordx4 v3, s[20:23], s60 offen offset:0 lds
    v_mfma_f32_16x16x32_bf16 v[88:91], v[144:147], a[16:19], v[88:91]
    ds_read_b128 v[140:143], v3 offset:46080
    v_mfma_f32_16x16x32_bf16 v[96:99], v[144:147], a[20:23], v[96:99]
    s_waitcnt lgkmcnt(6)
    v_mfma_f32_16x16x32_bf16 v[92:95], v[148:151], a[16:19], v[92:95]
    ds_read_b128 v[144:147], v3 offset:47104
    v_mfma_f32_16x16x32_bf16 v[100:103], v[148:151], a[20:23], v[100:103]
    s_waitcnt lgkmcnt(6)
    v_mfma_f32_16x16x32_bf16 v[104:107], v[120:123], a[16:19], v[104:107]
    ds_read_b128 v[148:151], v3 offset:48128
    v_mfma_f32_16x16x32_bf16 v[112:115], v[120:123], a[20:23], v[112:115]
    s_waitcnt lgkmcnt(6)
    v_mfma_f32_16x16x32_bf16 v[108:111], v[124:127], a[16:19], v[108:111]
    ds_read_b128 v[120:123], v3 offset:49152
    v_mfma_f32_16x16x32_bf16 v[116:119], v[124:127], a[20:23], v[116:119]
    s_waitcnt lgkmcnt(6)
    s_waitcnt vmcnt(13)
    buffer_load_dwordx4 v3, s[20:23], s60 offen offset:1024 lds
    v_mfma_f32_16x16x32_bf16 v[8:11], v[128:131], a[24:27], v[8:11]
    ds_read_b128 v[124:127], v3 offset:50176
    v_mfma_f32_16x16x32_bf16 v[16:19], v[128:131], a[28:31], v[16:19]
    s_waitcnt lgkmcnt(6)
    buffer_load_dwordx4 a[16:19], v243, s[8:11], s28 offen offset:0 sc1
    v_mfma_f32_16x16x32_bf16 v[12:15], v[132:135], a[24:27], v[12:15]
    ds_read_b128 v[128:131], v3 offset:51200
    v_mfma_f32_16x16x32_bf16 v[20:23], v[132:135], a[28:31], v[20:23]
    s_waitcnt lgkmcnt(6)
    v_mfma_f32_16x16x32_bf16 v[24:27], v[136:139], a[24:27], v[24:27]
    ds_read_b128 v[132:135], v3 offset:52224
    v_mfma_f32_16x16x32_bf16 v[32:35], v[136:139], a[28:31], v[32:35]
    s_waitcnt lgkmcnt(6)
    buffer_load_dwordx4 a[20:23], v243, s[8:11], s28 offen offset:256 sc1
    v_mfma_f32_16x16x32_bf16 v[28:31], v[140:143], a[24:27], v[28:31]
    ds_read_b128 v[136:139], v3 offset:53248
    v_mfma_f32_16x16x32_bf16 v[36:39], v[140:143], a[28:31], v[36:39]
    s_waitcnt lgkmcnt(6)
    buffer_load_dwordx4 v3, s[20:23], s60 offen offset:2048 lds
    s_add_u32 s29, s29, 28672
    v_mfma_f32_16x16x32_bf16 v[40:43], v[144:147], a[24:27], v[40:43]
    ds_read_b128 v[140:143], v3 offset:54272
    v_mfma_f32_16x16x32_bf16 v[48:51], v[144:147], a[28:31], v[48:51]
    s_waitcnt lgkmcnt(6)
    v_mfma_f32_16x16x32_bf16 v[44:47], v[148:151], a[24:27], v[44:47]
    ds_read_b128 v[144:147], v3 offset:55296
    v_mfma_f32_16x16x32_bf16 v[52:55], v[148:151], a[28:31], v[52:55]
    s_waitcnt lgkmcnt(6)
    v_mfma_f32_16x16x32_bf16 v[56:59], v[120:123], a[24:27], v[56:59]
    ds_read_b128 v[148:151], v3 offset:56320
    v_mfma_f32_16x16x32_bf16 v[64:67], v[120:123], a[28:31], v[64:67]
    s_waitcnt lgkmcnt(6)
    s_waitcnt vmcnt(11)
    s_barrier
    v_mfma_f32_16x16x32_bf16 v[60:63], v[124:127], a[24:27], v[60:63]
    ds_read_b128 v[120:123], v3 offset:57344
    v_mfma_f32_16x16x32_bf16 v[68:71], v[124:127], a[28:31], v[68:71]
    s_waitcnt lgkmcnt(6)
    s_add_u32 m0, s30, 0
    s_nop 0
    buffer_load_dwordx4 v3, s[20:23], s29 offen offset:0 lds
    v_mfma_f32_16x16x32_bf16 v[72:75], v[128:131], a[24:27], v[72:75]
    ds_read_b128 v[124:127], v3 offset:58368
    v_mfma_f32_16x16x32_bf16 v[80:83], v[128:131], a[28:31], v[80:83]
    s_waitcnt lgkmcnt(6)
    v_mfma_f32_16x16x32_bf16 v[76:79], v[132:135], a[24:27], v[76:79]
    ds_read_b128 v[128:131], v3 offset:59392
    v_mfma_f32_16x16x32_bf16 v[84:87], v[132:135], a[28:31], v[84:87]
    s_waitcnt lgkmcnt(6)
    v_mfma_f32_16x16x32_bf16 v[88:91], v[136:139], a[24:27], v[88:91]
    ds_read_b128 v[132:135], v3 offset:60416
    v_mfma_f32_16x16x32_bf16 v[96:99], v[136:139], a[28:31], v[96:99]
    s_waitcnt lgkmcnt(6)
    v_mfma_f32_16x16x32_bf16 v[92:95], v[140:143], a[24:27], v[92:95]
    ds_read_b128 v[136:139], v3 offset:61440
    v_mfma_f32_16x16x32_bf16 v[100:103], v[140:143], a[28:31], v[100:103]
    s_waitcnt lgkmcnt(6)
    buffer_load_dwordx4 v3, s[20:23], s29 offen offset:1024 lds
    v_mfma_f32_16x16x32_bf16 v[104:107], v[144:147], a[24:27], v[104:107]
    ds_read_b128 v[140:143], v3 offset:62464
    v_mfma_f32_16x16x32_bf16 v[112:115], v[144:147], a[28:31], v[112:115]
    s_waitcnt lgkmcnt(6)
    v_mfma_f32_16x16x32_bf16 v[108:111], v[148:151], a[24:27], v[108:111]
    ds_read_b128 v[144:147], v3 offset:63488
    v_mfma_f32_16x16x32_bf16 v[116:119], v[148:151], a[28:31], v[116:119]
    s_waitcnt lgkmcnt(6)
    s_waitcnt vmcnt(14)
    v_mfma_f32_16x16x32_bf16 v[8:11], v[120:123], a[0:3], v[8:11]
    ds_read_b128 v[148:151], v3 offset:64512
    v_mfma_f32_16x16x32_bf16 v[16:19], v[120:123], a[4:7], v[16:19]
    s_waitcnt lgkmcnt(6)
    buffer_load_dwordx4 a[24:27], v243, s[8:11], s28 offen offset:2048 sc1
    v_mfma_f32_16x16x32_bf16 v[12:15], v[124:127], a[0:3], v[12:15]
    ds_read_b128 v[120:123], v4 offset:0
    v_mfma_f32_16x16x32_bf16 v[20:23], v[124:127], a[4:7], v[20:23]
    s_waitcnt lgkmcnt(6)
    buffer_load_dwordx4 v3, s[20:23], s29 offen offset:2048 lds
    v_mfma_f32_16x16x32_bf16 v[24:27], v[128:131], a[0:3], v[24:27]
    ds_read_b128 v[124:127], v4 offset:1024
    v_mfma_f32_16x16x32_bf16 v[32:35], v[128:131], a[4:7], v[32:35]
    s_waitcnt lgkmcnt(6)
    buffer_load_dwordx4 a[28:31], v243, s[8:11], s28 offen offset:2304 sc1
    s_add_u32 s28, s28, 4096
    v_mfma_f32_16x16x32_bf16 v[28:31], v[132:135], a[0:3], v[28:31]
    ds_read_b128 v[128:131], v4 offset:2048
    v_mfma_f32_16x16x32_bf16 v[36:39], v[132:135], a[4:7], v[36:39]
    s_waitcnt lgkmcnt(6)
    v_mfma_f32_16x16x32_bf16 v[40:43], v[136:139], a[0:3], v[40:43]
    ds_read_b128 v[132:135], v4 offset:3072
    v_mfma_f32_16x16x32_bf16 v[48:51], v[136:139], a[4:7], v[48:51]
    s_waitcnt lgkmcnt(6)
    v_mfma_f32_16x16x32_bf16 v[44:47], v[140:143], a[0:3], v[44:47]
    ds_read_b128 v[136:139], v4 offset:4096
    v_mfma_f32_16x16x32_bf16 v[52:55], v[140:143], a[4:7], v[52:55]
    s_waitcnt lgkmcnt(6)
    buffer_load_dwordx4 v3, s[20:23], s29 offen offset:3072 lds
    v_mfma_f32_16x16x32_bf16 v[56:59], v[144:147], a[0:3], v[56:59]
    ds_read_b128 v[140:143], v4 offset:5120
    v_mfma_f32_16x16x32_bf16 v[64:67], v[144:147], a[4:7], v[64:67]
    s_waitcnt lgkmcnt(6)
    v_mfma_f32_16x16x32_bf16 v[60:63], v[148:151], a[0:3], v[60:63]
    ds_read_b128 v[144:147], v4 offset:6144
    v_mfma_f32_16x16x32_bf16 v[68:71], v[148:151], a[4:7], v[68:71]
    s_waitcnt lgkmcnt(6)
    v_mfma_f32_16x16x32_bf16 v[72:75], v[120:123], a[0:3], v[72:75]
    ds_read_b128 v[148:151], v4 offset:7168
    v_mfma_f32_16x16x32_bf16 v[80:83], v[120:123], a[4:7], v[80:83]
    s_waitcnt lgkmcnt(6)
    v_mfma_f32_16x16x32_bf16 v[76:79], v[124:127], a[0:3], v[76:79]
    ds_read_b128 v[120:123], v4 offset:8192
    v_mfma_f32_16x16x32_bf16 v[84:87], v[124:127], a[4:7], v[84:87]
    s_waitcnt lgkmcnt(6)
    s_add_u32 m0, s30, 4096
    s_add_u32 s60, s29, 4096
    buffer_load_dwordx4 v3, s[20:23], s60 offen offset:0 lds
    v_mfma_f32_16x16x32_bf16 v[88:91], v[128:131], a[0:3], v[88:91]
    ds_read_b128 v[124:127], v4 offset:9216
    v_mfma_f32_16x16x32_bf16 v[96:99], v[128:131], a[4:7], v[96:99]
    s_waitcnt lgkmcnt(6)
    v_mfma_f32_16x16x32_bf16 v[92:95], v[132:135], a[0:3], v[92:95]
    ds_read_b128 v[128:131], v4 offset:10240
    v_mfma_f32_16x16x32_bf16 v[100:103], v[132:135], a[4:7], v[100:103]
    s_waitcnt lgkmcnt(6)
    v_mfma_f32_16x16x32_bf16 v[104:107], v[136:139], a[0:3], v[104:107]
    ds_read_b128 v[132:135], v4 offset:11264
    v_mfma_f32_16x16x32_bf16 v[112:115], v[136:139], a[4:7], v[112:115]
    s_waitcnt lgkmcnt(6)
    v_mfma_f32_16x16x32_bf16 v[108:111], v[140:143], a[0:3], v[108:111]
    ds_read_b128 v[136:139], v4 offset:12288
    v_mfma_f32_16x16x32_bf16 v[116:119], v[140:143], a[4:7], v[116:119]
    s_waitcnt lgkmcnt(6)
    s_waitcnt vmcnt(13)
    buffer_load_dwordx4 v3, s[20:23], s60 offen offset:1024 lds
    v_mfma_f32_16x16x32_bf16 v[8:11], v[144:147], a[8:11], v[8:11]
    ds_read_b128 v[140:143], v4 offset:13312
    v_mfma_f32_16x16x32_bf16 v[16:19], v[144:147], a[12:15], v[16:19]
    s_waitcnt lgkmcnt(6)
    buffer_load_dwordx4 a[0:3], v243, s[8:11], s28 offen offset:0 sc1
    v_mfma_f32_16x16x32_bf16 v[12:15], v[148:151], a[8:11], v[12:15]
    ds_read_b128 v[144:147], v4 offset:14336
    v_mfma_f32_16x16x32_bf16 v[20:23], v[148:151], a[12:15], v[20:23]
    s_waitcnt lgkmcnt(6)
    v_mfma_f32_16x16x32_bf16 v[24:27], v[120:123], a[8:11], v[24:27]
    ds_read_b128 v[148:151], v4 offset:15360
    v_mfma_f32_16x16x32_bf16 v[32:35], v[120:123], a[12:15], v[32:35]
    s_waitcnt lgkmcnt(6)
    buffer_load_dwordx4 a[4:7], v243, s[8:11], s28 offen offset:256 sc1
    v_mfma_f32_16x16x32_bf16 v[28:31], v[124:127], a[8:11], v[28:31]
    ds_read_b128 v[120:123], v4 offset:16384
    v_mfma_f32_16x16x32_bf16 v[36:39], v[124:127], a[12:15], v[36:39]
    s_waitcnt lgkmcnt(6)
    buffer_load_dwordx4 v3, s[20:23], s60 offen offset:2048 lds
    s_add_u32 s29, s29, 28672
    v_mfma_f32_16x16x32_bf16 v[40:43], v[128:131], a[8:11], v[40:43]
    ds_read_b128 v[124:127], v4 offset:17408
    v_mfma_f32_16x16x32_bf16 v[48:51], v[128:131], a[12:15], v[48:51]
    s_waitcnt lgkmcnt(6)
    v_mfma_f32_16x16x32_bf16 v[44:47], v[132:135], a[8:11], v[44:47]
    ds_read_b128 v[128:131], v4 offset:18432
    v_mfma_f32_16x16x32_bf16 v[52:55], v[132:135], a[12:15], v[52:55]
    s_waitcnt lgkmcnt(6)
    v_mfma_f32_16x16x32_bf16 v[56:59], v[136:139], a[8:11], v[56:59]
    ds_read_b128 v[132:135], v4 offset:19456
    v_mfma_f32_16x16x32_bf16 v[64:67], v[136:139], a[12:15], v[64:67]
    s_waitcnt lgkmcnt(6)
    s_waitcnt vmcnt(11)
    s_barrier
    v_mfma_f32_16x16x32_bf16 v[60:63], v[140:143], a[8:11], v[60:63]
    ds_read_b128 v[136:139], v4 offset:20480
    v_mfma_f32_16x16x32_bf16 v[68:71], v[140:143], a[12:15], v[68:71]
    s_waitcnt lgkmcnt(6)
    s_add_u32 m0, s30, 28672
    s_nop 0
    buffer_load_dwordx4 v3, s[20:23], s29 offen offset:0 lds
    v_mfma_f32_16x16x32_bf16 v[72:75], v[144:147], a[8:11], v[72:75]
    ds_read_b128 v[140:143], v4 offset:21504
    v_mfma_f32_16x16x32_bf16 v[80:83], v[144:147], a[12:15], v[80:83]
    s_waitcnt lgkmcnt(6)
    v_mfma_f32_16x16x32_bf16 v[76:79], v[148:151], a[8:11], v[76:79]
    ds_read_b128 v[144:147], v4 offset:22528
    v_mfma_f32_16x16x32_bf16 v[84:87], v[148:151], a[12:15], v[84:87]
    s_waitcnt lgkmcnt(6)
    v_mfma_f32_16x16x32_bf16 v[88:91], v[120:123], a[8:11], v[88:91]
    ds_read_b128 v[148:151], v4 offset:23552
    v_mfma_f32_16x16x32_bf16 v[96:99], v[120:123], a[12:15], v[96:99]
    s_waitcnt lgkmcnt(6)
    v_mfma_f32_16x16x32_bf16 v[92:95], v[124:127], a[8:11], v[92:95]
    ds_read_b128 v[120:123], v4 offset:24576
    v_mfma_f32_16x16x32_bf16 v[100:103], v[124:127], a[12:15], v[100:103]
    s_waitcnt lgkmcnt(6)
    buffer_load_dwordx4 v3, s[20:23], s29 offen offset:1024 lds
    v_mfma_f32_16x16x32_bf16 v[104:107], v[128:131], a[8:11], v[104:107]
    ds_read_b128 v[124:127], v4 offset:25600
    v_mfma_f32_16x16x32_bf16 v[112:115], v[128:131], a[12:15], v[112:115]
    s_waitcnt lgkmcnt(6)
    v_mfma_f32_16x16x32_bf16 v[108:111], v[132:135], a[8:11], v[108:111]
    ds_read_b128 v[128:131], v4 offset:26624
    v_mfma_f32_16x16x32_bf16 v[116:119], v[132:135], a[12:15], v[116:119]
    s_waitcnt lgkmcnt(6)
    s_waitcnt vmcnt(14)
    v_mfma_f32_16x16x32_bf16 v[8:11], v[136:139], a[16:19], v[8:11]
    ds_read_b128 v[132:135], v4 offset:27648
    v_mfma_f32_16x16x32_bf16 v[16:19], v[136:139], a[20:23], v[16:19]
    s_waitcnt lgkmcnt(6)
    buffer_load_dwordx4 a[8:11], v243, s[8:11], s28 offen offset:2048 sc1
    v_mfma_f32_16x16x32_bf16 v[12:15], v[140:143], a[16:19], v[12:15]
    ds_read_b128 v[136:139], v4 offset:28672
    v_mfma_f32_16x16x32_bf16 v[20:23], v[140:143], a[20:23], v[20:23]
    s_waitcnt lgkmcnt(6)
    buffer_load_dwordx4 v3, s[20:23], s29 offen offset:2048 lds
    v_mfma_f32_16x16x32_bf16 v[24:27], v[144:147], a[16:19], v[24:27]
    ds_read_b128 v[140:143], v4 offset:29696
    v_mfma_f32_16x16x32_bf16 v[32:35], v[144:147], a[20:23], v[32:35]
    s_waitcnt lgkmcnt(6)
    buffer_load_dwordx4 a[12:15], v243, s[8:11], s28 offen offset:2304 sc1
    s_add_u32 s28, s28, 4096
    v_mfma_f32_16x16x32_bf16 v[28:31], v[148:151], a[16:19], v[28:31]
    ds_read_b128 v[144:147], v4 offset:30720
    v_mfma_f32_16x16x32_bf16 v[36:39], v[148:151], a[20:23], v[36:39]
    s_waitcnt lgkmcnt(6)
    v_mfma_f32_16x16x32_bf16 v[40:43], v[120:123], a[16:19], v[40:43]
    ds_read_b128 v[148:151], v4 offset:31744
    v_mfma_f32_16x16x32_bf16 v[48:51], v[120:123], a[20:23], v[48:51]
    s_waitcnt lgkmcnt(6)
    v_mfma_f32_16x16x32_bf16 v[44:47], v[124:127], a[16:19], v[44:47]
    ds_read_b128 v[120:123], v4 offset:32768
    v_mfma_f32_16x16x32_bf16 v[52:55], v[124:127], a[20:23], v[52:55]
    s_waitcnt lgkmcnt(6)
    buffer_load_dwordx4 v3, s[20:23], s29 offen offset:3072 lds
    v_mfma_f32_16x16x32_bf16 v[56:59], v[128:131], a[16:19], v[56:59]
    ds_read_b128 v[124:127], v4 offset:33792
    v_mfma_f32_16x16x32_bf16 v[64:67], v[128:131], a[20:23], v[64:67]
    s_waitcnt lgkmcnt(6)
    v_mfma_f32_16x16x32_bf16 v[60:63], v[132:135], a[16:19], v[60:63]
    ds_read_b128 v[128:131], v4 offset:34816
    v_mfma_f32_16x16x32_bf16 v[68:71], v[132:135], a[20:23], v[68:71]
    s_waitcnt lgkmcnt(6)
    v_mfma_f32_16x16x32_bf16 v[72:75], v[136:139], a[16:19], v[72:75]
    ds_read_b128 v[132:135], v4 offset:35840
    v_mfma_f32_16x16x32_bf16 v[80:83], v[136:139], a[20:23], v[80:83]
    s_waitcnt lgkmcnt(6)
    v_mfma_f32_16x16x32_bf16 v[76:79], v[140:143], a[16:19], v[76:79]
    ds_read_b128 v[136:139], v4 offset:36864
    v_mfma_f32_16x16x32_bf16 v[84:87], v[140:143], a[20:23], v[84:87]
    s_waitcnt lgkmcnt(6)
    s_add_u32 m0, s30, 32768
    s_add_u32 s60, s29, 4096
    buffer_load_dwordx4 v3, s[20:23], s60 offen offset:0 lds
    v_mfma_f32_16x16x32_bf16 v[88:91], v[144:147], a[16:19], v[88:91]
    ds_read_b128 v[140:143], v4 offset:37888
    v_mfma_f32_16x16x32_bf16 v[96:99], v[144:147], a[20:23], v[96:99]
    s_waitcnt lgkmcnt(6)
    v_mfma_f32_16x16x32_bf16 v[92:95], v[148:151], a[16:19], v[92:95]
    ds_read_b128 v[144:147], v4 offset:38912
    v_mfma_f32_16x16x32_bf16 v[100:103], v[148:151], a[20:23], v[100:103]
    s_waitcnt lgkmcnt(6)
    v_mfma_f32_16x16x32_bf16 v[104:107], v[120:123], a[16:19], v[104:107]
    ds_read_b128 v[148:151], v4 offset:39936
    v_mfma_f32_16x16x32_bf16 v[112:115], v[120:123], a[20:23], v[112:115]
    s_waitcnt lgkmcnt(6)
    v_mfma_f32_16x16x32_bf16 v[108:111], v[124:127], a[16:19], v[108:111]
    ds_read_b128 v[120:123], v4 offset:40960
    v_mfma_f32_16x16x32_bf16 v[116:119], v[124:127], a[20:23], v[116:119]
    s_waitcnt lgkmcnt(6)
    s_waitcnt vmcnt(13)
    buffer_load_dwordx4 v3, s[20:23], s60 offen offset:1024 lds
    v_mfma_f32_16x16x32_bf16 v[8:11], v[128:131], a[24:27], v[8:11]
    ds_read_b128 v[124:127], v4 offset:41984
    v_mfma_f32_16x16x32_bf16 v[16:19], v[128:131], a[28:31], v[16:19]
    s_waitcnt lgkmcnt(6)
    buffer_load_dwordx4 a[16:19], v243, s[8:11], s28 offen offset:0 sc1
    v_mfma_f32_16x16x32_bf16 v[12:15], v[132:135], a[24:27], v[12:15]
    ds_read_b128 v[128:131], v4 offset:43008
    v_mfma_f32_16x16x32_bf16 v[20:23], v[132:135], a[28:31], v[20:23]
    s_waitcnt lgkmcnt(6)
    v_mfma_f32_16x16x32_bf16 v[24:27], v[136:139], a[24:27], v[24:27]
    ds_read_b128 v[132:135], v4 offset:44032
    v_mfma_f32_16x16x32_bf16 v[32:35], v[136:139], a[28:31], v[32:35]
    s_waitcnt lgkmcnt(6)
    buffer_load_dwordx4 a[20:23], v243, s[8:11], s28 offen offset:256 sc1
    v_mfma_f32_16x16x32_bf16 v[28:31], v[140:143], a[24:27], v[28:31]
    ds_read_b128 v[136:139], v4 offset:45056
    v_mfma_f32_16x16x32_bf16 v[36:39], v[140:143], a[28:31], v[36:39]
    s_waitcnt lgkmcnt(6)
    buffer_load_dwordx4 v3, s[20:23], s60 offen offset:2048 lds
    s_add_u32 s29, s29, 28672
    v_mfma_f32_16x16x32_bf16 v[40:43], v[144:147], a[24:27], v[40:43]
    ds_read_b128 v[140:143], v4 offset:46080
    v_mfma_f32_16x16x32_bf16 v[48:51], v[144:147], a[28:31], v[48:51]
    s_waitcnt lgkmcnt(6)
    v_mfma_f32_16x16x32_bf16 v[44:47], v[148:151], a[24:27], v[44:47]
    ds_read_b128 v[144:147], v4 offset:47104
    v_mfma_f32_16x16x32_bf16 v[52:55], v[148:151], a[28:31], v[52:55]
    s_waitcnt lgkmcnt(6)
    v_mfma_f32_16x16x32_bf16 v[56:59], v[120:123], a[24:27], v[56:59]
    ds_read_b128 v[148:151], v4 offset:48128
    v_mfma_f32_16x16x32_bf16 v[64:67], v[120:123], a[28:31], v[64:67]
    s_waitcnt lgkmcnt(6)
    s_waitcnt vmcnt(11)
    s_barrier
    v_mfma_f32_16x16x32_bf16 v[60:63], v[124:127], a[24:27], v[60:63]
    ds_read_b128 v[120:123], v3 offset:0
    v_mfma_f32_16x16x32_bf16 v[68:71], v[124:127], a[28:31], v[68:71]
    s_waitcnt lgkmcnt(6)
    s_add_u32 m0, s30, 57344
    s_nop 0
    buffer_load_dwordx4 v3, s[20:23], s29 offen offset:0 lds
    v_mfma_f32_16x16x32_bf16 v[72:75], v[128:131], a[24:27], v[72:75]
    ds_read_b128 v[124:127], v3 offset:1024
    v_mfma_f32_16x16x32_bf16 v[80:83], v[128:131], a[28:31], v[80:83]
    s_waitcnt lgkmcnt(6)
    v_mfma_f32_16x16x32_bf16 v[76:79], v[132:135], a[24:27], v[76:79]
    ds_read_b128 v[128:131], v3 offset:2048
    v_mfma_f32_16x16x32_bf16 v[84:87], v[132:135], a[28:31], v[84:87]
    s_waitcnt lgkmcnt(6)
    v_mfma_f32_16x16x32_bf16 v[88:91], v[136:139], a[24:27], v[88:91]
    ds_read_b128 v[132:135], v3 offset:3072
    v_mfma_f32_16x16x32_bf16 v[96:99], v[136:139], a[28:31], v[96:99]
    s_waitcnt lgkmcnt(6)
    v_mfma_f32_16x16x32_bf16 v[92:95], v[140:143], a[24:27], v[92:95]
    ds_read_b128 v[136:139], v3 offset:4096
    v_mfma_f32_16x16x32_bf16 v[100:103], v[140:143], a[28:31], v[100:103]
    s_waitcnt lgkmcnt(6)
    buffer_load_dwordx4 v3, s[20:23], s29 offen offset:1024 lds
    v_mfma_f32_16x16x32_bf16 v[104:107], v[144:147], a[24:27], v[104:107]
    ds_read_b128 v[140:143], v3 offset:5120
    v_mfma_f32_16x16x32_bf16 v[112:115], v[144:147], a[28:31], v[112:115]
    s_waitcnt lgkmcnt(6)
    v_mfma_f32_16x16x32_bf16 v[108:111], v[148:151], a[24:27], v[108:111]
    ds_read_b128 v[144:147], v3 offset:6144
    v_mfma_f32_16x16x32_bf16 v[116:119], v[148:151], a[28:31], v[116:119]
    s_waitcnt lgkmcnt(6)
    s_waitcnt vmcnt(14)
    s_sub_u32 s31, s31, 1
    s_cmp_lg_u32 s31, 0
    s_cbranch_scc1 L_main_kernel_loop_1049
    v_mfma_f32_16x16x32_bf16 v[8:11], v[120:123], a[0:3], v[8:11]
    ds_read_b128 v[148:151], v3 offset:7168
    v_mfma_f32_16x16x32_bf16 v[16:19], v[120:123], a[4:7], v[16:19]
    s_waitcnt lgkmcnt(6)
    buffer_load_dwordx4 a[24:27], v243, s[8:11], s28 offen offset:2048 sc1
    v_mfma_f32_16x16x32_bf16 v[12:15], v[124:127], a[0:3], v[12:15]
    ds_read_b128 v[120:123], v3 offset:8192
    v_mfma_f32_16x16x32_bf16 v[20:23], v[124:127], a[4:7], v[20:23]
    s_waitcnt lgkmcnt(6)
    buffer_load_dwordx4 v3, s[20:23], s29 offen offset:2048 lds
    v_mfma_f32_16x16x32_bf16 v[24:27], v[128:131], a[0:3], v[24:27]
    ds_read_b128 v[124:127], v3 offset:9216
    v_mfma_f32_16x16x32_bf16 v[32:35], v[128:131], a[4:7], v[32:35]
    s_waitcnt lgkmcnt(6)
    buffer_load_dwordx4 a[28:31], v243, s[8:11], s28 offen offset:2304 sc1
    s_add_u32 s28, s28, 4096
    v_mfma_f32_16x16x32_bf16 v[28:31], v[132:135], a[0:3], v[28:31]
    ds_read_b128 v[128:131], v3 offset:10240
    v_mfma_f32_16x16x32_bf16 v[36:39], v[132:135], a[4:7], v[36:39]
    s_waitcnt lgkmcnt(6)
    v_mfma_f32_16x16x32_bf16 v[40:43], v[136:139], a[0:3], v[40:43]
    ds_read_b128 v[132:135], v3 offset:11264
    v_mfma_f32_16x16x32_bf16 v[48:51], v[136:139], a[4:7], v[48:51]
    s_waitcnt lgkmcnt(6)
    v_mfma_f32_16x16x32_bf16 v[44:47], v[140:143], a[0:3], v[44:47]
    ds_read_b128 v[136:139], v3 offset:12288
    v_mfma_f32_16x16x32_bf16 v[52:55], v[140:143], a[4:7], v[52:55]
    s_waitcnt lgkmcnt(6)
    buffer_load_dwordx4 v3, s[20:23], s29 offen offset:3072 lds
    v_mfma_f32_16x16x32_bf16 v[56:59], v[144:147], a[0:3], v[56:59]
    ds_read_b128 v[140:143], v3 offset:13312
    v_mfma_f32_16x16x32_bf16 v[64:67], v[144:147], a[4:7], v[64:67]
    s_waitcnt lgkmcnt(6)
    v_mfma_f32_16x16x32_bf16 v[60:63], v[148:151], a[0:3], v[60:63]
    ds_read_b128 v[144:147], v3 offset:14336
    v_mfma_f32_16x16x32_bf16 v[68:71], v[148:151], a[4:7], v[68:71]
    s_waitcnt lgkmcnt(6)
    v_mfma_f32_16x16x32_bf16 v[72:75], v[120:123], a[0:3], v[72:75]
    ds_read_b128 v[148:151], v3 offset:15360
    v_mfma_f32_16x16x32_bf16 v[80:83], v[120:123], a[4:7], v[80:83]
    s_waitcnt lgkmcnt(6)
    v_mfma_f32_16x16x32_bf16 v[76:79], v[124:127], a[0:3], v[76:79]
    ds_read_b128 v[120:123], v3 offset:16384
    v_mfma_f32_16x16x32_bf16 v[84:87], v[124:127], a[4:7], v[84:87]
    s_waitcnt lgkmcnt(6)
    s_add_u32 m0, s30, 61440
    s_add_u32 s60, s29, 4096
    buffer_load_dwordx4 v3, s[20:23], s60 offen offset:0 lds
    v_mfma_f32_16x16x32_bf16 v[88:91], v[128:131], a[0:3], v[88:91]
    ds_read_b128 v[124:127], v3 offset:17408
    v_mfma_f32_16x16x32_bf16 v[96:99], v[128:131], a[4:7], v[96:99]
    s_waitcnt lgkmcnt(6)
    v_mfma_f32_16x16x32_bf16 v[92:95], v[132:135], a[0:3], v[92:95]
    ds_read_b128 v[128:131], v3 offset:18432
    v_mfma_f32_16x16x32_bf16 v[100:103], v[132:135], a[4:7], v[100:103]
    s_waitcnt lgkmcnt(6)
    v_mfma_f32_16x16x32_bf16 v[104:107], v[136:139], a[0:3], v[104:107]
    ds_read_b128 v[132:135], v3 offset:19456
    v_mfma_f32_16x16x32_bf16 v[112:115], v[136:139], a[4:7], v[112:115]
    s_waitcnt lgkmcnt(6)
    v_mfma_f32_16x16x32_bf16 v[108:111], v[140:143], a[0:3], v[108:111]
    ds_read_b128 v[136:139], v3 offset:20480
    v_mfma_f32_16x16x32_bf16 v[116:119], v[140:143], a[4:7], v[116:119]
    s_waitcnt lgkmcnt(6)
    s_waitcnt vmcnt(13)
    buffer_load_dwordx4 v3, s[20:23], s60 offen offset:1024 lds
    v_mfma_f32_16x16x32_bf16 v[8:11], v[144:147], a[8:11], v[8:11]
    ds_read_b128 v[140:143], v3 offset:21504
    v_mfma_f32_16x16x32_bf16 v[16:19], v[144:147], a[12:15], v[16:19]
    s_waitcnt lgkmcnt(6)
    buffer_load_dwordx4 a[0:3], v243, s[8:11], s28 offen offset:0 sc1
    v_mfma_f32_16x16x32_bf16 v[12:15], v[148:151], a[8:11], v[12:15]
    ds_read_b128 v[144:147], v3 offset:22528
    v_mfma_f32_16x16x32_bf16 v[20:23], v[148:151], a[12:15], v[20:23]
    s_waitcnt lgkmcnt(6)
    v_mfma_f32_16x16x32_bf16 v[24:27], v[120:123], a[8:11], v[24:27]
    ds_read_b128 v[148:151], v3 offset:23552
    v_mfma_f32_16x16x32_bf16 v[32:35], v[120:123], a[12:15], v[32:35]
    s_waitcnt lgkmcnt(6)
    buffer_load_dwordx4 a[4:7], v243, s[8:11], s28 offen offset:256 sc1
    v_mfma_f32_16x16x32_bf16 v[28:31], v[124:127], a[8:11], v[28:31]
    ds_read_b128 v[120:123], v3 offset:24576
    v_mfma_f32_16x16x32_bf16 v[36:39], v[124:127], a[12:15], v[36:39]
    s_waitcnt lgkmcnt(6)
    buffer_load_dwordx4 v3, s[20:23], s60 offen offset:2048 lds
    s_add_u32 s29, s29, 28672
    v_mfma_f32_16x16x32_bf16 v[40:43], v[128:131], a[8:11], v[40:43]
    ds_read_b128 v[124:127], v3 offset:25600
    v_mfma_f32_16x16x32_bf16 v[48:51], v[128:131], a[12:15], v[48:51]
    s_waitcnt lgkmcnt(6)
    v_mfma_f32_16x16x32_bf16 v[44:47], v[132:135], a[8:11], v[44:47]
    ds_read_b128 v[128:131], v3 offset:26624
    v_mfma_f32_16x16x32_bf16 v[52:55], v[132:135], a[12:15], v[52:55]
    s_waitcnt lgkmcnt(6)
    v_mfma_f32_16x16x32_bf16 v[56:59], v[136:139], a[8:11], v[56:59]
    ds_read_b128 v[132:135], v3 offset:27648
    v_mfma_f32_16x16x32_bf16 v[64:67], v[136:139], a[12:15], v[64:67]
    s_waitcnt lgkmcnt(6)
    s_waitcnt vmcnt(11)
    s_barrier
    v_mfma_f32_16x16x32_bf16 v[60:63], v[140:143], a[8:11], v[60:63]
    ds_read_b128 v[136:139], v3 offset:28672
    v_mfma_f32_16x16x32_bf16 v[68:71], v[140:143], a[12:15], v[68:71]
    s_waitcnt lgkmcnt(6)
    s_add_u32 m0, s30, 86016
    s_nop 0
    buffer_load_dwordx4 v3, s[20:23], s29 offen offset:0 lds
    v_mfma_f32_16x16x32_bf16 v[72:75], v[144:147], a[8:11], v[72:75]
    ds_read_b128 v[140:143], v3 offset:29696
    v_mfma_f32_16x16x32_bf16 v[80:83], v[144:147], a[12:15], v[80:83]
    s_waitcnt lgkmcnt(6)
    v_mfma_f32_16x16x32_bf16 v[76:79], v[148:151], a[8:11], v[76:79]
    ds_read_b128 v[144:147], v3 offset:30720
    v_mfma_f32_16x16x32_bf16 v[84:87], v[148:151], a[12:15], v[84:87]
    s_waitcnt lgkmcnt(6)
    v_mfma_f32_16x16x32_bf16 v[88:91], v[120:123], a[8:11], v[88:91]
    ds_read_b128 v[148:151], v3 offset:31744
    v_mfma_f32_16x16x32_bf16 v[96:99], v[120:123], a[12:15], v[96:99]
    s_waitcnt lgkmcnt(6)
    buffer_load_dwordx4 v3, s[20:23], s29 offen offset:1024 lds
    v_mfma_f32_16x16x32_bf16 v[92:95], v[124:127], a[8:11], v[92:95]
    ds_read_b128 v[120:123], v3 offset:32768
    v_mfma_f32_16x16x32_bf16 v[100:103], v[124:127], a[12:15], v[100:103]
    s_waitcnt lgkmcnt(6)
    v_mfma_f32_16x16x32_bf16 v[104:107], v[128:131], a[8:11], v[104:107]
    ds_read_b128 v[124:127], v3 offset:33792
    v_mfma_f32_16x16x32_bf16 v[112:115], v[128:131], a[12:15], v[112:115]
    s_waitcnt lgkmcnt(6)
    v_mfma_f32_16x16x32_bf16 v[108:111], v[132:135], a[8:11], v[108:111]
    ds_read_b128 v[128:131], v3 offset:34816
    v_mfma_f32_16x16x32_bf16 v[116:119], v[132:135], a[12:15], v[116:119]
    s_waitcnt lgkmcnt(6)
    s_waitcnt vmcnt(14)
    buffer_load_dwordx4 v3, s[20:23], s29 offen offset:2048 lds
    v_mfma_f32_16x16x32_bf16 v[8:11], v[136:139], a[16:19], v[8:11]
    ds_read_b128 v[132:135], v3 offset:35840
    v_mfma_f32_16x16x32_bf16 v[16:19], v[136:139], a[20:23], v[16:19]
    s_waitcnt lgkmcnt(6)
    buffer_load_dwordx4 a[8:11], v243, s[8:11], s28 offen offset:2048 sc1
    v_mfma_f32_16x16x32_bf16 v[12:15], v[140:143], a[16:19], v[12:15]
    ds_read_b128 v[136:139], v3 offset:36864
    v_mfma_f32_16x16x32_bf16 v[20:23], v[140:143], a[20:23], v[20:23]
    s_waitcnt lgkmcnt(6)
    v_mfma_f32_16x16x32_bf16 v[24:27], v[144:147], a[16:19], v[24:27]
    ds_read_b128 v[140:143], v3 offset:37888
    v_mfma_f32_16x16x32_bf16 v[32:35], v[144:147], a[20:23], v[32:35]
    s_waitcnt lgkmcnt(6)
    buffer_load_dwordx4 v3, s[20:23], s29 offen offset:3072 lds
    buffer_load_dwordx4 a[12:15], v243, s[8:11], s28 offen offset:2304 sc1
    s_add_u32 s28, s28, 4096
    v_mfma_f32_16x16x32_bf16 v[28:31], v[148:151], a[16:19], v[28:31]
    ds_read_b128 v[144:147], v3 offset:38912
    v_mfma_f32_16x16x32_bf16 v[36:39], v[148:151], a[20:23], v[36:39]
    s_waitcnt lgkmcnt(6)
    v_mfma_f32_16x16x32_bf16 v[40:43], v[120:123], a[16:19], v[40:43]
    ds_read_b128 v[148:151], v3 offset:39936
    v_mfma_f32_16x16x32_bf16 v[48:51], v[120:123], a[20:23], v[48:51]
    s_waitcnt lgkmcnt(6)
    v_mfma_f32_16x16x32_bf16 v[44:47], v[124:127], a[16:19], v[44:47]
    ds_read_b128 v[120:123], v3 offset:40960
    v_mfma_f32_16x16x32_bf16 v[52:55], v[124:127], a[20:23], v[52:55]
    s_waitcnt lgkmcnt(6)
    s_add_u32 m0, s30, 90112
    s_add_u32 s60, s29, 4096
    buffer_load_dwordx4 v3, s[20:23], s60 offen offset:0 lds
    v_mfma_f32_16x16x32_bf16 v[56:59], v[128:131], a[16:19], v[56:59]
    ds_read_b128 v[124:127], v3 offset:41984
    v_mfma_f32_16x16x32_bf16 v[64:67], v[128:131], a[20:23], v[64:67]
    s_waitcnt lgkmcnt(6)
    buffer_load_dwordx4 a[32:35], v243, s[8:11], s28 offen offset:0 sc1
    v_mfma_f32_16x16x32_bf16 v[60:63], v[132:135], a[16:19], v[60:63]
    ds_read_b128 v[128:131], v3 offset:43008
    v_mfma_f32_16x16x32_bf16 v[68:71], v[132:135], a[20:23], v[68:71]
    s_waitcnt lgkmcnt(6)
    v_mfma_f32_16x16x32_bf16 v[72:75], v[136:139], a[16:19], v[72:75]
    ds_read_b128 v[132:135], v3 offset:44032
    v_mfma_f32_16x16x32_bf16 v[80:83], v[136:139], a[20:23], v[80:83]
    s_waitcnt lgkmcnt(6)
    buffer_load_dwordx4 v3, s[20:23], s60 offen offset:1024 lds
    v_mfma_f32_16x16x32_bf16 v[76:79], v[140:143], a[16:19], v[76:79]
    ds_read_b128 v[136:139], v3 offset:45056
    v_mfma_f32_16x16x32_bf16 v[84:87], v[140:143], a[20:23], v[84:87]
    s_waitcnt lgkmcnt(6)
    v_mfma_f32_16x16x32_bf16 v[88:91], v[144:147], a[16:19], v[88:91]
    ds_read_b128 v[140:143], v3 offset:46080
    v_mfma_f32_16x16x32_bf16 v[96:99], v[144:147], a[20:23], v[96:99]
    s_waitcnt lgkmcnt(6)
    buffer_load_dwordx4 a[36:39], v243, s[8:11], s28 offen offset:256 sc1
    v_mfma_f32_16x16x32_bf16 v[92:95], v[148:151], a[16:19], v[92:95]
    ds_read_b128 v[144:147], v3 offset:47104
    v_mfma_f32_16x16x32_bf16 v[100:103], v[148:151], a[20:23], v[100:103]
    s_waitcnt lgkmcnt(6)
    buffer_load_dwordx4 v3, s[20:23], s60 offen offset:2048 lds
    s_add_u32 s29, s29, 28672
    v_mfma_f32_16x16x32_bf16 v[104:107], v[120:123], a[16:19], v[104:107]
    ds_read_b128 v[148:151], v3 offset:48128
    v_mfma_f32_16x16x32_bf16 v[112:115], v[120:123], a[20:23], v[112:115]
    s_waitcnt lgkmcnt(6)
    v_mfma_f32_16x16x32_bf16 v[108:111], v[124:127], a[16:19], v[108:111]
    ds_read_b128 v[120:123], v3 offset:49152
    v_mfma_f32_16x16x32_bf16 v[116:119], v[124:127], a[20:23], v[116:119]
    s_waitcnt lgkmcnt(6)
    s_waitcnt vmcnt(17)
    v_mfma_f32_16x16x32_bf16 v[8:11], v[128:131], a[24:27], v[8:11]
    ds_read_b128 v[124:127], v3 offset:50176
    v_mfma_f32_16x16x32_bf16 v[16:19], v[128:131], a[28:31], v[16:19]
    s_waitcnt lgkmcnt(6)
    buffer_load_dwordx4 a[40:43], v243, s[8:11], s28 offen offset:2048 sc1
    v_mfma_f32_16x16x32_bf16 v[12:15], v[132:135], a[24:27], v[12:15]
    ds_read_b128 v[128:131], v3 offset:51200
    v_mfma_f32_16x16x32_bf16 v[20:23], v[132:135], a[28:31], v[20:23]
    s_waitcnt lgkmcnt(6)
    v_mfma_f32_16x16x32_bf16 v[24:27], v[136:139], a[24:27], v[24:27]
    ds_read_b128 v[132:135], v3 offset:52224
    v_mfma_f32_16x16x32_bf16 v[32:35], v[136:139], a[28:31], v[32:35]
    s_waitcnt lgkmcnt(6)
    v_mfma_f32_16x16x32_bf16 v[28:31], v[140:143], a[24:27], v[28:31]
    ds_read_b128 v[136:139], v3 offset:53248
    v_mfma_f32_16x16x32_bf16 v[36:39], v[140:143], a[28:31], v[36:39]
    s_waitcnt lgkmcnt(6)
    v_mfma_f32_16x16x32_bf16 v[40:43], v[144:147], a[24:27], v[40:43]
    ds_read_b128 v[140:143], v3 offset:54272
    v_mfma_f32_16x16x32_bf16 v[48:51], v[144:147], a[28:31], v[48:51]
    s_waitcnt lgkmcnt(6)
    buffer_load_dwordx4 a[44:47], v243, s[8:11], s28 offen offset:2304 sc1
    s_add_u32 s28, s28, 4096
    v_mfma_f32_16x16x32_bf16 v[44:47], v[148:151], a[24:27], v[44:47]
    ds_read_b128 v[144:147], v3 offset:55296
    v_mfma_f32_16x16x32_bf16 v[52:55], v[148:151], a[28:31], v[52:55]
    s_waitcnt lgkmcnt(6)
    v_mfma_f32_16x16x32_bf16 v[56:59], v[120:123], a[24:27], v[56:59]
    ds_read_b128 v[148:151], v3 offset:56320
    v_mfma_f32_16x16x32_bf16 v[64:67], v[120:123], a[28:31], v[64:67]
    s_waitcnt lgkmcnt(6)
    s_waitcnt vmcnt(13)
    s_barrier
    v_mfma_f32_16x16x32_bf16 v[60:63], v[124:127], a[24:27], v[60:63]
    ds_read_b128 v[120:123], v3 offset:57344
    v_mfma_f32_16x16x32_bf16 v[68:71], v[124:127], a[28:31], v[68:71]
    s_waitcnt lgkmcnt(6)
    s_add_u32 m0, s30, 0
    s_nop 0
    buffer_load_dwordx4 v3, s[20:23], s29 offen offset:0 lds
    v_mfma_f32_16x16x32_bf16 v[72:75], v[128:131], a[24:27], v[72:75]
    ds_read_b128 v[124:127], v3 offset:58368
    v_mfma_f32_16x16x32_bf16 v[80:83], v[128:131], a[28:31], v[80:83]
    s_waitcnt lgkmcnt(6)
    v_mfma_f32_16x16x32_bf16 v[76:79], v[132:135], a[24:27], v[76:79]
    ds_read_b128 v[128:131], v3 offset:59392
    v_mfma_f32_16x16x32_bf16 v[84:87], v[132:135], a[28:31], v[84:87]
    s_waitcnt lgkmcnt(6)
    buffer_load_dwordx4 v3, s[20:23], s29 offen offset:1024 lds
    v_mfma_f32_16x16x32_bf16 v[88:91], v[136:139], a[24:27], v[88:91]
    ds_read_b128 v[132:135], v3 offset:60416
    v_mfma_f32_16x16x32_bf16 v[96:99], v[136:139], a[28:31], v[96:99]
    s_waitcnt lgkmcnt(6)
    v_mfma_f32_16x16x32_bf16 v[92:95], v[140:143], a[24:27], v[92:95]
    ds_read_b128 v[136:139], v3 offset:61440
    v_mfma_f32_16x16x32_bf16 v[100:103], v[140:143], a[28:31], v[100:103]
    s_waitcnt lgkmcnt(6)
    v_mfma_f32_16x16x32_bf16 v[104:107], v[144:147], a[24:27], v[104:107]
    ds_read_b128 v[140:143], v3 offset:62464
    v_mfma_f32_16x16x32_bf16 v[112:115], v[144:147], a[28:31], v[112:115]
    s_waitcnt lgkmcnt(6)
    buffer_load_dwordx4 v3, s[20:23], s29 offen offset:2048 lds
    v_mfma_f32_16x16x32_bf16 v[108:111], v[148:151], a[24:27], v[108:111]
    ds_read_b128 v[144:147], v3 offset:63488
    v_mfma_f32_16x16x32_bf16 v[116:119], v[148:151], a[28:31], v[116:119]
    s_waitcnt lgkmcnt(6)
    s_waitcnt vmcnt(17)
    v_mfma_f32_16x16x32_bf16 v[8:11], v[120:123], a[0:3], v[8:11]
    ds_read_b128 v[148:151], v3 offset:64512
    v_mfma_f32_16x16x32_bf16 v[16:19], v[120:123], a[4:7], v[16:19]
    s_waitcnt lgkmcnt(6)
    v_mfma_f32_16x16x32_bf16 v[12:15], v[124:127], a[0:3], v[12:15]
    ds_read_b128 v[120:123], v4 offset:0
    v_mfma_f32_16x16x32_bf16 v[20:23], v[124:127], a[4:7], v[20:23]
    s_waitcnt lgkmcnt(6)
    buffer_load_dwordx4 v3, s[20:23], s29 offen offset:3072 lds
    v_mfma_f32_16x16x32_bf16 v[24:27], v[128:131], a[0:3], v[24:27]
    ds_read_b128 v[124:127], v4 offset:1024
    v_mfma_f32_16x16x32_bf16 v[32:35], v[128:131], a[4:7], v[32:35]
    s_waitcnt lgkmcnt(6)
    v_mfma_f32_16x16x32_bf16 v[28:31], v[132:135], a[0:3], v[28:31]
    ds_read_b128 v[128:131], v4 offset:2048
    v_mfma_f32_16x16x32_bf16 v[36:39], v[132:135], a[4:7], v[36:39]
    s_waitcnt lgkmcnt(6)
    v_mfma_f32_16x16x32_bf16 v[40:43], v[136:139], a[0:3], v[40:43]
    ds_read_b128 v[132:135], v4 offset:3072
    v_mfma_f32_16x16x32_bf16 v[48:51], v[136:139], a[4:7], v[48:51]
    s_waitcnt lgkmcnt(6)
    s_add_u32 m0, s30, 4096
    s_add_u32 s60, s29, 4096
    buffer_load_dwordx4 v3, s[20:23], s60 offen offset:0 lds
    v_mfma_f32_16x16x32_bf16 v[44:47], v[140:143], a[0:3], v[44:47]
    ds_read_b128 v[136:139], v4 offset:4096
    v_mfma_f32_16x16x32_bf16 v[52:55], v[140:143], a[4:7], v[52:55]
    s_waitcnt lgkmcnt(6)
    v_mfma_f32_16x16x32_bf16 v[56:59], v[144:147], a[0:3], v[56:59]
    ds_read_b128 v[140:143], v4 offset:5120
    v_mfma_f32_16x16x32_bf16 v[64:67], v[144:147], a[4:7], v[64:67]
    s_waitcnt lgkmcnt(6)
    v_mfma_f32_16x16x32_bf16 v[60:63], v[148:151], a[0:3], v[60:63]
    ds_read_b128 v[144:147], v4 offset:6144
    v_mfma_f32_16x16x32_bf16 v[68:71], v[148:151], a[4:7], v[68:71]
    s_waitcnt lgkmcnt(6)
    buffer_load_dwordx4 v3, s[20:23], s60 offen offset:1024 lds
    v_mfma_f32_16x16x32_bf16 v[72:75], v[120:123], a[0:3], v[72:75]
    ds_read_b128 v[148:151], v4 offset:7168
    v_mfma_f32_16x16x32_bf16 v[80:83], v[120:123], a[4:7], v[80:83]
    s_waitcnt lgkmcnt(6)
    s_waitcnt vmcnt(8)
    s_barrier
    v_mfma_f32_16x16x32_bf16 v[76:79], v[124:127], a[0:3], v[76:79]
    ds_read_b128 v[120:123], v4 offset:20480
    v_mfma_f32_16x16x32_bf16 v[84:87], v[124:127], a[4:7], v[84:87]
    s_waitcnt lgkmcnt(6)
    v_mfma_f32_16x16x32_bf16 v[88:91], v[128:131], a[0:3], v[88:91]
    ds_read_b128 v[124:127], v4 offset:21504
    v_mfma_f32_16x16x32_bf16 v[96:99], v[128:131], a[4:7], v[96:99]
    s_waitcnt lgkmcnt(6)
    buffer_load_dwordx4 v3, s[20:23], s60 offen offset:2048 lds
    s_add_u32 s29, s29, 28672
    v_mfma_f32_16x16x32_bf16 v[92:95], v[132:135], a[0:3], v[92:95]
    ds_read_b128 v[128:131], v4 offset:34816
    v_mfma_f32_16x16x32_bf16 v[100:103], v[132:135], a[4:7], v[100:103]
    s_waitcnt lgkmcnt(6)
    v_mfma_f32_16x16x32_bf16 v[104:107], v[136:139], a[0:3], v[104:107]
    ds_read_b128 v[132:135], v4 offset:35840
    v_mfma_f32_16x16x32_bf16 v[112:115], v[136:139], a[4:7], v[112:115]
    s_waitcnt lgkmcnt(6)
    v_mfma_f32_16x16x32_bf16 v[108:111], v[140:143], a[0:3], v[108:111]
    ds_read_b128 v[136:139], v4 offset:8192
    v_mfma_f32_16x16x32_bf16 v[116:119], v[140:143], a[4:7], v[116:119]
    s_waitcnt lgkmcnt(6)
    s_waitcnt vmcnt(14)
    v_mfma_f32_16x16x32_bf16 v[8:11], v[144:147], a[8:11], v[8:11]
    ds_read_b128 v[140:143], v4 offset:9216
    v_mfma_f32_16x16x32_bf16 v[16:19], v[144:147], a[12:15], v[16:19]
    s_waitcnt lgkmcnt(6)
    v_mfma_f32_16x16x32_bf16 v[12:15], v[148:151], a[8:11], v[12:15]
    ds_read_b128 v[144:147], v4 offset:22528
    v_mfma_f32_16x16x32_bf16 v[20:23], v[148:151], a[12:15], v[20:23]
    s_waitcnt lgkmcnt(6)
    s_waitcnt vmcnt(10)
    v_mfma_f32_16x16x32_bf16 v[8:11], v[120:123], a[32:35], v[8:11]
    ds_read_b128 v[148:151], v4 offset:23552
    v_mfma_f32_16x16x32_bf16 v[16:19], v[120:123], a[36:39], v[16:19]
    s_waitcnt lgkmcnt(6)
    v_mfma_f32_16x16x32_bf16 v[12:15], v[124:127], a[32:35], v[12:15]
    ds_read_b128 v[120:123], v4 offset:36864
    v_mfma_f32_16x16x32_bf16 v[20:23], v[124:127], a[36:39], v[20:23]
    s_waitcnt lgkmcnt(6)
    s_waitcnt vmcnt(7)
    v_mfma_f32_16x16x32_bf16 v[8:11], v[128:131], a[40:43], v[8:11]
    ds_read_b128 v[124:127], v4 offset:37888
    v_mfma_f32_16x16x32_bf16 v[16:19], v[128:131], a[44:47], v[16:19]
    s_waitcnt lgkmcnt(6)
    v_mfma_f32_16x16x32_bf16 v[12:15], v[132:135], a[40:43], v[12:15]
    ds_read_b128 v[128:131], v4 offset:10240
    v_mfma_f32_16x16x32_bf16 v[20:23], v[132:135], a[44:47], v[20:23]
    s_waitcnt lgkmcnt(6)
    s_lshl_b32 s90, s94, 16
    s_lshl_b32 s33, s40, 13
    s_add_u32 s90, s90, s33
    s_add_u32 s34, s90, 8388608
    s_xor_b32 s42, s41, s56
    s_cselect_b32 s34, s34, 2146435072
    s_add_u32 s90, s90, 12582912
    s_add_u32 s91, s90, 4096
    s_mul_i32 s85, s94, 229376
    s_and_b32 s32, s2, 1
    s_mul_i32 s32, s32, 114688
    s_add_u32 s33, s85, s32
    s_add_u32 s33, s33, 16777216
    s_add_u32 s8, s4, s33
    s_addc_u32 s9, s5, 0
    s_mov_b32 s10, 114688
    s_mov_b32 s11, 0x20000
    s_cmp_le_u32 s76, 6
    s_addc_u32 s93, s45, 6
    s_and_b32 s93, s93, 7
    s_mul_i32 s93, s93, 14336
    s_add_u32 s93, s93, s85
    s_sub_u32 s93, s93, s32
    s_add_u32 s93, s93, 16902144
    s_xor_b32 s92, s95, 8
    s_lshl_b32 s92, s92, 20
    s_add_u32 s92, s92, s87
    s_add_u32 s92, s92, 32358400
    s_mul_i32 s33, s95, 14336
    s_add_u32 s85, s85, s33
    s_add_u32 s85, s85, 16777216
    s_add_u32 m0, s30, 28672
    s_nop 0
    buffer_load_dwordx4 v3, s[20:23], s29 offen offset:0 lds
    v_pk_mul_f32 v[8:9], v[8:9], v[232:233]
    v_pk_mul_f32 v[10:11], v[10:11], v[232:233]
    v_pk_mul_f32 v[12:13], v[12:13], v[232:233]
    v_pk_mul_f32 v[14:15], v[14:15], v[232:233]
    v_pk_mul_f32 v[16:17], v[16:17], v[234:235]
    v_pk_mul_f32 v[18:19], v[18:19], v[234:235]
    v_pk_mul_f32 v[20:21], v[20:21], v[234:235]
    v_pk_mul_f32 v[22:23], v[22:23], v[234:235]
    v_exp_f32 v152, v8
    v_mfma_f32_16x16x32_bf16 v[24:27], v[136:139], a[8:11], v[24:27]
    ds_read_b128 v[132:135], v4 offset:11264
    v_exp_f32 v153, v9
    v_exp_f32 v154, v10
    v_mfma_f32_16x16x32_bf16 v[32:35], v[136:139], a[12:15], v[32:35]
    s_waitcnt lgkmcnt(6)
    v_exp_f32 v155, v11
    v_exp_f32 v156, v12
    v_mfma_f32_16x16x32_bf16 v[28:31], v[140:143], a[8:11], v[28:31]
    ds_read_b128 v[136:139], v4 offset:24576
    v_exp_f32 v157, v13
    v_exp_f32 v158, v14
    v_mfma_f32_16x16x32_bf16 v[36:39], v[140:143], a[12:15], v[36:39]
    s_waitcnt lgkmcnt(6)
    v_exp_f32 v159, v15
    v_exp_f32 v160, v16
    v_mfma_f32_16x16x32_bf16 v[24:27], v[144:147], a[32:35], v[24:27]
    ds_read_b128 v[140:143], v4 offset:25600
    v_exp_f32 v161, v17
    v_exp_f32 v162, v18
    v_mfma_f32_16x16x32_bf16 v[32:35], v[144:147], a[36:39], v[32:35]
    s_waitcnt lgkmcnt(6)
    v_exp_f32 v163, v19
    v_exp_f32 v164, v20
    v_exp_f32 v165, v21
    v_exp_f32 v166, v22
    v_exp_f32 v167, v23
    buffer_load_dwordx4 v3, s[20:23], s29 offen offset:1024 lds
    v_pk_fma_f32 v[152:153], v[152:153], s[68:69], s[68:69]
    v_pk_fma_f32 v[154:155], v[154:155], s[68:69], s[68:69]
    v_pk_fma_f32 v[156:157], v[156:157], s[68:69], s[68:69]
    v_pk_fma_f32 v[158:159], v[158:159], s[68:69], s[68:69]
    v_pk_fma_f32 v[160:161], v[160:161], s[68:69], s[68:69]
    v_pk_fma_f32 v[162:163], v[162:163], s[68:69], s[68:69]
    v_pk_fma_f32 v[164:165], v[164:165], s[68:69], s[68:69]
    v_pk_fma_f32 v[166:167], v[166:167], s[68:69], s[68:69]
    v_rcp_f32 v152, v152
    v_mfma_f32_16x16x32_bf16 v[28:31], v[148:151], a[32:35], v[28:31]
    ds_read_b128 v[144:147], v4 offset:38912
    v_rcp_f32 v153, v153
    v_rcp_f32 v154, v154
    v_mfma_f32_16x16x32_bf16 v[36:39], v[148:151], a[36:39], v[36:39]
    s_waitcnt lgkmcnt(6)
    v_rcp_f32 v155, v155
    v_rcp_f32 v156, v156
    v_mfma_f32_16x16x32_bf16 v[24:27], v[120:123], a[40:43], v[24:27]
    ds_read_b128 v[148:151], v4 offset:39936
    v_rcp_f32 v157, v157
    v_rcp_f32 v158, v158
    v_mfma_f32_16x16x32_bf16 v[32:35], v[120:123], a[44:47], v[32:35]
    s_waitcnt lgkmcnt(6)
    v_rcp_f32 v159, v159
    v_rcp_f32 v160, v160
    v_mfma_f32_16x16x32_bf16 v[28:31], v[124:127], a[40:43], v[28:31]
    ds_read_b128 v[120:123], v4 offset:12288
    v_rcp_f32 v161, v161
    v_rcp_f32 v162, v162
    v_mfma_f32_16x16x32_bf16 v[36:39], v[124:127], a[44:47], v[36:39]
    s_waitcnt lgkmcnt(6)
    v_rcp_f32 v163, v163
    v_rcp_f32 v164, v164
    v_rcp_f32 v165, v165
    v_rcp_f32 v166, v166
    v_rcp_f32 v167, v167
    buffer_load_dwordx4 v3, s[20:23], s29 offen offset:2048 lds
    v_pk_mul_f32 v[8:9], v[8:9], v[152:153]
    v_pk_mul_f32 v[10:11], v[10:11], v[154:155]
    v_pk_mul_f32 v[12:13], v[12:13], v[156:157]
    v_pk_mul_f32 v[14:15], v[14:15], v[158:159]
    v_pk_mul_f32 v[16:17], v[16:17], v[160:161]
    v_pk_mul_f32 v[18:19], v[18:19], v[162:163]
    v_pk_mul_f32 v[20:21], v[20:21], v[164:165]
    v_pk_mul_f32 v[22:23], v[22:23], v[166:167]
    v_cvt_pk_bf16_f32 v176, v8, v9
    v_cvt_pk_bf16_f32 v177, v10, v11
    v_cvt_pk_bf16_f32 v178, v12, v13
    v_cvt_pk_bf16_f32 v179, v14, v15
    buffer_store_dwordx4 v[176:179], v243, s[20:23], s85 offen offset:0 sc1
    v_cvt_pk_bf16_f32 v180, v16, v17
    v_cvt_pk_bf16_f32 v181, v18, v19
    v_cvt_pk_bf16_f32 v182, v20, v21
    v_cvt_pk_bf16_f32 v183, v22, v23
    buffer_store_dwordx4 v[180:183], v243, s[20:23], s85 offen offset:256 sc1
    buffer_load_dwordx4 v3, s[20:23], s29 offen offset:3072 lds
    v_pk_mul_f32 v[24:25], v[24:25], v[232:233]
    v_pk_mul_f32 v[26:27], v[26:27], v[232:233]
    v_pk_mul_f32 v[28:29], v[28:29], v[232:233]
    v_pk_mul_f32 v[30:31], v[30:31], v[232:233]
    v_pk_mul_f32 v[32:33], v[32:33], v[234:235]
    v_pk_mul_f32 v[34:35], v[34:35], v[234:235]
    v_pk_mul_f32 v[36:37], v[36:37], v[234:235]
    v_pk_mul_f32 v[38:39], v[38:39], v[234:235]
    v_exp_f32 v152, v24
    v_mfma_f32_16x16x32_bf16 v[40:43], v[128:131], a[8:11], v[40:43]
    ds_read_b128 v[124:127], v4 offset:13312
    v_exp_f32 v153, v25
    v_exp_f32 v154, v26
    v_mfma_f32_16x16x32_bf16 v[48:51], v[128:131], a[12:15], v[48:51]
    s_waitcnt lgkmcnt(6)
    v_exp_f32 v155, v27
    v_exp_f32 v156, v28
    v_mfma_f32_16x16x32_bf16 v[44:47], v[132:135], a[8:11], v[44:47]
    ds_read_b128 v[128:131], v4 offset:26624
    v_exp_f32 v157, v29
    v_exp_f32 v158, v30
    v_mfma_f32_16x16x32_bf16 v[52:55], v[132:135], a[12:15], v[52:55]
    s_waitcnt lgkmcnt(6)
    v_exp_f32 v159, v31
    v_exp_f32 v160, v32
    v_mfma_f32_16x16x32_bf16 v[40:43], v[136:139], a[32:35], v[40:43]
    ds_read_b128 v[132:135], v4 offset:27648
    v_exp_f32 v161, v33
    v_exp_f32 v162, v34
    v_mfma_f32_16x16x32_bf16 v[48:51], v[136:139], a[36:39], v[48:51]
    s_waitcnt lgkmcnt(6)
    v_exp_f32 v163, v35
    v_exp_f32 v164, v36
    v_exp_f32 v165, v37
    v_exp_f32 v166, v38
    v_exp_f32 v167, v39
    s_add_u32 m0, s30, 32768
    s_add_u32 s60, s29, 4096
    buffer_load_dwordx4 v3, s[20:23], s60 offen offset:0 lds
    v_pk_fma_f32 v[152:153], v[152:153], s[68:69], s[68:69]
    v_pk_fma_f32 v[154:155], v[154:155], s[68:69], s[68:69]
    v_pk_fma_f32 v[156:157], v[156:157], s[68:69], s[68:69]
    v_pk_fma_f32 v[158:159], v[158:159], s[68:69], s[68:69]
    v_pk_fma_f32 v[160:161], v[160:161], s[68:69], s[68:69]
    v_pk_fma_f32 v[162:163], v[162:163], s[68:69], s[68:69]
    v_pk_fma_f32 v[164:165], v[164:165], s[68:69], s[68:69]
    v_pk_fma_f32 v[166:167], v[166:167], s[68:69], s[68:69]
    v_rcp_f32 v152, v152
    v_mfma_f32_16x16x32_bf16 v[44:47], v[140:143], a[32:35], v[44:47]
    ds_read_b128 v[136:139], v4 offset:40960
    v_rcp_f32 v153, v153
    v_rcp_f32 v154, v154
    v_mfma_f32_16x16x32_bf16 v[52:55], v[140:143], a[36:39], v[52:55]
    s_waitcnt lgkmcnt(6)
    v_rcp_f32 v155, v155
    v_rcp_f32 v156, v156
    v_mfma_f32_16x16x32_bf16 v[40:43], v[144:147], a[40:43], v[40:43]
    ds_read_b128 v[140:143], v4 offset:41984
    v_rcp_f32 v157, v157
    v_rcp_f32 v158, v158
    v_mfma_f32_16x16x32_bf16 v[48:51], v[144:147], a[44:47], v[48:51]
    s_waitcnt lgkmcnt(6)
    v_rcp_f32 v159, v159
    v_rcp_f32 v160, v160
    v_mfma_f32_16x16x32_bf16 v[44:47], v[148:151], a[40:43], v[44:47]
    ds_read_b128 v[144:147], v4 offset:14336
    v_rcp_f32 v161, v161
    v_rcp_f32 v162, v162
    v_mfma_f32_16x16x32_bf16 v[52:55], v[148:151], a[44:47], v[52:55]
    s_waitcnt lgkmcnt(6)
    v_rcp_f32 v163, v163
    v_rcp_f32 v164, v164
    v_rcp_f32 v165, v165
    v_rcp_f32 v166, v166
    v_rcp_f32 v167, v167
    buffer_load_dwordx4 v3, s[20:23], s60 offen offset:1024 lds
    v_pk_mul_f32 v[24:25], v[24:25], v[152:153]
    v_pk_mul_f32 v[26:27], v[26:27], v[154:155]
    v_pk_mul_f32 v[28:29], v[28:29], v[156:157]
    v_pk_mul_f32 v[30:31], v[30:31], v[158:159]
    v_pk_mul_f32 v[32:33], v[32:33], v[160:161]
    v_pk_mul_f32 v[34:35], v[34:35], v[162:163]
    v_pk_mul_f32 v[36:37], v[36:37], v[164:165]
    v_pk_mul_f32 v[38:39], v[38:39], v[166:167]
    v_cvt_pk_bf16_f32 v184, v24, v25
    v_cvt_pk_bf16_f32 v185, v26, v27
    v_cvt_pk_bf16_f32 v186, v28, v29
    v_cvt_pk_bf16_f32 v187, v30, v31
    buffer_store_dwordx4 v[184:187], v243, s[20:23], s85 offen offset:2048 sc1
    v_cvt_pk_bf16_f32 v188, v32, v33
    v_cvt_pk_bf16_f32 v189, v34, v35
    v_cvt_pk_bf16_f32 v190, v36, v37
    v_cvt_pk_bf16_f32 v191, v38, v39
    buffer_store_dwordx4 v[188:191], v243, s[20:23], s85 offen offset:2304 sc1
    s_add_u32 s85, s85, 4096
    buffer_load_dwordx4 v3, s[20:23], s60 offen offset:2048 lds
    s_add_u32 s29, s29, 28672
    v_pk_mul_f32 v[40:41], v[40:41], v[232:233]
    v_pk_mul_f32 v[42:43], v[42:43], v[232:233]
    v_pk_mul_f32 v[44:45], v[44:45], v[232:233]
    v_pk_mul_f32 v[46:47], v[46:47], v[232:233]
    v_pk_mul_f32 v[48:49], v[48:49], v[234:235]
    v_pk_mul_f32 v[50:51], v[50:51], v[234:235]
    v_pk_mul_f32 v[52:53], v[52:53], v[234:235]
    v_pk_mul_f32 v[54:55], v[54:55], v[234:235]
    v_exp_f32 v152, v40
    v_mfma_f32_16x16x32_bf16 v[56:59], v[120:123], a[8:11], v[56:59]
    ds_read_b128 v[148:151], v4 offset:15360
    v_exp_f32 v153, v41
    v_exp_f32 v154, v42
    v_mfma_f32_16x16x32_bf16 v[64:67], v[120:123], a[12:15], v[64:67]
    s_waitcnt lgkmcnt(6)
    v_exp_f32 v155, v43
    v_exp_f32 v156, v44
    v_mfma_f32_16x16x32_bf16 v[60:63], v[124:127], a[8:11], v[60:63]
    ds_read_b128 v[120:123], v4 offset:28672
    v_exp_f32 v157, v45
    v_exp_f32 v158, v46
    v_mfma_f32_16x16x32_bf16 v[68:71], v[124:127], a[12:15], v[68:71]
    s_waitcnt lgkmcnt(6)
    v_exp_f32 v159, v47
    v_exp_f32 v160, v48
    v_mfma_f32_16x16x32_bf16 v[56:59], v[128:131], a[32:35], v[56:59]
    ds_read_b128 v[124:127], v4 offset:29696
    v_exp_f32 v161, v49
    v_exp_f32 v162, v50
    v_mfma_f32_16x16x32_bf16 v[64:67], v[128:131], a[36:39], v[64:67]
    s_waitcnt lgkmcnt(6)
    v_exp_f32 v163, v51
    v_exp_f32 v164, v52
    v_exp_f32 v165, v53
    v_exp_f32 v166, v54
    v_exp_f32 v167, v55
    buffer_load_dwordx4 a[112:115], v243, s[20:23], s34 offen offset:0 sc1
    v_pk_fma_f32 v[152:153], v[152:153], s[68:69], s[68:69]
    v_pk_fma_f32 v[154:155], v[154:155], s[68:69], s[68:69]
    v_pk_fma_f32 v[156:157], v[156:157], s[68:69], s[68:69]
    v_pk_fma_f32 v[158:159], v[158:159], s[68:69], s[68:69]
    v_pk_fma_f32 v[160:161], v[160:161], s[68:69], s[68:69]
    v_pk_fma_f32 v[162:163], v[162:163], s[68:69], s[68:69]
    v_pk_fma_f32 v[164:165], v[164:165], s[68:69], s[68:69]
    v_pk_fma_f32 v[166:167], v[166:167], s[68:69], s[68:69]
    v_rcp_f32 v152, v152
    v_mfma_f32_16x16x32_bf16 v[60:63], v[132:135], a[32:35], v[60:63]
    ds_read_b128 v[128:131], v4 offset:43008
    v_rcp_f32 v153, v153
    v_rcp_f32 v154, v154
    v_mfma_f32_16x16x32_bf16 v[68:71], v[132:135], a[36:39], v[68:71]
    s_waitcnt lgkmcnt(6)
    v_rcp_f32 v155, v155
    v_rcp_f32 v156, v156
    v_mfma_f32_16x16x32_bf16 v[56:59], v[136:139], a[40:43], v[56:59]
    ds_read_b128 v[132:135], v4 offset:44032
    v_rcp_f32 v157, v157
    v_rcp_f32 v158, v158
    v_mfma_f32_16x16x32_bf16 v[64:67], v[136:139], a[44:47], v[64:67]
    s_waitcnt lgkmcnt(6)
    v_rcp_f32 v159, v159
    v_rcp_f32 v160, v160
    v_mfma_f32_16x16x32_bf16 v[60:63], v[140:143], a[40:43], v[60:63]
    ds_read_b128 v[136:139], v4 offset:16384
    v_rcp_f32 v161, v161
    v_rcp_f32 v162, v162
    v_mfma_f32_16x16x32_bf16 v[68:71], v[140:143], a[44:47], v[68:71]
    s_waitcnt lgkmcnt(6)
    v_rcp_f32 v163, v163
    v_rcp_f32 v164, v164
    v_rcp_f32 v165, v165
    v_rcp_f32 v166, v166
    v_rcp_f32 v167, v167
    buffer_load_dwordx4 a[116:119], v243, s[20:23], s34 offen offset:256 sc1
    v_pk_mul_f32 v[40:41], v[40:41], v[152:153]
    v_pk_mul_f32 v[42:43], v[42:43], v[154:155]
    v_pk_mul_f32 v[44:45], v[44:45], v[156:157]
    v_pk_mul_f32 v[46:47], v[46:47], v[158:159]
    v_pk_mul_f32 v[48:49], v[48:49], v[160:161]
    v_pk_mul_f32 v[50:51], v[50:51], v[162:163]
    v_pk_mul_f32 v[52:53], v[52:53], v[164:165]
    v_pk_mul_f32 v[54:55], v[54:55], v[166:167]
    v_cvt_pk_bf16_f32 v192, v40, v41
    v_cvt_pk_bf16_f32 v193, v42, v43
    v_cvt_pk_bf16_f32 v194, v44, v45
    v_cvt_pk_bf16_f32 v195, v46, v47
    buffer_store_dwordx4 v[192:195], v243, s[20:23], s85 offen offset:0 sc1
    v_cvt_pk_bf16_f32 v196, v48, v49
    v_cvt_pk_bf16_f32 v197, v50, v51
    v_cvt_pk_bf16_f32 v198, v52, v53
    v_cvt_pk_bf16_f32 v199, v54, v55
    buffer_store_dwordx4 v[196:199], v243, s[20:23], s85 offen offset:256 sc1
    buffer_load_dwordx4 a[120:123], v243, s[20:23], s34 offen offset:2048 sc1
    v_pk_mul_f32 v[56:57], v[56:57], v[232:233]
    v_pk_mul_f32 v[58:59], v[58:59], v[232:233]
    v_pk_mul_f32 v[60:61], v[60:61], v[232:233]
    v_pk_mul_f32 v[62:63], v[62:63], v[232:233]
    v_pk_mul_f32 v[64:65], v[64:65], v[234:235]
    v_pk_mul_f32 v[66:67], v[66:67], v[234:235]
    v_pk_mul_f32 v[68:69], v[68:69], v[234:235]
    v_pk_mul_f32 v[70:71], v[70:71], v[234:235]
    v_exp_f32 v152, v56
    v_mfma_f32_16x16x32_bf16 v[72:75], v[144:147], a[8:11], v[72:75]
    ds_read_b128 v[140:143], v4 offset:17408
    v_exp_f32 v153, v57
    v_exp_f32 v154, v58
    v_mfma_f32_16x16x32_bf16 v[80:83], v[144:147], a[12:15], v[80:83]
    s_waitcnt lgkmcnt(6)
    v_exp_f32 v155, v59
    v_exp_f32 v156, v60
    v_mfma_f32_16x16x32_bf16 v[76:79], v[148:151], a[8:11], v[76:79]
    ds_read_b128 v[144:147], v4 offset:30720
    v_exp_f32 v157, v61
    v_exp_f32 v158, v62
    v_mfma_f32_16x16x32_bf16 v[84:87], v[148:151], a[12:15], v[84:87]
    s_waitcnt lgkmcnt(6)
    v_exp_f32 v159, v63
    v_exp_f32 v160, v64
    v_mfma_f32_16x16x32_bf16 v[72:75], v[120:123], a[32:35], v[72:75]
    ds_read_b128 v[148:151], v4 offset:31744
    v_exp_f32 v161, v65
    v_exp_f32 v162, v66
    v_mfma_f32_16x16x32_bf16 v[80:83], v[120:123], a[36:39], v[80:83]
    s_waitcnt lgkmcnt(6)
    v_exp_f32 v163, v67
    v_exp_f32 v164, v68
    v_exp_f32 v165, v69
    v_exp_f32 v166, v70
    v_exp_f32 v167, v71
    buffer_load_dwordx4 a[124:127], v243, s[20:23], s34 offen offset:2304 sc1
    v_pk_fma_f32 v[152:153], v[152:153], s[68:69], s[68:69]
    v_pk_fma_f32 v[154:155], v[154:155], s[68:69], s[68:69]
    v_pk_fma_f32 v[156:157], v[156:157], s[68:69], s[68:69]
    v_pk_fma_f32 v[158:159], v[158:159], s[68:69], s[68:69]
    v_pk_fma_f32 v[160:161], v[160:161], s[68:69], s[68:69]
    v_pk_fma_f32 v[162:163], v[162:163], s[68:69], s[68:69]
    v_pk_fma_f32 v[164:165], v[164:165], s[68:69], s[68:69]
    v_pk_fma_f32 v[166:167], v[166:167], s[68:69], s[68:69]
    v_rcp_f32 v152, v152
    v_mfma_f32_16x16x32_bf16 v[76:79], v[124:127], a[32:35], v[76:79]
    ds_read_b128 v[120:123], v4 offset:45056
    v_rcp_f32 v153, v153
    v_rcp_f32 v154, v154
    v_mfma_f32_16x16x32_bf16 v[84:87], v[124:127], a[36:39], v[84:87]
    s_waitcnt lgkmcnt(6)
    v_rcp_f32 v155, v155
    v_rcp_f32 v156, v156
    v_mfma_f32_16x16x32_bf16 v[72:75], v[128:131], a[40:43], v[72:75]
    ds_read_b128 v[124:127], v4 offset:46080
    v_rcp_f32 v157, v157
    v_rcp_f32 v158, v158
    v_mfma_f32_16x16x32_bf16 v[80:83], v[128:131], a[44:47], v[80:83]
    s_waitcnt lgkmcnt(6)
    v_rcp_f32 v159, v159
    v_rcp_f32 v160, v160
    v_mfma_f32_16x16x32_bf16 v[76:79], v[132:135], a[40:43], v[76:79]
    ds_read_b128 v[128:131], v4 offset:18432
    v_rcp_f32 v161, v161
    v_rcp_f32 v162, v162
    v_mfma_f32_16x16x32_bf16 v[84:87], v[132:135], a[44:47], v[84:87]
    s_waitcnt lgkmcnt(6)
    v_rcp_f32 v163, v163
    v_rcp_f32 v164, v164
    v_rcp_f32 v165, v165
    v_rcp_f32 v166, v166
    v_rcp_f32 v167, v167
    s_add_u32 s34, s34, 4096
    buffer_load_dwordx4 a[228:231], v243, s[20:23], s34 offen offset:0 sc1
    v_pk_mul_f32 v[56:57], v[56:57], v[152:153]
    v_pk_mul_f32 v[58:59], v[58:59], v[154:155]
    v_pk_mul_f32 v[60:61], v[60:61], v[156:157]
    v_pk_mul_f32 v[62:63], v[62:63], v[158:159]
    v_pk_mul_f32 v[64:65], v[64:65], v[160:161]
    v_pk_mul_f32 v[66:67], v[66:67], v[162:163]
    v_pk_mul_f32 v[68:69], v[68:69], v[164:165]
    v_pk_mul_f32 v[70:71], v[70:71], v[166:167]
    v_cvt_pk_bf16_f32 v200, v56, v57
    v_cvt_pk_bf16_f32 v201, v58, v59
    v_cvt_pk_bf16_f32 v202, v60, v61
    v_cvt_pk_bf16_f32 v203, v62, v63
    buffer_store_dwordx4 v[200:203], v243, s[20:23], s85 offen offset:2048 sc1
    v_cvt_pk_bf16_f32 v204, v64, v65
    v_cvt_pk_bf16_f32 v205, v66, v67
    v_cvt_pk_bf16_f32 v206, v68, v69
    v_cvt_pk_bf16_f32 v207, v70, v71
    buffer_store_dwordx4 v[204:207], v243, s[20:23], s85 offen offset:2304 sc1
    s_add_u32 s85, s85, 4096
    s_lshl_b32 s83, s94, 7
    s_lshl_b32 s32, s95, 3
    s_add_u32 s83, s83, s32
    s_add_u32 s33, s83, 811008
    s_waitcnt vmcnt(10)
    s_mov_b64 exec, 1
    buffer_store_dwordx2 v[244:245], off, s[16:19], s33
    s_add_u32 s32, s33, 53248
    buffer_store_dwordx2 v[244:245], off, s[16:19], s32 sc1
    s_mov_b64 exec, -1
    buffer_load_dwordx4 a[232:235], v243, s[20:23], s34 offen offset:256 sc1
    v_pk_mul_f32 v[72:73], v[72:73], v[232:233]
    v_pk_mul_f32 v[74:75], v[74:75], v[232:233]
    v_pk_mul_f32 v[76:77], v[76:77], v[232:233]
    v_pk_mul_f32 v[78:79], v[78:79], v[232:233]
    v_pk_mul_f32 v[80:81], v[80:81], v[234:235]
    v_pk_mul_f32 v[82:83], v[82:83], v[234:235]
    v_pk_mul_f32 v[84:85], v[84:85], v[234:235]
    v_pk_mul_f32 v[86:87], v[86:87], v[234:235]
    v_exp_f32 v152, v72
    v_mfma_f32_16x16x32_bf16 v[88:91], v[136:139], a[8:11], v[88:91]
    ds_read_b128 v[132:135], v4 offset:19456
    v_exp_f32 v153, v73
    v_exp_f32 v154, v74
    v_mfma_f32_16x16x32_bf16 v[96:99], v[136:139], a[12:15], v[96:99]
    s_waitcnt lgkmcnt(6)
    v_exp_f32 v155, v75
    v_exp_f32 v156, v76
    v_mfma_f32_16x16x32_bf16 v[92:95], v[140:143], a[8:11], v[92:95]
    ds_read_b128 v[136:139], v4 offset:32768
    v_exp_f32 v157, v77
    v_exp_f32 v158, v78
    v_mfma_f32_16x16x32_bf16 v[100:103], v[140:143], a[12:15], v[100:103]
    s_waitcnt lgkmcnt(6)
    v_exp_f32 v159, v79
    v_exp_f32 v160, v80
    v_mfma_f32_16x16x32_bf16 v[88:91], v[144:147], a[32:35], v[88:91]
    ds_read_b128 v[140:143], v4 offset:33792
    v_exp_f32 v161, v81
    v_exp_f32 v162, v82
    v_mfma_f32_16x16x32_bf16 v[96:99], v[144:147], a[36:39], v[96:99]
    s_waitcnt lgkmcnt(6)
    v_exp_f32 v163, v83
    v_exp_f32 v164, v84
    v_exp_f32 v165, v85
    v_exp_f32 v166, v86
    v_exp_f32 v167, v87
    buffer_load_dwordx4 a[236:239], v243, s[20:23], s34 offen offset:2048 sc1
    v_pk_fma_f32 v[152:153], v[152:153], s[68:69], s[68:69]
    v_pk_fma_f32 v[154:155], v[154:155], s[68:69], s[68:69]
    v_pk_fma_f32 v[156:157], v[156:157], s[68:69], s[68:69]
    v_pk_fma_f32 v[158:159], v[158:159], s[68:69], s[68:69]
    v_pk_fma_f32 v[160:161], v[160:161], s[68:69], s[68:69]
    v_pk_fma_f32 v[162:163], v[162:163], s[68:69], s[68:69]
    v_pk_fma_f32 v[164:165], v[164:165], s[68:69], s[68:69]
    v_pk_fma_f32 v[166:167], v[166:167], s[68:69], s[68:69]
    v_rcp_f32 v152, v152
    v_mfma_f32_16x16x32_bf16 v[92:95], v[148:151], a[32:35], v[92:95]
    ds_read_b128 v[144:147], v4 offset:47104
    v_rcp_f32 v153, v153
    v_rcp_f32 v154, v154
    v_mfma_f32_16x16x32_bf16 v[100:103], v[148:151], a[36:39], v[100:103]
    s_waitcnt lgkmcnt(6)
    v_rcp_f32 v155, v155
    v_rcp_f32 v156, v156
    v_mfma_f32_16x16x32_bf16 v[88:91], v[120:123], a[40:43], v[88:91]
    ds_read_b128 v[148:151], v4 offset:48128
    v_rcp_f32 v157, v157
    v_rcp_f32 v158, v158
    v_mfma_f32_16x16x32_bf16 v[96:99], v[120:123], a[44:47], v[96:99]
    s_waitcnt lgkmcnt(6)
    v_rcp_f32 v159, v159
    v_rcp_f32 v160, v160
    v_mfma_f32_16x16x32_bf16 v[92:95], v[124:127], a[40:43], v[92:95]
    v_rcp_f32 v161, v161
    v_rcp_f32 v162, v162
    v_mfma_f32_16x16x32_bf16 v[100:103], v[124:127], a[44:47], v[100:103]
    s_waitcnt lgkmcnt(5)
    v_rcp_f32 v163, v163
    v_rcp_f32 v164, v164
    v_rcp_f32 v165, v165
    v_rcp_f32 v166, v166
    v_rcp_f32 v167, v167
    buffer_load_dwordx4 a[240:243], v243, s[20:23], s34 offen offset:2304 sc1
    v_pk_mul_f32 v[72:73], v[72:73], v[152:153]
    v_pk_mul_f32 v[74:75], v[74:75], v[154:155]
    v_pk_mul_f32 v[76:77], v[76:77], v[156:157]
    v_pk_mul_f32 v[78:79], v[78:79], v[158:159]
    v_pk_mul_f32 v[80:81], v[80:81], v[160:161]
    v_pk_mul_f32 v[82:83], v[82:83], v[162:163]
    v_pk_mul_f32 v[84:85], v[84:85], v[164:165]
    v_pk_mul_f32 v[86:87], v[86:87], v[166:167]
    v_cvt_pk_bf16_f32 v208, v72, v73
    v_cvt_pk_bf16_f32 v209, v74, v75
    v_cvt_pk_bf16_f32 v210, v76, v77
    v_cvt_pk_bf16_f32 v211, v78, v79
    buffer_store_dwordx4 v[208:211], v243, s[20:23], s85 offen offset:0 sc1
    v_cvt_pk_bf16_f32 v212, v80, v81
    v_cvt_pk_bf16_f32 v213, v82, v83
    v_cvt_pk_bf16_f32 v214, v84, v85
    v_cvt_pk_bf16_f32 v215, v86, v87
    buffer_store_dwordx4 v[212:215], v243, s[20:23], s85 offen offset:256 sc1
    v_pk_mul_f32 v[88:89], v[88:89], v[232:233]
    v_pk_mul_f32 v[90:91], v[90:91], v[232:233]
    v_pk_mul_f32 v[92:93], v[92:93], v[232:233]
    v_pk_mul_f32 v[94:95], v[94:95], v[232:233]
    v_pk_mul_f32 v[96:97], v[96:97], v[234:235]
    v_pk_mul_f32 v[98:99], v[98:99], v[234:235]
    v_pk_mul_f32 v[100:101], v[100:101], v[234:235]
    v_pk_mul_f32 v[102:103], v[102:103], v[234:235]
    v_exp_f32 v152, v88
    v_mfma_f32_16x16x32_bf16 v[104:107], v[128:131], a[8:11], v[104:107]
    v_exp_f32 v153, v89
    v_exp_f32 v154, v90
    v_mfma_f32_16x16x32_bf16 v[112:115], v[128:131], a[12:15], v[112:115]
    s_waitcnt lgkmcnt(4)
    v_exp_f32 v155, v91
    v_exp_f32 v156, v92
    v_mfma_f32_16x16x32_bf16 v[108:111], v[132:135], a[8:11], v[108:111]
    v_exp_f32 v157, v93
    v_exp_f32 v158, v94
    v_mfma_f32_16x16x32_bf16 v[116:119], v[132:135], a[12:15], v[116:119]
    s_waitcnt lgkmcnt(3)
    v_exp_f32 v159, v95
    v_exp_f32 v160, v96
    v_mfma_f32_16x16x32_bf16 v[104:107], v[136:139], a[32:35], v[104:107]
    v_exp_f32 v161, v97
    v_exp_f32 v162, v98
    v_mfma_f32_16x16x32_bf16 v[112:115], v[136:139], a[36:39], v[112:115]
    s_waitcnt lgkmcnt(2)
    v_exp_f32 v163, v99
    v_exp_f32 v164, v100
    v_exp_f32 v165, v101
    v_exp_f32 v166, v102
    v_exp_f32 v167, v103
    v_pk_fma_f32 v[152:153], v[152:153], s[68:69], s[68:69]
    v_pk_fma_f32 v[154:155], v[154:155], s[68:69], s[68:69]
    v_pk_fma_f32 v[156:157], v[156:157], s[68:69], s[68:69]
    v_pk_fma_f32 v[158:159], v[158:159], s[68:69], s[68:69]
    v_pk_fma_f32 v[160:161], v[160:161], s[68:69], s[68:69]
    v_pk_fma_f32 v[162:163], v[162:163], s[68:69], s[68:69]
    v_pk_fma_f32 v[164:165], v[164:165], s[68:69], s[68:69]
    v_pk_fma_f32 v[166:167], v[166:167], s[68:69], s[68:69]
    v_rcp_f32 v152, v152
    v_mfma_f32_16x16x32_bf16 v[108:111], v[140:143], a[32:35], v[108:111]
    v_rcp_f32 v153, v153
    v_rcp_f32 v154, v154
    v_mfma_f32_16x16x32_bf16 v[116:119], v[140:143], a[36:39], v[116:119]
    s_waitcnt lgkmcnt(1)
    v_rcp_f32 v155, v155
    v_rcp_f32 v156, v156
    v_mfma_f32_16x16x32_bf16 v[104:107], v[144:147], a[40:43], v[104:107]
    v_rcp_f32 v157, v157
    v_rcp_f32 v158, v158
    v_mfma_f32_16x16x32_bf16 v[112:115], v[144:147], a[44:47], v[112:115]
    s_waitcnt lgkmcnt(0)
    v_rcp_f32 v159, v159
    v_rcp_f32 v160, v160
    v_mfma_f32_16x16x32_bf16 v[108:111], v[148:151], a[40:43], v[108:111]
    v_rcp_f32 v161, v161
    v_rcp_f32 v162, v162
    v_mfma_f32_16x16x32_bf16 v[116:119], v[148:151], a[44:47], v[116:119]
    v_rcp_f32 v163, v163
    v_rcp_f32 v164, v164
    v_rcp_f32 v165, v165
    v_rcp_f32 v166, v166
    v_rcp_f32 v167, v167
    v_pk_mul_f32 v[88:89], v[88:89], v[152:153]
    v_pk_mul_f32 v[90:91], v[90:91], v[154:155]
    v_pk_mul_f32 v[92:93], v[92:93], v[156:157]
    v_pk_mul_f32 v[94:95], v[94:95], v[158:159]
    v_pk_mul_f32 v[96:97], v[96:97], v[160:161]
    v_pk_mul_f32 v[98:99], v[98:99], v[162:163]
    v_pk_mul_f32 v[100:101], v[100:101], v[164:165]
    v_pk_mul_f32 v[102:103], v[102:103], v[166:167]
    v_cvt_pk_bf16_f32 v216, v88, v89
    v_cvt_pk_bf16_f32 v217, v90, v91
    v_cvt_pk_bf16_f32 v218, v92, v93
    v_cvt_pk_bf16_f32 v219, v94, v95
    buffer_store_dwordx4 v[216:219], v243, s[20:23], s85 offen offset:2048 sc1
    v_cvt_pk_bf16_f32 v220, v96, v97
    v_cvt_pk_bf16_f32 v221, v98, v99
    v_cvt_pk_bf16_f32 v222, v100, v101
    v_cvt_pk_bf16_f32 v223, v102, v103
    buffer_store_dwordx4 v[220:223], v243, s[20:23], s85 offen offset:2304 sc1
    s_add_u32 s85, s85, 4096
    s_barrier
    s_add_u32 s29, s46, 49152
    s_mov_b32 s35, 811008
    buffer_load_dwordx2 v[240:241], v1, s[16:19], s35 offen sc1
    s_add_u32 m0, s87, 49152
    s_nop 0
    buffer_load_dwordx4 v3, s[20:23], s29 offen offset:0 lds
    v_pk_mul_f32 v[104:105], v[104:105], v[232:233]
    v_pk_mul_f32 v[106:107], v[106:107], v[232:233]
    v_pk_mul_f32 v[108:109], v[108:109], v[232:233]
    v_pk_mul_f32 v[110:111], v[110:111], v[232:233]
    v_pk_mul_f32 v[112:113], v[112:113], v[234:235]
    v_pk_mul_f32 v[114:115], v[114:115], v[234:235]
    v_pk_mul_f32 v[116:117], v[116:117], v[234:235]
    v_pk_mul_f32 v[118:119], v[118:119], v[234:235]
    buffer_load_dwordx4 v3, s[20:23], s29 offen offset:1024 lds
    v_exp_f32 v152, v104
    v_exp_f32 v153, v105
    v_exp_f32 v154, v106
    v_exp_f32 v155, v107
    v_exp_f32 v156, v108
    v_exp_f32 v157, v109
    v_exp_f32 v158, v110
    v_exp_f32 v159, v111
    v_exp_f32 v160, v112
    v_exp_f32 v161, v113
    v_exp_f32 v162, v114
    v_exp_f32 v163, v115
    v_exp_f32 v164, v116
    v_exp_f32 v165, v117
    v_exp_f32 v166, v118
    v_exp_f32 v167, v119
    buffer_load_dwordx4 v3, s[20:23], s29 offen offset:2048 lds
    v_pk_fma_f32 v[152:153], v[152:153], s[68:69], s[68:69]
    v_pk_fma_f32 v[154:155], v[154:155], s[68:69], s[68:69]
    v_pk_fma_f32 v[156:157], v[156:157], s[68:69], s[68:69]
    v_pk_fma_f32 v[158:159], v[158:159], s[68:69], s[68:69]
    v_pk_fma_f32 v[160:161], v[160:161], s[68:69], s[68:69]
    v_pk_fma_f32 v[162:163], v[162:163], s[68:69], s[68:69]
    v_pk_fma_f32 v[164:165], v[164:165], s[68:69], s[68:69]
    v_pk_fma_f32 v[166:167], v[166:167], s[68:69], s[68:69]
    buffer_load_dwordx4 v3, s[20:23], s29 offen offset:3072 lds
    s_add_u32 s29, s29, 16384
    v_rcp_f32 v152, v152
    v_rcp_f32 v153, v153
    v_rcp_f32 v154, v154
    v_rcp_f32 v155, v155
    v_rcp_f32 v156, v156
    v_rcp_f32 v157, v157
    v_rcp_f32 v158, v158
    v_rcp_f32 v159, v159
    v_rcp_f32 v160, v160
    v_rcp_f32 v161, v161
    v_rcp_f32 v162, v162
    v_rcp_f32 v163, v163
    v_rcp_f32 v164, v164
    v_rcp_f32 v165, v165
    v_rcp_f32 v166, v166
    v_rcp_f32 v167, v167
    s_add_u32 m0, s87, 65536
    s_nop 0
    buffer_load_dwordx4 v3, s[20:23], s29 offen offset:0 lds
    v_pk_mul_f32 v[104:105], v[104:105], v[152:153]
    v_pk_mul_f32 v[106:107], v[106:107], v[154:155]
    v_pk_mul_f32 v[108:109], v[108:109], v[156:157]
    v_pk_mul_f32 v[110:111], v[110:111], v[158:159]
    v_pk_mul_f32 v[112:113], v[112:113], v[160:161]
    v_pk_mul_f32 v[114:115], v[114:115], v[162:163]
    v_pk_mul_f32 v[116:117], v[116:117], v[164:165]
    v_pk_mul_f32 v[118:119], v[118:119], v[166:167]
    buffer_load_dwordx4 v3, s[20:23], s29 offen offset:1024 lds
    v_cvt_pk_bf16_f32 v224, v104, v105
    v_cvt_pk_bf16_f32 v225, v106, v107
    v_cvt_pk_bf16_f32 v226, v108, v109
    v_cvt_pk_bf16_f32 v227, v110, v111
    buffer_store_dwordx4 v[224:227], v243, s[20:23], s85 offen offset:0 sc1
    v_cvt_pk_bf16_f32 v228, v112, v113
    v_cvt_pk_bf16_f32 v229, v114, v115
    v_cvt_pk_bf16_f32 v230, v116, v117
    v_cvt_pk_bf16_f32 v231, v118, v119
    buffer_store_dwordx4 v[228:231], v243, s[20:23], s85 offen offset:256 sc1
    s_waitcnt vmcnt(13)
    s_barrier
    ds_read_b128 v[72:75], v3 offset:0
    ds_read_b128 v[76:79], v3 offset:1024
    ds_read_b128 v[80:83], v3 offset:2048
    ds_read_b128 v[84:87], v3 offset:3072
    ds_read_b128 v[88:91], v3 offset:4096
    ds_read_b128 v[92:95], v3 offset:5120
    ds_read_b128 v[96:99], v3 offset:6144
    v_xor_b32 v235, 64, v1
    v_mfma_f32_16x16x32_bf16 v[8:11], a[204:207], a[112:115], 0
    v_mfma_f32_16x16x32_bf16 v[16:19], a[204:207], a[116:119], 0
    v_mfma_f32_16x16x32_bf16 v[24:27], a[204:207], a[120:123], 0
    v_mfma_f32_16x16x32_bf16 v[32:35], a[204:207], a[124:127], 0
    v_mfma_f32_16x16x32_bf16 v[40:43], a[204:207], a[228:231], 0
    v_mfma_f32_16x16x32_bf16 v[48:51], a[204:207], a[232:235], 0
    v_mfma_f32_16x16x32_bf16 v[56:59], a[204:207], a[236:239], 0
    v_mfma_f32_16x16x32_bf16 v[64:67], a[204:207], a[240:243], 0
    v_mfma_f32_16x16x32_bf16 v[12:15], a[208:211], a[112:115], 0
    v_mfma_f32_16x16x32_bf16 v[20:23], a[208:211], a[116:119], 0
    v_mfma_f32_16x16x32_bf16 v[28:31], a[208:211], a[120:123], 0
    v_mfma_f32_16x16x32_bf16 v[36:39], a[208:211], a[124:127], 0
    v_mfma_f32_16x16x32_bf16 v[44:47], a[208:211], a[228:231], 0
    v_mfma_f32_16x16x32_bf16 v[52:55], a[208:211], a[232:235], 0
    v_mfma_f32_16x16x32_bf16 v[60:63], a[208:211], a[236:239], 0
    v_mfma_f32_16x16x32_bf16 v[68:71], a[208:211], a[240:243], 0
    s_waitcnt lgkmcnt(6)
    v_mfma_f32_16x16x32_bf16 v[8:11], v[72:75], v[176:179], v[8:11]
    ds_read_b128 v[100:103], v3 offset:7168
    v_mfma_f32_16x16x32_bf16 v[16:19], v[72:75], v[180:183], v[16:19]
    s_waitcnt lgkmcnt(6)
    v_mfma_f32_16x16x32_bf16 v[12:15], v[76:79], v[176:179], v[12:15]
    ds_read_b128 v[72:75], v3 offset:8192
    v_mfma_f32_16x16x32_bf16 v[20:23], v[76:79], v[180:183], v[20:23]
    s_waitcnt lgkmcnt(6)
    buffer_load_dwordx4 v3, s[20:23], s29 offen offset:2048 lds
    v_mfma_f32_16x16x32_bf16 v[24:27], v[80:83], v[176:179], v[24:27]
    ds_read_b128 v[76:79], v3 offset:9216
    v_mfma_f32_16x16x32_bf16 v[32:35], v[80:83], v[180:183], v[32:35]
    s_waitcnt lgkmcnt(6)
    s_waitcnt vmcnt(9)
    v_cmp_ne_u64 vcc, s[74:75], v[240:241]
    s_cmp_lg_u64 vcc, 0
    s_cbranch_scc1 L_main_kernel_spin_1055
L_main_kernel_ok_1054:
    v_mfma_f32_16x16x32_bf16 v[28:31], v[84:87], v[176:179], v[28:31]
    ds_read_b128 v[80:83], v3 offset:10240
    v_mfma_f32_16x16x32_bf16 v[36:39], v[84:87], v[180:183], v[36:39]
    s_waitcnt lgkmcnt(6)
    buffer_load_dwordx4 v3, s[20:23], s29 offen offset:3072 lds
    s_add_u32 s29, s29, 16384
    v_mfma_f32_16x16x32_bf16 v[40:43], v[88:91], v[176:179], v[40:43]
    ds_read_b128 v[84:87], v3 offset:11264
    v_mfma_f32_16x16x32_bf16 v[48:51], v[88:91], v[180:183], v[48:51]
    s_waitcnt lgkmcnt(6)
    v_mfma_f32_16x16x32_bf16 v[44:47], v[92:95], v[176:179], v[44:47]
    ds_read_b128 v[88:91], v3 offset:12288
    v_mfma_f32_16x16x32_bf16 v[52:55], v[92:95], v[180:183], v[52:55]
    s_waitcnt lgkmcnt(6)
    s_add_u32 m0, s87, 81920
    s_nop 0
    buffer_load_dwordx4 v3, s[20:23], s29 offen offset:0 lds
    v_mfma_f32_16x16x32_bf16 v[56:59], v[96:99], v[176:179], v[56:59]
    ds_read_b128 v[92:95], v3 offset:13312
    v_mfma_f32_16x16x32_bf16 v[64:67], v[96:99], v[180:183], v[64:67]
    s_waitcnt lgkmcnt(6)
    v_mfma_f32_16x16x32_bf16 v[60:63], v[100:103], v[176:179], v[60:63]
    ds_read_b128 v[96:99], v3 offset:14336
    v_mfma_f32_16x16x32_bf16 v[68:71], v[100:103], v[180:183], v[68:71]
    s_waitcnt lgkmcnt(6)
    buffer_load_dwordx4 v3, s[20:23], s29 offen offset:1024 lds
    v_mfma_f32_16x16x32_bf16 v[8:11], v[72:75], v[184:187], v[8:11]
    ds_read_b128 v[100:103], v3 offset:15360
    v_mfma_f32_16x16x32_bf16 v[16:19], v[72:75], v[188:191], v[16:19]
    s_waitcnt lgkmcnt(6)
    v_mfma_f32_16x16x32_bf16 v[12:15], v[76:79], v[184:187], v[12:15]
    ds_read_b128 v[72:75], v3 offset:16384
    v_mfma_f32_16x16x32_bf16 v[20:23], v[76:79], v[188:191], v[20:23]
    s_waitcnt lgkmcnt(6)
    buffer_load_dwordx4 v3, s[20:23], s29 offen offset:2048 lds
    v_mfma_f32_16x16x32_bf16 v[24:27], v[80:83], v[184:187], v[24:27]
    ds_read_b128 v[76:79], v3 offset:17408
    v_mfma_f32_16x16x32_bf16 v[32:35], v[80:83], v[188:191], v[32:35]
    s_waitcnt lgkmcnt(6)
    v_mfma_f32_16x16x32_bf16 v[28:31], v[84:87], v[184:187], v[28:31]
    ds_read_b128 v[80:83], v3 offset:18432
    v_mfma_f32_16x16x32_bf16 v[36:39], v[84:87], v[188:191], v[36:39]
    s_waitcnt lgkmcnt(6)
    s_cmp_le_u32 s76, 0
    s_addc_u32 s28, s45, 0
    s_and_b32 s28, s28, 7
    s_mul_i32 s28, s28, 14336
    buffer_load_dwordx4 a[56:59], v243, s[8:11], s28 offen offset:0 sc1
    buffer_load_dwordx4 v3, s[20:23], s29 offen offset:3072 lds
    s_add_u32 s29, s29, 16384
    v_mfma_f32_16x16x32_bf16 v[40:43], v[88:91], v[184:187], v[40:43]
    ds_read_b128 v[84:87], v3 offset:19456
    v_mfma_f32_16x16x32_bf16 v[48:51], v[88:91], v[188:191], v[48:51]
    s_waitcnt lgkmcnt(6)
    v_mfma_f32_16x16x32_bf16 v[44:47], v[92:95], v[184:187], v[44:47]
    ds_read_b128 v[88:91], v3 offset:20480
    v_mfma_f32_16x16x32_bf16 v[52:55], v[92:95], v[188:191], v[52:55]
    s_waitcnt lgkmcnt(6)
    s_add_u32 m0, s87, 98304
    s_nop 0
    buffer_load_dwordx4 v3, s[20:23], s29 offen offset:0 lds
    v_mfma_f32_16x16x32_bf16 v[56:59], v[96:99], v[184:187], v[56:59]
    ds_read_b128 v[92:95], v3 offset:21504
    v_mfma_f32_16x16x32_bf16 v[64:67], v[96:99], v[188:191], v[64:67]
    s_waitcnt lgkmcnt(6)
    v_mfma_f32_16x16x32_bf16 v[60:63], v[100:103], v[184:187], v[60:63]
    ds_read_b128 v[96:99], v3 offset:22528
    v_mfma_f32_16x16x32_bf16 v[68:71], v[100:103], v[188:191], v[68:71]
    s_waitcnt lgkmcnt(6)
    buffer_load_dwordx4 a[60:63], v243, s[8:11], s28 offen offset:256 sc1
    buffer_load_dwordx4 v3, s[20:23], s29 offen offset:1024 lds
    v_mfma_f32_16x16x32_bf16 v[8:11], v[72:75], v[192:195], v[8:11]
    ds_read_b128 v[100:103], v3 offset:23552
    v_mfma_f32_16x16x32_bf16 v[16:19], v[72:75], v[196:199], v[16:19]
    s_waitcnt lgkmcnt(6)
    v_mfma_f32_16x16x32_bf16 v[12:15], v[76:79], v[192:195], v[12:15]
    ds_read_b128 v[72:75], v3 offset:24576
    v_mfma_f32_16x16x32_bf16 v[20:23], v[76:79], v[196:199], v[20:23]
    s_waitcnt lgkmcnt(6)
    buffer_load_dwordx4 v3, s[20:23], s29 offen offset:2048 lds
    v_mfma_f32_16x16x32_bf16 v[24:27], v[80:83], v[192:195], v[24:27]
    ds_read_b128 v[76:79], v3 offset:25600
    v_mfma_f32_16x16x32_bf16 v[32:35], v[80:83], v[196:199], v[32:35]
    s_waitcnt lgkmcnt(6)
    v_mfma_f32_16x16x32_bf16 v[28:31], v[84:87], v[192:195], v[28:31]
    ds_read_b128 v[80:83], v3 offset:26624
    v_mfma_f32_16x16x32_bf16 v[36:39], v[84:87], v[196:199], v[36:39]
    s_waitcnt lgkmcnt(6)
    buffer_load_dwordx4 a[64:67], v243, s[8:11], s28 offen offset:2048 sc1
    buffer_load_dwordx4 v3, s[20:23], s29 offen offset:3072 lds
    s_add_u32 s29, s29, 65536
    v_mfma_f32_16x16x32_bf16 v[40:43], v[88:91], v[192:195], v[40:43]
    ds_read_b128 v[84:87], v3 offset:27648
    v_mfma_f32_16x16x32_bf16 v[48:51], v[88:91], v[196:199], v[48:51]
    s_waitcnt lgkmcnt(6)
    v_mfma_f32_16x16x32_bf16 v[44:47], v[92:95], v[192:195], v[44:47]
    ds_read_b128 v[88:91], v3 offset:28672
    v_mfma_f32_16x16x32_bf16 v[52:55], v[92:95], v[196:199], v[52:55]
    s_waitcnt lgkmcnt(6)
    v_mfma_f32_16x16x32_bf16 v[56:59], v[96:99], v[192:195], v[56:59]
    ds_read_b128 v[92:95], v3 offset:29696
    v_mfma_f32_16x16x32_bf16 v[64:67], v[96:99], v[196:199], v[64:67]
    s_waitcnt lgkmcnt(6)
    v_mfma_f32_16x16x32_bf16 v[60:63], v[100:103], v[192:195], v[60:63]
    ds_read_b128 v[96:99], v3 offset:30720
    v_mfma_f32_16x16x32_bf16 v[68:71], v[100:103], v[196:199], v[68:71]
    s_waitcnt lgkmcnt(6)
    buffer_load_dwordx4 a[68:71], v243, s[8:11], s28 offen offset:2304 sc1
    s_add_u32 s28, s28, 4096
    v_mfma_f32_16x16x32_bf16 v[8:11], v[72:75], v[200:203], v[8:11]
    ds_read_b128 v[100:103], v3 offset:31744
    v_mfma_f32_16x16x32_bf16 v[16:19], v[72:75], v[204:207], v[16:19]
    s_waitcnt lgkmcnt(6)
    s_barrier
    v_mfma_f32_16x16x32_bf16 v[12:15], v[76:79], v[200:203], v[12:15]
    ds_read_b128 v[72:75], v3 offset:32768
    v_mfma_f32_16x16x32_bf16 v[20:23], v[76:79], v[204:207], v[20:23]
    s_waitcnt lgkmcnt(6)
    s_add_u32 m0, s87, 0
    s_nop 0
    buffer_load_dwordx4 v3, s[20:23], s29 offen offset:0 lds
    v_mfma_f32_16x16x32_bf16 v[24:27], v[80:83], v[200:203], v[24:27]
    ds_read_b128 v[76:79], v3 offset:33792
    v_mfma_f32_16x16x32_bf16 v[32:35], v[80:83], v[204:207], v[32:35]
    s_waitcnt lgkmcnt(6)
    v_mfma_f32_16x16x32_bf16 v[28:31], v[84:87], v[200:203], v[28:31]
    ds_read_b128 v[80:83], v3 offset:34816
    v_mfma_f32_16x16x32_bf16 v[36:39], v[84:87], v[204:207], v[36:39]
    s_waitcnt lgkmcnt(6)
    s_cmp_le_u32 s76, 1
    s_addc_u32 s28, s45, 1
    s_and_b32 s28, s28, 7
    s_mul_i32 s28, s28, 14336
    buffer_load_dwordx4 a[72:75], v243, s[8:11], s28 offen offset:0 sc1
    v_mfma_f32_16x16x32_bf16 v[40:43], v[88:91], v[200:203], v[40:43]
    ds_read_b128 v[84:87], v3 offset:35840
    v_mfma_f32_16x16x32_bf16 v[48:51], v[88:91], v[204:207], v[48:51]
    s_waitcnt lgkmcnt(6)
    v_mfma_f32_16x16x32_bf16 v[44:47], v[92:95], v[200:203], v[44:47]
    ds_read_b128 v[88:91], v3 offset:36864
    v_mfma_f32_16x16x32_bf16 v[52:55], v[92:95], v[204:207], v[52:55]
    s_waitcnt lgkmcnt(6)
    v_mfma_f32_16x16x32_bf16 v[56:59], v[96:99], v[200:203], v[56:59]
    ds_read_b128 v[92:95], v3 offset:37888
    v_mfma_f32_16x16x32_bf16 v[64:67], v[96:99], v[204:207], v[64:67]
    s_waitcnt lgkmcnt(6)
    buffer_load_dwordx4 v3, s[20:23], s29 offen offset:1024 lds
    v_mfma_f32_16x16x32_bf16 v[60:63], v[100:103], v[200:203], v[60:63]
    ds_read_b128 v[96:99], v3 offset:38912
    v_mfma_f32_16x16x32_bf16 v[68:71], v[100:103], v[204:207], v[68:71]
    s_waitcnt lgkmcnt(6)
    buffer_load_dwordx4 a[76:79], v243, s[8:11], s28 offen offset:256 sc1
    v_mfma_f32_16x16x32_bf16 v[8:11], v[72:75], v[208:211], v[8:11]
    ds_read_b128 v[100:103], v3 offset:39936
    v_mfma_f32_16x16x32_bf16 v[16:19], v[72:75], v[212:215], v[16:19]
    s_waitcnt lgkmcnt(6)
    v_mfma_f32_16x16x32_bf16 v[12:15], v[76:79], v[208:211], v[12:15]
    ds_read_b128 v[72:75], v3 offset:40960
    v_mfma_f32_16x16x32_bf16 v[20:23], v[76:79], v[212:215], v[20:23]
    s_waitcnt lgkmcnt(6)
    v_mfma_f32_16x16x32_bf16 v[24:27], v[80:83], v[208:211], v[24:27]
    ds_read_b128 v[76:79], v3 offset:41984
    v_mfma_f32_16x16x32_bf16 v[32:35], v[80:83], v[212:215], v[32:35]
    s_waitcnt lgkmcnt(6)
    v_mfma_f32_16x16x32_bf16 v[28:31], v[84:87], v[208:211], v[28:31]
    ds_read_b128 v[80:83], v3 offset:43008
    v_mfma_f32_16x16x32_bf16 v[36:39], v[84:87], v[212:215], v[36:39]
    s_waitcnt lgkmcnt(6)
    buffer_load_dwordx4 v3, s[20:23], s29 offen offset:2048 lds
    v_mfma_f32_16x16x32_bf16 v[40:43], v[88:91], v[208:211], v[40:43]
    ds_read_b128 v[84:87], v3 offset:44032
    v_mfma_f32_16x16x32_bf16 v[48:51], v[88:91], v[212:215], v[48:51]
    s_waitcnt lgkmcnt(6)
    buffer_load_dwordx4 a[80:83], v243, s[8:11], s28 offen offset:2048 sc1
    v_mfma_f32_16x16x32_bf16 v[44:47], v[92:95], v[208:211], v[44:47]
    ds_read_b128 v[88:91], v3 offset:45056
    v_mfma_f32_16x16x32_bf16 v[52:55], v[92:95], v[212:215], v[52:55]
    s_waitcnt lgkmcnt(6)
    v_mfma_f32_16x16x32_bf16 v[56:59], v[96:99], v[208:211], v[56:59]
    ds_read_b128 v[92:95], v3 offset:46080
    v_mfma_f32_16x16x32_bf16 v[64:67], v[96:99], v[212:215], v[64:67]
    s_waitcnt lgkmcnt(6)
    v_mfma_f32_16x16x32_bf16 v[60:63], v[100:103], v[208:211], v[60:63]
    ds_read_b128 v[96:99], v3 offset:47104
    v_mfma_f32_16x16x32_bf16 v[68:71], v[100:103], v[212:215], v[68:71]
    s_waitcnt lgkmcnt(6)
    buffer_load_dwordx4 a[84:87], v243, s[8:11], s28 offen offset:2304 sc1
    s_add_u32 s28, s28, 4096
    v_mfma_f32_16x16x32_bf16 v[8:11], v[72:75], v[216:219], v[8:11]
    ds_read_b128 v[100:103], v3 offset:48128
    v_mfma_f32_16x16x32_bf16 v[16:19], v[72:75], v[220:223], v[16:19]
    s_waitcnt lgkmcnt(6)
    buffer_load_dwordx4 v3, s[20:23], s29 offen offset:3072 lds
    s_add_u32 s29, s29, 16384
    s_waitcnt vmcnt(9)
    s_barrier
    v_mfma_f32_16x16x32_bf16 v[12:15], v[76:79], v[216:219], v[12:15]
    ds_read_b128 v[72:75], v3 offset:49152
    v_mfma_f32_16x16x32_bf16 v[20:23], v[76:79], v[220:223], v[20:23]
    s_waitcnt lgkmcnt(6)
    v_mfma_f32_16x16x32_bf16 v[24:27], v[80:83], v[216:219], v[24:27]
    ds_read_b128 v[76:79], v3 offset:50176
    v_mfma_f32_16x16x32_bf16 v[32:35], v[80:83], v[220:223], v[32:35]
    s_waitcnt lgkmcnt(6)
    v_mfma_f32_16x16x32_bf16 v[28:31], v[84:87], v[216:219], v[28:31]
    ds_read_b128 v[80:83], v3 offset:51200
    v_mfma_f32_16x16x32_bf16 v[36:39], v[84:87], v[220:223], v[36:39]
    s_waitcnt lgkmcnt(6)
    s_cmp_le_u32 s76, 2
    s_addc_u32 s28, s45, 2
    s_and_b32 s28, s28, 7
    s_mul_i32 s28, s28, 14336
    buffer_load_dwordx4 a[88:91], v243, s[8:11], s28 offen offset:0 sc1
    v_mfma_f32_16x16x32_bf16 v[40:43], v[88:91], v[216:219], v[40:43]
    ds_read_b128 v[84:87], v3 offset:52224
    v_mfma_f32_16x16x32_bf16 v[48:51], v[88:91], v[220:223], v[48:51]
    s_waitcnt lgkmcnt(6)
    v_mfma_f32_16x16x32_bf16 v[44:47], v[92:95], v[216:219], v[44:47]
    ds_read_b128 v[88:91], v3 offset:53248
    v_mfma_f32_16x16x32_bf16 v[52:55], v[92:95], v[220:223], v[52:55]
    s_waitcnt lgkmcnt(6)
    v_mfma_f32_16x16x32_bf16 v[56:59], v[96:99], v[216:219], v[56:59]
    ds_read_b128 v[92:95], v3 offset:54272
    v_mfma_f32_16x16x32_bf16 v[64:67], v[96:99], v[220:223], v[64:67]
    s_waitcnt lgkmcnt(6)
    s_add_u32 m0, s87, 16384
    s_nop 0
    buffer_load_dwordx4 v3, s[20:23], s29 offen offset:0 lds
    v_mfma_f32_16x16x32_bf16 v[60:63], v[100:103], v[216:219], v[60:63]
    ds_read_b128 v[96:99], v3 offset:55296
    v_mfma_f32_16x16x32_bf16 v[68:71], v[100:103], v[220:223], v[68:71]
    s_waitcnt lgkmcnt(6)
    buffer_load_dwordx4 a[92:95], v243, s[8:11], s28 offen offset:256 sc1
    v_mfma_f32_16x16x32_bf16 v[8:11], v[72:75], v[224:227], v[8:11]
    ds_read_b128 v[100:103], v3 offset:56320
    v_mfma_f32_16x16x32_bf16 v[16:19], v[72:75], v[228:231], v[16:19]
    s_waitcnt lgkmcnt(6)
    v_mfma_f32_16x16x32_bf16 v[12:15], v[76:79], v[224:227], v[12:15]
    ds_read_b128 v[72:75], v3 offset:57344
    v_mfma_f32_16x16x32_bf16 v[20:23], v[76:79], v[228:231], v[20:23]
    s_waitcnt lgkmcnt(6)
    v_mfma_f32_16x16x32_bf16 v[24:27], v[80:83], v[224:227], v[24:27]
    ds_read_b128 v[76:79], v3 offset:58368
    v_mfma_f32_16x16x32_bf16 v[32:35], v[80:83], v[228:231], v[32:35]
    s_waitcnt lgkmcnt(6)
    v_mfma_f32_16x16x32_bf16 v[28:31], v[84:87], v[224:227], v[28:31]
    ds_read_b128 v[80:83], v3 offset:59392
    v_mfma_f32_16x16x32_bf16 v[36:39], v[84:87], v[228:231], v[36:39]
    s_waitcnt lgkmcnt(6)
    buffer_load_dwordx4 v3, s[20:23], s29 offen offset:1024 lds
    v_mfma_f32_16x16x32_bf16 v[40:43], v[88:91], v[224:227], v[40:43]
    ds_read_b128 v[84:87], v3 offset:60416
    v_mfma_f32_16x16x32_bf16 v[48:51], v[88:91], v[228:231], v[48:51]
    s_waitcnt lgkmcnt(6)
    buffer_load_dwordx4 a[96:99], v243, s[8:11], s28 offen offset:2048 sc1
    v_mfma_f32_16x16x32_bf16 v[44:47], v[92:95], v[224:227], v[44:47]
    ds_read_b128 v[88:91], v3 offset:61440
    v_mfma_f32_16x16x32_bf16 v[52:55], v[92:95], v[228:231], v[52:55]
    s_waitcnt lgkmcnt(6)
    v_mfma_f32_16x16x32_bf16 v[56:59], v[96:99], v[224:227], v[56:59]
    ds_read_b128 v[92:95], v3 offset:62464
    v_mfma_f32_16x16x32_bf16 v[64:67], v[96:99], v[228:231], v[64:67]
    s_waitcnt lgkmcnt(6)
    v_mfma_f32_16x16x32_bf16 v[60:63], v[100:103], v[224:227], v[60:63]
    ds_read_b128 v[96:99], v3 offset:63488
    v_mfma_f32_16x16x32_bf16 v[68:71], v[100:103], v[228:231], v[68:71]
    s_waitcnt lgkmcnt(6)
    s_waitcnt vmcnt(18)
    buffer_load_dwordx4 a[100:103], v243, s[8:11], s28 offen offset:2304 sc1
    s_add_u32 s28, s28, 4096
    v_mfma_f32_16x16x32_bf16 v[8:11], v[72:75], a[56:59], v[8:11]
    ds_read_b128 v[100:103], v3 offset:64512
    v_mfma_f32_16x16x32_bf16 v[16:19], v[72:75], a[60:63], v[16:19]
    s_waitcnt lgkmcnt(6)
    buffer_load_dwordx4 v3, s[20:23], s29 offen offset:2048 lds
    s_barrier
    v_mfma_f32_16x16x32_bf16 v[12:15], v[76:79], a[56:59], v[12:15]
    ds_read_b128 v[72:75], v4 offset:0
    v_mfma_f32_16x16x32_bf16 v[20:23], v[76:79], a[60:63], v[20:23]
    s_waitcnt lgkmcnt(6)
    v_mfma_f32_16x16x32_bf16 v[24:27], v[80:83], a[56:59], v[24:27]
    ds_read_b128 v[76:79], v4 offset:1024
    v_mfma_f32_16x16x32_bf16 v[32:35], v[80:83], a[60:63], v[32:35]
    s_waitcnt lgkmcnt(6)
    v_mfma_f32_16x16x32_bf16 v[28:31], v[84:87], a[56:59], v[28:31]
    ds_read_b128 v[80:83], v4 offset:2048
    v_mfma_f32_16x16x32_bf16 v[36:39], v[84:87], a[60:63], v[36:39]
    s_waitcnt lgkmcnt(6)
    s_cmp_le_u32 s76, 3
    s_addc_u32 s28, s45, 3
    s_and_b32 s28, s28, 7
    s_mul_i32 s28, s28, 14336
    buffer_load_dwordx4 a[104:107], v243, s[8:11], s28 offen offset:0 sc1
    v_mfma_f32_16x16x32_bf16 v[40:43], v[88:91], a[56:59], v[40:43]
    ds_read_b128 v[84:87], v4 offset:3072
    v_mfma_f32_16x16x32_bf16 v[48:51], v[88:91], a[60:63], v[48:51]
    s_waitcnt lgkmcnt(6)
    s_lshl_b32 s83, s94, 7
    s_lshl_b32 s32, s95, 3
    s_add_u32 s83, s83, s32
    s_add_u32 s33, s83, 819200
    s_waitcnt vmcnt(30)
    s_mov_b64 exec, 1
    buffer_store_dwordx2 v[244:245], off, s[16:19], s33
    s_add_u32 s32, s33, 53248
    buffer_store_dwordx2 v[244:245], off, s[16:19], s32 sc1
    s_mov_b64 exec, -1
    v_mfma_f32_16x16x32_bf16 v[44:47], v[92:95], a[56:59], v[44:47]
    ds_read_b128 v[88:91], v4 offset:4096
    v_mfma_f32_16x16x32_bf16 v[52:55], v[92:95], a[60:63], v[52:55]
    s_waitcnt lgkmcnt(6)
    buffer_load_dwordx4 v3, s[20:23], s29 offen offset:3072 lds
    s_add_u32 s29, s29, 16384
    v_mfma_f32_16x16x32_bf16 v[56:59], v[96:99], a[56:59], v[56:59]
    ds_read_b128 v[92:95], v4 offset:5120
    v_mfma_f32_16x16x32_bf16 v[64:67], v[96:99], a[60:63], v[64:67]
    s_waitcnt lgkmcnt(6)
    v_mfma_f32_16x16x32_bf16 v[60:63], v[100:103], a[56:59], v[60:63]
    ds_read_b128 v[96:99], v4 offset:6144
    v_mfma_f32_16x16x32_bf16 v[68:71], v[100:103], a[60:63], v[68:71]
    s_waitcnt lgkmcnt(6)
    s_waitcnt vmcnt(17)
    buffer_load_dwordx4 a[108:111], v243, s[8:11], s28 offen offset:256 sc1
    v_mfma_f32_16x16x32_bf16 v[8:11], v[72:75], a[64:67], v[8:11]
    ds_read_b128 v[100:103], v4 offset:7168
    v_mfma_f32_16x16x32_bf16 v[16:19], v[72:75], a[68:71], v[16:19]
    s_waitcnt lgkmcnt(6)
    v_mfma_f32_16x16x32_bf16 v[12:15], v[76:79], a[64:67], v[12:15]
    ds_read_b128 v[72:75], v4 offset:8192
    v_mfma_f32_16x16x32_bf16 v[20:23], v[76:79], a[68:71], v[20:23]
    s_waitcnt lgkmcnt(6)
    v_mfma_f32_16x16x32_bf16 v[24:27], v[80:83], a[64:67], v[24:27]
    ds_read_b128 v[76:79], v4 offset:9216
    v_mfma_f32_16x16x32_bf16 v[32:35], v[80:83], a[68:71], v[32:35]
    s_waitcnt lgkmcnt(6)
    v_mfma_f32_16x16x32_bf16 v[28:31], v[84:87], a[64:67], v[28:31]
    ds_read_b128 v[80:83], v4 offset:10240
    v_mfma_f32_16x16x32_bf16 v[36:39], v[84:87], a[68:71], v[36:39]
    s_waitcnt lgkmcnt(6)
    s_add_u32 m0, s87, 32768
    s_nop 0
    buffer_load_dwordx4 v3, s[20:23], s29 offen offset:0 lds
    v_mfma_f32_16x16x32_bf16 v[40:43], v[88:91], a[64:67], v[40:43]
    ds_read_b128 v[84:87], v4 offset:11264
    v_mfma_f32_16x16x32_bf16 v[48:51], v[88:91], a[68:71], v[48:51]
    s_waitcnt lgkmcnt(6)
    buffer_load_dwordx4 a[0:3], v243, s[8:11], s28 offen offset:2048 sc1
    v_mfma_f32_16x16x32_bf16 v[44:47], v[92:95], a[64:67], v[44:47]
    ds_read_b128 v[88:91], v4 offset:12288
    v_mfma_f32_16x16x32_bf16 v[52:55], v[92:95], a[68:71], v[52:55]
    s_waitcnt lgkmcnt(6)
    v_mfma_f32_16x16x32_bf16 v[56:59], v[96:99], a[64:67], v[56:59]
    ds_read_b128 v[92:95], v4 offset:13312
    v_mfma_f32_16x16x32_bf16 v[64:67], v[96:99], a[68:71], v[64:67]
    s_waitcnt lgkmcnt(6)
    v_mfma_f32_16x16x32_bf16 v[60:63], v[100:103], a[64:67], v[60:63]
    ds_read_b128 v[96:99], v4 offset:14336
    v_mfma_f32_16x16x32_bf16 v[68:71], v[100:103], a[68:71], v[68:71]
    s_waitcnt lgkmcnt(6)
    s_waitcnt vmcnt(16)
    buffer_load_dwordx4 a[4:7], v243, s[8:11], s28 offen offset:2304 sc1
    s_add_u32 s28, s28, 4096
    v_mfma_f32_16x16x32_bf16 v[8:11], v[72:75], a[72:75], v[8:11]
    ds_read_b128 v[100:103], v4 offset:15360
    v_mfma_f32_16x16x32_bf16 v[16:19], v[72:75], a[76:79], v[16:19]
    s_waitcnt lgkmcnt(6)
    buffer_load_dwordx4 v3, s[20:23], s29 offen offset:1024 lds
    s_barrier
    v_mfma_f32_16x16x32_bf16 v[12:15], v[76:79], a[72:75], v[12:15]
    ds_read_b128 v[72:75], v4 offset:16384
    v_mfma_f32_16x16x32_bf16 v[20:23], v[76:79], a[76:79], v[20:23]
    s_waitcnt lgkmcnt(6)
    v_mfma_f32_16x16x32_bf16 v[24:27], v[80:83], a[72:75], v[24:27]
    ds_read_b128 v[76:79], v4 offset:17408
    v_mfma_f32_16x16x32_bf16 v[32:35], v[80:83], a[76:79], v[32:35]
    s_waitcnt lgkmcnt(6)
    v_mfma_f32_16x16x32_bf16 v[28:31], v[84:87], a[72:75], v[28:31]
    ds_read_b128 v[80:83], v4 offset:18432
    v_mfma_f32_16x16x32_bf16 v[36:39], v[84:87], a[76:79], v[36:39]
    s_waitcnt lgkmcnt(6)
    s_cmp_le_u32 s76, 4
    s_addc_u32 s28, s45, 4
    s_and_b32 s28, s28, 7
    s_mul_i32 s28, s28, 14336
    buffer_load_dwordx4 a[8:11], v243, s[8:11], s28 offen offset:0 sc1
    v_mfma_f32_16x16x32_bf16 v[40:43], v[88:91], a[72:75], v[40:43]
    ds_read_b128 v[84:87], v4 offset:19456
    v_mfma_f32_16x16x32_bf16 v[48:51], v[88:91], a[76:79], v[48:51]
    s_waitcnt lgkmcnt(6)
    v_mfma_f32_16x16x32_bf16 v[44:47], v[92:95], a[72:75], v[44:47]
    ds_read_b128 v[88:91], v4 offset:20480
    v_mfma_f32_16x16x32_bf16 v[52:55], v[92:95], a[76:79], v[52:55]
    s_waitcnt lgkmcnt(6)
    buffer_load_dwordx4 v3, s[20:23], s29 offen offset:2048 lds
    v_mfma_f32_16x16x32_bf16 v[56:59], v[96:99], a[72:75], v[56:59]
    ds_read_b128 v[92:95], v4 offset:21504
    v_mfma_f32_16x16x32_bf16 v[64:67], v[96:99], a[76:79], v[64:67]
    s_waitcnt lgkmcnt(6)
    v_mfma_f32_16x16x32_bf16 v[60:63], v[100:103], a[72:75], v[60:63]
    ds_read_b128 v[96:99], v4 offset:22528
    v_mfma_f32_16x16x32_bf16 v[68:71], v[100:103], a[76:79], v[68:71]
    s_waitcnt lgkmcnt(6)
    s_waitcnt vmcnt(17)
    buffer_load_dwordx4 a[12:15], v243, s[8:11], s28 offen offset:256 sc1
    v_mfma_f32_16x16x32_bf16 v[8:11], v[72:75], a[80:83], v[8:11]
    ds_read_b128 v[100:103], v4 offset:23552
    v_mfma_f32_16x16x32_bf16 v[16:19], v[72:75], a[84:87], v[16:19]
    s_waitcnt lgkmcnt(6)
    v_mfma_f32_16x16x32_bf16 v[12:15], v[76:79], a[80:83], v[12:15]
    ds_read_b128 v[72:75], v4 offset:24576
    v_mfma_f32_16x16x32_bf16 v[20:23], v[76:79], a[84:87], v[20:23]
    s_waitcnt lgkmcnt(6)
    v_mfma_f32_16x16x32_bf16 v[24:27], v[80:83], a[80:83], v[24:27]
    ds_read_b128 v[76:79], v4 offset:25600
    v_mfma_f32_16x16x32_bf16 v[32:35], v[80:83], a[84:87], v[32:35]
    s_waitcnt lgkmcnt(6)
    buffer_load_dwordx4 v3, s[20:23], s29 offen offset:3072 lds
    s_add_u32 s29, s29, 16384
    v_mfma_f32_16x16x32_bf16 v[28:31], v[84:87], a[80:83], v[28:31]
    ds_read_b128 v[80:83], v4 offset:26624
    v_mfma_f32_16x16x32_bf16 v[36:39], v[84:87], a[84:87], v[36:39]
    s_waitcnt lgkmcnt(6)
    buffer_load_dwordx4 a[16:19], v243, s[8:11], s28 offen offset:2048 sc1
    v_mfma_f32_16x16x32_bf16 v[40:43], v[88:91], a[80:83], v[40:43]
    ds_read_b128 v[84:87], v4 offset:27648
    v_mfma_f32_16x16x32_bf16 v[48:51], v[88:91], a[84:87], v[48:51]
    s_waitcnt lgkmcnt(6)
    v_mfma_f32_16x16x32_bf16 v[44:47], v[92:95], a[80:83], v[44:47]
    ds_read_b128 v[88:91], v4 offset:28672
    v_mfma_f32_16x16x32_bf16 v[52:55], v[92:95], a[84:87], v[52:55]
    s_waitcnt lgkmcnt(6)
    v_mfma_f32_16x16x32_bf16 v[56:59], v[96:99], a[80:83], v[56:59]
    ds_read_b128 v[92:95], v4 offset:29696
    v_mfma_f32_16x16x32_bf16 v[64:67], v[96:99], a[84:87], v[64:67]
    s_waitcnt lgkmcnt(6)
    v_mfma_f32_16x16x32_bf16 v[60:63], v[100:103], a[80:83], v[60:63]
    ds_read_b128 v[96:99], v4 offset:30720
    v_mfma_f32_16x16x32_bf16 v[68:71], v[100:103], a[84:87], v[68:71]
    s_waitcnt lgkmcnt(6)
    s_waitcnt vmcnt(16)
    buffer_load_dwordx4 a[20:23], v243, s[8:11], s28 offen offset:2304 sc1
    s_add_u32 s28, s28, 4096
    v_mfma_f32_16x16x32_bf16 v[8:11], v[72:75], a[88:91], v[8:11]
    ds_read_b128 v[100:103], v4 offset:31744
    v_mfma_f32_16x16x32_bf16 v[16:19], v[72:75], a[92:95], v[16:19]
    s_waitcnt lgkmcnt(6)
    s_add_u32 m0, s87, 49152
    s_nop 0
    buffer_load_dwordx4 v3, s[20:23], s29 offen offset:0 lds
    s_barrier
    v_mfma_f32_16x16x32_bf16 v[12:15], v[76:79], a[88:91], v[12:15]
    ds_read_b128 v[72:75], v4 offset:32768
    v_mfma_f32_16x16x32_bf16 v[20:23], v[76:79], a[92:95], v[20:23]
    s_waitcnt lgkmcnt(6)
    v_mfma_f32_16x16x32_bf16 v[24:27], v[80:83], a[88:91], v[24:27]
    ds_read_b128 v[76:79], v4 offset:33792
    v_mfma_f32_16x16x32_bf16 v[32:35], v[80:83], a[92:95], v[32:35]
    s_waitcnt lgkmcnt(6)
    v_mfma_f32_16x16x32_bf16 v[28:31], v[84:87], a[88:91], v[28:31]
    ds_read_b128 v[80:83], v4 offset:34816
    v_mfma_f32_16x16x32_bf16 v[36:39], v[84:87], a[92:95], v[36:39]
    s_waitcnt lgkmcnt(6)
    s_cmp_le_u32 s76, 5
    s_addc_u32 s28, s45, 5
    s_and_b32 s28, s28, 7
    s_mul_i32 s28, s28, 14336
    buffer_load_dwordx4 a[24:27], v243, s[8:11], s28 offen offset:0 sc1
    v_mfma_f32_16x16x32_bf16 v[40:43], v[88:91], a[88:91], v[40:43]
    ds_read_b128 v[84:87], v4 offset:35840
    v_mfma_f32_16x16x32_bf16 v[48:51], v[88:91], a[92:95], v[48:51]
    s_waitcnt lgkmcnt(6)
    v_mfma_f32_16x16x32_bf16 v[44:47], v[92:95], a[88:91], v[44:47]
    ds_read_b128 v[88:91], v4 offset:36864
    v_mfma_f32_16x16x32_bf16 v[52:55], v[92:95], a[92:95], v[52:55]
    s_waitcnt lgkmcnt(6)
    buffer_load_dwordx4 v3, s[20:23], s29 offen offset:1024 lds
    v_mfma_f32_16x16x32_bf16 v[56:59], v[96:99], a[88:91], v[56:59]
    ds_read_b128 v[92:95], v4 offset:37888
    v_mfma_f32_16x16x32_bf16 v[64:67], v[96:99], a[92:95], v[64:67]
    s_waitcnt lgkmcnt(6)
    v_mfma_f32_16x16x32_bf16 v[60:63], v[100:103], a[88:91], v[60:63]
    ds_read_b128 v[96:99], v4 offset:38912
    v_mfma_f32_16x16x32_bf16 v[68:71], v[100:103], a[92:95], v[68:71]
    s_waitcnt lgkmcnt(6)
    s_waitcnt vmcnt(17)
    buffer_load_dwordx4 a[28:31], v243, s[8:11], s28 offen offset:256 sc1
    v_mfma_f32_16x16x32_bf16 v[8:11], v[72:75], a[96:99], v[8:11]
    ds_read_b128 v[100:103], v4 offset:39936
    v_mfma_f32_16x16x32_bf16 v[16:19], v[72:75], a[100:103], v[16:19]
    s_waitcnt lgkmcnt(6)
    v_mfma_f32_16x16x32_bf16 v[12:15], v[76:79], a[96:99], v[12:15]
    ds_read_b128 v[72:75], v4 offset:40960
    v_mfma_f32_16x16x32_bf16 v[20:23], v[76:79], a[100:103], v[20:23]
    s_waitcnt lgkmcnt(6)
    v_mfma_f32_16x16x32_bf16 v[24:27], v[80:83], a[96:99], v[24:27]
    ds_read_b128 v[76:79], v4 offset:41984
    v_mfma_f32_16x16x32_bf16 v[32:35], v[80:83], a[100:103], v[32:35]
    s_waitcnt lgkmcnt(6)
    buffer_load_dwordx4 v3, s[20:23], s29 offen offset:2048 lds
    v_mfma_f32_16x16x32_bf16 v[28:31], v[84:87], a[96:99], v[28:31]
    ds_read_b128 v[80:83], v4 offset:43008
    v_mfma_f32_16x16x32_bf16 v[36:39], v[84:87], a[100:103], v[36:39]
    s_waitcnt lgkmcnt(6)
    buffer_load_dwordx4 a[32:35], v243, s[8:11], s28 offen offset:2048 sc1
    v_mfma_f32_16x16x32_bf16 v[40:43], v[88:91], a[96:99], v[40:43]
    ds_read_b128 v[84:87], v4 offset:44032
    v_mfma_f32_16x16x32_bf16 v[48:51], v[88:91], a[100:103], v[48:51]
    s_waitcnt lgkmcnt(6)
    v_mfma_f32_16x16x32_bf16 v[44:47], v[92:95], a[96:99], v[44:47]
    ds_read_b128 v[88:91], v4 offset:45056
    v_mfma_f32_16x16x32_bf16 v[52:55], v[92:95], a[100:103], v[52:55]
    s_waitcnt lgkmcnt(6)
    v_mfma_f32_16x16x32_bf16 v[56:59], v[96:99], a[96:99], v[56:59]
    ds_read_b128 v[92:95], v4 offset:46080
    v_mfma_f32_16x16x32_bf16 v[64:67], v[96:99], a[100:103], v[64:67]
    s_waitcnt lgkmcnt(6)
    v_mfma_f32_16x16x32_bf16 v[60:63], v[100:103], a[96:99], v[60:63]
    ds_read_b128 v[96:99], v4 offset:47104
    v_mfma_f32_16x16x32_bf16 v[68:71], v[100:103], a[100:103], v[68:71]
    s_waitcnt lgkmcnt(6)
    s_waitcnt vmcnt(16)
    buffer_load_dwordx4 v3, s[20:23], s29 offen offset:3072 lds
    s_add_u32 s29, s29, 16384
    v_mfma_f32_16x16x32_bf16 v[8:11], v[72:75], a[104:107], v[8:11]
    ds_read_b128 v[100:103], v4 offset:48128
    v_mfma_f32_16x16x32_bf16 v[16:19], v[72:75], a[108:111], v[16:19]
    s_waitcnt lgkmcnt(6)
    s_mov_b32 s35, 819200
    buffer_load_dwordx2 v[240:241], v1, s[16:19], s35 offen sc1
    buffer_load_dwordx4 a[36:39], v243, s[8:11], s28 offen offset:2304 sc1
    s_add_u32 s28, s28, 4096
    s_barrier
    v_mfma_f32_16x16x32_bf16 v[12:15], v[76:79], a[104:107], v[12:15]
    ds_read_b128 v[72:75], v4 offset:49152
    v_mfma_f32_16x16x32_bf16 v[20:23], v[76:79], a[108:111], v[20:23]
    s_waitcnt lgkmcnt(6)
    v_mfma_f32_16x16x32_bf16 v[24:27], v[80:83], a[104:107], v[24:27]
    ds_read_b128 v[76:79], v4 offset:50176
    v_mfma_f32_16x16x32_bf16 v[32:35], v[80:83], a[108:111], v[32:35]
    s_waitcnt lgkmcnt(6)
    v_mfma_f32_16x16x32_bf16 v[28:31], v[84:87], a[104:107], v[28:31]
    ds_read_b128 v[80:83], v4 offset:51200
    v_mfma_f32_16x16x32_bf16 v[36:39], v[84:87], a[108:111], v[36:39]
    s_waitcnt lgkmcnt(6)
    s_cmp_le_u32 s76, 6
    s_addc_u32 s28, s45, 6
    s_and_b32 s28, s28, 7
    s_mul_i32 s28, s28, 14336
    buffer_load_dwordx4 a[40:43], v243, s[8:11], s28 offen offset:0 sc1
    v_mfma_f32_16x16x32_bf16 v[40:43], v[88:91], a[104:107], v[40:43]
    ds_read_b128 v[84:87], v4 offset:52224
    v_mfma_f32_16x16x32_bf16 v[48:51], v[88:91], a[108:111], v[48:51]
    s_waitcnt lgkmcnt(6)
    v_mfma_f32_16x16x32_bf16 v[44:47], v[92:95], a[104:107], v[44:47]
    ds_read_b128 v[88:91], v4 offset:53248
    v_mfma_f32_16x16x32_bf16 v[52:55], v[92:95], a[108:111], v[52:55]
    s_waitcnt lgkmcnt(6)
    s_add_u32 m0, s87, 65536
    s_nop 0
    buffer_load_dwordx4 v3, s[20:23], s29 offen offset:0 lds
    v_mfma_f32_16x16x32_bf16 v[56:59], v[96:99], a[104:107], v[56:59]
    ds_read_b128 v[92:95], v4 offset:54272
    v_mfma_f32_16x16x32_bf16 v[64:67], v[96:99], a[108:111], v[64:67]
    s_waitcnt lgkmcnt(6)
    v_mfma_f32_16x16x32_bf16 v[60:63], v[100:103], a[104:107], v[60:63]
    ds_read_b128 v[96:99], v4 offset:55296
    v_mfma_f32_16x16x32_bf16 v[68:71], v[100:103], a[108:111], v[68:71]
    s_waitcnt lgkmcnt(6)
    s_waitcnt vmcnt(18)
    buffer_load_dwordx4 a[44:47], v243, s[8:11], s28 offen offset:256 sc1
    v_mfma_f32_16x16x32_bf16 v[8:11], v[72:75], a[0:3], v[8:11]
    ds_read_b128 v[100:103], v4 offset:56320
    v_mfma_f32_16x16x32_bf16 v[16:19], v[72:75], a[4:7], v[16:19]
    s_waitcnt lgkmcnt(6)
    v_mfma_f32_16x16x32_bf16 v[12:15], v[76:79], a[0:3], v[12:15]
    ds_read_b128 v[72:75], v4 offset:57344
    v_mfma_f32_16x16x32_bf16 v[20:23], v[76:79], a[4:7], v[20:23]
    s_waitcnt lgkmcnt(6)
    v_mfma_f32_16x16x32_bf16 v[24:27], v[80:83], a[0:3], v[24:27]
    ds_read_b128 v[76:79], v4 offset:58368
    v_mfma_f32_16x16x32_bf16 v[32:35], v[80:83], a[4:7], v[32:35]
    s_waitcnt lgkmcnt(6)
    buffer_load_dwordx4 v3, s[20:23], s29 offen offset:1024 lds
    v_mfma_f32_16x16x32_bf16 v[28:31], v[84:87], a[0:3], v[28:31]
    ds_read_b128 v[80:83], v4 offset:59392
    v_mfma_f32_16x16x32_bf16 v[36:39], v[84:87], a[4:7], v[36:39]
    s_waitcnt lgkmcnt(6)
    buffer_load_dwordx4 a[48:51], v243, s[8:11], s28 offen offset:2048 sc1
    v_mfma_f32_16x16x32_bf16 v[40:43], v[88:91], a[0:3], v[40:43]
    ds_read_b128 v[84:87], v4 offset:60416
    v_mfma_f32_16x16x32_bf16 v[48:51], v[88:91], a[4:7], v[48:51]
    s_waitcnt lgkmcnt(6)
    v_mfma_f32_16x16x32_bf16 v[44:47], v[92:95], a[0:3], v[44:47]
    ds_read_b128 v[88:91], v4 offset:61440
    v_mfma_f32_16x16x32_bf16 v[52:55], v[92:95], a[4:7], v[52:55]
    s_waitcnt lgkmcnt(6)
    v_mfma_f32_16x16x32_bf16 v[56:59], v[96:99], a[0:3], v[56:59]
    ds_read_b128 v[92:95], v4 offset:62464
    v_mfma_f32_16x16x32_bf16 v[64:67], v[96:99], a[4:7], v[64:67]
    s_waitcnt lgkmcnt(6)
    v_mfma_f32_16x16x32_bf16 v[60:63], v[100:103], a[0:3], v[60:63]
    ds_read_b128 v[96:99], v4 offset:63488
    v_mfma_f32_16x16x32_bf16 v[68:71], v[100:103], a[4:7], v[68:71]
    s_waitcnt lgkmcnt(6)
    s_waitcnt vmcnt(17)
    buffer_load_dwordx4 v3, s[20:23], s29 offen offset:2048 lds
    v_mfma_f32_16x16x32_bf16 v[8:11], v[72:75], a[8:11], v[8:11]
    ds_read_b128 v[100:103], v4 offset:64512
    v_mfma_f32_16x16x32_bf16 v[16:19], v[72:75], a[12:15], v[16:19]
    s_waitcnt lgkmcnt(6)
    buffer_load_dwordx4 a[52:55], v243, s[8:11], s28 offen offset:2304 sc1
    s_add_u32 s28, s28, 4096
    s_barrier
    v_mfma_f32_16x16x32_bf16 v[12:15], v[76:79], a[8:11], v[12:15]
    ds_read_b128 v[72:75], v242 offset:0
    v_mfma_f32_16x16x32_bf16 v[20:23], v[76:79], a[12:15], v[20:23]
    s_waitcnt lgkmcnt(6)
    v_mfma_f32_16x16x32_bf16 v[24:27], v[80:83], a[8:11], v[24:27]
    ds_read_b128 v[76:79], v242 offset:1024
    v_mfma_f32_16x16x32_bf16 v[32:35], v[80:83], a[12:15], v[32:35]
    s_waitcnt lgkmcnt(6)
    v_mfma_f32_16x16x32_bf16 v[28:31], v[84:87], a[8:11], v[28:31]
    ds_read_b128 v[80:83], v242 offset:2048
    v_mfma_f32_16x16x32_bf16 v[36:39], v[84:87], a[12:15], v[36:39]
    s_waitcnt lgkmcnt(6)
    v_mfma_f32_16x16x32_bf16 v[40:43], v[88:91], a[8:11], v[40:43]
    ds_read_b128 v[84:87], v242 offset:3072
    v_mfma_f32_16x16x32_bf16 v[48:51], v[88:91], a[12:15], v[48:51]
    s_waitcnt lgkmcnt(6)
    buffer_load_dwordx4 v3, s[20:23], s29 offen offset:3072 lds
    s_add_u32 s29, s29, 16384
    v_mfma_f32_16x16x32_bf16 v[44:47], v[92:95], a[8:11], v[44:47]
    ds_read_b128 v[88:91], v242 offset:4096
    v_mfma_f32_16x16x32_bf16 v[52:55], v[92:95], a[12:15], v[52:55]
    s_waitcnt lgkmcnt(6)
    v_mfma_f32_16x16x32_bf16 v[56:59], v[96:99], a[8:11], v[56:59]
    ds_read_b128 v[92:95], v242 offset:5120
    v_mfma_f32_16x16x32_bf16 v[64:67], v[96:99], a[12:15], v[64:67]
    s_waitcnt lgkmcnt(6)
    s_waitcnt vmcnt(9)
    v_cmp_ne_u64 vcc, s[74:75], v[240:241]
    s_cmp_lg_u64 vcc, 0
    s_cbranch_scc1 L_main_kernel_spin_1058
L_main_kernel_ok_1057:
    v_mfma_f32_16x16x32_bf16 v[60:63], v[100:103], a[8:11], v[60:63]
    ds_read_b128 v[96:99], v242 offset:6144
    v_mfma_f32_16x16x32_bf16 v[68:71], v[100:103], a[12:15], v[68:71]
    s_waitcnt lgkmcnt(6)
    s_waitcnt vmcnt(17)
    s_cmp_le_u32 s76, 0
    s_addc_u32 s28, s45, 0
    s_and_b32 s28, s28, 7
    s_mul_i32 s28, s28, 14336
    s_add_u32 s28, s28, 4096
    buffer_load_dwordx4 a[56:59], v243, s[8:11], s28 offen offset:0 sc1
    v_mfma_f32_16x16x32_bf16 v[8:11], v[72:75], a[16:19], v[8:11]
    ds_read_b128 v[100:103], v242 offset:7168
    v_mfma_f32_16x16x32_bf16 v[16:19], v[72:75], a[20:23], v[16:19]
    s_waitcnt lgkmcnt(6)
    v_mfma_f32_16x16x32_bf16 v[12:15], v[76:79], a[16:19], v[12:15]
    ds_read_b128 v[72:75], v242 offset:8192
    v_mfma_f32_16x16x32_bf16 v[20:23], v[76:79], a[20:23], v[20:23]
    s_waitcnt lgkmcnt(6)
    v_mfma_f32_16x16x32_bf16 v[24:27], v[80:83], a[16:19], v[24:27]
    ds_read_b128 v[76:79], v242 offset:9216
    v_mfma_f32_16x16x32_bf16 v[32:35], v[80:83], a[20:23], v[32:35]
    s_waitcnt lgkmcnt(6)
    s_add_u32 m0, s87, 81920
    s_nop 0
    buffer_load_dwordx4 v3, s[20:23], s29 offen offset:0 lds
    v_mfma_f32_16x16x32_bf16 v[28:31], v[84:87], a[16:19], v[28:31]
    ds_read_b128 v[80:83], v242 offset:10240
    v_mfma_f32_16x16x32_bf16 v[36:39], v[84:87], a[20:23], v[36:39]
    s_waitcnt lgkmcnt(6)
    buffer_load_dwordx4 a[60:63], v243, s[8:11], s28 offen offset:256 sc1
    v_mfma_f32_16x16x32_bf16 v[40:43], v[88:91], a[16:19], v[40:43]
    ds_read_b128 v[84:87], v242 offset:11264
    v_mfma_f32_16x16x32_bf16 v[48:51], v[88:91], a[20:23], v[48:51]
    s_waitcnt lgkmcnt(6)
    v_mfma_f32_16x16x32_bf16 v[44:47], v[92:95], a[16:19], v[44:47]
    ds_read_b128 v[88:91], v242 offset:12288
    v_mfma_f32_16x16x32_bf16 v[52:55], v[92:95], a[20:23], v[52:55]
    s_waitcnt lgkmcnt(6)
    v_mfma_f32_16x16x32_bf16 v[56:59], v[96:99], a[16:19], v[56:59]
    ds_read_b128 v[92:95], v242 offset:13312
    v_mfma_f32_16x16x32_bf16 v[64:67], v[96:99], a[20:23], v[64:67]
    s_waitcnt lgkmcnt(6)
    buffer_load_dwordx4 a[64:67], v243, s[8:11], s28 offen offset:2048 sc1
    v_mfma_f32_16x16x32_bf16 v[60:63], v[100:103], a[16:19], v[60:63]
    ds_read_b128 v[96:99], v242 offset:14336
    v_mfma_f32_16x16x32_bf16 v[68:71], v[100:103], a[20:23], v[68:71]
    s_waitcnt lgkmcnt(6)
    s_waitcnt vmcnt(17)
    buffer_load_dwordx4 v3, s[20:23], s29 offen offset:1024 lds
    v_mfma_f32_16x16x32_bf16 v[8:11], v[72:75], a[24:27], v[8:11]
    ds_read_b128 v[100:103], v242 offset:15360
    v_mfma_f32_16x16x32_bf16 v[16:19], v[72:75], a[28:31], v[16:19]
    s_waitcnt lgkmcnt(6)
    s_barrier
    v_mfma_f32_16x16x32_bf16 v[12:15], v[76:79], a[24:27], v[12:15]
    ds_read_b128 v[72:75], v242 offset:16384
    v_mfma_f32_16x16x32_bf16 v[20:23], v[76:79], a[28:31], v[20:23]
    s_waitcnt lgkmcnt(6)
    buffer_load_dwordx4 a[68:71], v243, s[8:11], s28 offen offset:2304 sc1
    s_add_u32 s28, s28, 4096
    v_mfma_f32_16x16x32_bf16 v[24:27], v[80:83], a[24:27], v[24:27]
    ds_read_b128 v[76:79], v242 offset:17408
    v_mfma_f32_16x16x32_bf16 v[32:35], v[80:83], a[28:31], v[32:35]
    s_waitcnt lgkmcnt(6)
    v_mfma_f32_16x16x32_bf16 v[28:31], v[84:87], a[24:27], v[28:31]
    ds_read_b128 v[80:83], v242 offset:18432
    v_mfma_f32_16x16x32_bf16 v[36:39], v[84:87], a[28:31], v[36:39]
    s_waitcnt lgkmcnt(6)
    v_mfma_f32_16x16x32_bf16 v[40:43], v[88:91], a[24:27], v[40:43]
    ds_read_b128 v[84:87], v242 offset:19456
    v_mfma_f32_16x16x32_bf16 v[48:51], v[88:91], a[28:31], v[48:51]
    s_waitcnt lgkmcnt(6)
    buffer_load_dwordx4 v3, s[20:23], s29 offen offset:2048 lds
    v_mfma_f32_16x16x32_bf16 v[44:47], v[92:95], a[24:27], v[44:47]
    ds_read_b128 v[88:91], v242 offset:20480
    v_mfma_f32_16x16x32_bf16 v[52:55], v[92:95], a[28:31], v[52:55]
    s_waitcnt lgkmcnt(6)
    buffer_load_dwordx4 a[72:75], v243, s[8:11], s28 offen offset:0 sc1
    v_mfma_f32_16x16x32_bf16 v[56:59], v[96:99], a[24:27], v[56:59]
    ds_read_b128 v[92:95], v242 offset:21504
    v_mfma_f32_16x16x32_bf16 v[64:67], v[96:99], a[28:31], v[64:67]
    s_waitcnt lgkmcnt(6)
    v_mfma_f32_16x16x32_bf16 v[60:63], v[100:103], a[24:27], v[60:63]
    ds_read_b128 v[96:99], v242 offset:22528
    v_mfma_f32_16x16x32_bf16 v[68:71], v[100:103], a[28:31], v[68:71]
    s_waitcnt lgkmcnt(6)
    s_waitcnt vmcnt(16)
    v_mfma_f32_16x16x32_bf16 v[8:11], v[72:75], a[32:35], v[8:11]
    ds_read_b128 v[100:103], v242 offset:23552
    v_mfma_f32_16x16x32_bf16 v[16:19], v[72:75], a[36:39], v[16:19]
    s_waitcnt lgkmcnt(6)
    buffer_load_dwordx4 a[76:79], v243, s[8:11], s28 offen offset:256 sc1
    v_mfma_f32_16x16x32_bf16 v[12:15], v[76:79], a[32:35], v[12:15]
    ds_read_b128 v[72:75], v242 offset:24576
    v_mfma_f32_16x16x32_bf16 v[20:23], v[76:79], a[36:39], v[20:23]
    s_waitcnt lgkmcnt(6)
    buffer_load_dwordx4 v3, s[20:23], s29 offen offset:3072 lds
    s_add_u32 s29, s29, 16384
    v_mfma_f32_16x16x32_bf16 v[24:27], v[80:83], a[32:35], v[24:27]
    ds_read_b128 v[76:79], v242 offset:25600
    v_mfma_f32_16x16x32_bf16 v[32:35], v[80:83], a[36:39], v[32:35]
    s_waitcnt lgkmcnt(6)
    v_mfma_f32_16x16x32_bf16 v[28:31], v[84:87], a[32:35], v[28:31]
    ds_read_b128 v[80:83], v242 offset:26624
    v_mfma_f32_16x16x32_bf16 v[36:39], v[84:87], a[36:39], v[36:39]
    s_waitcnt lgkmcnt(6)
    buffer_load_dwordx4 a[80:83], v243, s[8:11], s28 offen offset:2048 sc1
    v_mfma_f32_16x16x32_bf16 v[40:43], v[88:91], a[32:35], v[40:43]
    ds_read_b128 v[84:87], v242 offset:27648
    v_mfma_f32_16x16x32_bf16 v[48:51], v[88:91], a[36:39], v[48:51]
    s_waitcnt lgkmcnt(6)
    v_mfma_f32_16x16x32_bf16 v[44:47], v[92:95], a[32:35], v[44:47]
    ds_read_b128 v[88:91], v242 offset:28672
    v_mfma_f32_16x16x32_bf16 v[52:55], v[92:95], a[36:39], v[52:55]
    s_waitcnt lgkmcnt(6)
    v_mfma_f32_16x16x32_bf16 v[56:59], v[96:99], a[32:35], v[56:59]
    ds_read_b128 v[92:95], v242 offset:29696
    v_mfma_f32_16x16x32_bf16 v[64:67], v[96:99], a[36:39], v[64:67]
    s_waitcnt lgkmcnt(6)
    v_mfma_f32_16x16x32_bf16 v[60:63], v[100:103], a[32:35], v[60:63]
    ds_read_b128 v[96:99], v242 offset:30720
    v_mfma_f32_16x16x32_bf16 v[68:71], v[100:103], a[36:39], v[68:71]
    s_waitcnt lgkmcnt(6)
    s_waitcnt vmcnt(16)
    s_add_u32 m0, s87, 98304
    s_nop 0
    buffer_load_dwordx4 v3, s[20:23], s29 offen offset:0 lds
    v_mfma_f32_16x16x32_bf16 v[8:11], v[72:75], a[40:43], v[8:11]
    ds_read_b128 v[100:103], v242 offset:31744
    v_mfma_f32_16x16x32_bf16 v[16:19], v[72:75], a[44:47], v[16:19]
    s_waitcnt lgkmcnt(6)
    buffer_load_dwordx4 a[84:87], v243, s[8:11], s28 offen offset:2304 sc1
    s_add_u32 s28, s28, 4096
    s_waitcnt vmcnt(50)
    s_barrier
    v_mfma_f32_16x16x32_bf16 v[12:15], v[76:79], a[40:43], v[12:15]
    ds_read_b128 v[72:75], v3 offset:0
    v_mfma_f32_16x16x32_bf16 v[20:23], v[76:79], a[44:47], v[20:23]
    s_waitcnt lgkmcnt(6)
    v_mfma_f32_16x16x32_bf16 v[24:27], v[80:83], a[40:43], v[24:27]
    ds_read_b128 v[76:79], v3 offset:1024
    v_mfma_f32_16x16x32_bf16 v[32:35], v[80:83], a[44:47], v[32:35]
    s_waitcnt lgkmcnt(6)
    v_mfma_f32_16x16x32_bf16 v[28:31], v[84:87], a[40:43], v[28:31]
    ds_read_b128 v[80:83], v3 offset:2048
    v_mfma_f32_16x16x32_bf16 v[36:39], v[84:87], a[44:47], v[36:39]
    s_waitcnt lgkmcnt(6)
    buffer_load_dwordx4 a[88:91], v243, s[8:11], s28 offen offset:0 sc1
    v_mfma_f32_16x16x32_bf16 v[40:43], v[88:91], a[40:43], v[40:43]
    ds_read_b128 v[84:87], v3 offset:3072
    v_mfma_f32_16x16x32_bf16 v[48:51], v[88:91], a[44:47], v[48:51]
    s_waitcnt lgkmcnt(6)
    buffer_load_dwordx4 v3, s[20:23], s29 offen offset:1024 lds
    v_mfma_f32_16x16x32_bf16 v[44:47], v[92:95], a[40:43], v[44:47]
    ds_read_b128 v[88:91], v3 offset:4096
    v_mfma_f32_16x16x32_bf16 v[52:55], v[92:95], a[44:47], v[52:55]
    s_waitcnt lgkmcnt(6)
    v_mfma_f32_16x16x32_bf16 v[56:59], v[96:99], a[40:43], v[56:59]
    ds_read_b128 v[92:95], v3 offset:5120
    v_mfma_f32_16x16x32_bf16 v[64:67], v[96:99], a[44:47], v[64:67]
    s_waitcnt lgkmcnt(6)
    v_mfma_f32_16x16x32_bf16 v[60:63], v[100:103], a[40:43], v[60:63]
    ds_read_b128 v[96:99], v3 offset:6144
    v_mfma_f32_16x16x32_bf16 v[68:71], v[100:103], a[44:47], v[68:71]
    s_waitcnt lgkmcnt(6)
    s_waitcnt vmcnt(16)
    buffer_load_dwordx4 a[92:95], v243, s[8:11], s28 offen offset:256 sc1
    v_mfma_f32_16x16x32_bf16 v[8:11], v[72:75], a[48:51], v[8:11]
    ds_read_b128 v[100:103], v3 offset:7168
    v_mfma_f32_16x16x32_bf16 v[16:19], v[72:75], a[52:55], v[16:19]
    s_waitcnt lgkmcnt(6)
    v_mfma_f32_16x16x32_bf16 v[12:15], v[76:79], a[48:51], v[12:15]
    ds_read_b128 v[72:75], v3 offset:8192
    v_mfma_f32_16x16x32_bf16 v[20:23], v[76:79], a[52:55], v[20:23]
    s_waitcnt lgkmcnt(6)
    buffer_load_dwordx4 v3, s[20:23], s29 offen offset:2048 lds
    v_mfma_f32_16x16x32_bf16 v[24:27], v[80:83], a[48:51], v[24:27]
    ds_read_b128 v[76:79], v3 offset:9216
    v_mfma_f32_16x16x32_bf16 v[32:35], v[80:83], a[52:55], v[32:35]
    s_waitcnt lgkmcnt(6)
    v_mfma_f32_16x16x32_bf16 v[28:31], v[84:87], a[48:51], v[28:31]
    ds_read_b128 v[80:83], v3 offset:10240
    v_mfma_f32_16x16x32_bf16 v[36:39], v[84:87], a[52:55], v[36:39]
    s_waitcnt lgkmcnt(6)
    s_cmp_le_u32 s76, 1
    s_addc_u32 s28, s45, 1
    s_and_b32 s28, s28, 7
    s_mul_i32 s28, s28, 14336
    s_add_u32 s28, s28, 4096
    buffer_load_dwordx4 a[96:99], v243, s[8:11], s28 offen offset:0 sc1
    v_mfma_f32_16x16x32_bf16 v[40:43], v[88:91], a[48:51], v[40:43]
    ds_read_b128 v[84:87], v3 offset:11264
    v_mfma_f32_16x16x32_bf16 v[48:51], v[88:91], a[52:55], v[48:51]
    s_waitcnt lgkmcnt(6)
    v_mfma_f32_16x16x32_bf16 v[44:47], v[92:95], a[48:51], v[44:47]
    ds_read_b128 v[88:91], v3 offset:12288
    v_mfma_f32_16x16x32_bf16 v[52:55], v[92:95], a[52:55], v[52:55]
    s_waitcnt lgkmcnt(6)
    v_mfma_f32_16x16x32_bf16 v[56:59], v[96:99], a[48:51], v[56:59]
    ds_read_b128 v[92:95], v3 offset:13312
    v_mfma_f32_16x16x32_bf16 v[64:67], v[96:99], a[52:55], v[64:67]
    s_waitcnt lgkmcnt(6)
    buffer_load_dwordx4 v3, s[20:23], s29 offen offset:3072 lds
    s_add_u32 s29, s29, 16384
    v_mfma_f32_16x16x32_bf16 v[60:63], v[100:103], a[48:51], v[60:63]
    ds_read_b128 v[96:99], v3 offset:14336
    v_mfma_f32_16x16x32_bf16 v[68:71], v[100:103], a[52:55], v[68:71]
    s_waitcnt lgkmcnt(6)
    s_waitcnt vmcnt(16)
    buffer_load_dwordx4 a[100:103], v243, s[8:11], s28 offen offset:256 sc1
    v_mfma_f32_16x16x32_bf16 v[8:11], v[72:75], a[56:59], v[8:11]
    ds_read_b128 v[100:103], v3 offset:15360
    v_mfma_f32_16x16x32_bf16 v[16:19], v[72:75], a[60:63], v[16:19]
    s_waitcnt lgkmcnt(6)
    s_waitcnt vmcnt(48)
    s_barrier
    v_mfma_f32_16x16x32_bf16 v[12:15], v[76:79], a[56:59], v[12:15]
    ds_read_b128 v[72:75], v3 offset:16384
    v_mfma_f32_16x16x32_bf16 v[20:23], v[76:79], a[60:63], v[20:23]
    s_waitcnt lgkmcnt(6)
    v_mfma_f32_16x16x32_bf16 v[24:27], v[80:83], a[56:59], v[24:27]
    ds_read_b128 v[76:79], v3 offset:17408
    v_mfma_f32_16x16x32_bf16 v[32:35], v[80:83], a[60:63], v[32:35]
    s_waitcnt lgkmcnt(6)
    v_mfma_f32_16x16x32_bf16 v[28:31], v[84:87], a[56:59], v[28:31]
    ds_read_b128 v[80:83], v3 offset:18432
    v_mfma_f32_16x16x32_bf16 v[36:39], v[84:87], a[60:63], v[36:39]
    s_waitcnt lgkmcnt(6)
    buffer_load_dwordx4 a[104:107], v243, s[8:11], s28 offen offset:2048 sc1
    v_mfma_f32_16x16x32_bf16 v[40:43], v[88:91], a[56:59], v[40:43]
    ds_read_b128 v[84:87], v3 offset:19456
    v_mfma_f32_16x16x32_bf16 v[48:51], v[88:91], a[60:63], v[48:51]
    s_waitcnt lgkmcnt(6)
    s_add_u32 m0, s87, 114688
    s_nop 0
    buffer_load_dwordx4 v3, s[20:23], s29 offen offset:0 lds
    v_mfma_f32_16x16x32_bf16 v[44:47], v[92:95], a[56:59], v[44:47]
    ds_read_b128 v[88:91], v3 offset:20480
    v_mfma_f32_16x16x32_bf16 v[52:55], v[92:95], a[60:63], v[52:55]
    s_waitcnt lgkmcnt(6)
    v_mfma_f32_16x16x32_bf16 v[56:59], v[96:99], a[56:59], v[56:59]
    ds_read_b128 v[92:95], v3 offset:21504
    v_mfma_f32_16x16x32_bf16 v[64:67], v[96:99], a[60:63], v[64:67]
    s_waitcnt lgkmcnt(6)
    v_mfma_f32_16x16x32_bf16 v[60:63], v[100:103], a[56:59], v[60:63]
    ds_read_b128 v[96:99], v3 offset:22528
    v_mfma_f32_16x16x32_bf16 v[68:71], v[100:103], a[60:63], v[68:71]
    s_waitcnt lgkmcnt(6)
    s_waitcnt vmcnt(16)
    buffer_load_dwordx4 a[108:111], v243, s[8:11], s28 offen offset:2304 sc1
    s_add_u32 s28, s28, 4096
    v_mfma_f32_16x16x32_bf16 v[8:11], v[72:75], a[64:67], v[8:11]
    ds_read_b128 v[100:103], v3 offset:23552
    v_mfma_f32_16x16x32_bf16 v[16:19], v[72:75], a[68:71], v[16:19]
    s_waitcnt lgkmcnt(6)
    v_mfma_f32_16x16x32_bf16 v[12:15], v[76:79], a[64:67], v[12:15]
    ds_read_b128 v[72:75], v3 offset:24576
    v_mfma_f32_16x16x32_bf16 v[20:23], v[76:79], a[68:71], v[20:23]
    s_waitcnt lgkmcnt(6)
    buffer_load_dwordx4 v3, s[20:23], s29 offen offset:1024 lds
    v_mfma_f32_16x16x32_bf16 v[24:27], v[80:83], a[64:67], v[24:27]
    ds_read_b128 v[76:79], v3 offset:25600
    v_mfma_f32_16x16x32_bf16 v[32:35], v[80:83], a[68:71], v[32:35]
    s_waitcnt lgkmcnt(6)
    v_mfma_f32_16x16x32_bf16 v[28:31], v[84:87], a[64:67], v[28:31]
    ds_read_b128 v[80:83], v3 offset:26624
    v_mfma_f32_16x16x32_bf16 v[36:39], v[84:87], a[68:71], v[36:39]
    s_waitcnt lgkmcnt(6)
    buffer_load_dwordx4 a[0:3], v243, s[8:11], s28 offen offset:0 sc1
    v_mfma_f32_16x16x32_bf16 v[40:43], v[88:91], a[64:67], v[40:43]
    ds_read_b128 v[84:87], v3 offset:27648
    v_mfma_f32_16x16x32_bf16 v[48:51], v[88:91], a[68:71], v[48:51]
    s_waitcnt lgkmcnt(6)
    v_mfma_f32_16x16x32_bf16 v[44:47], v[92:95], a[64:67], v[44:47]
    ds_read_b128 v[88:91], v3 offset:28672
    v_mfma_f32_16x16x32_bf16 v[52:55], v[92:95], a[68:71], v[52:55]
    s_waitcnt lgkmcnt(6)
    v_mfma_f32_16x16x32_bf16 v[56:59], v[96:99], a[64:67], v[56:59]
    ds_read_b128 v[92:95], v3 offset:29696
    v_mfma_f32_16x16x32_bf16 v[64:67], v[96:99], a[68:71], v[64:67]
    s_waitcnt lgkmcnt(6)
    buffer_load_dwordx4 v3, s[20:23], s29 offen offset:2048 lds
    v_mfma_f32_16x16x32_bf16 v[60:63], v[100:103], a[64:67], v[60:63]
    ds_read_b128 v[96:99], v3 offset:30720
    v_mfma_f32_16x16x32_bf16 v[68:71], v[100:103], a[68:71], v[68:71]
    s_waitcnt lgkmcnt(6)
    s_waitcnt vmcnt(17)
    buffer_load_dwordx4 a[4:7], v243, s[8:11], s28 offen offset:256 sc1
    v_mfma_f32_16x16x32_bf16 v[8:11], v[72:75], a[72:75], v[8:11]
    ds_read_b128 v[100:103], v3 offset:31744
    v_mfma_f32_16x16x32_bf16 v[16:19], v[72:75], a[76:79], v[16:19]
    s_waitcnt lgkmcnt(6)
    s_waitcnt vmcnt(46)
    s_barrier
    v_mfma_f32_16x16x32_bf16 v[12:15], v[76:79], a[72:75], v[12:15]
    ds_read_b128 v[72:75], v3 offset:32768
    v_mfma_f32_16x16x32_bf16 v[20:23], v[76:79], a[76:79], v[20:23]
    s_waitcnt lgkmcnt(6)
    v_mfma_f32_16x16x32_bf16 v[24:27], v[80:83], a[72:75], v[24:27]
    ds_read_b128 v[76:79], v3 offset:33792
    v_mfma_f32_16x16x32_bf16 v[32:35], v[80:83], a[76:79], v[32:35]
    s_waitcnt lgkmcnt(6)
    v_mfma_f32_16x16x32_bf16 v[28:31], v[84:87], a[72:75], v[28:31]
    ds_read_b128 v[80:83], v3 offset:34816
    v_mfma_f32_16x16x32_bf16 v[36:39], v[84:87], a[76:79], v[36:39]
    s_waitcnt lgkmcnt(6)
    buffer_load_dwordx4 v3, s[20:23], s29 offen offset:3072 lds
    s_add_u32 s29, s29, 16384
    v_mfma_f32_16x16x32_bf16 v[40:43], v[88:91], a[72:75], v[40:43]
    ds_read_b128 v[84:87], v3 offset:35840
    v_mfma_f32_16x16x32_bf16 v[48:51], v[88:91], a[76:79], v[48:51]
    s_waitcnt lgkmcnt(6)
    buffer_load_dwordx4 a[8:11], v243, s[8:11], s28 offen offset:2048 sc1
    v_mfma_f32_16x16x32_bf16 v[44:47], v[92:95], a[72:75], v[44:47]
    ds_read_b128 v[88:91], v3 offset:36864
    v_mfma_f32_16x16x32_bf16 v[52:55], v[92:95], a[76:79], v[52:55]
    s_waitcnt lgkmcnt(6)
    v_mfma_f32_16x16x32_bf16 v[56:59], v[96:99], a[72:75], v[56:59]
    ds_read_b128 v[92:95], v3 offset:37888
    v_mfma_f32_16x16x32_bf16 v[64:67], v[96:99], a[76:79], v[64:67]
    s_waitcnt lgkmcnt(6)
    v_mfma_f32_16x16x32_bf16 v[60:63], v[100:103], a[72:75], v[60:63]
    ds_read_b128 v[96:99], v3 offset:38912
    v_mfma_f32_16x16x32_bf16 v[68:71], v[100:103], a[76:79], v[68:71]
    s_waitcnt lgkmcnt(6)
    s_waitcnt vmcnt(16)
    buffer_load_dwordx4 a[12:15], v243, s[8:11], s28 offen offset:2304 sc1
    s_add_u32 s28, s28, 4096
    v_mfma_f32_16x16x32_bf16 v[8:11], v[72:75], a[80:83], v[8:11]
    ds_read_b128 v[100:103], v3 offset:39936
    v_mfma_f32_16x16x32_bf16 v[16:19], v[72:75], a[84:87], v[16:19]
    s_waitcnt lgkmcnt(6)
    v_mfma_f32_16x16x32_bf16 v[12:15], v[76:79], a[80:83], v[12:15]
    ds_read_b128 v[72:75], v3 offset:40960
    v_mfma_f32_16x16x32_bf16 v[20:23], v[76:79], a[84:87], v[20:23]
    s_waitcnt lgkmcnt(6)
    s_add_u32 m0, s87, 131072
    s_nop 0
    buffer_load_dwordx4 v3, s[20:23], s29 offen offset:0 lds
    v_mfma_f32_16x16x32_bf16 v[24:27], v[80:83], a[80:83], v[24:27]
    ds_read_b128 v[76:79], v3 offset:41984
    v_mfma_f32_16x16x32_bf16 v[32:35], v[80:83], a[84:87], v[32:35]
    s_waitcnt lgkmcnt(6)
    v_mfma_f32_16x16x32_bf16 v[28:31], v[84:87], a[80:83], v[28:31]
    ds_read_b128 v[80:83], v3 offset:43008
    v_mfma_f32_16x16x32_bf16 v[36:39], v[84:87], a[84:87], v[36:39]
    s_waitcnt lgkmcnt(6)
    buffer_load_dwordx4 a[16:19], v243, s[8:11], s28 offen offset:0 sc1
    v_mfma_f32_16x16x32_bf16 v[40:43], v[88:91], a[80:83], v[40:43]
    ds_read_b128 v[84:87], v3 offset:44032
    v_mfma_f32_16x16x32_bf16 v[48:51], v[88:91], a[84:87], v[48:51]
    s_waitcnt lgkmcnt(6)
    v_mfma_f32_16x16x32_bf16 v[44:47], v[92:95], a[80:83], v[44:47]
    ds_read_b128 v[88:91], v3 offset:45056
    v_mfma_f32_16x16x32_bf16 v[52:55], v[92:95], a[84:87], v[52:55]
    s_waitcnt lgkmcnt(6)
    v_mfma_f32_16x16x32_bf16 v[56:59], v[96:99], a[80:83], v[56:59]
    ds_read_b128 v[92:95], v3 offset:46080
    v_mfma_f32_16x16x32_bf16 v[64:67], v[96:99], a[84:87], v[64:67]
    s_waitcnt lgkmcnt(6)
    buffer_load_dwordx4 v3, s[20:23], s29 offen offset:1024 lds
    v_mfma_f32_16x16x32_bf16 v[60:63], v[100:103], a[80:83], v[60:63]
    ds_read_b128 v[96:99], v3 offset:47104
    v_mfma_f32_16x16x32_bf16 v[68:71], v[100:103], a[84:87], v[68:71]
    s_waitcnt lgkmcnt(6)
    s_waitcnt vmcnt(17)
    buffer_load_dwordx4 a[20:23], v243, s[8:11], s28 offen offset:256 sc1
    v_mfma_f32_16x16x32_bf16 v[8:11], v[72:75], a[88:91], v[8:11]
    ds_read_b128 v[100:103], v3 offset:48128
    v_mfma_f32_16x16x32_bf16 v[16:19], v[72:75], a[92:95], v[16:19]
    s_waitcnt lgkmcnt(6)
    s_waitcnt vmcnt(44)
    s_barrier
    v_mfma_f32_16x16x32_bf16 v[12:15], v[76:79], a[88:91], v[12:15]
    ds_read_b128 v[72:75], v3 offset:49152
    v_mfma_f32_16x16x32_bf16 v[20:23], v[76:79], a[92:95], v[20:23]
    s_waitcnt lgkmcnt(6)
    v_mfma_f32_16x16x32_bf16 v[24:27], v[80:83], a[88:91], v[24:27]
    ds_read_b128 v[76:79], v3 offset:50176
    v_mfma_f32_16x16x32_bf16 v[32:35], v[80:83], a[92:95], v[32:35]
    s_waitcnt lgkmcnt(6)
    v_mfma_f32_16x16x32_bf16 v[28:31], v[84:87], a[88:91], v[28:31]
    ds_read_b128 v[80:83], v3 offset:51200
    v_mfma_f32_16x16x32_bf16 v[36:39], v[84:87], a[92:95], v[36:39]
    s_waitcnt lgkmcnt(6)
    buffer_load_dwordx4 v3, s[20:23], s29 offen offset:2048 lds
    v_mfma_f32_16x16x32_bf16 v[40:43], v[88:91], a[88:91], v[40:43]
    ds_read_b128 v[84:87], v3 offset:52224
    v_mfma_f32_16x16x32_bf16 v[48:51], v[88:91], a[92:95], v[48:51]
    s_waitcnt lgkmcnt(6)
    s_cmp_le_u32 s76, 2
    s_addc_u32 s28, s45, 2
    s_and_b32 s28, s28, 7
    s_mul_i32 s28, s28, 14336
    s_add_u32 s28, s28, 4096
    buffer_load_dwordx4 a[24:27], v243, s[8:11], s28 offen offset:0 sc1
    v_mfma_f32_16x16x32_bf16 v[44:47], v[92:95], a[88:91], v[44:47]
    ds_read_b128 v[88:91], v3 offset:53248
    v_mfma_f32_16x16x32_bf16 v[52:55], v[92:95], a[92:95], v[52:55]
    s_waitcnt lgkmcnt(6)
    v_mfma_f32_16x16x32_bf16 v[56:59], v[96:99], a[88:91], v[56:59]
    ds_read_b128 v[92:95], v3 offset:54272
    v_mfma_f32_16x16x32_bf16 v[64:67], v[96:99], a[92:95], v[64:67]
    s_waitcnt lgkmcnt(6)
    v_mfma_f32_16x16x32_bf16 v[60:63], v[100:103], a[88:91], v[60:63]
    ds_read_b128 v[96:99], v3 offset:55296
    v_mfma_f32_16x16x32_bf16 v[68:71], v[100:103], a[92:95], v[68:71]
    s_waitcnt lgkmcnt(6)
    s_waitcnt vmcnt(16)
    buffer_load_dwordx4 a[28:31], v243, s[8:11], s28 offen offset:256 sc1
    v_mfma_f32_16x16x32_bf16 v[8:11], v[72:75], a[96:99], v[8:11]
    ds_read_b128 v[100:103], v3 offset:56320
    v_mfma_f32_16x16x32_bf16 v[16:19], v[72:75], a[100:103], v[16:19]
    s_waitcnt lgkmcnt(6)
    buffer_load_dwordx4 v3, s[20:23], s29 offen offset:3072 lds
    s_add_u32 s29, s29, 16384
    v_mfma_f32_16x16x32_bf16 v[12:15], v[76:79], a[96:99], v[12:15]
    ds_read_b128 v[72:75], v3 offset:57344
    v_mfma_f32_16x16x32_bf16 v[20:23], v[76:79], a[100:103], v[20:23]
    s_waitcnt lgkmcnt(6)
    v_mfma_f32_16x16x32_bf16 v[24:27], v[80:83], a[96:99], v[24:27]
    ds_read_b128 v[76:79], v3 offset:58368
    v_mfma_f32_16x16x32_bf16 v[32:35], v[80:83], a[100:103], v[32:35]
    s_waitcnt lgkmcnt(6)
    v_mfma_f32_16x16x32_bf16 v[28:31], v[84:87], a[96:99], v[28:31]
    ds_read_b128 v[80:83], v3 offset:59392
    v_mfma_f32_16x16x32_bf16 v[36:39], v[84:87], a[100:103], v[36:39]
    s_waitcnt lgkmcnt(6)
    buffer_load_dwordx4 a[32:35], v243, s[8:11], s28 offen offset:2048 sc1
    v_mfma_f32_16x16x32_bf16 v[40:43], v[88:91], a[96:99], v[40:43]
    ds_read_b128 v[84:87], v3 offset:60416
    v_mfma_f32_16x16x32_bf16 v[48:51], v[88:91], a[100:103], v[48:51]
    s_waitcnt lgkmcnt(6)
    v_mfma_f32_16x16x32_bf16 v[44:47], v[92:95], a[96:99], v[44:47]
    ds_read_b128 v[88:91], v3 offset:61440
    v_mfma_f32_16x16x32_bf16 v[52:55], v[92:95], a[100:103], v[52:55]
    s_waitcnt lgkmcnt(6)
    v_mfma_f32_16x16x32_bf16 v[56:59], v[96:99], a[96:99], v[56:59]
    ds_read_b128 v[92:95], v3 offset:62464
    v_mfma_f32_16x16x32_bf16 v[64:67], v[96:99], a[100:103], v[64:67]
    s_waitcnt lgkmcnt(6)
    s_add_u32 m0, s87, 147456
    s_nop 0
    buffer_load_dwordx4 v3, s[20:23], s29 offen offset:0 lds
    v_mfma_f32_16x16x32_bf16 v[60:63], v[100:103], a[96:99], v[60:63]
    ds_read_b128 v[96:99], v3 offset:63488
    v_mfma_f32_16x16x32_bf16 v[68:71], v[100:103], a[100:103], v[68:71]
    s_waitcnt lgkmcnt(6)
    s_waitcnt vmcnt(17)
    buffer_load_dwordx4 a[36:39], v243, s[8:11], s28 offen offset:2304 sc1
    s_add_u32 s28, s28, 4096
    v_mfma_f32_16x16x32_bf16 v[8:11], v[72:75], a[104:107], v[8:11]
    ds_read_b128 v[100:103], v3 offset:64512
    v_mfma_f32_16x16x32_bf16 v[16:19], v[72:75], a[108:111], v[16:19]
    s_waitcnt lgkmcnt(6)
    s_waitcnt vmcnt(41)
    s_barrier
    v_mfma_f32_16x16x32_bf16 v[12:15], v[76:79], a[104:107], v[12:15]
    ds_read_b128 v[72:75], v4 offset:0
    v_mfma_f32_16x16x32_bf16 v[20:23], v[76:79], a[108:111], v[20:23]
    s_waitcnt lgkmcnt(6)
    v_mfma_f32_16x16x32_bf16 v[24:27], v[80:83], a[104:107], v[24:27]
    ds_read_b128 v[76:79], v4 offset:1024
    v_mfma_f32_16x16x32_bf16 v[32:35], v[80:83], a[108:111], v[32:35]
    s_waitcnt lgkmcnt(6)
    v_mfma_f32_16x16x32_bf16 v[28:31], v[84:87], a[104:107], v[28:31]
    ds_read_b128 v[80:83], v4 offset:2048
    v_mfma_f32_16x16x32_bf16 v[36:39], v[84:87], a[108:111], v[36:39]
    s_waitcnt lgkmcnt(6)
    buffer_load_dwordx4 v3, s[20:23], s29 offen offset:1024 lds
    v_mfma_f32_16x16x32_bf16 v[40:43], v[88:91], a[104:107], v[40:43]
    ds_read_b128 v[84:87], v4 offset:3072
    v_mfma_f32_16x16x32_bf16 v[48:51], v[88:91], a[108:111], v[48:51]
    s_waitcnt lgkmcnt(6)
    buffer_load_dwordx4 a[40:43], v243, s[8:11], s28 offen offset:0 sc1
    v_mfma_f32_16x16x32_bf16 v[44:47], v[92:95], a[104:107], v[44:47]
    ds_read_b128 v[88:91], v4 offset:4096
    v_mfma_f32_16x16x32_bf16 v[52:55], v[92:95], a[108:111], v[52:55]
    s_waitcnt lgkmcnt(6)
    v_mfma_f32_16x16x32_bf16 v[56:59], v[96:99], a[104:107], v[56:59]
    ds_read_b128 v[92:95], v4 offset:5120
    v_mfma_f32_16x16x32_bf16 v[64:67], v[96:99], a[108:111], v[64:67]
    s_waitcnt lgkmcnt(6)
    v_mfma_f32_16x16x32_bf16 v[60:63], v[100:103], a[104:107], v[60:63]
    ds_read_b128 v[96:99], v4 offset:6144
    v_mfma_f32_16x16x32_bf16 v[68:71], v[100:103], a[108:111], v[68:71]
    s_waitcnt lgkmcnt(6)
    s_waitcnt vmcnt(16)
    buffer_load_dwordx4 a[44:47], v243, s[8:11], s28 offen offset:256 sc1
    v_mfma_f32_16x16x32_bf16 v[8:11], v[72:75], a[0:3], v[8:11]
    ds_read_b128 v[100:103], v4 offset:7168
    v_mfma_f32_16x16x32_bf16 v[16:19], v[72:75], a[4:7], v[16:19]
    s_waitcnt lgkmcnt(6)
    buffer_load_dwordx4 v3, s[20:23], s29 offen offset:2048 lds
    v_mfma_f32_16x16x32_bf16 v[12:15], v[76:79], a[0:3], v[12:15]
    ds_read_b128 v[72:75], v4 offset:8192
    v_mfma_f32_16x16x32_bf16 v[20:23], v[76:79], a[4:7], v[20:23]
    s_waitcnt lgkmcnt(6)
    v_mfma_f32_16x16x32_bf16 v[24:27], v[80:83], a[0:3], v[24:27]
    ds_read_b128 v[76:79], v4 offset:9216
    v_mfma_f32_16x16x32_bf16 v[32:35], v[80:83], a[4:7], v[32:35]
    s_waitcnt lgkmcnt(6)
    v_mfma_f32_16x16x32_bf16 v[28:31], v[84:87], a[0:3], v[28:31]
    ds_read_b128 v[80:83], v4 offset:10240
    v_mfma_f32_16x16x32_bf16 v[36:39], v[84:87], a[4:7], v[36:39]
    s_waitcnt lgkmcnt(6)
    buffer_load_dwordx4 a[48:51], v243, s[8:11], s28 offen offset:2048 sc1
    v_mfma_f32_16x16x32_bf16 v[40:43], v[88:91], a[0:3], v[40:43]
    ds_read_b128 v[84:87], v4 offset:11264
    v_mfma_f32_16x16x32_bf16 v[48:51], v[88:91], a[4:7], v[48:51]
    s_waitcnt lgkmcnt(6)
    v_mfma_f32_16x16x32_bf16 v[44:47], v[92:95], a[0:3], v[44:47]
    ds_read_b128 v[88:91], v4 offset:12288
    v_mfma_f32_16x16x32_bf16 v[52:55], v[92:95], a[4:7], v[52:55]
    s_waitcnt lgkmcnt(6)
    buffer_load_dwordx4 v3, s[20:23], s29 offen offset:3072 lds
    s_add_u32 s29, s29, 16384
    v_mfma_f32_16x16x32_bf16 v[56:59], v[96:99], a[0:3], v[56:59]
    ds_read_b128 v[92:95], v4 offset:13312
    v_mfma_f32_16x16x32_bf16 v[64:67], v[96:99], a[4:7], v[64:67]
    s_waitcnt lgkmcnt(6)
    v_mfma_f32_16x16x32_bf16 v[60:63], v[100:103], a[0:3], v[60:63]
    ds_read_b128 v[96:99], v4 offset:14336
    v_mfma_f32_16x16x32_bf16 v[68:71], v[100:103], a[4:7], v[68:71]
    s_waitcnt lgkmcnt(6)
    s_waitcnt vmcnt(17)
    buffer_load_dwordx4 a[52:55], v243, s[8:11], s28 offen offset:2304 sc1
    s_add_u32 s28, s28, 4096
    v_mfma_f32_16x16x32_bf16 v[8:11], v[72:75], a[8:11], v[8:11]
    ds_read_b128 v[100:103], v4 offset:15360
    v_mfma_f32_16x16x32_bf16 v[16:19], v[72:75], a[12:15], v[16:19]
    s_waitcnt lgkmcnt(6)
    s_waitcnt vmcnt(38)
    s_barrier
    v_mfma_f32_16x16x32_bf16 v[12:15], v[76:79], a[8:11], v[12:15]
    ds_read_b128 v[72:75], v4 offset:16384
    v_mfma_f32_16x16x32_bf16 v[20:23], v[76:79], a[12:15], v[20:23]
    s_waitcnt lgkmcnt(6)
    v_mfma_f32_16x16x32_bf16 v[24:27], v[80:83], a[8:11], v[24:27]
    ds_read_b128 v[76:79], v4 offset:17408
    v_mfma_f32_16x16x32_bf16 v[32:35], v[80:83], a[12:15], v[32:35]
    s_waitcnt lgkmcnt(6)
    v_mfma_f32_16x16x32_bf16 v[28:31], v[84:87], a[8:11], v[28:31]
    ds_read_b128 v[80:83], v4 offset:18432
    v_mfma_f32_16x16x32_bf16 v[36:39], v[84:87], a[12:15], v[36:39]
    s_waitcnt lgkmcnt(6)
    s_add_u32 m0, s87, 0
    s_nop 0
    buffer_load_dwordx4 v3, s[20:23], s29 offen offset:0 lds
    v_mfma_f32_16x16x32_bf16 v[40:43], v[88:91], a[8:11], v[40:43]
    ds_read_b128 v[84:87], v4 offset:19456
    v_mfma_f32_16x16x32_bf16 v[48:51], v[88:91], a[12:15], v[48:51]
    s_waitcnt lgkmcnt(6)
    buffer_load_dwordx4 a[56:59], v243, s[8:11], s28 offen offset:0 sc1
    v_mfma_f32_16x16x32_bf16 v[44:47], v[92:95], a[8:11], v[44:47]
    ds_read_b128 v[88:91], v4 offset:20480
    v_mfma_f32_16x16x32_bf16 v[52:55], v[92:95], a[12:15], v[52:55]
    s_waitcnt lgkmcnt(6)
    v_mfma_f32_16x16x32_bf16 v[56:59], v[96:99], a[8:11], v[56:59]
    ds_read_b128 v[92:95], v4 offset:21504
    v_mfma_f32_16x16x32_bf16 v[64:67], v[96:99], a[12:15], v[64:67]
    s_waitcnt lgkmcnt(6)
    v_mfma_f32_16x16x32_bf16 v[60:63], v[100:103], a[8:11], v[60:63]
    ds_read_b128 v[96:99], v4 offset:22528
    v_mfma_f32_16x16x32_bf16 v[68:71], v[100:103], a[12:15], v[68:71]
    s_waitcnt lgkmcnt(6)
    s_waitcnt vmcnt(16)
    buffer_load_dwordx4 a[60:63], v243, s[8:11], s28 offen offset:256 sc1
    v_mfma_f32_16x16x32_bf16 v[8:11], v[72:75], a[16:19], v[8:11]
    ds_read_b128 v[100:103], v4 offset:23552
    v_mfma_f32_16x16x32_bf16 v[16:19], v[72:75], a[20:23], v[16:19]
    s_waitcnt lgkmcnt(6)
    buffer_load_dwordx4 v3, s[20:23], s29 offen offset:1024 lds
    v_mfma_f32_16x16x32_bf16 v[12:15], v[76:79], a[16:19], v[12:15]
    ds_read_b128 v[72:75], v4 offset:24576
    v_mfma_f32_16x16x32_bf16 v[20:23], v[76:79], a[20:23], v[20:23]
    s_waitcnt lgkmcnt(6)
    v_mfma_f32_16x16x32_bf16 v[24:27], v[80:83], a[16:19], v[24:27]
    ds_read_b128 v[76:79], v4 offset:25600
    v_mfma_f32_16x16x32_bf16 v[32:35], v[80:83], a[20:23], v[32:35]
    s_waitcnt lgkmcnt(6)
    v_mfma_f32_16x16x32_bf16 v[28:31], v[84:87], a[16:19], v[28:31]
    ds_read_b128 v[80:83], v4 offset:26624
    v_mfma_f32_16x16x32_bf16 v[36:39], v[84:87], a[20:23], v[36:39]
    s_waitcnt lgkmcnt(6)
    s_cmp_le_u32 s76, 3
    s_addc_u32 s28, s45, 3
    s_and_b32 s28, s28, 7
    s_mul_i32 s28, s28, 14336
    s_add_u32 s28, s28, 4096
    buffer_load_dwordx4 a[64:67], v243, s[8:11], s28 offen offset:0 sc1
    v_mfma_f32_16x16x32_bf16 v[40:43], v[88:91], a[16:19], v[40:43]
    ds_read_b128 v[84:87], v4 offset:27648
    v_mfma_f32_16x16x32_bf16 v[48:51], v[88:91], a[20:23], v[48:51]
    s_waitcnt lgkmcnt(6)
    v_mfma_f32_16x16x32_bf16 v[44:47], v[92:95], a[16:19], v[44:47]
    ds_read_b128 v[88:91], v4 offset:28672
    v_mfma_f32_16x16x32_bf16 v[52:55], v[92:95], a[20:23], v[52:55]
    s_waitcnt lgkmcnt(6)
    buffer_load_dwordx4 v3, s[20:23], s29 offen offset:2048 lds
    v_mfma_f32_16x16x32_bf16 v[56:59], v[96:99], a[16:19], v[56:59]
    ds_read_b128 v[92:95], v4 offset:29696
    v_mfma_f32_16x16x32_bf16 v[64:67], v[96:99], a[20:23], v[64:67]
    s_waitcnt lgkmcnt(6)
    v_mfma_f32_16x16x32_bf16 v[60:63], v[100:103], a[16:19], v[60:63]
    ds_read_b128 v[96:99], v4 offset:30720
    v_mfma_f32_16x16x32_bf16 v[68:71], v[100:103], a[20:23], v[68:71]
    s_waitcnt lgkmcnt(6)
    s_waitcnt vmcnt(17)
    buffer_load_dwordx4 a[68:71], v243, s[8:11], s28 offen offset:256 sc1
    v_mfma_f32_16x16x32_bf16 v[8:11], v[72:75], a[24:27], v[8:11]
    ds_read_b128 v[100:103], v4 offset:31744
    v_mfma_f32_16x16x32_bf16 v[16:19], v[72:75], a[28:31], v[16:19]
    s_waitcnt lgkmcnt(6)
    s_waitcnt vmcnt(36)
    s_barrier
    v_mfma_f32_16x16x32_bf16 v[12:15], v[76:79], a[24:27], v[12:15]
    ds_read_b128 v[72:75], v4 offset:32768
    v_mfma_f32_16x16x32_bf16 v[20:23], v[76:79], a[28:31], v[20:23]
    s_waitcnt lgkmcnt(6)
    v_mfma_f32_16x16x32_bf16 v[24:27], v[80:83], a[24:27], v[24:27]
    ds_read_b128 v[76:79], v4 offset:33792
    v_mfma_f32_16x16x32_bf16 v[32:35], v[80:83], a[28:31], v[32:35]
    s_waitcnt lgkmcnt(6)
    buffer_load_dwordx4 v3, s[20:23], s29 offen offset:3072 lds
    s_add_u32 s29, s29, 16384
    v_mfma_f32_16x16x32_bf16 v[28:31], v[84:87], a[24:27], v[28:31]
    ds_read_b128 v[80:83], v4 offset:34816
    v_mfma_f32_16x16x32_bf16 v[36:39], v[84:87], a[28:31], v[36:39]
    s_waitcnt lgkmcnt(6)
    buffer_load_dwordx4 a[72:75], v243, s[8:11], s28 offen offset:2048 sc1
    v_mfma_f32_16x16x32_bf16 v[40:43], v[88:91], a[24:27], v[40:43]
    ds_read_b128 v[84:87], v4 offset:35840
    v_mfma_f32_16x16x32_bf16 v[48:51], v[88:91], a[28:31], v[48:51]
    s_waitcnt lgkmcnt(6)
    v_mfma_f32_16x16x32_bf16 v[44:47], v[92:95], a[24:27], v[44:47]
    ds_read_b128 v[88:91], v4 offset:36864
    v_mfma_f32_16x16x32_bf16 v[52:55], v[92:95], a[28:31], v[52:55]
    s_waitcnt lgkmcnt(6)
    v_mfma_f32_16x16x32_bf16 v[56:59], v[96:99], a[24:27], v[56:59]
    ds_read_b128 v[92:95], v4 offset:37888
    v_mfma_f32_16x16x32_bf16 v[64:67], v[96:99], a[28:31], v[64:67]
    s_waitcnt lgkmcnt(6)
    v_mfma_f32_16x16x32_bf16 v[60:63], v[100:103], a[24:27], v[60:63]
    ds_read_b128 v[96:99], v4 offset:38912
    v_mfma_f32_16x16x32_bf16 v[68:71], v[100:103], a[28:31], v[68:71]
    s_waitcnt lgkmcnt(6)
    s_waitcnt vmcnt(16)
    buffer_load_dwordx4 a[76:79], v243, s[8:11], s28 offen offset:2304 sc1
    s_add_u32 s28, s28, 4096
    v_mfma_f32_16x16x32_bf16 v[8:11], v[72:75], a[32:35], v[8:11]
    ds_read_b128 v[100:103], v4 offset:39936
    v_mfma_f32_16x16x32_bf16 v[16:19], v[72:75], a[36:39], v[16:19]
    s_waitcnt lgkmcnt(6)
    s_add_u32 m0, s87, 16384
    s_nop 0
    buffer_load_dwordx4 v3, s[20:23], s29 offen offset:0 lds
    v_mfma_f32_16x16x32_bf16 v[12:15], v[76:79], a[32:35], v[12:15]
    ds_read_b128 v[72:75], v4 offset:40960
    v_mfma_f32_16x16x32_bf16 v[20:23], v[76:79], a[36:39], v[20:23]
    s_waitcnt lgkmcnt(6)
    v_mfma_f32_16x16x32_bf16 v[24:27], v[80:83], a[32:35], v[24:27]
    ds_read_b128 v[76:79], v4 offset:41984
    v_mfma_f32_16x16x32_bf16 v[32:35], v[80:83], a[36:39], v[32:35]
    s_waitcnt lgkmcnt(6)
    v_mfma_f32_16x16x32_bf16 v[28:31], v[84:87], a[32:35], v[28:31]
    ds_read_b128 v[80:83], v4 offset:43008
    v_mfma_f32_16x16x32_bf16 v[36:39], v[84:87], a[36:39], v[36:39]
    s_waitcnt lgkmcnt(6)
    buffer_load_dwordx4 a[80:83], v243, s[8:11], s28 offen offset:0 sc1
    v_mfma_f32_16x16x32_bf16 v[40:43], v[88:91], a[32:35], v[40:43]
    ds_read_b128 v[84:87], v4 offset:44032
    v_mfma_f32_16x16x32_bf16 v[48:51], v[88:91], a[36:39], v[48:51]
    s_waitcnt lgkmcnt(6)
    v_mfma_f32_16x16x32_bf16 v[44:47], v[92:95], a[32:35], v[44:47]
    ds_read_b128 v[88:91], v4 offset:45056
    v_mfma_f32_16x16x32_bf16 v[52:55], v[92:95], a[36:39], v[52:55]
    s_waitcnt lgkmcnt(6)
    buffer_load_dwordx4 v3, s[20:23], s29 offen offset:1024 lds
    v_mfma_f32_16x16x32_bf16 v[56:59], v[96:99], a[32:35], v[56:59]
    ds_read_b128 v[92:95], v4 offset:46080
    v_mfma_f32_16x16x32_bf16 v[64:67], v[96:99], a[36:39], v[64:67]
    s_waitcnt lgkmcnt(6)
    v_mfma_f32_16x16x32_bf16 v[60:63], v[100:103], a[32:35], v[60:63]
    ds_read_b128 v[96:99], v4 offset:47104
    v_mfma_f32_16x16x32_bf16 v[68:71], v[100:103], a[36:39], v[68:71]
    s_waitcnt lgkmcnt(6)
    s_waitcnt vmcnt(17)
    buffer_load_dwordx4 a[84:87], v243, s[8:11], s28 offen offset:256 sc1
    v_mfma_f32_16x16x32_bf16 v[8:11], v[72:75], a[40:43], v[8:11]
    ds_read_b128 v[100:103], v4 offset:48128
    v_mfma_f32_16x16x32_bf16 v[16:19], v[72:75], a[44:47], v[16:19]
    s_waitcnt lgkmcnt(6)
    s_waitcnt vmcnt(34)
    s_barrier
    v_mfma_f32_16x16x32_bf16 v[12:15], v[76:79], a[40:43], v[12:15]
    ds_read_b128 v[72:75], v4 offset:49152
    v_mfma_f32_16x16x32_bf16 v[20:23], v[76:79], a[44:47], v[20:23]
    s_waitcnt lgkmcnt(6)
    v_mfma_f32_16x16x32_bf16 v[24:27], v[80:83], a[40:43], v[24:27]
    ds_read_b128 v[76:79], v4 offset:50176
    v_mfma_f32_16x16x32_bf16 v[32:35], v[80:83], a[44:47], v[32:35]
    s_waitcnt lgkmcnt(6)
    buffer_load_dwordx4 v3, s[20:23], s29 offen offset:2048 lds
    v_mfma_f32_16x16x32_bf16 v[28:31], v[84:87], a[40:43], v[28:31]
    ds_read_b128 v[80:83], v4 offset:51200
    v_mfma_f32_16x16x32_bf16 v[36:39], v[84:87], a[44:47], v[36:39]
    s_waitcnt lgkmcnt(6)
    buffer_load_dwordx4 a[88:91], v243, s[8:11], s28 offen offset:2048 sc1
    v_mfma_f32_16x16x32_bf16 v[40:43], v[88:91], a[40:43], v[40:43]
    ds_read_b128 v[84:87], v4 offset:52224
    v_mfma_f32_16x16x32_bf16 v[48:51], v[88:91], a[44:47], v[48:51]
    s_waitcnt lgkmcnt(6)
    v_mfma_f32_16x16x32_bf16 v[44:47], v[92:95], a[40:43], v[44:47]
    ds_read_b128 v[88:91], v4 offset:53248
    v_mfma_f32_16x16x32_bf16 v[52:55], v[92:95], a[44:47], v[52:55]
    s_waitcnt lgkmcnt(6)
    v_mfma_f32_16x16x32_bf16 v[56:59], v[96:99], a[40:43], v[56:59]
    ds_read_b128 v[92:95], v4 offset:54272
    v_mfma_f32_16x16x32_bf16 v[64:67], v[96:99], a[44:47], v[64:67]
    s_waitcnt lgkmcnt(6)
    v_mfma_f32_16x16x32_bf16 v[60:63], v[100:103], a[40:43], v[60:63]
    ds_read_b128 v[96:99], v4 offset:55296
    v_mfma_f32_16x16x32_bf16 v[68:71], v[100:103], a[44:47], v[68:71]
    s_waitcnt lgkmcnt(6)
    s_waitcnt vmcnt(16)
    buffer_load_dwordx4 v3, s[20:23], s29 offen offset:3072 lds
    s_add_u32 s29, s29, 16384
    v_mfma_f32_16x16x32_bf16 v[8:11], v[72:75], a[48:51], v[8:11]
    ds_read_b128 v[100:103], v4 offset:56320
    v_mfma_f32_16x16x32_bf16 v[16:19], v[72:75], a[52:55], v[16:19]
    s_waitcnt lgkmcnt(6)
    buffer_load_dwordx4 a[92:95], v243, s[8:11], s28 offen offset:2304 sc1
    s_add_u32 s28, s28, 4096
    v_mfma_f32_16x16x32_bf16 v[12:15], v[76:79], a[48:51], v[12:15]
    ds_read_b128 v[72:75], v4 offset:57344
    v_mfma_f32_16x16x32_bf16 v[20:23], v[76:79], a[52:55], v[20:23]
    s_waitcnt lgkmcnt(6)
    v_mfma_f32_16x16x32_bf16 v[24:27], v[80:83], a[48:51], v[24:27]
    ds_read_b128 v[76:79], v4 offset:58368
    v_mfma_f32_16x16x32_bf16 v[32:35], v[80:83], a[52:55], v[32:35]
    s_waitcnt lgkmcnt(6)
    v_mfma_f32_16x16x32_bf16 v[28:31], v[84:87], a[48:51], v[28:31]
    ds_read_b128 v[80:83], v4 offset:59392
    v_mfma_f32_16x16x32_bf16 v[36:39], v[84:87], a[52:55], v[36:39]
    s_waitcnt lgkmcnt(6)
    buffer_load_dwordx4 a[96:99], v243, s[8:11], s28 offen offset:0 sc1
    v_mfma_f32_16x16x32_bf16 v[40:43], v[88:91], a[48:51], v[40:43]
    ds_read_b128 v[84:87], v4 offset:60416
    v_mfma_f32_16x16x32_bf16 v[48:51], v[88:91], a[52:55], v[48:51]
    s_waitcnt lgkmcnt(6)
    v_mfma_f32_16x16x32_bf16 v[44:47], v[92:95], a[48:51], v[44:47]
    ds_read_b128 v[88:91], v4 offset:61440
    v_mfma_f32_16x16x32_bf16 v[52:55], v[92:95], a[52:55], v[52:55]
    s_waitcnt lgkmcnt(6)
    s_add_u32 m0, s87, 32768
    s_nop 0
    buffer_load_dwordx4 v3, s[20:23], s29 offen offset:0 lds
    v_mfma_f32_16x16x32_bf16 v[56:59], v[96:99], a[48:51], v[56:59]
    ds_read_b128 v[92:95], v4 offset:62464
    v_mfma_f32_16x16x32_bf16 v[64:67], v[96:99], a[52:55], v[64:67]
    s_waitcnt lgkmcnt(6)
    v_mfma_f32_16x16x32_bf16 v[60:63], v[100:103], a[48:51], v[60:63]
    ds_read_b128 v[96:99], v4 offset:63488
    v_mfma_f32_16x16x32_bf16 v[68:71], v[100:103], a[52:55], v[68:71]
    s_waitcnt lgkmcnt(6)
    s_waitcnt vmcnt(17)
    buffer_load_dwordx4 a[100:103], v243, s[8:11], s28 offen offset:256 sc1
    v_mfma_f32_16x16x32_bf16 v[8:11], v[72:75], a[56:59], v[8:11]
    ds_read_b128 v[100:103], v4 offset:64512
    v_mfma_f32_16x16x32_bf16 v[16:19], v[72:75], a[60:63], v[16:19]
    s_waitcnt lgkmcnt(6)
    s_waitcnt vmcnt(31)
    s_barrier
    v_mfma_f32_16x16x32_bf16 v[12:15], v[76:79], a[56:59], v[12:15]
    ds_read_b128 v[72:75], v242 offset:0
    v_mfma_f32_16x16x32_bf16 v[20:23], v[76:79], a[60:63], v[20:23]
    s_waitcnt lgkmcnt(6)
    v_mfma_f32_16x16x32_bf16 v[24:27], v[80:83], a[56:59], v[24:27]
    ds_read_b128 v[76:79], v242 offset:1024
    v_mfma_f32_16x16x32_bf16 v[32:35], v[80:83], a[60:63], v[32:35]
    s_waitcnt lgkmcnt(6)
    buffer_load_dwordx4 v3, s[20:23], s29 offen offset:1024 lds
    v_mfma_f32_16x16x32_bf16 v[28:31], v[84:87], a[56:59], v[28:31]
    ds_read_b128 v[80:83], v242 offset:2048
    v_mfma_f32_16x16x32_bf16 v[36:39], v[84:87], a[60:63], v[36:39]
    s_waitcnt lgkmcnt(6)
    s_cmp_le_u32 s76, 4
    s_addc_u32 s28, s45, 4
    s_and_b32 s28, s28, 7
    s_mul_i32 s28, s28, 14336
    s_add_u32 s28, s28, 4096
    buffer_load_dwordx4 a[104:107], v243, s[8:11], s28 offen offset:0 sc1
    v_mfma_f32_16x16x32_bf16 v[40:43], v[88:91], a[56:59], v[40:43]
    ds_read_b128 v[84:87], v242 offset:3072
    v_mfma_f32_16x16x32_bf16 v[48:51], v[88:91], a[60:63], v[48:51]
    s_waitcnt lgkmcnt(6)
    v_mfma_f32_16x16x32_bf16 v[44:47], v[92:95], a[56:59], v[44:47]
    ds_read_b128 v[88:91], v242 offset:4096
    v_mfma_f32_16x16x32_bf16 v[52:55], v[92:95], a[60:63], v[52:55]
    s_waitcnt lgkmcnt(6)
    v_mfma_f32_16x16x32_bf16 v[56:59], v[96:99], a[56:59], v[56:59]
    ds_read_b128 v[92:95], v242 offset:5120
    v_mfma_f32_16x16x32_bf16 v[64:67], v[96:99], a[60:63], v[64:67]
    s_waitcnt lgkmcnt(6)
    v_mfma_f32_16x16x32_bf16 v[60:63], v[100:103], a[56:59], v[60:63]
    ds_read_b128 v[96:99], v242 offset:6144
    v_mfma_f32_16x16x32_bf16 v[68:71], v[100:103], a[60:63], v[68:71]
    s_waitcnt lgkmcnt(6)
    s_waitcnt vmcnt(16)
    buffer_load_dwordx4 v3, s[20:23], s29 offen offset:2048 lds
    v_mfma_f32_16x16x32_bf16 v[8:11], v[72:75], a[64:67], v[8:11]
    ds_read_b128 v[100:103], v242 offset:7168
    v_mfma_f32_16x16x32_bf16 v[16:19], v[72:75], a[68:71], v[16:19]
    s_waitcnt lgkmcnt(6)
    buffer_load_dwordx4 a[108:111], v243, s[8:11], s28 offen offset:256 sc1
    v_mfma_f32_16x16x32_bf16 v[12:15], v[76:79], a[64:67], v[12:15]
    ds_read_b128 v[72:75], v242 offset:8192
    v_mfma_f32_16x16x32_bf16 v[20:23], v[76:79], a[68:71], v[20:23]
    s_waitcnt lgkmcnt(6)
    v_mfma_f32_16x16x32_bf16 v[24:27], v[80:83], a[64:67], v[24:27]
    ds_read_b128 v[76:79], v242 offset:9216
    v_mfma_f32_16x16x32_bf16 v[32:35], v[80:83], a[68:71], v[32:35]
    s_waitcnt lgkmcnt(6)
    v_mfma_f32_16x16x32_bf16 v[28:31], v[84:87], a[64:67], v[28:31]
    ds_read_b128 v[80:83], v242 offset:10240
    v_mfma_f32_16x16x32_bf16 v[36:39], v[84:87], a[68:71], v[36:39]
    s_waitcnt lgkmcnt(6)
    buffer_load_dwordx4 a[0:3], v243, s[8:11], s28 offen offset:2048 sc1
    v_mfma_f32_16x16x32_bf16 v[40:43], v[88:91], a[64:67], v[40:43]
    ds_read_b128 v[84:87], v242 offset:11264
    v_mfma_f32_16x16x32_bf16 v[48:51], v[88:91], a[68:71], v[48:51]
    s_waitcnt lgkmcnt(6)
    buffer_load_dwordx4 v3, s[20:23], s29 offen offset:3072 lds
    s_add_u32 s29, s29, 16384
    v_mfma_f32_16x16x32_bf16 v[44:47], v[92:95], a[64:67], v[44:47]
    ds_read_b128 v[88:91], v242 offset:12288
    v_mfma_f32_16x16x32_bf16 v[52:55], v[92:95], a[68:71], v[52:55]
    s_waitcnt lgkmcnt(6)
    v_mfma_f32_16x16x32_bf16 v[56:59], v[96:99], a[64:67], v[56:59]
    ds_read_b128 v[92:95], v242 offset:13312
    v_mfma_f32_16x16x32_bf16 v[64:67], v[96:99], a[68:71], v[64:67]
    s_waitcnt lgkmcnt(6)
    v_mfma_f32_16x16x32_bf16 v[60:63], v[100:103], a[64:67], v[60:63]
    ds_read_b128 v[96:99], v242 offset:14336
    v_mfma_f32_16x16x32_bf16 v[68:71], v[100:103], a[68:71], v[68:71]
    s_waitcnt lgkmcnt(6)
    s_waitcnt vmcnt(17)
    buffer_load_dwordx4 a[4:7], v243, s[8:11], s28 offen offset:2304 sc1
    s_add_u32 s28, s28, 4096
    v_mfma_f32_16x16x32_bf16 v[8:11], v[72:75], a[72:75], v[8:11]
    ds_read_b128 v[100:103], v242 offset:15360
    v_mfma_f32_16x16x32_bf16 v[16:19], v[72:75], a[76:79], v[16:19]
    s_waitcnt lgkmcnt(6)
    s_waitcnt vmcnt(29)
    s_barrier
    v_mfma_f32_16x16x32_bf16 v[12:15], v[76:79], a[72:75], v[12:15]
    ds_read_b128 v[72:75], v242 offset:16384
    v_mfma_f32_16x16x32_bf16 v[20:23], v[76:79], a[76:79], v[20:23]
    s_waitcnt lgkmcnt(6)
    v_mfma_f32_16x16x32_bf16 v[24:27], v[80:83], a[72:75], v[24:27]
    ds_read_b128 v[76:79], v242 offset:17408
    v_mfma_f32_16x16x32_bf16 v[32:35], v[80:83], a[76:79], v[32:35]
    s_waitcnt lgkmcnt(6)
    s_add_u32 m0, s87, 49152
    s_nop 0
    buffer_load_dwordx4 v3, s[20:23], s29 offen offset:0 lds
    v_mfma_f32_16x16x32_bf16 v[28:31], v[84:87], a[72:75], v[28:31]
    ds_read_b128 v[80:83], v242 offset:18432
    v_mfma_f32_16x16x32_bf16 v[36:39], v[84:87], a[76:79], v[36:39]
    s_waitcnt lgkmcnt(6)
    buffer_load_dwordx4 a[8:11], v243, s[8:11], s28 offen offset:0 sc1
    v_mfma_f32_16x16x32_bf16 v[40:43], v[88:91], a[72:75], v[40:43]
    ds_read_b128 v[84:87], v242 offset:19456
    v_mfma_f32_16x16x32_bf16 v[48:51], v[88:91], a[76:79], v[48:51]
    s_waitcnt lgkmcnt(6)
    v_mfma_f32_16x16x32_bf16 v[44:47], v[92:95], a[72:75], v[44:47]
    ds_read_b128 v[88:91], v242 offset:20480
    v_mfma_f32_16x16x32_bf16 v[52:55], v[92:95], a[76:79], v[52:55]
    s_waitcnt lgkmcnt(6)
    v_mfma_f32_16x16x32_bf16 v[56:59], v[96:99], a[72:75], v[56:59]
    ds_read_b128 v[92:95], v242 offset:21504
    v_mfma_f32_16x16x32_bf16 v[64:67], v[96:99], a[76:79], v[64:67]
    s_waitcnt lgkmcnt(6)
    v_mfma_f32_16x16x32_bf16 v[60:63], v[100:103], a[72:75], v[60:63]
    ds_read_b128 v[96:99], v242 offset:22528
    v_mfma_f32_16x16x32_bf16 v[68:71], v[100:103], a[76:79], v[68:71]
    s_waitcnt lgkmcnt(6)
    s_waitcnt vmcnt(16)
    s_add_u32 m0, s87, 49152
    s_nop 0
    buffer_load_dwordx4 v3, s[20:23], s29 offen offset:1024 lds
    v_mfma_f32_16x16x32_bf16 v[8:11], v[72:75], a[80:83], v[8:11]
    ds_read_b128 v[100:103], v242 offset:23552
    v_mfma_f32_16x16x32_bf16 v[16:19], v[72:75], a[84:87], v[16:19]
    s_waitcnt lgkmcnt(6)
    buffer_load_dwordx4 a[12:15], v243, s[8:11], s28 offen offset:256 sc1
    v_mfma_f32_16x16x32_bf16 v[12:15], v[76:79], a[80:83], v[12:15]
    ds_read_b128 v[72:75], v242 offset:24576
    v_mfma_f32_16x16x32_bf16 v[20:23], v[76:79], a[84:87], v[20:23]
    s_waitcnt lgkmcnt(6)
    v_mfma_f32_16x16x32_bf16 v[24:27], v[80:83], a[80:83], v[24:27]
    ds_read_b128 v[76:79], v242 offset:25600
    v_mfma_f32_16x16x32_bf16 v[32:35], v[80:83], a[84:87], v[32:35]
    s_waitcnt lgkmcnt(6)
    v_mfma_f32_16x16x32_bf16 v[28:31], v[84:87], a[80:83], v[28:31]
    ds_read_b128 v[80:83], v242 offset:26624
    v_mfma_f32_16x16x32_bf16 v[36:39], v[84:87], a[84:87], v[36:39]
    s_waitcnt lgkmcnt(6)
    buffer_load_dwordx4 a[16:19], v243, s[8:11], s28 offen offset:2048 sc1
    v_mfma_f32_16x16x32_bf16 v[40:43], v[88:91], a[80:83], v[40:43]
    ds_read_b128 v[84:87], v242 offset:27648
    v_mfma_f32_16x16x32_bf16 v[48:51], v[88:91], a[84:87], v[48:51]
    s_waitcnt lgkmcnt(6)
    s_add_u32 m0, s87, 49152
    s_nop 0
    buffer_load_dwordx4 v3, s[20:23], s29 offen offset:2048 lds
    v_mfma_f32_16x16x32_bf16 v[44:47], v[92:95], a[80:83], v[44:47]
    ds_read_b128 v[88:91], v242 offset:28672
    v_mfma_f32_16x16x32_bf16 v[52:55], v[92:95], a[84:87], v[52:55]
    s_waitcnt lgkmcnt(6)
    v_mfma_f32_16x16x32_bf16 v[56:59], v[96:99], a[80:83], v[56:59]
    ds_read_b128 v[92:95], v242 offset:29696
    v_mfma_f32_16x16x32_bf16 v[64:67], v[96:99], a[84:87], v[64:67]
    s_waitcnt lgkmcnt(6)
    v_mfma_f32_16x16x32_bf16 v[60:63], v[100:103], a[80:83], v[60:63]
    ds_read_b128 v[96:99], v242 offset:30720
    v_mfma_f32_16x16x32_bf16 v[68:71], v[100:103], a[84:87], v[68:71]
    s_waitcnt lgkmcnt(6)
    s_waitcnt vmcnt(16)
    buffer_load_dwordx4 a[20:23], v243, s[8:11], s28 offen offset:2304 sc1
    s_add_u32 s28, s28, 4096
    s_andn2_b32 s32, s42, s56
    s_cbranch_scc0 L_main_kernel_f2l1_1060
    v_mfma_f32_16x16x32_bf16 v[8:11], v[72:75], a[88:91], v[8:11]
    ds_read_b128 v[100:103], v242 offset:31744
    v_mfma_f32_16x16x32_bf16 v[16:19], v[72:75], a[92:95], v[16:19]
    s_waitcnt lgkmcnt(6)
    s_waitcnt vmcnt(27)
    s_barrier
    v_mfma_f32_16x16x32_bf16 v[12:15], v[76:79], a[88:91], v[12:15]
    ds_read_b128 v[72:75], v3 offset:0
    v_mfma_f32_16x16x32_bf16 v[20:23], v[76:79], a[92:95], v[20:23]
    s_waitcnt lgkmcnt(6)
    s_add_u32 m0, s87, 49152
    s_nop 0
    buffer_load_dwordx4 v3, s[20:23], s29 offen offset:3072 lds
    s_add_u32 s29, s29, 16384
    v_mfma_f32_16x16x32_bf16 v[24:27], v[80:83], a[88:91], v[24:27]
    ds_read_b128 v[76:79], v3 offset:1024
    v_mfma_f32_16x16x32_bf16 v[32:35], v[80:83], a[92:95], v[32:35]
    s_waitcnt lgkmcnt(6)
    v_mfma_f32_16x16x32_bf16 v[28:31], v[84:87], a[88:91], v[28:31]
    ds_read_b128 v[80:83], v3 offset:2048
    v_mfma_f32_16x16x32_bf16 v[36:39], v[84:87], a[92:95], v[36:39]
    s_waitcnt lgkmcnt(6)
    buffer_load_dwordx4 a[24:27], v243, s[8:11], s28 offen offset:0 sc1
    v_mfma_f32_16x16x32_bf16 v[40:43], v[88:91], a[88:91], v[40:43]
    ds_read_b128 v[84:87], v3 offset:3072
    v_mfma_f32_16x16x32_bf16 v[48:51], v[88:91], a[92:95], v[48:51]
    s_waitcnt lgkmcnt(6)
    v_mfma_f32_16x16x32_bf16 v[44:47], v[92:95], a[88:91], v[44:47]
    ds_read_b128 v[88:91], v3 offset:4096
    v_mfma_f32_16x16x32_bf16 v[52:55], v[92:95], a[92:95], v[52:55]
    s_waitcnt lgkmcnt(6)
    v_mfma_f32_16x16x32_bf16 v[56:59], v[96:99], a[88:91], v[56:59]
    ds_read_b128 v[92:95], v3 offset:5120
    v_mfma_f32_16x16x32_bf16 v[64:67], v[96:99], a[92:95], v[64:67]
    s_waitcnt lgkmcnt(6)
    v_mfma_f32_16x16x32_bf16 v[60:63], v[100:103], a[88:91], v[60:63]
    ds_read_b128 v[96:99], v3 offset:6144
    v_mfma_f32_16x16x32_bf16 v[68:71], v[100:103], a[92:95], v[68:71]
    s_waitcnt lgkmcnt(6)
    s_waitcnt vmcnt(16)
    s_add_u32 m0, s87, 65536
    s_nop 0
    buffer_load_dwordx4 v3, s[20:23], s29 offen offset:0 lds
    buffer_load_dwordx4 a[28:31], v243, s[8:11], s28 offen offset:256 sc1
    v_mfma_f32_16x16x32_bf16 v[8:11], v[72:75], a[96:99], v[8:11]
    ds_read_b128 v[100:103], v3 offset:7168
    v_mfma_f32_16x16x32_bf16 v[16:19], v[72:75], a[100:103], v[16:19]
    s_waitcnt lgkmcnt(6)
    v_mfma_f32_16x16x32_bf16 v[12:15], v[76:79], a[96:99], v[12:15]
    ds_read_b128 v[72:75], v3 offset:8192
    v_mfma_f32_16x16x32_bf16 v[20:23], v[76:79], a[100:103], v[20:23]
    s_waitcnt lgkmcnt(6)
    v_mfma_f32_16x16x32_bf16 v[24:27], v[80:83], a[96:99], v[24:27]
    ds_read_b128 v[76:79], v3 offset:9216
    v_mfma_f32_16x16x32_bf16 v[32:35], v[80:83], a[100:103], v[32:35]
    s_waitcnt lgkmcnt(6)
    s_add_u32 m0, s87, 131072
    s_add_u32 s60, s92, 0
    buffer_load_dwordx4 v3, s[20:23], s60 offen offset:0 lds
    v_mfma_f32_16x16x32_bf16 v[28:31], v[84:87], a[96:99], v[28:31]
    ds_read_b128 v[80:83], v3 offset:10240
    v_mfma_f32_16x16x32_bf16 v[36:39], v[84:87], a[100:103], v[36:39]
    s_waitcnt lgkmcnt(6)
    s_cmp_le_u32 s76, 5
    s_addc_u32 s28, s45, 5
    s_and_b32 s28, s28, 7
    s_mul_i32 s28, s28, 14336
    s_add_u32 s28, s28, 4096
    buffer_load_dwordx4 a[32:35], v243, s[8:11], s28 offen offset:0 sc1
    v_mfma_f32_16x16x32_bf16 v[40:43], v[88:91], a[96:99], v[40:43]
    ds_read_b128 v[84:87], v3 offset:11264
    v_mfma_f32_16x16x32_bf16 v[48:51], v[88:91], a[100:103], v[48:51]
    s_waitcnt lgkmcnt(6)
    s_add_u32 m0, s87, 65536
    s_nop 0
    buffer_load_dwordx4 v3, s[20:23], s29 offen offset:1024 lds
    v_mfma_f32_16x16x32_bf16 v[44:47], v[92:95], a[96:99], v[44:47]
    ds_read_b128 v[88:91], v3 offset:12288
    v_mfma_f32_16x16x32_bf16 v[52:55], v[92:95], a[100:103], v[52:55]
    s_waitcnt lgkmcnt(6)
    v_mfma_f32_16x16x32_bf16 v[56:59], v[96:99], a[96:99], v[56:59]
    ds_read_b128 v[92:95], v3 offset:13312
    v_mfma_f32_16x16x32_bf16 v[64:67], v[96:99], a[100:103], v[64:67]
    s_waitcnt lgkmcnt(6)
    v_mfma_f32_16x16x32_bf16 v[60:63], v[100:103], a[96:99], v[60:63]
    ds_read_b128 v[96:99], v3 offset:14336
    v_mfma_f32_16x16x32_bf16 v[68:71], v[100:103], a[100:103], v[68:71]
    s_waitcnt lgkmcnt(6)
    s_waitcnt vmcnt(17)
    buffer_load_dwordx4 a[36:39], v243, s[8:11], s28 offen offset:256 sc1
    v_mfma_f32_16x16x32_bf16 v[8:11], v[72:75], a[104:107], v[8:11]
    ds_read_b128 v[100:103], v3 offset:15360
    v_mfma_f32_16x16x32_bf16 v[16:19], v[72:75], a[108:111], v[16:19]
    s_waitcnt lgkmcnt(6)
    s_add_u32 m0, s87, 131072
    s_add_u32 s60, s92, 0
    buffer_load_dwordx4 v3, s[20:23], s60 offen offset:1024 lds
    s_waitcnt vmcnt(27)
    s_barrier
    v_mfma_f32_16x16x32_bf16 v[12:15], v[76:79], a[104:107], v[12:15]
    ds_read_b128 v[72:75], v3 offset:16384
    v_mfma_f32_16x16x32_bf16 v[20:23], v[76:79], a[108:111], v[20:23]
    s_waitcnt lgkmcnt(6)
    s_add_u32 m0, s87, 65536
    s_nop 0
    buffer_load_dwordx4 v3, s[20:23], s29 offen offset:2048 lds
    v_mfma_f32_16x16x32_bf16 v[24:27], v[80:83], a[104:107], v[24:27]
    ds_read_b128 v[76:79], v3 offset:17408
    v_mfma_f32_16x16x32_bf16 v[32:35], v[80:83], a[108:111], v[32:35]
    s_waitcnt lgkmcnt(6)
    s_add_u32 m0, s87, 147456
    s_add_u32 s60, s47, 262144
    buffer_load_dwordx4 v252, s[96:99], s60 offen offset:0 lds
    v_mfma_f32_16x16x32_bf16 v[28:31], v[84:87], a[104:107], v[28:31]
    ds_read_b128 v[80:83], v3 offset:18432
    v_mfma_f32_16x16x32_bf16 v[36:39], v[84:87], a[108:111], v[36:39]
    s_waitcnt lgkmcnt(6)
    buffer_load_dwordx4 a[40:43], v243, s[8:11], s28 offen offset:2048 sc1
    v_mfma_f32_16x16x32_bf16 v[40:43], v[88:91], a[104:107], v[40:43]
    ds_read_b128 v[84:87], v3 offset:19456
    v_mfma_f32_16x16x32_bf16 v[48:51], v[88:91], a[108:111], v[48:51]
    s_waitcnt lgkmcnt(6)
    v_mfma_f32_16x16x32_bf16 v[44:47], v[92:95], a[104:107], v[44:47]
    ds_read_b128 v[88:91], v3 offset:20480
    v_mfma_f32_16x16x32_bf16 v[52:55], v[92:95], a[108:111], v[52:55]
    s_waitcnt lgkmcnt(6)
    s_add_u32 m0, s87, 147456
    s_add_u32 s60, s47, 277504
    buffer_load_dwordx4 v252, s[96:99], s60 offen offset:1024 lds
    v_mfma_f32_16x16x32_bf16 v[56:59], v[96:99], a[104:107], v[56:59]
    ds_read_b128 v[92:95], v3 offset:21504
    v_mfma_f32_16x16x32_bf16 v[64:67], v[96:99], a[108:111], v[64:67]
    s_waitcnt lgkmcnt(6)
    s_add_u32 m0, s87, 131072
    s_add_u32 s60, s92, 0
    buffer_load_dwordx4 v3, s[20:23], s60 offen offset:2048 lds
    v_mfma_f32_16x16x32_bf16 v[60:63], v[100:103], a[104:107], v[60:63]
    ds_read_b128 v[96:99], v3 offset:22528
    v_mfma_f32_16x16x32_bf16 v[68:71], v[100:103], a[108:111], v[68:71]
    s_waitcnt lgkmcnt(6)
    s_waitcnt vmcnt(21)
    s_add_u32 m0, s87, 65536
    s_nop 0
    buffer_load_dwordx4 v3, s[20:23], s29 offen offset:3072 lds
    s_add_u32 s29, s29, 16384
    buffer_load_dwordx4 a[44:47], v243, s[8:11], s28 offen offset:2304 sc1
    s_add_u32 s28, s28, 4096
    v_mfma_f32_16x16x32_bf16 v[8:11], v[72:75], a[0:3], v[8:11]
    ds_read_b128 v[100:103], v3 offset:23552
    v_mfma_f32_16x16x32_bf16 v[16:19], v[72:75], a[4:7], v[16:19]
    s_waitcnt lgkmcnt(6)
    v_mfma_f32_16x16x32_bf16 v[12:15], v[76:79], a[0:3], v[12:15]
    ds_read_b128 v[72:75], v3 offset:24576
    v_mfma_f32_16x16x32_bf16 v[20:23], v[76:79], a[4:7], v[20:23]
    s_waitcnt lgkmcnt(6)
    s_add_u32 m0, s87, 147456
    s_add_u32 s60, s47, 292864
    buffer_load_dwordx4 v252, s[96:99], s60 offen offset:2048 lds
    v_mfma_f32_16x16x32_bf16 v[24:27], v[80:83], a[0:3], v[24:27]
    ds_read_b128 v[76:79], v3 offset:25600
    v_mfma_f32_16x16x32_bf16 v[32:35], v[80:83], a[4:7], v[32:35]
    s_waitcnt lgkmcnt(6)
    v_mfma_f32_16x16x32_bf16 v[28:31], v[84:87], a[0:3], v[28:31]
    ds_read_b128 v[80:83], v3 offset:26624
    v_mfma_f32_16x16x32_bf16 v[36:39], v[84:87], a[4:7], v[36:39]
    s_waitcnt lgkmcnt(6)
    buffer_load_dwordx4 a[48:51], v243, s[8:11], s28 offen offset:0 sc1
    v_mfma_f32_16x16x32_bf16 v[40:43], v[88:91], a[0:3], v[40:43]
    ds_read_b128 v[84:87], v3 offset:27648
    v_mfma_f32_16x16x32_bf16 v[48:51], v[88:91], a[4:7], v[48:51]
    s_waitcnt lgkmcnt(6)
    s_mov_b32 s35, 872448
    buffer_load_dwordx2 v[240:241], v235, s[16:19], s35 offen sc1
    s_add_u32 m0, s87, 131072
    s_add_u32 s60, s92, 0
    buffer_load_dwordx4 v3, s[20:23], s60 offen offset:3072 lds
    v_mfma_f32_16x16x32_bf16 v[44:47], v[92:95], a[0:3], v[44:47]
    ds_read_b128 v[88:91], v3 offset:28672
    v_mfma_f32_16x16x32_bf16 v[52:55], v[92:95], a[4:7], v[52:55]
    s_waitcnt lgkmcnt(6)
    s_add_u32 m0, s87, 81920
    s_nop 0
    buffer_load_dwordx4 v3, s[20:23], s29 offen offset:0 lds
    v_mfma_f32_16x16x32_bf16 v[56:59], v[96:99], a[0:3], v[56:59]
    ds_read_b128 v[92:95], v3 offset:29696
    v_mfma_f32_16x16x32_bf16 v[64:67], v[96:99], a[4:7], v[64:67]
    s_waitcnt lgkmcnt(6)
    s_add_u32 m0, s87, 147456
    s_add_u32 s60, s47, 308224
    buffer_load_dwordx4 v252, s[96:99], s60 offen offset:3072 lds
    v_mfma_f32_16x16x32_bf16 v[60:63], v[100:103], a[0:3], v[60:63]
    ds_read_b128 v[96:99], v3 offset:30720
    v_mfma_f32_16x16x32_bf16 v[68:71], v[100:103], a[4:7], v[68:71]
    s_waitcnt lgkmcnt(6)
    s_waitcnt vmcnt(25)
    buffer_load_dwordx4 a[52:55], v243, s[8:11], s28 offen offset:256 sc1
    v_mfma_f32_16x16x32_bf16 v[8:11], v[72:75], a[8:11], v[8:11]
    ds_read_b128 v[100:103], v3 offset:31744
    v_mfma_f32_16x16x32_bf16 v[16:19], v[72:75], a[12:15], v[16:19]
    s_waitcnt lgkmcnt(6)
    s_waitcnt vmcnt(31)
    s_barrier
    v_mfma_f32_16x16x32_bf16 v[12:15], v[76:79], a[8:11], v[12:15]
    ds_read_b128 v[72:75], v3 offset:32768
    v_mfma_f32_16x16x32_bf16 v[20:23], v[76:79], a[12:15], v[20:23]
    s_waitcnt lgkmcnt(6)
    s_add_u32 m0, s87, 81920
    s_nop 0
    buffer_load_dwordx4 v3, s[20:23], s29 offen offset:1024 lds
    v_mfma_f32_16x16x32_bf16 v[24:27], v[80:83], a[8:11], v[24:27]
    ds_read_b128 v[76:79], v3 offset:33792
    v_mfma_f32_16x16x32_bf16 v[32:35], v[80:83], a[12:15], v[32:35]
    s_waitcnt lgkmcnt(6)
    s_add_u32 m0, s87, 0
    s_add_u32 s60, s47, 524288
    buffer_load_dwordx4 v252, s[96:99], s60 offen offset:0 lds
    v_mfma_f32_16x16x32_bf16 v[28:31], v[84:87], a[8:11], v[28:31]
    ds_read_b128 v[80:83], v3 offset:34816
    v_mfma_f32_16x16x32_bf16 v[36:39], v[84:87], a[12:15], v[36:39]
    s_waitcnt lgkmcnt(6)
    buffer_load_dwordx4 a[56:59], v243, s[8:11], s28 offen offset:2048 sc1
    v_mfma_f32_16x16x32_bf16 v[40:43], v[88:91], a[8:11], v[40:43]
    ds_read_b128 v[84:87], v3 offset:35840
    v_mfma_f32_16x16x32_bf16 v[48:51], v[88:91], a[12:15], v[48:51]
    s_waitcnt lgkmcnt(6)
    v_mfma_f32_16x16x32_bf16 v[44:47], v[92:95], a[8:11], v[44:47]
    ds_read_b128 v[88:91], v3 offset:36864
    v_mfma_f32_16x16x32_bf16 v[52:55], v[92:95], a[12:15], v[52:55]
    s_waitcnt lgkmcnt(6)
    s_add_u32 m0, s87, 0
    s_add_u32 s60, s47, 539648
    buffer_load_dwordx4 v252, s[96:99], s60 offen offset:1024 lds
    v_mfma_f32_16x16x32_bf16 v[56:59], v[96:99], a[8:11], v[56:59]
    ds_read_b128 v[92:95], v3 offset:37888
    v_mfma_f32_16x16x32_bf16 v[64:67], v[96:99], a[12:15], v[64:67]
    s_waitcnt lgkmcnt(6)
    s_add_u32 m0, s87, 81920
    s_nop 0
    buffer_load_dwordx4 v3, s[20:23], s29 offen offset:2048 lds
    v_mfma_f32_16x16x32_bf16 v[60:63], v[100:103], a[8:11], v[60:63]
    ds_read_b128 v[96:99], v3 offset:38912
    v_mfma_f32_16x16x32_bf16 v[68:71], v[100:103], a[12:15], v[68:71]
    s_waitcnt lgkmcnt(6)
    s_waitcnt vmcnt(28)
    buffer_load_dwordx4 a[60:63], v243, s[8:11], s28 offen offset:2304 sc1
    s_add_u32 s28, s28, 4096
    v_mfma_f32_16x16x32_bf16 v[8:11], v[72:75], a[16:19], v[8:11]
    ds_read_b128 v[100:103], v3 offset:39936
    v_mfma_f32_16x16x32_bf16 v[16:19], v[72:75], a[20:23], v[16:19]
    s_waitcnt lgkmcnt(6)
    v_mfma_f32_16x16x32_bf16 v[12:15], v[76:79], a[16:19], v[12:15]
    ds_read_b128 v[72:75], v3 offset:40960
    v_mfma_f32_16x16x32_bf16 v[20:23], v[76:79], a[20:23], v[20:23]
    s_waitcnt lgkmcnt(6)
    s_add_u32 m0, s87, 0
    s_add_u32 s60, s47, 555008
    buffer_load_dwordx4 v252, s[96:99], s60 offen offset:2048 lds
    v_mfma_f32_16x16x32_bf16 v[24:27], v[80:83], a[16:19], v[24:27]
    ds_read_b128 v[76:79], v3 offset:41984
    v_mfma_f32_16x16x32_bf16 v[32:35], v[80:83], a[20:23], v[32:35]
    s_waitcnt lgkmcnt(6)
    v_mfma_f32_16x16x32_bf16 v[28:31], v[84:87], a[16:19], v[28:31]
    ds_read_b128 v[80:83], v3 offset:43008
    v_mfma_f32_16x16x32_bf16 v[36:39], v[84:87], a[20:23], v[36:39]
    s_waitcnt lgkmcnt(6)
    s_add_u32 m0, s87, 81920
    s_nop 0
    buffer_load_dwordx4 v3, s[20:23], s29 offen offset:3072 lds
    s_add_u32 s29, s29, 16384
    buffer_load_dwordx4 a[64:67], v243, s[8:11], s28 offen offset:0 sc1
    v_mfma_f32_16x16x32_bf16 v[40:43], v[88:91], a[16:19], v[40:43]
    ds_read_b128 v[84:87], v3 offset:44032
    v_mfma_f32_16x16x32_bf16 v[48:51], v[88:91], a[20:23], v[48:51]
    s_waitcnt lgkmcnt(6)
    v_mfma_f32_16x16x32_bf16 v[44:47], v[92:95], a[16:19], v[44:47]
    ds_read_b128 v[88:91], v3 offset:45056
    v_mfma_f32_16x16x32_bf16 v[52:55], v[92:95], a[20:23], v[52:55]
    s_waitcnt lgkmcnt(6)
    s_add_u32 m0, s87, 0
    s_add_u32 s60, s47, 570368
    buffer_load_dwordx4 v252, s[96:99], s60 offen offset:3072 lds
    v_mfma_f32_16x16x32_bf16 v[56:59], v[96:99], a[16:19], v[56:59]
    ds_read_b128 v[92:95], v3 offset:46080
    v_mfma_f32_16x16x32_bf16 v[64:67], v[96:99], a[20:23], v[64:67]
    s_waitcnt lgkmcnt(6)
    v_mfma_f32_16x16x32_bf16 v[60:63], v[100:103], a[16:19], v[60:63]
    ds_read_b128 v[96:99], v3 offset:47104
    v_mfma_f32_16x16x32_bf16 v[68:71], v[100:103], a[20:23], v[68:71]
    s_waitcnt lgkmcnt(6)
    s_waitcnt vmcnt(29)
    buffer_load_dwordx4 a[68:71], v243, s[8:11], s28 offen offset:256 sc1
    v_mfma_f32_16x16x32_bf16 v[8:11], v[72:75], a[24:27], v[8:11]
    ds_read_b128 v[100:103], v3 offset:48128
    v_mfma_f32_16x16x32_bf16 v[16:19], v[72:75], a[28:31], v[16:19]
    s_waitcnt lgkmcnt(6)
    s_waitcnt vmcnt(33)
    s_barrier
    v_mfma_f32_16x16x32_bf16 v[12:15], v[76:79], a[24:27], v[12:15]
    ds_read_b128 v[72:75], v3 offset:49152
    v_mfma_f32_16x16x32_bf16 v[20:23], v[76:79], a[28:31], v[20:23]
    s_waitcnt lgkmcnt(6)
    s_add_u32 m0, s87, 98304
    s_nop 0
    buffer_load_dwordx4 v3, s[20:23], s29 offen offset:0 lds
    v_mfma_f32_16x16x32_bf16 v[24:27], v[80:83], a[24:27], v[24:27]
    ds_read_b128 v[76:79], v3 offset:50176
    v_mfma_f32_16x16x32_bf16 v[32:35], v[80:83], a[28:31], v[32:35]
    s_waitcnt lgkmcnt(6)
    s_add_u32 m0, s87, 16384
    s_add_u32 s60, s47, 786432
    buffer_load_dwordx4 v252, s[96:99], s60 offen offset:0 lds
    v_mfma_f32_16x16x32_bf16 v[28:31], v[84:87], a[24:27], v[28:31]
    ds_read_b128 v[80:83], v3 offset:51200
    v_mfma_f32_16x16x32_bf16 v[36:39], v[84:87], a[28:31], v[36:39]
    s_waitcnt lgkmcnt(6)
    s_cmp_le_u32 s76, 6
    s_addc_u32 s28, s45, 6
    s_and_b32 s28, s28, 7
    s_mul_i32 s28, s28, 14336
    s_add_u32 s28, s28, 4096
    buffer_load_dwordx4 a[72:75], v243, s[8:11], s28 offen offset:0 sc1
    v_mfma_f32_16x16x32_bf16 v[40:43], v[88:91], a[24:27], v[40:43]
    ds_read_b128 v[84:87], v3 offset:52224
    v_mfma_f32_16x16x32_bf16 v[48:51], v[88:91], a[28:31], v[48:51]
    s_waitcnt lgkmcnt(6)
    v_mfma_f32_16x16x32_bf16 v[44:47], v[92:95], a[24:27], v[44:47]
    ds_read_b128 v[88:91], v3 offset:53248
    v_mfma_f32_16x16x32_bf16 v[52:55], v[92:95], a[28:31], v[52:55]
    s_waitcnt lgkmcnt(6)
    s_add_u32 m0, s87, 16384
    s_add_u32 s60, s47, 801792
    buffer_load_dwordx4 v252, s[96:99], s60 offen offset:1024 lds
    v_mfma_f32_16x16x32_bf16 v[56:59], v[96:99], a[24:27], v[56:59]
    ds_read_b128 v[92:95], v3 offset:54272
    v_mfma_f32_16x16x32_bf16 v[64:67], v[96:99], a[28:31], v[64:67]
    s_waitcnt lgkmcnt(6)
    s_add_u32 m0, s87, 98304
    s_nop 0
    buffer_load_dwordx4 v3, s[20:23], s29 offen offset:1024 lds
    v_mfma_f32_16x16x32_bf16 v[60:63], v[100:103], a[24:27], v[60:63]
    ds_read_b128 v[96:99], v3 offset:55296
    v_mfma_f32_16x16x32_bf16 v[68:71], v[100:103], a[28:31], v[68:71]
    s_waitcnt lgkmcnt(6)
    s_waitcnt vmcnt(31)
    buffer_load_dwordx4 a[76:79], v243, s[8:11], s28 offen offset:256 sc1
    v_mfma_f32_16x16x32_bf16 v[8:11], v[72:75], a[32:35], v[8:11]
    ds_read_b128 v[100:103], v3 offset:56320
    v_mfma_f32_16x16x32_bf16 v[16:19], v[72:75], a[36:39], v[16:19]
    s_waitcnt lgkmcnt(6)
    v_mfma_f32_16x16x32_bf16 v[12:15], v[76:79], a[32:35], v[12:15]
    ds_read_b128 v[72:75], v3 offset:57344
    v_mfma_f32_16x16x32_bf16 v[20:23], v[76:79], a[36:39], v[20:23]
    s_waitcnt lgkmcnt(6)
    s_add_u32 m0, s87, 16384
    s_add_u32 s60, s47, 817152
    buffer_load_dwordx4 v252, s[96:99], s60 offen offset:2048 lds
    v_mfma_f32_16x16x32_bf16 v[24:27], v[80:83], a[32:35], v[24:27]
    ds_read_b128 v[76:79], v3 offset:58368
    v_mfma_f32_16x16x32_bf16 v[32:35], v[80:83], a[36:39], v[32:35]
    s_waitcnt lgkmcnt(6)
    v_mfma_f32_16x16x32_bf16 v[28:31], v[84:87], a[32:35], v[28:31]
    ds_read_b128 v[80:83], v3 offset:59392
    v_mfma_f32_16x16x32_bf16 v[36:39], v[84:87], a[36:39], v[36:39]
    s_waitcnt lgkmcnt(6)
    s_add_u32 m0, s87, 98304
    s_nop 0
    buffer_load_dwordx4 v3, s[20:23], s29 offen offset:2048 lds
    buffer_load_dwordx4 a[80:83], v243, s[8:11], s28 offen offset:2048 sc1
    v_mfma_f32_16x16x32_bf16 v[40:43], v[88:91], a[32:35], v[40:43]
    ds_read_b128 v[84:87], v3 offset:60416
    v_mfma_f32_16x16x32_bf16 v[48:51], v[88:91], a[36:39], v[48:51]
    s_waitcnt lgkmcnt(6)
    v_mfma_f32_16x16x32_bf16 v[44:47], v[92:95], a[32:35], v[44:47]
    ds_read_b128 v[88:91], v3 offset:61440
    v_mfma_f32_16x16x32_bf16 v[52:55], v[92:95], a[36:39], v[52:55]
    s_waitcnt lgkmcnt(6)
    s_add_u32 m0, s87, 16384
    s_add_u32 s60, s47, 832512
    buffer_load_dwordx4 v252, s[96:99], s60 offen offset:3072 lds
    v_mfma_f32_16x16x32_bf16 v[56:59], v[96:99], a[32:35], v[56:59]
    ds_read_b128 v[92:95], v3 offset:62464
    v_mfma_f32_16x16x32_bf16 v[64:67], v[96:99], a[36:39], v[64:67]
    s_waitcnt lgkmcnt(6)
    v_mfma_f32_16x16x32_bf16 v[60:63], v[100:103], a[32:35], v[60:63]
    ds_read_b128 v[96:99], v3 offset:63488
    v_mfma_f32_16x16x32_bf16 v[68:71], v[100:103], a[36:39], v[68:71]
    s_waitcnt lgkmcnt(6)
    s_waitcnt vmcnt(28)
    buffer_load_dwordx4 a[84:87], v243, s[8:11], s28 offen offset:2304 sc1
    s_add_u32 s28, s28, 4096
    v_mfma_f32_16x16x32_bf16 v[8:11], v[72:75], a[40:43], v[8:11]
    ds_read_b128 v[100:103], v3 offset:64512
    v_mfma_f32_16x16x32_bf16 v[16:19], v[72:75], a[44:47], v[16:19]
    s_waitcnt lgkmcnt(6)
    s_add_u32 m0, s87, 98304
    s_nop 0
    buffer_load_dwordx4 v3, s[20:23], s29 offen offset:3072 lds
    s_add_u32 s29, s29, 16384
    s_waitcnt vmcnt(31)
    s_barrier
    v_mfma_f32_16x16x32_bf16 v[12:15], v[76:79], a[40:43], v[12:15]
    ds_read_b128 v[72:75], v4 offset:0
    v_mfma_f32_16x16x32_bf16 v[20:23], v[76:79], a[44:47], v[20:23]
    s_waitcnt lgkmcnt(6)
    s_add_u32 m0, s87, 32768
    s_add_u32 s60, s47, 1048576
    buffer_load_dwordx4 v252, s[96:99], s60 offen offset:0 lds
    v_mfma_f32_16x16x32_bf16 v[24:27], v[80:83], a[40:43], v[24:27]
    ds_read_b128 v[76:79], v4 offset:1024
    v_mfma_f32_16x16x32_bf16 v[32:35], v[80:83], a[44:47], v[32:35]
    s_waitcnt lgkmcnt(6)
    v_mfma_f32_16x16x32_bf16 v[28:31], v[84:87], a[40:43], v[28:31]
    ds_read_b128 v[80:83], v4 offset:2048
    v_mfma_f32_16x16x32_bf16 v[36:39], v[84:87], a[44:47], v[36:39]
    s_waitcnt lgkmcnt(6)
    buffer_load_dwordx4 a[88:91], v243, s[8:11], s28 offen offset:0 sc1
    v_mfma_f32_16x16x32_bf16 v[40:43], v[88:91], a[40:43], v[40:43]
    ds_read_b128 v[84:87], v4 offset:3072
    v_mfma_f32_16x16x32_bf16 v[48:51], v[88:91], a[44:47], v[48:51]
    s_waitcnt lgkmcnt(6)
    s_waitcnt vmcnt(29)
    v_cmp_ne_u64 vcc, s[74:75], v[240:241]
    s_cmp_lg_u64 vcc, 0
    s_cbranch_scc1 L_main_kernel_spin_1063
L_main_kernel_ok_1062:
    v_mfma_f32_16x16x32_bf16 v[44:47], v[92:95], a[40:43], v[44:47]
    ds_read_b128 v[88:91], v4 offset:4096
    v_mfma_f32_16x16x32_bf16 v[52:55], v[92:95], a[44:47], v[52:55]
    s_waitcnt lgkmcnt(6)
    s_add_u32 m0, s87, 32768
    s_add_u32 s60, s47, 1063936
    buffer_load_dwordx4 v252, s[96:99], s60 offen offset:1024 lds
    v_mfma_f32_16x16x32_bf16 v[56:59], v[96:99], a[40:43], v[56:59]
    ds_read_b128 v[92:95], v4 offset:5120
    v_mfma_f32_16x16x32_bf16 v[64:67], v[96:99], a[44:47], v[64:67]
    s_waitcnt lgkmcnt(6)
    s_add_u32 m0, s87, 114688
    s_nop 0
    buffer_load_dwordx4 v3, s[20:23], s29 offen offset:0 lds
    v_mfma_f32_16x16x32_bf16 v[60:63], v[100:103], a[40:43], v[60:63]
    ds_read_b128 v[96:99], v4 offset:6144
    v_mfma_f32_16x16x32_bf16 v[68:71], v[100:103], a[44:47], v[68:71]
    s_waitcnt lgkmcnt(6)
    s_waitcnt vmcnt(27)
    buffer_load_dwordx4 a[92:95], v243, s[8:11], s28 offen offset:256 sc1
    v_mfma_f32_16x16x32_bf16 v[8:11], v[72:75], a[48:51], v[8:11]
    ds_read_b128 v[100:103], v4 offset:7168
    v_mfma_f32_16x16x32_bf16 v[16:19], v[72:75], a[52:55], v[16:19]
    s_waitcnt lgkmcnt(6)
    v_mfma_f32_16x16x32_bf16 v[12:15], v[76:79], a[48:51], v[12:15]
    ds_read_b128 v[72:75], v4 offset:8192
    v_mfma_f32_16x16x32_bf16 v[20:23], v[76:79], a[52:55], v[20:23]
    s_waitcnt lgkmcnt(6)
    s_add_u32 m0, s87, 32768
    s_add_u32 s60, s47, 1079296
    buffer_load_dwordx4 v252, s[96:99], s60 offen offset:2048 lds
    v_mfma_f32_16x16x32_bf16 v[24:27], v[80:83], a[48:51], v[24:27]
    ds_read_b128 v[76:79], v4 offset:9216
    v_mfma_f32_16x16x32_bf16 v[32:35], v[80:83], a[52:55], v[32:35]
    s_waitcnt lgkmcnt(6)
    v_mfma_f32_16x16x32_bf16 v[28:31], v[84:87], a[48:51], v[28:31]
    ds_read_b128 v[80:83], v4 offset:10240
    v_mfma_f32_16x16x32_bf16 v[36:39], v[84:87], a[52:55], v[36:39]
    s_waitcnt lgkmcnt(6)
    s_add_u32 m0, s87, 114688
    s_nop 0
    buffer_load_dwordx4 v3, s[20:23], s29 offen offset:1024 lds
    buffer_load_dwordx4 a[96:99], v243, s[8:11], s28 offen offset:2048 sc1
    v_mfma_f32_16x16x32_bf16 v[40:43], v[88:91], a[48:51], v[40:43]
    ds_read_b128 v[84:87], v4 offset:11264
    v_mfma_f32_16x16x32_bf16 v[48:51], v[88:91], a[52:55], v[48:51]
    s_waitcnt lgkmcnt(6)
    v_mfma_f32_16x16x32_bf16 v[44:47], v[92:95], a[48:51], v[44:47]
    ds_read_b128 v[88:91], v4 offset:12288
    v_mfma_f32_16x16x32_bf16 v[52:55], v[92:95], a[52:55], v[52:55]
    s_waitcnt lgkmcnt(6)
    s_add_u32 m0, s87, 32768
    s_add_u32 s60, s47, 1094656
    buffer_load_dwordx4 v252, s[96:99], s60 offen offset:3072 lds
    v_mfma_f32_16x16x32_bf16 v[56:59], v[96:99], a[48:51], v[56:59]
    ds_read_b128 v[92:95], v4 offset:13312
    v_mfma_f32_16x16x32_bf16 v[64:67], v[96:99], a[52:55], v[64:67]
    s_waitcnt lgkmcnt(6)
    v_mfma_f32_16x16x32_bf16 v[60:63], v[100:103], a[48:51], v[60:63]
    ds_read_b128 v[96:99], v4 offset:14336
    v_mfma_f32_16x16x32_bf16 v[68:71], v[100:103], a[52:55], v[68:71]
    s_waitcnt lgkmcnt(6)
    s_waitcnt vmcnt(26)
    buffer_load_dwordx4 a[100:103], v243, s[8:11], s28 offen offset:2304 sc1
    s_add_u32 s28, s28, 4096
    v_mfma_f32_16x16x32_bf16 v[8:11], v[72:75], a[56:59], v[8:11]
    ds_read_b128 v[100:103], v4 offset:15360
    v_mfma_f32_16x16x32_bf16 v[16:19], v[72:75], a[60:63], v[16:19]
    s_waitcnt lgkmcnt(6)
    s_add_u32 m0, s87, 114688
    s_nop 0
    buffer_load_dwordx4 v3, s[20:23], s29 offen offset:2048 lds
    s_waitcnt vmcnt(26)
    s_barrier
    v_mfma_f32_16x16x32_bf16 v[12:15], v[76:79], a[56:59], v[12:15]
    ds_read_b128 v[72:75], v4 offset:16384
    v_mfma_f32_16x16x32_bf16 v[20:23], v[76:79], a[60:63], v[20:23]
    s_waitcnt lgkmcnt(6)
    s_add_u32 m0, s87, 49152
    s_add_u32 s60, s47, 1310720
    buffer_load_dwordx4 v252, s[96:99], s60 offen offset:0 lds
    v_mfma_f32_16x16x32_bf16 v[24:27], v[80:83], a[56:59], v[24:27]
    ds_read_b128 v[76:79], v4 offset:17408
    v_mfma_f32_16x16x32_bf16 v[32:35], v[80:83], a[60:63], v[32:35]
    s_waitcnt lgkmcnt(6)
    v_mfma_f32_16x16x32_bf16 v[28:31], v[84:87], a[56:59], v[28:31]
    ds_read_b128 v[80:83], v4 offset:18432
    v_mfma_f32_16x16x32_bf16 v[36:39], v[84:87], a[60:63], v[36:39]
    s_waitcnt lgkmcnt(6)
    buffer_load_dwordx4 a[104:107], v243, s[8:11], s28 offen offset:0 sc1
    v_mfma_f32_16x16x32_bf16 v[40:43], v[88:91], a[56:59], v[40:43]
    ds_read_b128 v[84:87], v4 offset:19456
    v_mfma_f32_16x16x32_bf16 v[48:51], v[88:91], a[60:63], v[48:51]
    s_waitcnt lgkmcnt(6)
    v_mfma_f32_16x16x32_bf16 v[44:47], v[92:95], a[56:59], v[44:47]
    ds_read_b128 v[88:91], v4 offset:20480
    v_mfma_f32_16x16x32_bf16 v[52:55], v[92:95], a[60:63], v[52:55]
    s_waitcnt lgkmcnt(6)
    s_add_u32 m0, s87, 114688
    s_nop 0
    buffer_load_dwordx4 v3, s[20:23], s29 offen offset:3072 lds
    s_add_u32 s29, s29, 16384
    v_mfma_f32_16x16x32_bf16 v[56:59], v[96:99], a[56:59], v[56:59]
    ds_read_b128 v[92:95], v4 offset:21504
    v_mfma_f32_16x16x32_bf16 v[64:67], v[96:99], a[60:63], v[64:67]
    s_waitcnt lgkmcnt(6)
    s_add_u32 m0, s87, 49152
    s_add_u32 s60, s47, 1326080
    buffer_load_dwordx4 v252, s[96:99], s60 offen offset:1024 lds
    v_mfma_f32_16x16x32_bf16 v[60:63], v[100:103], a[56:59], v[60:63]
    ds_read_b128 v[96:99], v4 offset:22528
    v_mfma_f32_16x16x32_bf16 v[68:71], v[100:103], a[60:63], v[68:71]
    s_waitcnt lgkmcnt(6)
    s_waitcnt vmcnt(27)
    buffer_load_dwordx4 a[108:111], v243, s[8:11], s28 offen offset:256 sc1
    v_mfma_f32_16x16x32_bf16 v[8:11], v[72:75], a[64:67], v[8:11]
    ds_read_b128 v[100:103], v4 offset:23552
    v_mfma_f32_16x16x32_bf16 v[16:19], v[72:75], a[68:71], v[16:19]
    s_waitcnt lgkmcnt(6)
    v_mfma_f32_16x16x32_bf16 v[12:15], v[76:79], a[64:67], v[12:15]
    ds_read_b128 v[72:75], v4 offset:24576
    v_mfma_f32_16x16x32_bf16 v[20:23], v[76:79], a[68:71], v[20:23]
    s_waitcnt lgkmcnt(6)
    s_add_u32 m0, s87, 49152
    s_add_u32 s60, s47, 1341440
    buffer_load_dwordx4 v252, s[96:99], s60 offen offset:2048 lds
    v_mfma_f32_16x16x32_bf16 v[24:27], v[80:83], a[64:67], v[24:27]
    ds_read_b128 v[76:79], v4 offset:25600
    v_mfma_f32_16x16x32_bf16 v[32:35], v[80:83], a[68:71], v[32:35]
    s_waitcnt lgkmcnt(6)
    v_mfma_f32_16x16x32_bf16 v[28:31], v[84:87], a[64:67], v[28:31]
    ds_read_b128 v[80:83], v4 offset:26624
    v_mfma_f32_16x16x32_bf16 v[36:39], v[84:87], a[68:71], v[36:39]
    s_waitcnt lgkmcnt(6)
    buffer_load_dwordx4 a[0:3], v243, s[20:23], s93 offen offset:0 sc1
    v_mfma_f32_16x16x32_bf16 v[40:43], v[88:91], a[64:67], v[40:43]
    ds_read_b128 v[84:87], v4 offset:27648
    v_mfma_f32_16x16x32_bf16 v[48:51], v[88:91], a[68:71], v[48:51]
    s_waitcnt lgkmcnt(6)
    s_cmp_lg_u32 s42, 0
    s_cselect_b32 s88, s90, 2146435072
    s_cselect_b32 s89, s91, 2146435072
    buffer_load_dwordx4 v[132:135], v243, s[20:23], s89 offen offset:2304 sc1
    v_mfma_f32_16x16x32_bf16 v[44:47], v[92:95], a[64:67], v[44:47]
    ds_read_b128 v[88:91], v4 offset:28672
    v_mfma_f32_16x16x32_bf16 v[52:55], v[92:95], a[68:71], v[52:55]
    s_waitcnt lgkmcnt(6)
    s_add_u32 m0, s87, 49152
    s_add_u32 s60, s47, 1356800
    buffer_load_dwordx4 v252, s[96:99], s60 offen offset:3072 lds
    v_mfma_f32_16x16x32_bf16 v[56:59], v[96:99], a[64:67], v[56:59]
    ds_read_b128 v[92:95], v4 offset:29696
    v_mfma_f32_16x16x32_bf16 v[64:67], v[96:99], a[68:71], v[64:67]
    s_waitcnt lgkmcnt(6)
    v_mfma_f32_16x16x32_bf16 v[60:63], v[100:103], a[64:67], v[60:63]
    ds_read_b128 v[96:99], v4 offset:30720
    v_mfma_f32_16x16x32_bf16 v[68:71], v[100:103], a[68:71], v[68:71]
    s_waitcnt lgkmcnt(6)
    s_waitcnt vmcnt(26)
    buffer_load_dwordx4 a[4:7], v243, s[20:23], s93 offen offset:256 sc1
    v_mfma_f32_16x16x32_bf16 v[8:11], v[72:75], a[72:75], v[8:11]
    ds_read_b128 v[100:103], v4 offset:31744
    v_mfma_f32_16x16x32_bf16 v[16:19], v[72:75], a[76:79], v[16:19]
    s_waitcnt lgkmcnt(6)
    s_waitcnt vmcnt(21)
    s_barrier
    v_mfma_f32_16x16x32_bf16 v[12:15], v[76:79], a[72:75], v[12:15]
    ds_read_b128 v[72:75], v4 offset:32768
    v_mfma_f32_16x16x32_bf16 v[20:23], v[76:79], a[76:79], v[20:23]
    s_waitcnt lgkmcnt(6)
    v_mfma_f32_16x16x32_bf16 v[24:27], v[80:83], a[72:75], v[24:27]
    ds_read_b128 v[76:79], v4 offset:33792
    v_mfma_f32_16x16x32_bf16 v[32:35], v[80:83], a[76:79], v[32:35]
    s_waitcnt lgkmcnt(6)
    v_mfma_f32_16x16x32_bf16 v[28:31], v[84:87], a[72:75], v[28:31]
    ds_read_b128 v[80:83], v4 offset:34816
    v_mfma_f32_16x16x32_bf16 v[36:39], v[84:87], a[76:79], v[36:39]
    s_waitcnt lgkmcnt(6)
    buffer_load_dwordx4 a[8:11], v243, s[20:23], s93 offen offset:2048 sc1
    v_mfma_f32_16x16x32_bf16 v[40:43], v[88:91], a[72:75], v[40:43]
    ds_read_b128 v[84:87], v4 offset:35840
    v_mfma_f32_16x16x32_bf16 v[48:51], v[88:91], a[76:79], v[48:51]
    s_waitcnt lgkmcnt(6)
    v_mfma_f32_16x16x32_bf16 v[44:47], v[92:95], a[72:75], v[44:47]
    ds_read_b128 v[88:91], v4 offset:36864
    v_mfma_f32_16x16x32_bf16 v[52:55], v[92:95], a[76:79], v[52:55]
    s_waitcnt lgkmcnt(6)
    v_mfma_f32_16x16x32_bf16 v[56:59], v[96:99], a[72:75], v[56:59]
    ds_read_b128 v[92:95], v4 offset:37888
    v_mfma_f32_16x16x32_bf16 v[64:67], v[96:99], a[76:79], v[64:67]
    s_waitcnt lgkmcnt(6)
    v_mfma_f32_16x16x32_bf16 v[60:63], v[100:103], a[72:75], v[60:63]
    ds_read_b128 v[96:99], v4 offset:38912
    v_mfma_f32_16x16x32_bf16 v[68:71], v[100:103], a[76:79], v[68:71]
    s_waitcnt lgkmcnt(6)
    s_waitcnt vmcnt(23)
    buffer_load_dwordx4 a[12:15], v243, s[20:23], s93 offen offset:2304 sc1
    s_add_u32 s93, s93, 4096
    v_mfma_f32_16x16x32_bf16 v[8:11], v[72:75], a[80:83], v[8:11]
    ds_read_b128 v[100:103], v4 offset:39936
    v_mfma_f32_16x16x32_bf16 v[16:19], v[72:75], a[84:87], v[16:19]
    s_waitcnt lgkmcnt(6)
    v_mfma_f32_16x16x32_bf16 v[12:15], v[76:79], a[80:83], v[12:15]
    ds_read_b128 v[72:75], v4 offset:40960
    v_mfma_f32_16x16x32_bf16 v[20:23], v[76:79], a[84:87], v[20:23]
    s_waitcnt lgkmcnt(6)
    v_mfma_f32_16x16x32_bf16 v[24:27], v[80:83], a[80:83], v[24:27]
    ds_read_b128 v[76:79], v4 offset:41984
    v_mfma_f32_16x16x32_bf16 v[32:35], v[80:83], a[84:87], v[32:35]
    s_waitcnt lgkmcnt(6)
    v_mfma_f32_16x16x32_bf16 v[28:31], v[84:87], a[80:83], v[28:31]
    ds_read_b128 v[80:83], v4 offset:43008
    v_mfma_f32_16x16x32_bf16 v[36:39], v[84:87], a[84:87], v[36:39]
    s_waitcnt lgkmcnt(6)
    v_mfma_f32_16x16x32_bf16 v[40:43], v[88:91], a[80:83], v[40:43]
    ds_read_b128 v[84:87], v4 offset:44032
    v_mfma_f32_16x16x32_bf16 v[48:51], v[88:91], a[84:87], v[48:51]
    s_waitcnt lgkmcnt(6)
    v_mfma_f32_16x16x32_bf16 v[44:47], v[92:95], a[80:83], v[44:47]
    ds_read_b128 v[88:91], v4 offset:45056
    v_mfma_f32_16x16x32_bf16 v[52:55], v[92:95], a[84:87], v[52:55]
    s_waitcnt lgkmcnt(6)
    v_mfma_f32_16x16x32_bf16 v[56:59], v[96:99], a[80:83], v[56:59]
    ds_read_b128 v[92:95], v4 offset:46080
    v_mfma_f32_16x16x32_bf16 v[64:67], v[96:99], a[84:87], v[64:67]
    s_waitcnt lgkmcnt(6)
    v_mfma_f32_16x16x32_bf16 v[60:63], v[100:103], a[80:83], v[60:63]
    ds_read_b128 v[96:99], v4 offset:47104
    v_mfma_f32_16x16x32_bf16 v[68:71], v[100:103], a[84:87], v[68:71]
    s_waitcnt lgkmcnt(6)
    s_waitcnt vmcnt(18)
    v_mfma_f32_16x16x32_bf16 v[8:11], v[72:75], a[88:91], v[8:11]
    ds_read_b128 v[100:103], v4 offset:48128
    v_mfma_f32_16x16x32_bf16 v[16:19], v[72:75], a[92:95], v[16:19]
    s_waitcnt lgkmcnt(6)
    s_waitcnt vmcnt(9)
    s_barrier
    v_mfma_f32_16x16x32_bf16 v[12:15], v[76:79], a[88:91], v[12:15]
    ds_read_b128 v[72:75], v4 offset:49152
    v_mfma_f32_16x16x32_bf16 v[20:23], v[76:79], a[92:95], v[20:23]
    s_waitcnt lgkmcnt(6)
    v_mfma_f32_16x16x32_bf16 v[24:27], v[80:83], a[88:91], v[24:27]
    ds_read_b128 v[76:79], v4 offset:50176
    v_mfma_f32_16x16x32_bf16 v[32:35], v[80:83], a[92:95], v[32:35]
    s_waitcnt lgkmcnt(6)
    v_mfma_f32_16x16x32_bf16 v[28:31], v[84:87], a[88:91], v[28:31]
    ds_read_b128 v[80:83], v4 offset:51200
    v_mfma_f32_16x16x32_bf16 v[36:39], v[84:87], a[92:95], v[36:39]
    s_waitcnt lgkmcnt(6)
    v_mfma_f32_16x16x32_bf16 v[40:43], v[88:91], a[88:91], v[40:43]
    ds_read_b128 v[84:87], v4 offset:52224
    v_mfma_f32_16x16x32_bf16 v[48:51], v[88:91], a[92:95], v[48:51]
    s_waitcnt lgkmcnt(6)
    v_mfma_f32_16x16x32_bf16 v[44:47], v[92:95], a[88:91], v[44:47]
    ds_read_b128 v[88:91], v4 offset:53248
    v_mfma_f32_16x16x32_bf16 v[52:55], v[92:95], a[92:95], v[52:55]
    s_waitcnt lgkmcnt(6)
    v_mfma_f32_16x16x32_bf16 v[56:59], v[96:99], a[88:91], v[56:59]
    ds_read_b128 v[92:95], v4 offset:54272
    v_mfma_f32_16x16x32_bf16 v[64:67], v[96:99], a[92:95], v[64:67]
    s_waitcnt lgkmcnt(6)
    v_mfma_f32_16x16x32_bf16 v[60:63], v[100:103], a[88:91], v[60:63]
    ds_read_b128 v[96:99], v4 offset:55296
    v_mfma_f32_16x16x32_bf16 v[68:71], v[100:103], a[92:95], v[68:71]
    s_waitcnt lgkmcnt(6)
    s_waitcnt vmcnt(13)
    v_mfma_f32_16x16x32_bf16 v[8:11], v[72:75], a[96:99], v[8:11]
    ds_read_b128 v[100:103], v4 offset:56320
    v_mfma_f32_16x16x32_bf16 v[16:19], v[72:75], a[100:103], v[16:19]
    s_waitcnt lgkmcnt(6)
    v_mfma_f32_16x16x32_bf16 v[12:15], v[76:79], a[96:99], v[12:15]
    ds_read_b128 v[72:75], v4 offset:57344
    v_mfma_f32_16x16x32_bf16 v[20:23], v[76:79], a[100:103], v[20:23]
    s_waitcnt lgkmcnt(6)
    v_mfma_f32_16x16x32_bf16 v[24:27], v[80:83], a[96:99], v[24:27]
    ds_read_b128 v[76:79], v4 offset:58368
    v_mfma_f32_16x16x32_bf16 v[32:35], v[80:83], a[100:103], v[32:35]
    s_waitcnt lgkmcnt(6)
    s_waitcnt vmcnt(4)
    v_max3_u32 v5, v132, v133, v134
    v_max_u32 v5, v5, v135
    v_cmp_eq_u32 vcc, -1, v5
    s_cmp_lg_u64 vcc, 0
    s_cselect_b32 s88, 2146435072, s88
    s_cselect_b32 s89, 2146435072, s89
    v_mfma_f32_16x16x32_bf16 v[28:31], v[84:87], a[96:99], v[28:31]
    ds_read_b128 v[80:83], v4 offset:59392
    v_mfma_f32_16x16x32_bf16 v[36:39], v[84:87], a[100:103], v[36:39]
    s_waitcnt lgkmcnt(6)
    v_mfma_f32_16x16x32_bf16 v[40:43], v[88:91], a[96:99], v[40:43]
    ds_read_b128 v[84:87], v4 offset:60416
    v_mfma_f32_16x16x32_bf16 v[48:51], v[88:91], a[100:103], v[48:51]
    s_waitcnt lgkmcnt(6)
    buffer_load_dwordx4 v[104:107], v243, s[20:23], s88 offen offset:0 sc1
    v_mfma_f32_16x16x32_bf16 v[44:47], v[92:95], a[96:99], v[44:47]
    ds_read_b128 v[88:91], v4 offset:61440
    v_mfma_f32_16x16x32_bf16 v[52:55], v[92:95], a[100:103], v[52:55]
    s_waitcnt lgkmcnt(6)
    v_mfma_f32_16x16x32_bf16 v[56:59], v[96:99], a[96:99], v[56:59]
    ds_read_b128 v[92:95], v4 offset:62464
    v_mfma_f32_16x16x32_bf16 v[64:67], v[96:99], a[100:103], v[64:67]
    s_waitcnt lgkmcnt(6)
    buffer_load_dwordx4 v[108:111], v243, s[20:23], s88 offen offset:256 sc1
    v_mfma_f32_16x16x32_bf16 v[60:63], v[100:103], a[96:99], v[60:63]
    ds_read_b128 v[96:99], v4 offset:63488
    v_mfma_f32_16x16x32_bf16 v[68:71], v[100:103], a[100:103], v[68:71]
    s_waitcnt lgkmcnt(6)
    s_waitcnt vmcnt(9)
    v_mfma_f32_16x16x32_bf16 v[8:11], v[72:75], a[104:107], v[8:11]
    ds_read_b128 v[100:103], v4 offset:64512
    v_mfma_f32_16x16x32_bf16 v[16:19], v[72:75], a[108:111], v[16:19]
    s_waitcnt lgkmcnt(6)
    buffer_load_dwordx4 v[112:115], v243, s[20:23], s88 offen offset:2048 sc1
    s_waitcnt vmcnt(52)
    s_barrier
    v_mfma_f32_16x16x32_bf16 v[12:15], v[76:79], a[104:107], v[12:15]
    ds_read_b128 v[72:75], v242 offset:0
    v_mfma_f32_16x16x32_bf16 v[20:23], v[76:79], a[108:111], v[20:23]
    s_waitcnt lgkmcnt(6)
    v_mfma_f32_16x16x32_bf16 v[24:27], v[80:83], a[104:107], v[24:27]
    ds_read_b128 v[76:79], v242 offset:1024
    v_mfma_f32_16x16x32_bf16 v[32:35], v[80:83], a[108:111], v[32:35]
    s_waitcnt lgkmcnt(6)
    buffer_load_dwordx4 v[116:119], v243, s[20:23], s88 offen offset:2304 sc1
    v_mfma_f32_16x16x32_bf16 v[28:31], v[84:87], a[104:107], v[28:31]
    ds_read_b128 v[80:83], v242 offset:2048
    v_mfma_f32_16x16x32_bf16 v[36:39], v[84:87], a[108:111], v[36:39]
    s_waitcnt lgkmcnt(6)
    v_mfma_f32_16x16x32_bf16 v[40:43], v[88:91], a[104:107], v[40:43]
    ds_read_b128 v[84:87], v242 offset:3072
    v_mfma_f32_16x16x32_bf16 v[48:51], v[88:91], a[108:111], v[48:51]
    s_waitcnt lgkmcnt(6)
    buffer_load_dwordx4 v[120:123], v243, s[20:23], s89 offen offset:0 sc1
    v_mfma_f32_16x16x32_bf16 v[44:47], v[92:95], a[104:107], v[44:47]
    ds_read_b128 v[88:91], v242 offset:4096
    v_mfma_f32_16x16x32_bf16 v[52:55], v[92:95], a[108:111], v[52:55]
    s_waitcnt lgkmcnt(6)
    v_mfma_f32_16x16x32_bf16 v[56:59], v[96:99], a[104:107], v[56:59]
    ds_read_b128 v[92:95], v242 offset:5120
    v_mfma_f32_16x16x32_bf16 v[64:67], v[96:99], a[108:111], v[64:67]
    s_waitcnt lgkmcnt(6)
    buffer_load_dwordx4 v[124:127], v243, s[20:23], s89 offen offset:256 sc1
    v_mfma_f32_16x16x32_bf16 v[60:63], v[100:103], a[104:107], v[60:63]
    ds_read_b128 v[96:99], v242 offset:6144
    v_mfma_f32_16x16x32_bf16 v[68:71], v[100:103], a[108:111], v[68:71]
    s_waitcnt lgkmcnt(6)
    s_waitcnt vmcnt(8)
    v_mfma_f32_16x16x32_bf16 v[8:11], v[72:75], a[0:3], v[8:11]
    ds_read_b128 v[100:103], v242 offset:7168
    v_mfma_f32_16x16x32_bf16 v[16:19], v[72:75], a[4:7], v[16:19]
    s_waitcnt lgkmcnt(6)
    buffer_load_dwordx4 v[128:131], v243, s[20:23], s89 offen offset:2048 sc1
    v_mfma_f32_16x16x32_bf16 v[12:15], v[76:79], a[0:3], v[12:15]
    ds_read_b128 v[72:75], v242 offset:8192
    v_mfma_f32_16x16x32_bf16 v[20:23], v[76:79], a[4:7], v[20:23]
    s_waitcnt lgkmcnt(6)
    v_mfma_f32_16x16x32_bf16 v[24:27], v[80:83], a[0:3], v[24:27]
    ds_read_b128 v[76:79], v242 offset:9216
    v_mfma_f32_16x16x32_bf16 v[32:35], v[80:83], a[4:7], v[32:35]
    s_waitcnt lgkmcnt(6)
    v_mfma_f32_16x16x32_bf16 v[28:31], v[84:87], a[0:3], v[28:31]
    ds_read_b128 v[80:83], v242 offset:10240
    v_mfma_f32_16x16x32_bf16 v[36:39], v[84:87], a[4:7], v[36:39]
    s_waitcnt lgkmcnt(6)
    v_mfma_f32_16x16x32_bf16 v[40:43], v[88:91], a[0:3], v[40:43]
    ds_read_b128 v[84:87], v242 offset:11264
    v_mfma_f32_16x16x32_bf16 v[48:51], v[88:91], a[4:7], v[48:51]
    s_waitcnt lgkmcnt(6)
    v_mfma_f32_16x16x32_bf16 v[44:47], v[92:95], a[0:3], v[44:47]
    ds_read_b128 v[88:91], v242 offset:12288
    v_mfma_f32_16x16x32_bf16 v[52:55], v[92:95], a[4:7], v[52:55]
    s_waitcnt lgkmcnt(6)
    v_mfma_f32_16x16x32_bf16 v[56:59], v[96:99], a[0:3], v[56:59]
    ds_read_b128 v[92:95], v242 offset:13312
    v_mfma_f32_16x16x32_bf16 v[64:67], v[96:99], a[4:7], v[64:67]
    s_waitcnt lgkmcnt(6)
    v_mfma_f32_16x16x32_bf16 v[60:63], v[100:103], a[0:3], v[60:63]
    ds_read_b128 v[96:99], v242 offset:14336
    v_mfma_f32_16x16x32_bf16 v[68:71], v[100:103], a[4:7], v[68:71]
    s_waitcnt lgkmcnt(6)
    s_waitcnt vmcnt(7)
    v_mfma_f32_16x16x32_bf16 v[8:11], v[72:75], a[8:11], v[8:11]
    ds_read_b128 v[100:103], v242 offset:15360
    v_mfma_f32_16x16x32_bf16 v[16:19], v[72:75], a[12:15], v[16:19]
    s_waitcnt lgkmcnt(6)
    v_mfma_f32_16x16x32_bf16 v[12:15], v[76:79], a[8:11], v[12:15]
    v_mfma_f32_16x16x32_bf16 v[20:23], v[76:79], a[12:15], v[20:23]
    s_waitcnt lgkmcnt(5)
    v_mfma_f32_16x16x32_bf16 v[24:27], v[80:83], a[8:11], v[24:27]
    v_mfma_f32_16x16x32_bf16 v[32:35], v[80:83], a[12:15], v[32:35]
    s_waitcnt lgkmcnt(4)
    v_mfma_f32_16x16x32_bf16 v[28:31], v[84:87], a[8:11], v[28:31]
    v_mfma_f32_16x16x32_bf16 v[36:39], v[84:87], a[12:15], v[36:39]
    s_waitcnt lgkmcnt(3)
    v_mfma_f32_16x16x32_bf16 v[40:43], v[88:91], a[8:11], v[40:43]
    v_mfma_f32_16x16x32_bf16 v[48:51], v[88:91], a[12:15], v[48:51]
    s_waitcnt lgkmcnt(2)
    v_mfma_f32_16x16x32_bf16 v[44:47], v[92:95], a[8:11], v[44:47]
    v_mfma_f32_16x16x32_bf16 v[52:55], v[92:95], a[12:15], v[52:55]
    s_waitcnt lgkmcnt(1)
    v_mfma_f32_16x16x32_bf16 v[56:59], v[96:99], a[8:11], v[56:59]
    v_mfma_f32_16x16x32_bf16 v[64:67], v[96:99], a[12:15], v[64:67]
    s_waitcnt lgkmcnt(0)
    v_mfma_f32_16x16x32_bf16 v[60:63], v[100:103], a[8:11], v[60:63]
    v_mfma_f32_16x16x32_bf16 v[68:71], v[100:103], a[12:15], v[68:71]
    s_branch L_main_kernel_f2j_1061
L_main_kernel_f2l1_1060:
    v_mfma_f32_16x16x32_bf16 v[8:11], v[72:75], a[88:91], v[8:11]
    ds_read_b128 v[100:103], v242 offset:31744
    v_mfma_f32_16x16x32_bf16 v[16:19], v[72:75], a[92:95], v[16:19]
    s_waitcnt lgkmcnt(6)
    s_waitcnt vmcnt(27)
    s_barrier
    v_mfma_f32_16x16x32_bf16 v[12:15], v[76:79], a[88:91], v[12:15]
    ds_read_b128 v[72:75], v3 offset:0
    v_mfma_f32_16x16x32_bf16 v[20:23], v[76:79], a[92:95], v[20:23]
    s_waitcnt lgkmcnt(6)
    s_add_u32 m0, s87, 49152
    s_nop 0
    buffer_load_dwordx4 v3, s[20:23], s29 offen offset:3072 lds
    s_add_u32 s29, s29, 16384
    v_mfma_f32_16x16x32_bf16 v[24:27], v[80:83], a[88:91], v[24:27]
    ds_read_b128 v[76:79], v3 offset:1024
    v_mfma_f32_16x16x32_bf16 v[32:35], v[80:83], a[92:95], v[32:35]
    s_waitcnt lgkmcnt(6)
    v_mfma_f32_16x16x32_bf16 v[28:31], v[84:87], a[88:91], v[28:31]
    ds_read_b128 v[80:83], v3 offset:2048
    v_mfma_f32_16x16x32_bf16 v[36:39], v[84:87], a[92:95], v[36:39]
    s_waitcnt lgkmcnt(6)
    buffer_load_dwordx4 a[24:27], v243, s[8:11], s28 offen offset:0 sc1
    v_mfma_f32_16x16x32_bf16 v[40:43], v[88:91], a[88:91], v[40:43]
    ds_read_b128 v[84:87], v3 offset:3072
    v_mfma_f32_16x16x32_bf16 v[48:51], v[88:91], a[92:95], v[48:51]
    s_waitcnt lgkmcnt(6)
    v_mfma_f32_16x16x32_bf16 v[44:47], v[92:95], a[88:91], v[44:47]
    ds_read_b128 v[88:91], v3 offset:4096
    v_mfma_f32_16x16x32_bf16 v[52:55], v[92:95], a[92:95], v[52:55]
    s_waitcnt lgkmcnt(6)
    v_mfma_f32_16x16x32_bf16 v[56:59], v[96:99], a[88:91], v[56:59]
    ds_read_b128 v[92:95], v3 offset:5120
    v_mfma_f32_16x16x32_bf16 v[64:67], v[96:99], a[92:95], v[64:67]
    s_waitcnt lgkmcnt(6)
    v_mfma_f32_16x16x32_bf16 v[60:63], v[100:103], a[88:91], v[60:63]
    ds_read_b128 v[96:99], v3 offset:6144
    v_mfma_f32_16x16x32_bf16 v[68:71], v[100:103], a[92:95], v[68:71]
    s_waitcnt lgkmcnt(6)
    s_waitcnt vmcnt(16)
    s_add_u32 m0, s87, 65536
    s_nop 0
    buffer_load_dwordx4 v3, s[20:23], s29 offen offset:0 lds
    buffer_load_dwordx4 a[28:31], v243, s[8:11], s28 offen offset:256 sc1
    v_mfma_f32_16x16x32_bf16 v[8:11], v[72:75], a[96:99], v[8:11]
    ds_read_b128 v[100:103], v3 offset:7168
    v_mfma_f32_16x16x32_bf16 v[16:19], v[72:75], a[100:103], v[16:19]
    s_waitcnt lgkmcnt(6)
    v_mfma_f32_16x16x32_bf16 v[12:15], v[76:79], a[96:99], v[12:15]
    ds_read_b128 v[72:75], v3 offset:8192
    v_mfma_f32_16x16x32_bf16 v[20:23], v[76:79], a[100:103], v[20:23]
    s_waitcnt lgkmcnt(6)
    v_mfma_f32_16x16x32_bf16 v[24:27], v[80:83], a[96:99], v[24:27]
    ds_read_b128 v[76:79], v3 offset:9216
    v_mfma_f32_16x16x32_bf16 v[32:35], v[80:83], a[100:103], v[32:35]
    s_waitcnt lgkmcnt(6)
    s_add_u32 m0, s87, 131072
    s_add_u32 s60, s92, 0
    buffer_load_dwordx4 v3, s[20:23], s60 offen offset:0 lds
    v_mfma_f32_16x16x32_bf16 v[28:31], v[84:87], a[96:99], v[28:31]
    ds_read_b128 v[80:83], v3 offset:10240
    v_mfma_f32_16x16x32_bf16 v[36:39], v[84:87], a[100:103], v[36:39]
    s_waitcnt lgkmcnt(6)
    s_cmp_le_u32 s76, 5
    s_addc_u32 s28, s45, 5
    s_and_b32 s28, s28, 7
    s_mul_i32 s28, s28, 14336
    s_add_u32 s28, s28, 4096
    buffer_load_dwordx4 a[32:35], v243, s[8:11], s28 offen offset:0 sc1
    v_mfma_f32_16x16x32_bf16 v[40:43], v[88:91], a[96:99], v[40:43]
    ds_read_b128 v[84:87], v3 offset:11264
    v_mfma_f32_16x16x32_bf16 v[48:51], v[88:91], a[100:103], v[48:51]
    s_waitcnt lgkmcnt(6)
    s_add_u32 m0, s87, 65536
    s_nop 0
    buffer_load_dwordx4 v3, s[20:23], s29 offen offset:1024 lds
    v_mfma_f32_16x16x32_bf16 v[44:47], v[92:95], a[96:99], v[44:47]
    ds_read_b128 v[88:91], v3 offset:12288
    v_mfma_f32_16x16x32_bf16 v[52:55], v[92:95], a[100:103], v[52:55]
    s_waitcnt lgkmcnt(6)
    v_mfma_f32_16x16x32_bf16 v[56:59], v[96:99], a[96:99], v[56:59]
    ds_read_b128 v[92:95], v3 offset:13312
    v_mfma_f32_16x16x32_bf16 v[64:67], v[96:99], a[100:103], v[64:67]
    s_waitcnt lgkmcnt(6)
    v_mfma_f32_16x16x32_bf16 v[60:63], v[100:103], a[96:99], v[60:63]
    ds_read_b128 v[96:99], v3 offset:14336
    v_mfma_f32_16x16x32_bf16 v[68:71], v[100:103], a[100:103], v[68:71]
    s_waitcnt lgkmcnt(6)
    s_waitcnt vmcnt(17)
    buffer_load_dwordx4 a[36:39], v243, s[8:11], s28 offen offset:256 sc1
    v_mfma_f32_16x16x32_bf16 v[8:11], v[72:75], a[104:107], v[8:11]
    ds_read_b128 v[100:103], v3 offset:15360
    v_mfma_f32_16x16x32_bf16 v[16:19], v[72:75], a[108:111], v[16:19]
    s_waitcnt lgkmcnt(6)
    s_add_u32 m0, s87, 131072
    s_add_u32 s60, s92, 0
    buffer_load_dwordx4 v3, s[20:23], s60 offen offset:1024 lds
    s_waitcnt vmcnt(27)
    s_barrier
    v_mfma_f32_16x16x32_bf16 v[12:15], v[76:79], a[104:107], v[12:15]
    ds_read_b128 v[72:75], v3 offset:16384
    v_mfma_f32_16x16x32_bf16 v[20:23], v[76:79], a[108:111], v[20:23]
    s_waitcnt lgkmcnt(6)
    s_add_u32 m0, s87, 65536
    s_nop 0
    buffer_load_dwordx4 v3, s[20:23], s29 offen offset:2048 lds
    v_mfma_f32_16x16x32_bf16 v[24:27], v[80:83], a[104:107], v[24:27]
    ds_read_b128 v[76:79], v3 offset:17408
    v_mfma_f32_16x16x32_bf16 v[32:35], v[80:83], a[108:111], v[32:35]
    s_waitcnt lgkmcnt(6)
    v_mfma_f32_16x16x32_bf16 v[28:31], v[84:87], a[104:107], v[28:31]
    ds_read_b128 v[80:83], v3 offset:18432
    v_mfma_f32_16x16x32_bf16 v[36:39], v[84:87], a[108:111], v[36:39]
    s_waitcnt lgkmcnt(6)
    buffer_load_dwordx4 a[40:43], v243, s[8:11], s28 offen offset:2048 sc1
    v_mfma_f32_16x16x32_bf16 v[40:43], v[88:91], a[104:107], v[40:43]
    ds_read_b128 v[84:87], v3 offset:19456
    v_mfma_f32_16x16x32_bf16 v[48:51], v[88:91], a[108:111], v[48:51]
    s_waitcnt lgkmcnt(6)
    v_mfma_f32_16x16x32_bf16 v[44:47], v[92:95], a[104:107], v[44:47]
    ds_read_b128 v[88:91], v3 offset:20480
    v_mfma_f32_16x16x32_bf16 v[52:55], v[92:95], a[108:111], v[52:55]
    s_waitcnt lgkmcnt(6)
    v_mfma_f32_16x16x32_bf16 v[56:59], v[96:99], a[104:107], v[56:59]
    ds_read_b128 v[92:95], v3 offset:21504
    v_mfma_f32_16x16x32_bf16 v[64:67], v[96:99], a[108:111], v[64:67]
    s_waitcnt lgkmcnt(6)
    s_add_u32 m0, s87, 131072
    s_add_u32 s60, s92, 0
    buffer_load_dwordx4 v3, s[20:23], s60 offen offset:2048 lds
    v_mfma_f32_16x16x32_bf16 v[60:63], v[100:103], a[104:107], v[60:63]
    ds_read_b128 v[96:99], v3 offset:22528
    v_mfma_f32_16x16x32_bf16 v[68:71], v[100:103], a[108:111], v[68:71]
    s_waitcnt lgkmcnt(6)
    s_waitcnt vmcnt(19)
    s_add_u32 m0, s87, 65536
    s_nop 0
    buffer_load_dwordx4 v3, s[20:23], s29 offen offset:3072 lds
    s_add_u32 s29, s29, 16384
    buffer_load_dwordx4 a[44:47], v243, s[8:11], s28 offen offset:2304 sc1
    s_add_u32 s28, s28, 4096
    v_mfma_f32_16x16x32_bf16 v[8:11], v[72:75], a[0:3], v[8:11]
    ds_read_b128 v[100:103], v3 offset:23552
    v_mfma_f32_16x16x32_bf16 v[16:19], v[72:75], a[4:7], v[16:19]
    s_waitcnt lgkmcnt(6)
    v_mfma_f32_16x16x32_bf16 v[12:15], v[76:79], a[0:3], v[12:15]
    ds_read_b128 v[72:75], v3 offset:24576
    v_mfma_f32_16x16x32_bf16 v[20:23], v[76:79], a[4:7], v[20:23]
    s_waitcnt lgkmcnt(6)
    v_mfma_f32_16x16x32_bf16 v[24:27], v[80:83], a[0:3], v[24:27]
    ds_read_b128 v[76:79], v3 offset:25600
    v_mfma_f32_16x16x32_bf16 v[32:35], v[80:83], a[4:7], v[32:35]
    s_waitcnt lgkmcnt(6)
    v_mfma_f32_16x16x32_bf16 v[28:31], v[84:87], a[0:3], v[28:31]
    ds_read_b128 v[80:83], v3 offset:26624
    v_mfma_f32_16x16x32_bf16 v[36:39], v[84:87], a[4:7], v[36:39]
    s_waitcnt lgkmcnt(6)
    buffer_load_dwordx4 a[48:51], v243, s[8:11], s28 offen offset:0 sc1
    v_mfma_f32_16x16x32_bf16 v[40:43], v[88:91], a[0:3], v[40:43]
    ds_read_b128 v[84:87], v3 offset:27648
    v_mfma_f32_16x16x32_bf16 v[48:51], v[88:91], a[4:7], v[48:51]
    s_waitcnt lgkmcnt(6)
    s_mov_b32 s35, 872448
    buffer_load_dwordx2 v[240:241], v235, s[16:19], s35 offen sc1
    s_add_u32 m0, s87, 131072
    s_add_u32 s60, s92, 0
    buffer_load_dwordx4 v3, s[20:23], s60 offen offset:3072 lds
    v_mfma_f32_16x16x32_bf16 v[44:47], v[92:95], a[0:3], v[44:47]
    ds_read_b128 v[88:91], v3 offset:28672
    v_mfma_f32_16x16x32_bf16 v[52:55], v[92:95], a[4:7], v[52:55]
    s_waitcnt lgkmcnt(6)
    s_add_u32 m0, s87, 81920
    s_nop 0
    buffer_load_dwordx4 v3, s[20:23], s29 offen offset:0 lds
    v_mfma_f32_16x16x32_bf16 v[56:59], v[96:99], a[0:3], v[56:59]
    ds_read_b128 v[92:95], v3 offset:29696
    v_mfma_f32_16x16x32_bf16 v[64:67], v[96:99], a[4:7], v[64:67]
    s_waitcnt lgkmcnt(6)
    v_mfma_f32_16x16x32_bf16 v[60:63], v[100:103], a[0:3], v[60:63]
    ds_read_b128 v[96:99], v3 offset:30720
    v_mfma_f32_16x16x32_bf16 v[68:71], v[100:103], a[4:7], v[68:71]
    s_waitcnt lgkmcnt(6)
    s_waitcnt vmcnt(21)
    buffer_load_dwordx4 a[52:55], v243, s[8:11], s28 offen offset:256 sc1
    v_mfma_f32_16x16x32_bf16 v[8:11], v[72:75], a[8:11], v[8:11]
    ds_read_b128 v[100:103], v3 offset:31744
    v_mfma_f32_16x16x32_bf16 v[16:19], v[72:75], a[12:15], v[16:19]
    s_waitcnt lgkmcnt(6)
    s_waitcnt vmcnt(27)
    s_barrier
    v_mfma_f32_16x16x32_bf16 v[12:15], v[76:79], a[8:11], v[12:15]
    ds_read_b128 v[72:75], v3 offset:32768
    v_mfma_f32_16x16x32_bf16 v[20:23], v[76:79], a[12:15], v[20:23]
    s_waitcnt lgkmcnt(6)
    s_add_u32 m0, s87, 81920
    s_nop 0
    buffer_load_dwordx4 v3, s[20:23], s29 offen offset:1024 lds
    v_mfma_f32_16x16x32_bf16 v[24:27], v[80:83], a[8:11], v[24:27]
    ds_read_b128 v[76:79], v3 offset:33792
    v_mfma_f32_16x16x32_bf16 v[32:35], v[80:83], a[12:15], v[32:35]
    s_waitcnt lgkmcnt(6)
    v_mfma_f32_16x16x32_bf16 v[28:31], v[84:87], a[8:11], v[28:31]
    ds_read_b128 v[80:83], v3 offset:34816
    v_mfma_f32_16x16x32_bf16 v[36:39], v[84:87], a[12:15], v[36:39]
    s_waitcnt lgkmcnt(6)
    buffer_load_dwordx4 a[56:59], v243, s[8:11], s28 offen offset:2048 sc1
    v_mfma_f32_16x16x32_bf16 v[40:43], v[88:91], a[8:11], v[40:43]
    ds_read_b128 v[84:87], v3 offset:35840
    v_mfma_f32_16x16x32_bf16 v[48:51], v[88:91], a[12:15], v[48:51]
    s_waitcnt lgkmcnt(6)
    v_mfma_f32_16x16x32_bf16 v[44:47], v[92:95], a[8:11], v[44:47]
    ds_read_b128 v[88:91], v3 offset:36864
    v_mfma_f32_16x16x32_bf16 v[52:55], v[92:95], a[12:15], v[52:55]
    s_waitcnt lgkmcnt(6)
    v_mfma_f32_16x16x32_bf16 v[56:59], v[96:99], a[8:11], v[56:59]
    ds_read_b128 v[92:95], v3 offset:37888
    v_mfma_f32_16x16x32_bf16 v[64:67], v[96:99], a[12:15], v[64:67]
    s_waitcnt lgkmcnt(6)
    s_add_u32 m0, s87, 81920
    s_nop 0
    buffer_load_dwordx4 v3, s[20:23], s29 offen offset:2048 lds
    v_mfma_f32_16x16x32_bf16 v[60:63], v[100:103], a[8:11], v[60:63]
    ds_read_b128 v[96:99], v3 offset:38912
    v_mfma_f32_16x16x32_bf16 v[68:71], v[100:103], a[12:15], v[68:71]
    s_waitcnt lgkmcnt(6)
    s_waitcnt vmcnt(22)
    buffer_load_dwordx4 a[60:63], v243, s[8:11], s28 offen offset:2304 sc1
    s_add_u32 s28, s28, 4096
    v_mfma_f32_16x16x32_bf16 v[8:11], v[72:75], a[16:19], v[8:11]
    ds_read_b128 v[100:103], v3 offset:39936
    v_mfma_f32_16x16x32_bf16 v[16:19], v[72:75], a[20:23], v[16:19]
    s_waitcnt lgkmcnt(6)
    v_mfma_f32_16x16x32_bf16 v[12:15], v[76:79], a[16:19], v[12:15]
    ds_read_b128 v[72:75], v3 offset:40960
    v_mfma_f32_16x16x32_bf16 v[20:23], v[76:79], a[20:23], v[20:23]
    s_waitcnt lgkmcnt(6)
    v_mfma_f32_16x16x32_bf16 v[24:27], v[80:83], a[16:19], v[24:27]
    ds_read_b128 v[76:79], v3 offset:41984
    v_mfma_f32_16x16x32_bf16 v[32:35], v[80:83], a[20:23], v[32:35]
    s_waitcnt lgkmcnt(6)
    v_mfma_f32_16x16x32_bf16 v[28:31], v[84:87], a[16:19], v[28:31]
    ds_read_b128 v[80:83], v3 offset:43008
    v_mfma_f32_16x16x32_bf16 v[36:39], v[84:87], a[20:23], v[36:39]
    s_waitcnt lgkmcnt(6)
    s_add_u32 m0, s87, 81920
    s_nop 0
    buffer_load_dwordx4 v3, s[20:23], s29 offen offset:3072 lds
    s_add_u32 s29, s29, 16384
    buffer_load_dwordx4 a[64:67], v243, s[8:11], s28 offen offset:0 sc1
    v_mfma_f32_16x16x32_bf16 v[40:43], v[88:91], a[16:19], v[40:43]
    ds_read_b128 v[84:87], v3 offset:44032
    v_mfma_f32_16x16x32_bf16 v[48:51], v[88:91], a[20:23], v[48:51]
    s_waitcnt lgkmcnt(6)
    v_mfma_f32_16x16x32_bf16 v[44:47], v[92:95], a[16:19], v[44:47]
    ds_read_b128 v[88:91], v3 offset:45056
    v_mfma_f32_16x16x32_bf16 v[52:55], v[92:95], a[20:23], v[52:55]
    s_waitcnt lgkmcnt(6)
    v_mfma_f32_16x16x32_bf16 v[56:59], v[96:99], a[16:19], v[56:59]
    ds_read_b128 v[92:95], v3 offset:46080
    v_mfma_f32_16x16x32_bf16 v[64:67], v[96:99], a[20:23], v[64:67]
    s_waitcnt lgkmcnt(6)
    v_mfma_f32_16x16x32_bf16 v[60:63], v[100:103], a[16:19], v[60:63]
    ds_read_b128 v[96:99], v3 offset:47104
    v_mfma_f32_16x16x32_bf16 v[68:71], v[100:103], a[20:23], v[68:71]
    s_waitcnt lgkmcnt(6)
    s_waitcnt vmcnt(21)
    buffer_load_dwordx4 a[68:71], v243, s[8:11], s28 offen offset:256 sc1
    v_mfma_f32_16x16x32_bf16 v[8:11], v[72:75], a[24:27], v[8:11]
    ds_read_b128 v[100:103], v3 offset:48128
    v_mfma_f32_16x16x32_bf16 v[16:19], v[72:75], a[28:31], v[16:19]
    s_waitcnt lgkmcnt(6)
    s_waitcnt vmcnt(25)
    s_barrier
    v_mfma_f32_16x16x32_bf16 v[12:15], v[76:79], a[24:27], v[12:15]
    ds_read_b128 v[72:75], v3 offset:49152
    v_mfma_f32_16x16x32_bf16 v[20:23], v[76:79], a[28:31], v[20:23]
    s_waitcnt lgkmcnt(6)
    s_add_u32 m0, s87, 98304
    s_nop 0
    buffer_load_dwordx4 v3, s[20:23], s29 offen offset:0 lds
    v_mfma_f32_16x16x32_bf16 v[24:27], v[80:83], a[24:27], v[24:27]
    ds_read_b128 v[76:79], v3 offset:50176
    v_mfma_f32_16x16x32_bf16 v[32:35], v[80:83], a[28:31], v[32:35]
    s_waitcnt lgkmcnt(6)
    v_mfma_f32_16x16x32_bf16 v[28:31], v[84:87], a[24:27], v[28:31]
    ds_read_b128 v[80:83], v3 offset:51200
    v_mfma_f32_16x16x32_bf16 v[36:39], v[84:87], a[28:31], v[36:39]
    s_waitcnt lgkmcnt(6)
    s_cmp_le_u32 s76, 6
    s_addc_u32 s28, s45, 6
    s_and_b32 s28, s28, 7
    s_mul_i32 s28, s28, 14336
    s_add_u32 s28, s28, 4096
    buffer_load_dwordx4 a[72:75], v243, s[8:11], s28 offen offset:0 sc1
    v_mfma_f32_16x16x32_bf16 v[40:43], v[88:91], a[24:27], v[40:43]
    ds_read_b128 v[84:87], v3 offset:52224
    v_mfma_f32_16x16x32_bf16 v[48:51], v[88:91], a[28:31], v[48:51]
    s_waitcnt lgkmcnt(6)
    v_mfma_f32_16x16x32_bf16 v[44:47], v[92:95], a[24:27], v[44:47]
    ds_read_b128 v[88:91], v3 offset:53248
    v_mfma_f32_16x16x32_bf16 v[52:55], v[92:95], a[28:31], v[52:55]
    s_waitcnt lgkmcnt(6)
    v_mfma_f32_16x16x32_bf16 v[56:59], v[96:99], a[24:27], v[56:59]
    ds_read_b128 v[92:95], v3 offset:54272
    v_mfma_f32_16x16x32_bf16 v[64:67], v[96:99], a[28:31], v[64:67]
    s_waitcnt lgkmcnt(6)
    s_add_u32 m0, s87, 98304
    s_nop 0
    buffer_load_dwordx4 v3, s[20:23], s29 offen offset:1024 lds
    v_mfma_f32_16x16x32_bf16 v[60:63], v[100:103], a[24:27], v[60:63]
    ds_read_b128 v[96:99], v3 offset:55296
    v_mfma_f32_16x16x32_bf16 v[68:71], v[100:103], a[28:31], v[68:71]
    s_waitcnt lgkmcnt(6)
    s_waitcnt vmcnt(21)
    buffer_load_dwordx4 a[76:79], v243, s[8:11], s28 offen offset:256 sc1
    v_mfma_f32_16x16x32_bf16 v[8:11], v[72:75], a[32:35], v[8:11]
    ds_read_b128 v[100:103], v3 offset:56320
    v_mfma_f32_16x16x32_bf16 v[16:19], v[72:75], a[36:39], v[16:19]
    s_waitcnt lgkmcnt(6)
    v_mfma_f32_16x16x32_bf16 v[12:15], v[76:79], a[32:35], v[12:15]
    ds_read_b128 v[72:75], v3 offset:57344
    v_mfma_f32_16x16x32_bf16 v[20:23], v[76:79], a[36:39], v[20:23]
    s_waitcnt lgkmcnt(6)
    v_mfma_f32_16x16x32_bf16 v[24:27], v[80:83], a[32:35], v[24:27]
    ds_read_b128 v[76:79], v3 offset:58368
    v_mfma_f32_16x16x32_bf16 v[32:35], v[80:83], a[36:39], v[32:35]
    s_waitcnt lgkmcnt(6)
    v_mfma_f32_16x16x32_bf16 v[28:31], v[84:87], a[32:35], v[28:31]
    ds_read_b128 v[80:83], v3 offset:59392
    v_mfma_f32_16x16x32_bf16 v[36:39], v[84:87], a[36:39], v[36:39]
    s_waitcnt lgkmcnt(6)
    s_add_u32 m0, s87, 98304
    s_nop 0
    buffer_load_dwordx4 v3, s[20:23], s29 offen offset:2048 lds
    buffer_load_dwordx4 a[80:83], v243, s[8:11], s28 offen offset:2048 sc1
    v_mfma_f32_16x16x32_bf16 v[40:43], v[88:91], a[32:35], v[40:43]
    ds_read_b128 v[84:87], v3 offset:60416
    v_mfma_f32_16x16x32_bf16 v[48:51], v[88:91], a[36:39], v[48:51]
    s_waitcnt lgkmcnt(6)
    v_mfma_f32_16x16x32_bf16 v[44:47], v[92:95], a[32:35], v[44:47]
    ds_read_b128 v[88:91], v3 offset:61440
    v_mfma_f32_16x16x32_bf16 v[52:55], v[92:95], a[36:39], v[52:55]
    s_waitcnt lgkmcnt(6)
    v_mfma_f32_16x16x32_bf16 v[56:59], v[96:99], a[32:35], v[56:59]
    ds_read_b128 v[92:95], v3 offset:62464
    v_mfma_f32_16x16x32_bf16 v[64:67], v[96:99], a[36:39], v[64:67]
    s_waitcnt lgkmcnt(6)
    v_mfma_f32_16x16x32_bf16 v[60:63], v[100:103], a[32:35], v[60:63]
    ds_read_b128 v[96:99], v3 offset:63488
    v_mfma_f32_16x16x32_bf16 v[68:71], v[100:103], a[36:39], v[68:71]
    s_waitcnt lgkmcnt(6)
    s_waitcnt vmcnt(18)
    buffer_load_dwordx4 a[84:87], v243, s[8:11], s28 offen offset:2304 sc1
    s_add_u32 s28, s28, 4096
    v_mfma_f32_16x16x32_bf16 v[8:11], v[72:75], a[40:43], v[8:11]
    ds_read_b128 v[100:103], v3 offset:64512
    v_mfma_f32_16x16x32_bf16 v[16:19], v[72:75], a[44:47], v[16:19]
    s_waitcnt lgkmcnt(6)
    s_add_u32 m0, s87, 98304
    s_nop 0
    buffer_load_dwordx4 v3, s[20:23], s29 offen offset:3072 lds
    s_add_u32 s29, s29, 16384
    s_waitcnt vmcnt(21)
    s_barrier
    v_mfma_f32_16x16x32_bf16 v[12:15], v[76:79], a[40:43], v[12:15]
    ds_read_b128 v[72:75], v4 offset:0
    v_mfma_f32_16x16x32_bf16 v[20:23], v[76:79], a[44:47], v[20:23]
    s_waitcnt lgkmcnt(6)
    v_mfma_f32_16x16x32_bf16 v[24:27], v[80:83], a[40:43], v[24:27]
    ds_read_b128 v[76:79], v4 offset:1024
    v_mfma_f32_16x16x32_bf16 v[32:35], v[80:83], a[44:47], v[32:35]
    s_waitcnt lgkmcnt(6)
    v_mfma_f32_16x16x32_bf16 v[28:31], v[84:87], a[40:43], v[28:31]
    ds_read_b128 v[80:83], v4 offset:2048
    v_mfma_f32_16x16x32_bf16 v[36:39], v[84:87], a[44:47], v[36:39]
    s_waitcnt lgkmcnt(6)
    buffer_load_dwordx4 a[88:91], v243, s[8:11], s28 offen offset:0 sc1
    v_mfma_f32_16x16x32_bf16 v[40:43], v[88:91], a[40:43], v[40:43]
    ds_read_b128 v[84:87], v4 offset:3072
    v_mfma_f32_16x16x32_bf16 v[48:51], v[88:91], a[44:47], v[48:51]
    s_waitcnt lgkmcnt(6)
    s_waitcnt vmcnt(19)
    v_cmp_ne_u64 vcc, s[74:75], v[240:241]
    s_cmp_lg_u64 vcc, 0
    s_cbranch_scc1 L_main_kernel_spin_1066
L_main_kernel_ok_1065:
    v_mfma_f32_16x16x32_bf16 v[44:47], v[92:95], a[40:43], v[44:47]
    ds_read_b128 v[88:91], v4 offset:4096
    v_mfma_f32_16x16x32_bf16 v[52:55], v[92:95], a[44:47], v[52:55]
    s_waitcnt lgkmcnt(6)
    v_mfma_f32_16x16x32_bf16 v[56:59], v[96:99], a[40:43], v[56:59]
    ds_read_b128 v[92:95], v4 offset:5120
    v_mfma_f32_16x16x32_bf16 v[64:67], v[96:99], a[44:47], v[64:67]
    s_waitcnt lgkmcnt(6)
    s_add_u32 m0, s87, 114688
    s_nop 0
    buffer_load_dwordx4 v3, s[20:23], s29 offen offset:0 lds
    v_mfma_f32_16x16x32_bf16 v[60:63], v[100:103], a[40:43], v[60:63]
    ds_read_b128 v[96:99], v4 offset:6144
    v_mfma_f32_16x16x32_bf16 v[68:71], v[100:103], a[44:47], v[68:71]
    s_waitcnt lgkmcnt(6)
    s_waitcnt vmcnt(17)
    buffer_load_dwordx4 a[92:95], v243, s[8:11], s28 offen offset:256 sc1
    v_mfma_f32_16x16x32_bf16 v[8:11], v[72:75], a[48:51], v[8:11]
    ds_read_b128 v[100:103], v4 offset:7168
    v_mfma_f32_16x16x32_bf16 v[16:19], v[72:75], a[52:55], v[16:19]
    s_waitcnt lgkmcnt(6)
    v_mfma_f32_16x16x32_bf16 v[12:15], v[76:79], a[48:51], v[12:15]
    ds_read_b128 v[72:75], v4 offset:8192
    v_mfma_f32_16x16x32_bf16 v[20:23], v[76:79], a[52:55], v[20:23]
    s_waitcnt lgkmcnt(6)
    v_mfma_f32_16x16x32_bf16 v[24:27], v[80:83], a[48:51], v[24:27]
    ds_read_b128 v[76:79], v4 offset:9216
    v_mfma_f32_16x16x32_bf16 v[32:35], v[80:83], a[52:55], v[32:35]
    s_waitcnt lgkmcnt(6)
    v_mfma_f32_16x16x32_bf16 v[28:31], v[84:87], a[48:51], v[28:31]
    ds_read_b128 v[80:83], v4 offset:10240
    v_mfma_f32_16x16x32_bf16 v[36:39], v[84:87], a[52:55], v[36:39]
    s_waitcnt lgkmcnt(6)
    s_add_u32 m0, s87, 114688
    s_nop 0
    buffer_load_dwordx4 v3, s[20:23], s29 offen offset:1024 lds
    buffer_load_dwordx4 a[96:99], v243, s[8:11], s28 offen offset:2048 sc1
    v_mfma_f32_16x16x32_bf16 v[40:43], v[88:91], a[48:51], v[40:43]
    ds_read_b128 v[84:87], v4 offset:11264
    v_mfma_f32_16x16x32_bf16 v[48:51], v[88:91], a[52:55], v[48:51]
    s_waitcnt lgkmcnt(6)
    v_mfma_f32_16x16x32_bf16 v[44:47], v[92:95], a[48:51], v[44:47]
    ds_read_b128 v[88:91], v4 offset:12288
    v_mfma_f32_16x16x32_bf16 v[52:55], v[92:95], a[52:55], v[52:55]
    s_waitcnt lgkmcnt(6)
    v_mfma_f32_16x16x32_bf16 v[56:59], v[96:99], a[48:51], v[56:59]
    ds_read_b128 v[92:95], v4 offset:13312
    v_mfma_f32_16x16x32_bf16 v[64:67], v[96:99], a[52:55], v[64:67]
    s_waitcnt lgkmcnt(6)
    v_mfma_f32_16x16x32_bf16 v[60:63], v[100:103], a[48:51], v[60:63]
    ds_read_b128 v[96:99], v4 offset:14336
    v_mfma_f32_16x16x32_bf16 v[68:71], v[100:103], a[52:55], v[68:71]
    s_waitcnt lgkmcnt(6)
    s_waitcnt vmcnt(16)
    buffer_load_dwordx4 a[100:103], v243, s[8:11], s28 offen offset:2304 sc1
    s_add_u32 s28, s28, 4096
    v_mfma_f32_16x16x32_bf16 v[8:11], v[72:75], a[56:59], v[8:11]
    ds_read_b128 v[100:103], v4 offset:15360
    v_mfma_f32_16x16x32_bf16 v[16:19], v[72:75], a[60:63], v[16:19]
    s_waitcnt lgkmcnt(6)
    s_add_u32 m0, s87, 114688
    s_nop 0
    buffer_load_dwordx4 v3, s[20:23], s29 offen offset:2048 lds
    s_waitcnt vmcnt(17)
    s_barrier
    v_mfma_f32_16x16x32_bf16 v[12:15], v[76:79], a[56:59], v[12:15]
    ds_read_b128 v[72:75], v4 offset:16384
    v_mfma_f32_16x16x32_bf16 v[20:23], v[76:79], a[60:63], v[20:23]
    s_waitcnt lgkmcnt(6)
    v_mfma_f32_16x16x32_bf16 v[24:27], v[80:83], a[56:59], v[24:27]
    ds_read_b128 v[76:79], v4 offset:17408
    v_mfma_f32_16x16x32_bf16 v[32:35], v[80:83], a[60:63], v[32:35]
    s_waitcnt lgkmcnt(6)
    v_mfma_f32_16x16x32_bf16 v[28:31], v[84:87], a[56:59], v[28:31]
    ds_read_b128 v[80:83], v4 offset:18432
    v_mfma_f32_16x16x32_bf16 v[36:39], v[84:87], a[60:63], v[36:39]
    s_waitcnt lgkmcnt(6)
    buffer_load_dwordx4 a[104:107], v243, s[8:11], s28 offen offset:0 sc1
    v_mfma_f32_16x16x32_bf16 v[40:43], v[88:91], a[56:59], v[40:43]
    ds_read_b128 v[84:87], v4 offset:19456
    v_mfma_f32_16x16x32_bf16 v[48:51], v[88:91], a[60:63], v[48:51]
    s_waitcnt lgkmcnt(6)
    v_mfma_f32_16x16x32_bf16 v[44:47], v[92:95], a[56:59], v[44:47]
    ds_read_b128 v[88:91], v4 offset:20480
    v_mfma_f32_16x16x32_bf16 v[52:55], v[92:95], a[60:63], v[52:55]
    s_waitcnt lgkmcnt(6)
    s_add_u32 m0, s87, 114688
    s_nop 0
    buffer_load_dwordx4 v3, s[20:23], s29 offen offset:3072 lds
    s_add_u32 s29, s29, 16384
    v_mfma_f32_16x16x32_bf16 v[56:59], v[96:99], a[56:59], v[56:59]
    ds_read_b128 v[92:95], v4 offset:21504
    v_mfma_f32_16x16x32_bf16 v[64:67], v[96:99], a[60:63], v[64:67]
    s_waitcnt lgkmcnt(6)
    v_mfma_f32_16x16x32_bf16 v[60:63], v[100:103], a[56:59], v[60:63]
    ds_read_b128 v[96:99], v4 offset:22528
    v_mfma_f32_16x16x32_bf16 v[68:71], v[100:103], a[60:63], v[68:71]
    s_waitcnt lgkmcnt(6)
    s_waitcnt vmcnt(17)
    buffer_load_dwordx4 a[108:111], v243, s[8:11], s28 offen offset:256 sc1
    v_mfma_f32_16x16x32_bf16 v[8:11], v[72:75], a[64:67], v[8:11]
    ds_read_b128 v[100:103], v4 offset:23552
    v_mfma_f32_16x16x32_bf16 v[16:19], v[72:75], a[68:71], v[16:19]
    s_waitcnt lgkmcnt(6)
    v_mfma_f32_16x16x32_bf16 v[12:15], v[76:79], a[64:67], v[12:15]
    ds_read_b128 v[72:75], v4 offset:24576
    v_mfma_f32_16x16x32_bf16 v[20:23], v[76:79], a[68:71], v[20:23]
    s_waitcnt lgkmcnt(6)
    v_mfma_f32_16x16x32_bf16 v[24:27], v[80:83], a[64:67], v[24:27]
    ds_read_b128 v[76:79], v4 offset:25600
    v_mfma_f32_16x16x32_bf16 v[32:35], v[80:83], a[68:71], v[32:35]
    s_waitcnt lgkmcnt(6)
    v_mfma_f32_16x16x32_bf16 v[28:31], v[84:87], a[64:67], v[28:31]
    ds_read_b128 v[80:83], v4 offset:26624
    v_mfma_f32_16x16x32_bf16 v[36:39], v[84:87], a[68:71], v[36:39]
    s_waitcnt lgkmcnt(6)
    buffer_load_dwordx4 a[0:3], v243, s[20:23], s93 offen offset:0 sc1
    v_mfma_f32_16x16x32_bf16 v[40:43], v[88:91], a[64:67], v[40:43]
    ds_read_b128 v[84:87], v4 offset:27648
    v_mfma_f32_16x16x32_bf16 v[48:51], v[88:91], a[68:71], v[48:51]
    s_waitcnt lgkmcnt(6)
    s_cmp_lg_u32 s42, 0
    s_cselect_b32 s88, s90, 2146435072
    s_cselect_b32 s89, s91, 2146435072
    buffer_load_dwordx4 v[132:135], v243, s[20:23], s89 offen offset:2304 sc1
    v_mfma_f32_16x16x32_bf16 v[44:47], v[92:95], a[64:67], v[44:47]
    ds_read_b128 v[88:91], v4 offset:28672
    v_mfma_f32_16x16x32_bf16 v[52:55], v[92:95], a[68:71], v[52:55]
    s_waitcnt lgkmcnt(6)
    v_mfma_f32_16x16x32_bf16 v[56:59], v[96:99], a[64:67], v[56:59]
    ds_read_b128 v[92:95], v4 offset:29696
    v_mfma_f32_16x16x32_bf16 v[64:67], v[96:99], a[68:71], v[64:67]
    s_waitcnt lgkmcnt(6)
    v_mfma_f32_16x16x32_bf16 v[60:63], v[100:103], a[64:67], v[60:63]
    ds_read_b128 v[96:99], v4 offset:30720
    v_mfma_f32_16x16x32_bf16 v[68:71], v[100:103], a[68:71], v[68:71]
    s_waitcnt lgkmcnt(6)
    s_waitcnt vmcnt(16)
    buffer_load_dwordx4 a[4:7], v243, s[20:23], s93 offen offset:256 sc1
    v_mfma_f32_16x16x32_bf16 v[8:11], v[72:75], a[72:75], v[8:11]
    ds_read_b128 v[100:103], v4 offset:31744
    v_mfma_f32_16x16x32_bf16 v[16:19], v[72:75], a[76:79], v[16:19]
    s_waitcnt lgkmcnt(6)
    s_waitcnt vmcnt(13)
    s_barrier
    v_mfma_f32_16x16x32_bf16 v[12:15], v[76:79], a[72:75], v[12:15]
    ds_read_b128 v[72:75], v4 offset:32768
    v_mfma_f32_16x16x32_bf16 v[20:23], v[76:79], a[76:79], v[20:23]
    s_waitcnt lgkmcnt(6)
    v_mfma_f32_16x16x32_bf16 v[24:27], v[80:83], a[72:75], v[24:27]
    ds_read_b128 v[76:79], v4 offset:33792
    v_mfma_f32_16x16x32_bf16 v[32:35], v[80:83], a[76:79], v[32:35]
    s_waitcnt lgkmcnt(6)
    v_mfma_f32_16x16x32_bf16 v[28:31], v[84:87], a[72:75], v[28:31]
    ds_read_b128 v[80:83], v4 offset:34816
    v_mfma_f32_16x16x32_bf16 v[36:39], v[84:87], a[76:79], v[36:39]
    s_waitcnt lgkmcnt(6)
    buffer_load_dwordx4 a[8:11], v243, s[20:23], s93 offen offset:2048 sc1
    v_mfma_f32_16x16x32_bf16 v[40:43], v[88:91], a[72:75], v[40:43]
    ds_read_b128 v[84:87], v4 offset:35840
    v_mfma_f32_16x16x32_bf16 v[48:51], v[88:91], a[76:79], v[48:51]
    s_waitcnt lgkmcnt(6)
    v_mfma_f32_16x16x32_bf16 v[44:47], v[92:95], a[72:75], v[44:47]
    ds_read_b128 v[88:91], v4 offset:36864
    v_mfma_f32_16x16x32_bf16 v[52:55], v[92:95], a[76:79], v[52:55]
    s_waitcnt lgkmcnt(6)
    v_mfma_f32_16x16x32_bf16 v[56:59], v[96:99], a[72:75], v[56:59]
    ds_read_b128 v[92:95], v4 offset:37888
    v_mfma_f32_16x16x32_bf16 v[64:67], v[96:99], a[76:79], v[64:67]
    s_waitcnt lgkmcnt(6)
    v_mfma_f32_16x16x32_bf16 v[60:63], v[100:103], a[72:75], v[60:63]
    ds_read_b128 v[96:99], v4 offset:38912
    v_mfma_f32_16x16x32_bf16 v[68:71], v[100:103], a[76:79], v[68:71]
    s_waitcnt lgkmcnt(6)
    s_waitcnt vmcnt(15)
    buffer_load_dwordx4 a[12:15], v243, s[20:23], s93 offen offset:2304 sc1
    s_add_u32 s93, s93, 4096
    v_mfma_f32_16x16x32_bf16 v[8:11], v[72:75], a[80:83], v[8:11]
    ds_read_b128 v[100:103], v4 offset:39936
    v_mfma_f32_16x16x32_bf16 v[16:19], v[72:75], a[84:87], v[16:19]
    s_waitcnt lgkmcnt(6)
    v_mfma_f32_16x16x32_bf16 v[12:15], v[76:79], a[80:83], v[12:15]
    ds_read_b128 v[72:75], v4 offset:40960
    v_mfma_f32_16x16x32_bf16 v[20:23], v[76:79], a[84:87], v[20:23]
    s_waitcnt lgkmcnt(6)
    v_mfma_f32_16x16x32_bf16 v[24:27], v[80:83], a[80:83], v[24:27]
    ds_read_b128 v[76:79], v4 offset:41984
    v_mfma_f32_16x16x32_bf16 v[32:35], v[80:83], a[84:87], v[32:35]
    s_waitcnt lgkmcnt(6)
    v_mfma_f32_16x16x32_bf16 v[28:31], v[84:87], a[80:83], v[28:31]
    ds_read_b128 v[80:83], v4 offset:43008
    v_mfma_f32_16x16x32_bf16 v[36:39], v[84:87], a[84:87], v[36:39]
    s_waitcnt lgkmcnt(6)
    v_mfma_f32_16x16x32_bf16 v[40:43], v[88:91], a[80:83], v[40:43]
    ds_read_b128 v[84:87], v4 offset:44032
    v_mfma_f32_16x16x32_bf16 v[48:51], v[88:91], a[84:87], v[48:51]
    s_waitcnt lgkmcnt(6)
    v_mfma_f32_16x16x32_bf16 v[44:47], v[92:95], a[80:83], v[44:47]
    ds_read_b128 v[88:91], v4 offset:45056
    v_mfma_f32_16x16x32_bf16 v[52:55], v[92:95], a[84:87], v[52:55]
    s_waitcnt lgkmcnt(6)
    v_mfma_f32_16x16x32_bf16 v[56:59], v[96:99], a[80:83], v[56:59]
    ds_read_b128 v[92:95], v4 offset:46080
    v_mfma_f32_16x16x32_bf16 v[64:67], v[96:99], a[84:87], v[64:67]
    s_waitcnt lgkmcnt(6)
    v_mfma_f32_16x16x32_bf16 v[60:63], v[100:103], a[80:83], v[60:63]
    ds_read_b128 v[96:99], v4 offset:47104
    v_mfma_f32_16x16x32_bf16 v[68:71], v[100:103], a[84:87], v[68:71]
    s_waitcnt lgkmcnt(6)
    s_waitcnt vmcnt(12)
    v_mfma_f32_16x16x32_bf16 v[8:11], v[72:75], a[88:91], v[8:11]
    ds_read_b128 v[100:103], v4 offset:48128
    v_mfma_f32_16x16x32_bf16 v[16:19], v[72:75], a[92:95], v[16:19]
    s_waitcnt lgkmcnt(6)
    s_waitcnt vmcnt(6)
    s_barrier
    v_mfma_f32_16x16x32_bf16 v[12:15], v[76:79], a[88:91], v[12:15]
    ds_read_b128 v[72:75], v4 offset:49152
    v_mfma_f32_16x16x32_bf16 v[20:23], v[76:79], a[92:95], v[20:23]
    s_waitcnt lgkmcnt(6)
    v_mfma_f32_16x16x32_bf16 v[24:27], v[80:83], a[88:91], v[24:27]
    ds_read_b128 v[76:79], v4 offset:50176
    v_mfma_f32_16x16x32_bf16 v[32:35], v[80:83], a[92:95], v[32:35]
    s_waitcnt lgkmcnt(6)
    v_mfma_f32_16x16x32_bf16 v[28:31], v[84:87], a[88:91], v[28:31]
    ds_read_b128 v[80:83], v4 offset:51200
    v_mfma_f32_16x16x32_bf16 v[36:39], v[84:87], a[92:95], v[36:39]
    s_waitcnt lgkmcnt(6)
    v_mfma_f32_16x16x32_bf16 v[40:43], v[88:91], a[88:91], v[40:43]
    ds_read_b128 v[84:87], v4 offset:52224
    v_mfma_f32_16x16x32_bf16 v[48:51], v[88:91], a[92:95], v[48:51]
    s_waitcnt lgkmcnt(6)
    v_mfma_f32_16x16x32_bf16 v[44:47], v[92:95], a[88:91], v[44:47]
    ds_read_b128 v[88:91], v4 offset:53248
    v_mfma_f32_16x16x32_bf16 v[52:55], v[92:95], a[92:95], v[52:55]
    s_waitcnt lgkmcnt(6)
    v_mfma_f32_16x16x32_bf16 v[56:59], v[96:99], a[88:91], v[56:59]
    ds_read_b128 v[92:95], v4 offset:54272
    v_mfma_f32_16x16x32_bf16 v[64:67], v[96:99], a[92:95], v[64:67]
    s_waitcnt lgkmcnt(6)
    v_mfma_f32_16x16x32_bf16 v[60:63], v[100:103], a[88:91], v[60:63]
    ds_read_b128 v[96:99], v4 offset:55296
    v_mfma_f32_16x16x32_bf16 v[68:71], v[100:103], a[92:95], v[68:71]
    s_waitcnt lgkmcnt(6)
    s_waitcnt vmcnt(9)
    s_cmp_eq_u32 s42, 0
    s_cbranch_scc1 L_main_kernel_send_1053
    v_mfma_f32_16x16x32_bf16 v[8:11], v[72:75], a[96:99], v[8:11]
    ds_read_b128 v[100:103], v4 offset:56320
    v_mfma_f32_16x16x32_bf16 v[16:19], v[72:75], a[100:103], v[16:19]
    s_waitcnt lgkmcnt(6)
    v_mfma_f32_16x16x32_bf16 v[12:15], v[76:79], a[96:99], v[12:15]
    ds_read_b128 v[72:75], v4 offset:57344
    v_mfma_f32_16x16x32_bf16 v[20:23], v[76:79], a[100:103], v[20:23]
    s_waitcnt lgkmcnt(6)
    v_mfma_f32_16x16x32_bf16 v[24:27], v[80:83], a[96:99], v[24:27]
    ds_read_b128 v[76:79], v4 offset:58368
    v_mfma_f32_16x16x32_bf16 v[32:35], v[80:83], a[100:103], v[32:35]
    s_waitcnt lgkmcnt(6)
    s_waitcnt vmcnt(3)
    v_max3_u32 v5, v132, v133, v134
    v_max_u32 v5, v5, v135
    v_cmp_eq_u32 vcc, -1, v5
    s_cmp_lg_u64 vcc, 0
    s_cselect_b32 s88, 2146435072, s88
    s_cselect_b32 s89, 2146435072, s89
    v_mfma_f32_16x16x32_bf16 v[28:31], v[84:87], a[96:99], v[28:31]
    ds_read_b128 v[80:83], v4 offset:59392
    v_mfma_f32_16x16x32_bf16 v[36:39], v[84:87], a[100:103], v[36:39]
    s_waitcnt lgkmcnt(6)
    v_mfma_f32_16x16x32_bf16 v[40:43], v[88:91], a[96:99], v[40:43]
    ds_read_b128 v[84:87], v4 offset:60416
    v_mfma_f32_16x16x32_bf16 v[48:51], v[88:91], a[100:103], v[48:51]
    s_waitcnt lgkmcnt(6)
    buffer_load_dwordx4 v[104:107], v243, s[20:23], s88 offen offset:0 sc1
    v_mfma_f32_16x16x32_bf16 v[44:47], v[92:95], a[96:99], v[44:47]
    ds_read_b128 v[88:91], v4 offset:61440
    v_mfma_f32_16x16x32_bf16 v[52:55], v[92:95], a[100:103], v[52:55]
    s_waitcnt lgkmcnt(6)
    v_mfma_f32_16x16x32_bf16 v[56:59], v[96:99], a[96:99], v[56:59]
    ds_read_b128 v[92:95], v4 offset:62464
    v_mfma_f32_16x16x32_bf16 v[64:67], v[96:99], a[100:103], v[64:67]
    s_waitcnt lgkmcnt(6)
    buffer_load_dwordx4 v[108:111], v243, s[20:23], s88 offen offset:256 sc1
    v_mfma_f32_16x16x32_bf16 v[60:63], v[100:103], a[96:99], v[60:63]
    ds_read_b128 v[96:99], v4 offset:63488
    v_mfma_f32_16x16x32_bf16 v[68:71], v[100:103], a[100:103], v[68:71]
    s_waitcnt lgkmcnt(6)
    s_waitcnt vmcnt(7)
    v_mfma_f32_16x16x32_bf16 v[8:11], v[72:75], a[104:107], v[8:11]
    ds_read_b128 v[100:103], v4 offset:64512
    v_mfma_f32_16x16x32_bf16 v[16:19], v[72:75], a[108:111], v[16:19]
    s_waitcnt lgkmcnt(6)
    buffer_load_dwordx4 v[112:115], v243, s[20:23], s88 offen offset:2048 sc1
    s_waitcnt vmcnt(35)
    s_barrier
    v_mfma_f32_16x16x32_bf16 v[12:15], v[76:79], a[104:107], v[12:15]
    ds_read_b128 v[72:75], v242 offset:0
    v_mfma_f32_16x16x32_bf16 v[20:23], v[76:79], a[108:111], v[20:23]
    s_waitcnt lgkmcnt(6)
    v_mfma_f32_16x16x32_bf16 v[24:27], v[80:83], a[104:107], v[24:27]
    ds_read_b128 v[76:79], v242 offset:1024
    v_mfma_f32_16x16x32_bf16 v[32:35], v[80:83], a[108:111], v[32:35]
    s_waitcnt lgkmcnt(6)
    buffer_load_dwordx4 v[116:119], v243, s[20:23], s88 offen offset:2304 sc1
    v_mfma_f32_16x16x32_bf16 v[28:31], v[84:87], a[104:107], v[28:31]
    ds_read_b128 v[80:83], v242 offset:2048
    v_mfma_f32_16x16x32_bf16 v[36:39], v[84:87], a[108:111], v[36:39]
    s_waitcnt lgkmcnt(6)
    v_mfma_f32_16x16x32_bf16 v[40:43], v[88:91], a[104:107], v[40:43]
    ds_read_b128 v[84:87], v242 offset:3072
    v_mfma_f32_16x16x32_bf16 v[48:51], v[88:91], a[108:111], v[48:51]
    s_waitcnt lgkmcnt(6)
    buffer_load_dwordx4 v[120:123], v243, s[20:23], s89 offen offset:0 sc1
    v_mfma_f32_16x16x32_bf16 v[44:47], v[92:95], a[104:107], v[44:47]
    ds_read_b128 v[88:91], v242 offset:4096
    v_mfma_f32_16x16x32_bf16 v[52:55], v[92:95], a[108:111], v[52:55]
    s_waitcnt lgkmcnt(6)
    v_mfma_f32_16x16x32_bf16 v[56:59], v[96:99], a[104:107], v[56:59]
    ds_read_b128 v[92:95], v242 offset:5120
    v_mfma_f32_16x16x32_bf16 v[64:67], v[96:99], a[108:111], v[64:67]
    s_waitcnt lgkmcnt(6)
    buffer_load_dwordx4 v[124:127], v243, s[20:23], s89 offen offset:256 sc1
    v_mfma_f32_16x16x32_bf16 v[60:63], v[100:103], a[104:107], v[60:63]
    ds_read_b128 v[96:99], v242 offset:6144
    v_mfma_f32_16x16x32_bf16 v[68:71], v[100:103], a[108:111], v[68:71]
    s_waitcnt lgkmcnt(6)
    s_waitcnt vmcnt(8)
    v_mfma_f32_16x16x32_bf16 v[8:11], v[72:75], a[0:3], v[8:11]
    ds_read_b128 v[100:103], v242 offset:7168
    v_mfma_f32_16x16x32_bf16 v[16:19], v[72:75], a[4:7], v[16:19]
    s_waitcnt lgkmcnt(6)
    buffer_load_dwordx4 v[128:131], v243, s[20:23], s89 offen offset:2048 sc1
    v_mfma_f32_16x16x32_bf16 v[12:15], v[76:79], a[0:3], v[12:15]
    ds_read_b128 v[72:75], v242 offset:8192
    v_mfma_f32_16x16x32_bf16 v[20:23], v[76:79], a[4:7], v[20:23]
    s_waitcnt lgkmcnt(6)
    v_mfma_f32_16x16x32_bf16 v[24:27], v[80:83], a[0:3], v[24:27]
    ds_read_b128 v[76:79], v242 offset:9216
    v_mfma_f32_16x16x32_bf16 v[32:35], v[80:83], a[4:7], v[32:35]
    s_waitcnt lgkmcnt(6)
    v_mfma_f32_16x16x32_bf16 v[28:31], v[84:87], a[0:3], v[28:31]
    ds_read_b128 v[80:83], v242 offset:10240
    v_mfma_f32_16x16x32_bf16 v[36:39], v[84:87], a[4:7], v[36:39]
    s_waitcnt lgkmcnt(6)
    v_mfma_f32_16x16x32_bf16 v[40:43], v[88:91], a[0:3], v[40:43]
    ds_read_b128 v[84:87], v242 offset:11264
    v_mfma_f32_16x16x32_bf16 v[48:51], v[88:91], a[4:7], v[48:51]
    s_waitcnt lgkmcnt(6)
    v_mfma_f32_16x16x32_bf16 v[44:47], v[92:95], a[0:3], v[44:47]
    ds_read_b128 v[88:91], v242 offset:12288
    v_mfma_f32_16x16x32_bf16 v[52:55], v[92:95], a[4:7], v[52:55]
    s_waitcnt lgkmcnt(6)
    v_mfma_f32_16x16x32_bf16 v[56:59], v[96:99], a[0:3], v[56:59]
    ds_read_b128 v[92:95], v242 offset:13312
    v_mfma_f32_16x16x32_bf16 v[64:67], v[96:99], a[4:7], v[64:67]
    s_waitcnt lgkmcnt(6)
    v_mfma_f32_16x16x32_bf16 v[60:63], v[100:103], a[0:3], v[60:63]
    ds_read_b128 v[96:99], v242 offset:14336
    v_mfma_f32_16x16x32_bf16 v[68:71], v[100:103], a[4:7], v[68:71]
    s_waitcnt lgkmcnt(6)
    s_waitcnt vmcnt(7)
    v_mfma_f32_16x16x32_bf16 v[8:11], v[72:75], a[8:11], v[8:11]
    ds_read_b128 v[100:103], v242 offset:15360
    v_mfma_f32_16x16x32_bf16 v[16:19], v[72:75], a[12:15], v[16:19]
    s_waitcnt lgkmcnt(6)
    v_mfma_f32_16x16x32_bf16 v[12:15], v[76:79], a[8:11], v[12:15]
    v_mfma_f32_16x16x32_bf16 v[20:23], v[76:79], a[12:15], v[20:23]
    s_waitcnt lgkmcnt(5)
    v_mfma_f32_16x16x32_bf16 v[24:27], v[80:83], a[8:11], v[24:27]
    v_mfma_f32_16x16x32_bf16 v[32:35], v[80:83], a[12:15], v[32:35]
    s_waitcnt lgkmcnt(4)
    v_mfma_f32_16x16x32_bf16 v[28:31], v[84:87], a[8:11], v[28:31]
    v_mfma_f32_16x16x32_bf16 v[36:39], v[84:87], a[12:15], v[36:39]
    s_waitcnt lgkmcnt(3)
    v_mfma_f32_16x16x32_bf16 v[40:43], v[88:91], a[8:11], v[40:43]
    v_mfma_f32_16x16x32_bf16 v[48:51], v[88:91], a[12:15], v[48:51]
    s_waitcnt lgkmcnt(2)
    v_mfma_f32_16x16x32_bf16 v[44:47], v[92:95], a[8:11], v[44:47]
    v_mfma_f32_16x16x32_bf16 v[52:55], v[92:95], a[12:15], v[52:55]
    s_waitcnt lgkmcnt(1)
    v_mfma_f32_16x16x32_bf16 v[56:59], v[96:99], a[8:11], v[56:59]
    v_mfma_f32_16x16x32_bf16 v[64:67], v[96:99], a[12:15], v[64:67]
    s_waitcnt lgkmcnt(0)
    v_mfma_f32_16x16x32_bf16 v[60:63], v[100:103], a[8:11], v[60:63]
    v_mfma_f32_16x16x32_bf16 v[68:71], v[100:103], a[12:15], v[68:71]
L_main_kernel_f2j_1061:
    s_cmp_lg_u32 s42, 0
    s_cbranch_scc1 L_main_kernel_recv_1050
L_main_kernel_send_1053:
    v_cvt_pk_bf16_f32 v136, v8, v9
    v_cvt_pk_bf16_f32 v137, v10, v11
    v_cvt_pk_bf16_f32 v138, v12, v13
    v_cvt_pk_bf16_f32 v139, v14, v15
    buffer_store_dwordx4 v[136:139], v243, s[20:23], s90 offen offset:0 sc1
    v_cvt_pk_bf16_f32 v140, v16, v17
    v_cvt_pk_bf16_f32 v141, v18, v19
    v_cvt_pk_bf16_f32 v142, v20, v21
    v_cvt_pk_bf16_f32 v143, v22, v23
    buffer_store_dwordx4 v[140:143], v243, s[20:23], s90 offen offset:256 sc1
    v_cvt_pk_bf16_f32 v144, v24, v25
    v_cvt_pk_bf16_f32 v145, v26, v27
    v_cvt_pk_bf16_f32 v146, v28, v29
    v_cvt_pk_bf16_f32 v147, v30, v31
    buffer_store_dwordx4 v[144:147], v243, s[20:23], s90 offen offset:2048 sc1
    v_cvt_pk_bf16_f32 v148, v32, v33
    v_cvt_pk_bf16_f32 v149, v34, v35
    v_cvt_pk_bf16_f32 v150, v36, v37
    v_cvt_pk_bf16_f32 v151, v38, v39
    buffer_store_dwordx4 v[148:151], v243, s[20:23], s90 offen offset:2304 sc1
    v_cvt_pk_bf16_f32 v152, v40, v41
    v_cvt_pk_bf16_f32 v153, v42, v43
    v_cvt_pk_bf16_f32 v154, v44, v45
    v_cvt_pk_bf16_f32 v155, v46, v47
    buffer_store_dwordx4 v[152:155], v243, s[20:23], s91 offen offset:0 sc1
    v_cvt_pk_bf16_f32 v156, v48, v49
    v_cvt_pk_bf16_f32 v157, v50, v51
    v_cvt_pk_bf16_f32 v158, v52, v53
    v_cvt_pk_bf16_f32 v159, v54, v55
    buffer_store_dwordx4 v[156:159], v243, s[20:23], s91 offen offset:256 sc1
    v_cvt_pk_bf16_f32 v160, v56, v57
    v_cvt_pk_bf16_f32 v161, v58, v59
    v_cvt_pk_bf16_f32 v162, v60, v61
    v_cvt_pk_bf16_f32 v163, v62, v63
    buffer_store_dwordx4 v[160:163], v243, s[20:23], s91 offen offset:2048 sc1
    v_cvt_pk_bf16_f32 v164, v64, v65
    v_cvt_pk_bf16_f32 v165, v66, v67
    v_cvt_pk_bf16_f32 v166, v68, v69
    v_cvt_pk_bf16_f32 v167, v70, v71
    buffer_store_dwordx4 v[164:167], v243, s[20:23], s91 offen offset:2304 sc1
    s_cmp_lg_u32 s56, 0
    s_cbranch_scc1 L_main_kernel_end_1001
    s_waitcnt vmcnt(0) lgkmcnt(0)
    s_add_u32 m0, s87, 131072
    s_add_u32 s60, s47, 0
    buffer_load_dwordx4 v252, s[96:99], s60 offen offset:0 lds
    s_add_u32 s60, s47, 15360
    buffer_load_dwordx4 v252, s[96:99], s60 offen offset:1024 lds
    s_add_u32 s60, s47, 30720
    buffer_load_dwordx4 v252, s[96:99], s60 offen offset:2048 lds
    s_add_u32 s60, s47, 46080
    buffer_load_dwordx4 v252, s[96:99], s60 offen offset:3072 lds
    s_add_u32 m0, s87, 147456
    s_add_u32 s60, s47, 262144
    buffer_load_dwordx4 v252, s[96:99], s60 offen offset:0 lds
    s_add_u32 s60, s47, 277504
    buffer_load_dwordx4 v252, s[96:99], s60 offen offset:1024 lds
    s_add_u32 s60, s47, 292864
    buffer_load_dwordx4 v252, s[96:99], s60 offen offset:2048 lds
    s_add_u32 s60, s47, 308224
    buffer_load_dwordx4 v252, s[96:99], s60 offen offset:3072 lds
    s_add_u32 m0, s87, 0
    s_add_u32 s60, s47, 524288
    buffer_load_dwordx4 v252, s[96:99], s60 offen offset:0 lds
    s_add_u32 s60, s47, 539648
    buffer_load_dwordx4 v252, s[96:99], s60 offen offset:1024 lds
    s_add_u32 s60, s47, 555008
    buffer_load_dwordx4 v252, s[96:99], s60 offen offset:2048 lds
    s_add_u32 s60, s47, 570368
    buffer_load_dwordx4 v252, s[96:99], s60 offen offset:3072 lds
    s_add_u32 m0, s87, 16384
    s_add_u32 s60, s47, 786432
    buffer_load_dwordx4 v252, s[96:99], s60 offen offset:0 lds
    s_add_u32 s60, s47, 801792
    buffer_load_dwordx4 v252, s[96:99], s60 offen offset:1024 lds
    s_add_u32 s60, s47, 817152
    buffer_load_dwordx4 v252, s[96:99], s60 offen offset:2048 lds
    s_add_u32 s60, s47, 832512
    buffer_load_dwordx4 v252, s[96:99], s60 offen offset:3072 lds
    s_add_u32 m0, s87, 32768
    s_add_u32 s60, s47, 1048576
    buffer_load_dwordx4 v252, s[96:99], s60 offen offset:0 lds
    s_add_u32 s60, s47, 1063936
    buffer_load_dwordx4 v252, s[96:99], s60 offen offset:1024 lds
    s_add_u32 s60, s47, 1079296
    buffer_load_dwordx4 v252, s[96:99], s60 offen offset:2048 lds
    s_add_u32 s60, s47, 1094656
    buffer_load_dwordx4 v252, s[96:99], s60 offen offset:3072 lds
    s_add_u32 m0, s87, 49152
    s_add_u32 s60, s47, 1310720
    buffer_load_dwordx4 v252, s[96:99], s60 offen offset:0 lds
    s_add_u32 s60, s47, 1326080
    buffer_load_dwordx4 v252, s[96:99], s60 offen offset:1024 lds
    s_add_u32 s60, s47, 1341440
    buffer_load_dwordx4 v252, s[96:99], s60 offen offset:2048 lds
    s_add_u32 s60, s47, 1356800
    buffer_load_dwordx4 v252, s[96:99], s60 offen offset:3072 lds
    s_add_u32 m0, s87, 65536
    s_add_u32 s60, s47, 1572864
    buffer_load_dwordx4 v252, s[96:99], s60 offen offset:0 lds
    s_add_u32 s60, s47, 1588224
    buffer_load_dwordx4 v252, s[96:99], s60 offen offset:1024 lds
    s_add_u32 s60, s47, 1603584
    buffer_load_dwordx4 v252, s[96:99], s60 offen offset:2048 lds
    s_add_u32 s60, s47, 1618944
    buffer_load_dwordx4 v252, s[96:99], s60 offen offset:3072 lds
    s_add_u32 m0, s87, 81920
    s_add_u32 s60, s47, 1835008
    buffer_load_dwordx4 v252, s[96:99], s60 offen offset:0 lds
    s_add_u32 s60, s47, 1850368
    buffer_load_dwordx4 v252, s[96:99], s60 offen offset:1024 lds
    s_add_u32 s60, s47, 1865728
    buffer_load_dwordx4 v252, s[96:99], s60 offen offset:2048 lds
    s_add_u32 s60, s47, 1881088
    buffer_load_dwordx4 v252, s[96:99], s60 offen offset:3072 lds
    s_mov_b32 s35, 1835008
    buffer_load_dwordx2 v[240:241], v251, s[16:19], s35 offen sc1
    s_waitcnt vmcnt(0)
    v_cmp_ne_u64 vcc, s[74:75], v[240:241]
    s_cmp_lg_u64 vcc, 0
    s_cbranch_scc1 L_main_kernel_spin_1069
L_main_kernel_ok_1068:
    s_mov_b32 s83, 2146435072
    s_branch L_main_kernel_ywait_1051
L_main_kernel_recv_1050:
    s_barrier
    s_waitcnt vmcnt(0)
    v_max3_u32 v5, v104, v105, v106
    v_max3_u32 v5, v5, v107, v108
    v_max3_u32 v5, v5, v109, v110
    v_max3_u32 v5, v5, v111, v112
    v_max3_u32 v5, v5, v113, v114
    v_max3_u32 v5, v5, v115, v116
    v_max3_u32 v5, v5, v117, v118
    v_max3_u32 v5, v5, v119, v120
    v_max3_u32 v5, v5, v121, v122
    v_max3_u32 v5, v5, v123, v124
    v_max3_u32 v5, v5, v125, v126
    v_max3_u32 v5, v5, v127, v128
    v_max3_u32 v5, v5, v129, v130
    v_max3_u32 v5, v5, v131, v132
    v_max3_u32 v5, v5, v133, v134
    v_max_u32 v5, v5, v135
    v_cmp_eq_u32 vcc, -1, v5
    s_cmp_lg_u64 vcc, 0
    s_cbranch_scc1 L_main_kernel_spin_1072
L_main_kernel_ok_1071:
    v_mfma_f32_16x16x32_bf16 v[8:11], a[212:215], v[104:107], v[8:11]
    v_mfma_f32_16x16x32_bf16 v[16:19], a[212:215], v[108:111], v[16:19]
    v_mfma_f32_16x16x32_bf16 v[24:27], a[212:215], v[112:115], v[24:27]
    v_mfma_f32_16x16x32_bf16 v[32:35], a[212:215], v[116:119], v[32:35]
    v_mfma_f32_16x16x32_bf16 v[40:43], a[212:215], v[120:123], v[40:43]
    v_mfma_f32_16x16x32_bf16 v[48:51], a[212:215], v[124:127], v[48:51]
    v_mfma_f32_16x16x32_bf16 v[56:59], a[212:215], v[128:131], v[56:59]
    v_mfma_f32_16x16x32_bf16 v[64:67], a[212:215], v[132:135], v[64:67]
    v_mfma_f32_16x16x32_bf16 v[12:15], a[216:219], v[104:107], v[12:15]
    v_mfma_f32_16x16x32_bf16 v[20:23], a[216:219], v[108:111], v[20:23]
    v_mfma_f32_16x16x32_bf16 v[28:31], a[216:219], v[112:115], v[28:31]
    v_mfma_f32_16x16x32_bf16 v[36:39], a[216:219], v[116:119], v[36:39]
    v_mfma_f32_16x16x32_bf16 v[44:47], a[216:219], v[120:123], v[44:47]
    v_mfma_f32_16x16x32_bf16 v[52:55], a[216:219], v[124:127], v[52:55]
    v_mfma_f32_16x16x32_bf16 v[60:63], a[216:219], v[128:131], v[60:63]
    v_mfma_f32_16x16x32_bf16 v[68:71], a[216:219], v[132:135], v[68:71]
    s_cmp_lg_u32 s56, 0
    s_cbranch_scc1 L_main_kernel_final_1052
    v_mov_b32 v168, 0
    v_mov_b32 v169, 0
    v_mov_b32 v170, 0
    v_mov_b32 v171, 0
    v_mov_b32 v172, 0
    v_mov_b32 v173, 0
    v_mov_b32 v174, 0
    v_mov_b32 v175, 0
    v_mov_b32 v176, 0x3f803f80
    v_and_b32 v5, 31, v2
    v_lshlrev_b32 v5, 3, v5
    s_lshl_b32 s35, s94, 16
    s_lshl_b32 s33, s40, 13
    s_add_u32 s35, s35, s33
    s_add_u32 s35, s35, 0
    s_lshl_b32 s34, s40, 15
    s_lshl_b32 s33, s94, 8
    s_add_u32 s34, s34, s33
    s_add_u32 s34, s34, 1310720
    v_cvt_pk_bf16_f32 v136, v8, v9
    v_cvt_pk_bf16_f32 v137, v10, v11
    v_cvt_pk_bf16_f32 v138, v12, v13
    v_cvt_pk_bf16_f32 v139, v14, v15
    v_cvt_pk_bf16_f32 v140, v16, v17
    v_cvt_pk_bf16_f32 v141, v18, v19
    v_cvt_pk_bf16_f32 v142, v20, v21
    v_cvt_pk_bf16_f32 v143, v22, v23
    v_cvt_pk_bf16_f32 v144, v24, v25
    v_cvt_pk_bf16_f32 v145, v26, v27
    v_cvt_pk_bf16_f32 v146, v28, v29
    v_cvt_pk_bf16_f32 v147, v30, v31
    v_cvt_pk_bf16_f32 v148, v32, v33
    v_cvt_pk_bf16_f32 v149, v34, v35
    v_cvt_pk_bf16_f32 v150, v36, v37
    v_cvt_pk_bf16_f32 v151, v38, v39
    buffer_store_dwordx4 v[136:139], v243, s[20:23], s35 offen offset:0 sc1
    buffer_store_dwordx4 v[140:143], v243, s[20:23], s35 offen offset:256 sc1
    buffer_store_dwordx4 v[144:147], v243, s[20:23], s35 offen offset:2048 sc1
    buffer_store_dwordx4 v[148:151], v243, s[20:23], s35 offen offset:2304 sc1
    v_cvt_pk_bf16_f32 v152, v40, v41
    v_cvt_pk_bf16_f32 v153, v42, v43
    v_cvt_pk_bf16_f32 v154, v44, v45
    v_cvt_pk_bf16_f32 v155, v46, v47
    v_cvt_pk_bf16_f32 v156, v48, v49
    v_cvt_pk_bf16_f32 v157, v50, v51
    v_cvt_pk_bf16_f32 v158, v52, v53
    v_cvt_pk_bf16_f32 v159, v54, v55
    v_cvt_pk_bf16_f32 v160, v56, v57
    v_cvt_pk_bf16_f32 v161, v58, v59
    v_cvt_pk_bf16_f32 v162, v60, v61
    v_cvt_pk_bf16_f32 v163, v62, v63
    v_cvt_pk_bf16_f32 v164, v64, v65
    v_cvt_pk_bf16_f32 v165, v66, v67
    v_cvt_pk_bf16_f32 v166, v68, v69
    v_cvt_pk_bf16_f32 v167, v70, v71
    s_add_u32 s35, s35, 4096
    buffer_store_dwordx4 v[152:155], v243, s[20:23], s35 offen offset:0 sc1
    buffer_store_dwordx4 v[156:159], v243, s[20:23], s35 offen offset:256 sc1
    buffer_store_dwordx4 v[160:163], v243, s[20:23], s35 offen offset:2048 sc1
    buffer_store_dwordx4 v[164:167], v243, s[20:23], s35 offen offset:2304 sc1
    v_dot2_f32_bf16 v168, v136, v176, v168
    v_dot2_f32_bf16 v169, v136, v136, v169
    v_dot2_f32_bf16 v172, v152, v176, v172
    v_dot2_f32_bf16 v173, v152, v152, v173
    v_dot2_f32_bf16 v168, v137, v176, v168
    v_dot2_f32_bf16 v169, v137, v137, v169
    v_dot2_f32_bf16 v172, v153, v176, v172
    v_dot2_f32_bf16 v173, v153, v153, v173
    v_dot2_f32_bf16 v168, v138, v176, v168
    v_dot2_f32_bf16 v169, v138, v138, v169
    v_dot2_f32_bf16 v172, v154, v176, v172
    v_dot2_f32_bf16 v173, v154, v154, v173
    v_dot2_f32_bf16 v168, v139, v176, v168
    v_dot2_f32_bf16 v169, v139, v139, v169
    v_dot2_f32_bf16 v172, v155, v176, v172
    v_dot2_f32_bf16 v173, v155, v155, v173
    v_dot2_f32_bf16 v170, v140, v176, v170
    v_dot2_f32_bf16 v171, v140, v140, v171
    v_dot2_f32_bf16 v174, v156, v176, v174
    v_dot2_f32_bf16 v175, v156, v156, v175
    v_dot2_f32_bf16 v170, v141, v176, v170
    v_dot2_f32_bf16 v171, v141, v141, v171
    v_dot2_f32_bf16 v174, v157, v176, v174
    v_dot2_f32_bf16 v175, v157, v157, v175
    v_dot2_f32_bf16 v170, v142, v176, v170
    v_dot2_f32_bf16 v171, v142, v142, v171
    v_dot2_f32_bf16 v174, v158, v176, v174
    v_dot2_f32_bf16 v175, v158, v158, v175
    v_dot2_f32_bf16 v170, v143, v176, v170
    v_dot2_f32_bf16 v171, v143, v143, v171
    v_dot2_f32_bf16 v174, v159, v176, v174
    v_dot2_f32_bf16 v175, v159, v159, v175
    v_dot2_f32_bf16 v168, v144, v176, v168
    v_dot2_f32_bf16 v169, v144, v144, v169
    v_dot2_f32_bf16 v172, v160, v176, v172
    v_dot2_f32_bf16 v173, v160, v160, v173
    v_dot2_f32_bf16 v168, v145, v176, v168
    v_dot2_f32_bf16 v169, v145, v145, v169
    v_dot2_f32_bf16 v172, v161, v176, v172
    v_dot2_f32_bf16 v173, v161, v161, v173
    v_dot2_f32_bf16 v168, v146, v176, v168
    v_dot2_f32_bf16 v169, v146, v146, v169
    v_dot2_f32_bf16 v172, v162, v176, v172
    v_dot2_f32_bf16 v173, v162, v162, v173
    v_dot2_f32_bf16 v168, v147, v176, v168
    v_dot2_f32_bf16 v169, v147, v147, v169
    v_dot2_f32_bf16 v172, v163, v176, v172
    v_dot2_f32_bf16 v173, v163, v163, v173
    v_dot2_f32_bf16 v170, v148, v176, v170
    v_dot2_f32_bf16 v171, v148, v148, v171
    v_dot2_f32_bf16 v174, v164, v176, v174
    v_dot2_f32_bf16 v175, v164, v164, v175
    v_dot2_f32_bf16 v170, v149, v176, v170
    v_dot2_f32_bf16 v171, v149, v149, v171
    v_dot2_f32_bf16 v174, v165, v176, v174
    v_dot2_f32_bf16 v175, v165, v165, v175
    v_dot2_f32_bf16 v170, v150, v176, v170
    v_dot2_f32_bf16 v171, v150, v150, v171
    v_dot2_f32_bf16 v174, v166, v176, v174
    v_dot2_f32_bf16 v175, v166, v166, v175
    v_dot2_f32_bf16 v170, v151, v176, v170
    v_dot2_f32_bf16 v171, v151, v151, v171
    v_dot2_f32_bf16 v174, v167, v176, v174
    v_dot2_f32_bf16 v175, v167, v167, v175
    s_nop 2
    v_permlane16_swap_b32 v168, v170
    v_permlane16_swap_b32 v169, v171
    v_permlane16_swap_b32 v172, v174
    v_permlane16_swap_b32 v173, v175
    s_nop 0
    v_add_f32 v168, v168, v170
    v_add_f32 v169, v169, v171
    v_add_f32 v172, v172, v174
    v_add_f32 v173, v173, v175
    v_mov_b32 v170, v168
    v_mov_b32 v171, v169
    v_mov_b32 v174, v172
    v_mov_b32 v175, v173
    s_nop 1
    v_permlane32_swap_b32 v168, v170
    v_permlane32_swap_b32 v169, v171
    v_permlane32_swap_b32 v172, v174
    v_permlane32_swap_b32 v173, v175
    s_nop 0
    v_add_f32 v168, v168, v170
    v_add_f32 v169, v169, v171
    v_add_f32 v172, v172, v174
    v_add_f32 v173, v173, v175
    buffer_store_dwordx2 v[168:169], v5, s[16:19], s34 offen sc1
    s_add_u32 s34, s34, 16384
    buffer_store_dwordx2 v[172:173], v5, s[16:19], s34 offen sc1
    s_add_u32 m0, s87, 131072
    s_add_u32 s60, s47, 0
    buffer_load_dwordx4 v252, s[96:99], s60 offen offset:0 lds
    s_add_u32 s60, s47, 15360
    buffer_load_dwordx4 v252, s[96:99], s60 offen offset:1024 lds
    s_add_u32 s60, s47, 30720
    buffer_load_dwordx4 v252, s[96:99], s60 offen offset:2048 lds
    s_add_u32 s60, s47, 46080
    buffer_load_dwordx4 v252, s[96:99], s60 offen offset:3072 lds
    s_add_u32 m0, s87, 65536
    s_add_u32 s60, s47, 1572864
    buffer_load_dwordx4 v252, s[96:99], s60 offen offset:0 lds
    s_add_u32 s60, s47, 1588224
    buffer_load_dwordx4 v252, s[96:99], s60 offen offset:1024 lds
    s_add_u32 s60, s47, 1603584
    buffer_load_dwordx4 v252, s[96:99], s60 offen offset:2048 lds
    s_add_u32 s60, s47, 1618944
    buffer_load_dwordx4 v252, s[96:99], s60 offen offset:3072 lds
    s_lshl_b32 s83, s94, 7
    s_lshl_b32 s32, s40, 4
    s_add_u32 s83, s83, s32
    s_add_u32 s33, s83, 1835008
    s_waitcnt vmcnt(8)
    s_mov_b64 exec, 1
    buffer_store_dwordx4 v[244:247], off, s[16:19], s33
    s_mov_b64 exec, -1
    s_mov_b32 s35, 1835008
    buffer_load_dwordx2 v[240:241], v251, s[16:19], s35 offen sc1
    s_add_u32 m0, s87, 81920
    s_add_u32 s60, s47, 1835008
    buffer_load_dwordx4 v252, s[96:99], s60 offen offset:0 lds
    s_add_u32 s60, s47, 1850368
    buffer_load_dwordx4 v252, s[96:99], s60 offen offset:1024 lds
    s_add_u32 s60, s47, 1865728
    buffer_load_dwordx4 v252, s[96:99], s60 offen offset:2048 lds
    s_add_u32 s60, s47, 1881088
    buffer_load_dwordx4 v252, s[96:99], s60 offen offset:3072 lds
    s_waitcnt vmcnt(4)
    v_cmp_ne_u64 vcc, s[74:75], v[240:241]
    s_cmp_lg_u64 vcc, 0
    s_cbranch_scc1 L_main_kernel_spin_1076
L_main_kernel_ok_1075:
L_main_kernel_ywait_1051:
    s_add_u32 s16, s16, 1048576
    s_addc_u32 s17, s17, 0
    s_mov_b32 s56, 1
    s_branch L_main_kernel_layer_1005
L_main_kernel_final_1052:
    s_mov_b32 s8, s6
    s_mov_b32 s9, s7
    s_mov_b32 s10, 4194304
    s_mov_b32 s11, 0x20000
    s_lshl_b32 s35, s94, 16
    s_lshl_b32 s33, s40, 8
    s_add_u32 s35, s35, s33
    s_lshl_b32 s33, s54, 14
    v_and_b32 v5, 15, v2
    v_lshrrev_b32 v6, 4, v2
    v_mul_u32_u24 v7, 272, v5
    v_lshl_add_u32 v7, v6, 3, v7
    v_add_u32 v7, s33, v7
    v_add_u32 v168, 4352, v7
    v_mul_u32_u24 v169, 272, v6
    v_lshl_add_u32 v169, v5, 4, v169
    v_add_u32 v169, s33, v169
    v_lshlrev_b32 v6, 11, v6
    v_lshl_add_u32 v5, v5, 4, v6
    v_cvt_pk_bf16_f32 v136, v8, v9
    v_cvt_pk_bf16_f32 v137, v10, v11
    v_cvt_pk_bf16_f32 v138, v12, v13
    v_cvt_pk_bf16_f32 v139, v14, v15
    ds_write2_b64 v7, v[136:137], v[138:139] offset0:0 offset1:4
    v_cvt_pk_bf16_f32 v140, v16, v17
    v_cvt_pk_bf16_f32 v141, v18, v19
    v_cvt_pk_bf16_f32 v142, v20, v21
    v_cvt_pk_bf16_f32 v143, v22, v23
    ds_write2_b64 v168, v[140:141], v[142:143] offset0:0 offset1:4
    v_cvt_pk_bf16_f32 v144, v24, v25
    v_cvt_pk_bf16_f32 v145, v26, v27
    v_cvt_pk_bf16_f32 v146, v28, v29
    v_cvt_pk_bf16_f32 v147, v30, v31
    ds_write2_b64 v7, v[144:145], v[146:147] offset0:8 offset1:12
    v_cvt_pk_bf16_f32 v148, v32, v33
    v_cvt_pk_bf16_f32 v149, v34, v35
    v_cvt_pk_bf16_f32 v150, v36, v37
    v_cvt_pk_bf16_f32 v151, v38, v39
    ds_write2_b64 v168, v[148:149], v[150:151] offset0:8 offset1:12
    v_cvt_pk_bf16_f32 v152, v40, v41
    v_cvt_pk_bf16_f32 v153, v42, v43
    v_cvt_pk_bf16_f32 v154, v44, v45
    v_cvt_pk_bf16_f32 v155, v46, v47
    ds_write2_b64 v7, v[152:153], v[154:155] offset0:16 offset1:20
    v_cvt_pk_bf16_f32 v156, v48, v49
    v_cvt_pk_bf16_f32 v157, v50, v51
    v_cvt_pk_bf16_f32 v158, v52, v53
    v_cvt_pk_bf16_f32 v159, v54, v55
    ds_write2_b64 v168, v[156:157], v[158:159] offset0:16 offset1:20
    v_cvt_pk_bf16_f32 v160, v56, v57
    v_cvt_pk_bf16_f32 v161, v58, v59
    v_cvt_pk_bf16_f32 v162, v60, v61
    v_cvt_pk_bf16_f32 v163, v62, v63
    ds_write2_b64 v7, v[160:161], v[162:163] offset0:24 offset1:28
    v_cvt_pk_bf16_f32 v164, v64, v65
    v_cvt_pk_bf16_f32 v165, v66, v67
    v_cvt_pk_bf16_f32 v166, v68, v69
    v_cvt_pk_bf16_f32 v167, v70, v71
    ds_write2_b64 v168, v[164:165], v[166:167] offset0:24 offset1:28
    s_waitcnt lgkmcnt(0)
    ds_read_b128 v[176:179], v169 offset:0
    ds_read_b128 v[180:183], v169 offset:1088
    ds_read_b128 v[184:187], v169 offset:2176
    ds_read_b128 v[188:191], v169 offset:3264
    ds_read_b128 v[192:195], v169 offset:4352
    ds_read_b128 v[196:199], v169 offset:5440
    ds_read_b128 v[200:203], v169 offset:6528
    ds_read_b128 v[204:207], v169 offset:7616
    s_waitcnt lgkmcnt(7)
    buffer_store_dwordx4 v[176:179], v5, s[8:11], s35 offen sc1
    s_add_u32 s35, s35, 8192
    s_waitcnt lgkmcnt(6)
    buffer_store_dwordx4 v[180:183], v5, s[8:11], s35 offen sc1
    s_add_u32 s35, s35, 8192
    s_waitcnt lgkmcnt(5)
    buffer_store_dwordx4 v[184:187], v5, s[8:11], s35 offen sc1
    s_add_u32 s35, s35, 8192
    s_waitcnt lgkmcnt(4)
    buffer_store_dwordx4 v[188:191], v5, s[8:11], s35 offen sc1
    s_add_u32 s35, s35, 8192
    s_waitcnt lgkmcnt(3)
    buffer_store_dwordx4 v[192:195], v5, s[8:11], s35 offen sc1
    s_add_u32 s35, s35, 8192
    s_waitcnt lgkmcnt(2)
    buffer_store_dwordx4 v[196:199], v5, s[8:11], s35 offen sc1
    s_add_u32 s35, s35, 8192
    s_waitcnt lgkmcnt(1)
    buffer_store_dwordx4 v[200:203], v5, s[8:11], s35 offen sc1
    s_add_u32 s35, s35, 8192
    s_waitcnt lgkmcnt(0)
    buffer_store_dwordx4 v[204:207], v5, s[8:11], s35 offen sc1
    s_xor_b32 s33, s2, 128
    s_or_b32 s33, s33, s54
    s_cselect_b32 s33, 2098200576, 0
    s_add_u32 s33, s33, 48234496
    s_mov_b64 exec, 1
    buffer_store_dwordx2 v[244:245], off, s[20:23], s33
    s_mov_b64 exec, -1
L_main_kernel_end_1001:
    s_endpgm
L_main_kernel_spin_1008:
    s_mov_b32 s32, 262143
    s_mov_b32 s33, s35
L_main_kernel_sl_1009:
    s_and_b32 s59, s32, 15
    s_cselect_b32 s35, s33, 839680
    s_cbranch_scc1 L_main_kernel_sk_1010
    s_mov_b64 exec, 1
    s_add_u32 s59, s83, 839680
    buffer_store_dwordx2 v[244:245], off, s[16:19], s59 sc1
    s_mov_b64 exec, -1
L_main_kernel_sk_1010:
    buffer_load_dwordx2 v[240:241], v251, s[16:19], s35 offen sc1
    s_waitcnt vmcnt(0)
    v_cmp_ne_u64 vcc, s[74:75], v[240:241]
    s_cmp_lg_u64 vcc, 0
    s_cbranch_scc0 L_main_kernel_ok_1007
    s_sub_u32 s32, s32, 1
    s_cmp_lg_u32 s32, 0
    s_cbranch_scc1 L_main_kernel_sl_1009
    s_branch L_main_kernel_ok_1007
L_main_kernel_spin_1013:
    s_mov_b32 s32, 262143
    s_mov_b32 s33, s35
L_main_kernel_sl_1014:
    s_and_b32 s59, s32, 15
    s_cselect_b32 s35, s33, 888832
    buffer_load_dwordx2 v[240:241], v7, s[16:19], s35 offen sc1
    s_waitcnt vmcnt(0)
    v_cmp_ne_u64 vcc, s[74:75], v[240:241]
    s_cmp_lg_u64 vcc, 0
    s_cbranch_scc0 L_main_kernel_ok_1012
    s_sub_u32 s32, s32, 1
    s_cmp_lg_u32 s32, 0
    s_cbranch_scc1 L_main_kernel_sl_1014
    s_branch L_main_kernel_ok_1012
L_main_kernel_spin_1017:
    s_mov_b32 s32, 262143
L_main_kernel_sl_1018:
    buffer_load_dwordx2 v[240:241], v254, s[16:19], s78 offen sc1
    s_waitcnt vmcnt(0)
    v_cmp_ne_u64 vcc, s[74:75], v[240:241]
    s_cmp_lg_u64 vcc, 0
    s_cbranch_scc0 L_main_kernel_ok_1016
    s_sub_u32 s32, s32, 1
    s_cmp_lg_u32 s32, 0
    s_cbranch_scc1 L_main_kernel_sl_1018
    s_branch L_main_kernel_ok_1016
L_main_kernel_spin_1022:
    s_mov_b32 s32, 262143
L_main_kernel_sl_1023:
    buffer_load_dwordx2 v[108:109], v254, s[16:19], s78 offen sc1
    s_waitcnt vmcnt(0)
    v_cmp_ne_u64 vcc, s[74:75], v[108:109]
    s_cmp_lg_u64 vcc, 0
    s_cbranch_scc0 L_main_kernel_ok_1021
    s_sub_u32 s32, s32, 1
    s_cmp_lg_u32 s32, 0
    s_cbranch_scc1 L_main_kernel_sl_1023
    s_branch L_main_kernel_ok_1021
L_main_kernel_spin_1025:
    s_mov_b32 s32, 262143
L_main_kernel_sl_1026:
    buffer_load_dwordx2 v[108:109], v254, s[16:19], s78 offen sc1
    s_waitcnt vmcnt(0)
    v_cmp_ne_u64 vcc, s[74:75], v[108:109]
    s_cmp_lg_u64 vcc, 0
    s_cbranch_scc0 L_main_kernel_ok_1024
    s_sub_u32 s32, s32, 1
    s_cmp_lg_u32 s32, 0
    s_cbranch_scc1 L_main_kernel_sl_1026
    s_branch L_main_kernel_ok_1024
L_main_kernel_spec_1027:
    s_mov_b64 exec, 1
    buffer_store_dwordx2 v[244:245], off, s[20:23], s67 sc1
    s_mov_b64 exec, -1
    s_branch L_main_kernel_bk_1028
L_main_kernel_slow_1030:
    v_mov_b32 v200, 0
    v_mov_b32 v201, 0
    v_mov_b32 v202, 0
    v_mov_b32 v203, 0
    v_mov_b32 v204, 0
    v_mov_b32 v205, 0
    v_mov_b32 v206, 0
    v_mov_b32 v207, 0
    v_mov_b32 v208, 0
    v_mov_b32 v209, 0
    v_mov_b32 v210, 0
    v_mov_b32 v211, 0
    v_mov_b32 v212, 0
    v_mov_b32 v213, 0
    v_mov_b32 v214, 0
    v_mov_b32 v215, 0
    v_mov_b32 v232, 0
    v_mov_b32 v233, 0
    v_mov_b32 v234, 0
    v_mov_b32 v235, 0
    v_mov_b32 v48, 0xff800000
    s_mov_b32 s33, 0
L_main_kernel_sloop_1031:
    buffer_load_dwordx4 v[8:11], v3, s[12:15], s33 offen offset:0 sc1
    buffer_load_dwordx4 v[12:15], v3, s[12:15], s33 offen offset:1024 sc1
    buffer_load_dwordx4 v[16:19], v3, s[12:15], s33 offen offset:2048 sc1
    buffer_load_dwordx4 v[20:23], v3, s[12:15], s33 offen offset:3072 sc1
    s_waitcnt vmcnt(0)
    v_mfma_f32_32x32x16_bf16 v[24:39], v[8:11], v[112:115], 0
    v_mfma_f32_32x32x16_bf16 v[24:39], v[12:15], v[116:119], v[24:39]
    s_nop 11
    v_max3_f32 v6, v24, v25, v26
    v_max3_f32 v6, v6, v27, v28
    v_max3_f32 v6, v6, v29, v30
    v_max3_f32 v6, v6, v31, v32
    v_max3_f32 v6, v6, v33, v34
    v_max3_f32 v6, v6, v35, v36
    v_max3_f32 v6, v6, v37, v38
    v_max_f32 v6, v6, v39
    v_mov_b32 v5, v6
    s_nop 1
    v_permlane32_swap_b32 v6, v5
    s_nop 0
    v_max_f32 v6, v6, v5
    v_max_f32 v6, v6, v48
    v_sub_f32 v49, v48, v6
    v_exp_f32 v49, v49
    v_mov_b32 v48, v6
    v_sub_f32 v24, v24, v6
    v_sub_f32 v25, v25, v6
    v_sub_f32 v26, v26, v6
    v_sub_f32 v27, v27, v6
    v_sub_f32 v28, v28, v6
    v_sub_f32 v29, v29, v6
    v_sub_f32 v30, v30, v6
    v_sub_f32 v31, v31, v6
    v_sub_f32 v32, v32, v6
    v_sub_f32 v33, v33, v6
    v_sub_f32 v34, v34, v6
    v_sub_f32 v35, v35, v6
    v_sub_f32 v36, v36, v6
    v_sub_f32 v37, v37, v6
    v_sub_f32 v38, v38, v6
    v_sub_f32 v39, v39, v6
    v_exp_f32 v24, v24
    v_exp_f32 v25, v25
    v_exp_f32 v26, v26
    v_exp_f32 v27, v27
    v_exp_f32 v28, v28
    v_exp_f32 v29, v29
    v_exp_f32 v30, v30
    v_exp_f32 v31, v31
    v_exp_f32 v32, v32
    v_exp_f32 v33, v33
    v_exp_f32 v34, v34
    v_exp_f32 v35, v35
    v_exp_f32 v36, v36
    v_exp_f32 v37, v37
    v_exp_f32 v38, v38
    v_exp_f32 v39, v39
    v_mul_f32 v200, v200, v49
    v_mul_f32 v201, v201, v49
    v_mul_f32 v202, v202, v49
    v_mul_f32 v203, v203, v49
    v_mul_f32 v204, v204, v49
    v_mul_f32 v205, v205, v49
    v_mul_f32 v206, v206, v49
    v_mul_f32 v207, v207, v49
    v_mul_f32 v208, v208, v49
    v_mul_f32 v209, v209, v49
    v_mul_f32 v210, v210, v49
    v_mul_f32 v211, v211, v49
    v_mul_f32 v212, v212, v49
    v_mul_f32 v213, v213, v49
    v_mul_f32 v214, v214, v49
    v_mul_f32 v215, v215, v49
    v_mul_f32 v232, v232, v49
    v_mul_f32 v233, v233, v49
    v_mul_f32 v234, v234, v49
    v_mul_f32 v235, v235, v49
    s_nop 1
    v_smfmac_f32_32x32x32_bf16 v[200:215], v[16:19], v[24:31], v111
    v_smfmac_f32_16x16x64_bf16 v[232:235], a[252:255], v[24:31], v111
    v_smfmac_f32_32x32x32_bf16 v[200:215], v[20:23], v[32:39], v111
    v_smfmac_f32_16x16x64_bf16 v[232:235], a[252:255], v[32:39], v111
    s_nop 11
    s_add_u32 s33, s33, 4096
    s_cmp_lt_u32 s33, 262144
    s_cbranch_scc1 L_main_kernel_sloop_1031
    s_branch L_main_kernel_fin_1029
L_main_kernel_slow_1033:
    v_mov_b32 v216, 0
    v_mov_b32 v217, 0
    v_mov_b32 v218, 0
    v_mov_b32 v219, 0
    v_mov_b32 v220, 0
    v_mov_b32 v221, 0
    v_mov_b32 v222, 0
    v_mov_b32 v223, 0
    v_mov_b32 v224, 0
    v_mov_b32 v225, 0
    v_mov_b32 v226, 0
    v_mov_b32 v227, 0
    v_mov_b32 v228, 0
    v_mov_b32 v229, 0
    v_mov_b32 v230, 0
    v_mov_b32 v231, 0
    v_mov_b32 v236, 0
    v_mov_b32 v237, 0
    v_mov_b32 v238, 0
    v_mov_b32 v239, 0
    v_mov_b32 v48, 0xff800000
    s_mov_b32 s33, 0
L_main_kernel_sloop_1034:
    buffer_load_dwordx4 v[8:11], v3, s[12:15], s33 offen offset:0 sc1
    buffer_load_dwordx4 v[12:15], v3, s[12:15], s33 offen offset:1024 sc1
    buffer_load_dwordx4 v[16:19], v3, s[12:15], s33 offen offset:2048 sc1
    buffer_load_dwordx4 v[20:23], v3, s[12:15], s33 offen offset:3072 sc1
    s_waitcnt vmcnt(0)
    v_mfma_f32_32x32x16_bf16 v[24:39], v[8:11], v[120:123], 0
    v_mfma_f32_32x32x16_bf16 v[24:39], v[12:15], v[124:127], v[24:39]
    s_nop 11
    v_max3_f32 v6, v24, v25, v26
    v_max3_f32 v6, v6, v27, v28
    v_max3_f32 v6, v6, v29, v30
    v_max3_f32 v6, v6, v31, v32
    v_max3_f32 v6, v6, v33, v34
    v_max3_f32 v6, v6, v35, v36
    v_max3_f32 v6, v6, v37, v38
    v_max_f32 v6, v6, v39
    v_mov_b32 v5, v6
    s_nop 1
    v_permlane32_swap_b32 v6, v5
    s_nop 0
    v_max_f32 v6, v6, v5
    v_max_f32 v6, v6, v48
    v_sub_f32 v49, v48, v6
    v_exp_f32 v49, v49
    v_mov_b32 v48, v6
    v_sub_f32 v24, v24, v6
    v_sub_f32 v25, v25, v6
    v_sub_f32 v26, v26, v6
    v_sub_f32 v27, v27, v6
    v_sub_f32 v28, v28, v6
    v_sub_f32 v29, v29, v6
    v_sub_f32 v30, v30, v6
    v_sub_f32 v31, v31, v6
    v_sub_f32 v32, v32, v6
    v_sub_f32 v33, v33, v6
    v_sub_f32 v34, v34, v6
    v_sub_f32 v35, v35, v6
    v_sub_f32 v36, v36, v6
    v_sub_f32 v37, v37, v6
    v_sub_f32 v38, v38, v6
    v_sub_f32 v39, v39, v6
    v_exp_f32 v24, v24
    v_exp_f32 v25, v25
    v_exp_f32 v26, v26
    v_exp_f32 v27, v27
    v_exp_f32 v28, v28
    v_exp_f32 v29, v29
    v_exp_f32 v30, v30
    v_exp_f32 v31, v31
    v_exp_f32 v32, v32
    v_exp_f32 v33, v33
    v_exp_f32 v34, v34
    v_exp_f32 v35, v35
    v_exp_f32 v36, v36
    v_exp_f32 v37, v37
    v_exp_f32 v38, v38
    v_exp_f32 v39, v39
    v_mul_f32 v216, v216, v49
    v_mul_f32 v217, v217, v49
    v_mul_f32 v218, v218, v49
    v_mul_f32 v219, v219, v49
    v_mul_f32 v220, v220, v49
    v_mul_f32 v221, v221, v49
    v_mul_f32 v222, v222, v49
    v_mul_f32 v223, v223, v49
    v_mul_f32 v224, v224, v49
    v_mul_f32 v225, v225, v49
    v_mul_f32 v226, v226, v49
    v_mul_f32 v227, v227, v49
    v_mul_f32 v228, v228, v49
    v_mul_f32 v229, v229, v49
    v_mul_f32 v230, v230, v49
    v_mul_f32 v231, v231, v49
    v_mul_f32 v236, v236, v49
    v_mul_f32 v237, v237, v49
    v_mul_f32 v238, v238, v49
    v_mul_f32 v239, v239, v49
    s_nop 1
    v_smfmac_f32_32x32x32_bf16 v[216:231], v[16:19], v[24:31], v111
    v_smfmac_f32_16x16x64_bf16 v[236:239], a[252:255], v[24:31], v111
    v_smfmac_f32_32x32x32_bf16 v[216:231], v[20:23], v[32:39], v111
    v_smfmac_f32_16x16x64_bf16 v[236:239], a[252:255], v[32:39], v111
    s_nop 11
    s_add_u32 s33, s33, 4096
    s_cmp_lt_u32 s33, 262144
    s_cbranch_scc1 L_main_kernel_sloop_1034
    s_branch L_main_kernel_fin_1032
L_main_kernel_spin_1036:
    s_mov_b32 s32, 262143
L_main_kernel_sl_1037:
    buffer_load_dwordx4 v[16:19], v3, s[20:23], s89 offen sc1
    buffer_load_dwordx4 v[20:23], v3, s[20:23], s89 offen offset:1024 sc1
    s_waitcnt vmcnt(0)
    v_cmp_ne_u64 vcc, s[74:75], v[16:17]
    v_cmp_ne_u64 s[34:35], s[74:75], v[18:19]
    s_or_b64 vcc, vcc, s[34:35]
    v_cmp_ne_u64 s[34:35], s[74:75], v[20:21]
    s_or_b64 vcc, vcc, s[34:35]
    v_cmp_ne_u64 s[34:35], s[74:75], v[22:23]
    s_or_b64 vcc, vcc, s[34:35]
    s_cmp_lg_u64 vcc, 0
    s_cbranch_scc0 L_main_kernel_ok_1035
    s_sub_u32 s32, s32, 1
    s_cmp_lg_u32 s32, 0
    s_cbranch_scc1 L_main_kernel_sl_1037
    s_branch L_main_kernel_ok_1035
L_main_kernel_spin_1039:
    s_mov_b32 s32, 262143
    s_mov_b32 s33, s35
L_main_kernel_sl_1040:
    s_and_b32 s59, s32, 15
    s_cselect_b32 s35, s33, 847872
    s_cbranch_scc1 L_main_kernel_sk_1041
    s_mov_b64 exec, 1
    s_add_u32 s59, s83, 847872
    buffer_store_dwordx2 v[244:245], off, s[16:19], s59 sc1
    s_mov_b64 exec, -1
L_main_kernel_sk_1041:
    buffer_load_dwordx2 v[240:241], v250, s[16:19], s35 offen sc1
    s_waitcnt vmcnt(0)
    v_cmp_ne_u64 vcc, s[74:75], v[240:241]
    s_cmp_lg_u64 vcc, 0
    s_cbranch_scc0 L_main_kernel_ok_1038
    s_sub_u32 s32, s32, 1
    s_cmp_lg_u32 s32, 0
    s_cbranch_scc1 L_main_kernel_sl_1040
    s_branch L_main_kernel_ok_1038
L_main_kernel_spin_1043:
    s_mov_b32 s32, 262143
    s_mov_b32 s33, s35
L_main_kernel_sl_1044:
    s_and_b32 s59, s32, 15
    s_cselect_b32 s35, s33, 880640
    s_cbranch_scc1 L_main_kernel_sk_1045
    s_mov_b64 exec, 1
    s_add_u32 s59, s83, 880640
    buffer_store_dwordx2 v[244:245], off, s[16:19], s59 sc1
    s_mov_b64 exec, -1
L_main_kernel_sk_1045:
    buffer_load_dwordx2 v[240:241], v250, s[16:19], s35 offen sc1
    s_waitcnt vmcnt(0)
    v_cmp_ne_u64 vcc, s[74:75], v[240:241]
    s_cmp_lg_u64 vcc, 0
    s_cbranch_scc0 L_main_kernel_ok_1042
    s_sub_u32 s32, s32, 1
    s_cmp_lg_u32 s32, 0
    s_cbranch_scc1 L_main_kernel_sl_1044
    s_branch L_main_kernel_ok_1042
L_main_kernel_spin_1047:
    s_mov_b32 s32, 262143
    s_mov_b32 s33, s35
L_main_kernel_sl_1048:
    s_and_b32 s59, s32, 15
    s_cselect_b32 s35, s33, 856064
    buffer_load_dwordx2 v[240:241], v0, s[16:19], s35 offen sc1
    s_waitcnt vmcnt(0)
    v_cmp_ne_u64 vcc, s[74:75], v[240:241]
    s_cmp_lg_u64 vcc, 0
    s_cbranch_scc0 L_main_kernel_ok_1046
    s_sub_u32 s32, s32, 1
    s_cmp_lg_u32 s32, 0
    s_cbranch_scc1 L_main_kernel_sl_1048
    s_branch L_main_kernel_ok_1046
L_main_kernel_spin_1055:
    s_mov_b32 s32, 262143
    s_mov_b32 s33, s35
L_main_kernel_sl_1056:
    s_and_b32 s59, s32, 15
    s_cselect_b32 s35, s33, 864256
    buffer_load_dwordx2 v[240:241], v1, s[16:19], s35 offen sc1
    s_waitcnt vmcnt(0)
    v_cmp_ne_u64 vcc, s[74:75], v[240:241]
    s_cmp_lg_u64 vcc, 0
    s_cbranch_scc0 L_main_kernel_ok_1054
    s_sub_u32 s32, s32, 1
    s_cmp_lg_u32 s32, 0
    s_cbranch_scc1 L_main_kernel_sl_1056
    s_branch L_main_kernel_ok_1054
L_main_kernel_spin_1058:
    s_mov_b32 s32, 262143
    s_mov_b32 s33, s35
L_main_kernel_sl_1059:
    s_and_b32 s59, s32, 15
    s_cselect_b32 s35, s33, 872448
    buffer_load_dwordx2 v[240:241], v1, s[16:19], s35 offen sc1
    s_waitcnt vmcnt(0)
    v_cmp_ne_u64 vcc, s[74:75], v[240:241]
    s_cmp_lg_u64 vcc, 0
    s_cbranch_scc0 L_main_kernel_ok_1057
    s_sub_u32 s32, s32, 1
    s_cmp_lg_u32 s32, 0
    s_cbranch_scc1 L_main_kernel_sl_1059
    s_branch L_main_kernel_ok_1057
L_main_kernel_spin_1063:
    s_mov_b32 s32, 262143
L_main_kernel_sl_1064:
    buffer_load_dwordx2 v[240:241], v235, s[16:19], s35 offen sc1
    s_waitcnt vmcnt(0)
    v_cmp_ne_u64 vcc, s[74:75], v[240:241]
    s_cmp_lg_u64 vcc, 0
    s_cbranch_scc0 L_main_kernel_ok_1062
    s_sub_u32 s32, s32, 1
    s_cmp_lg_u32 s32, 0
    s_cbranch_scc1 L_main_kernel_sl_1064
    s_branch L_main_kernel_ok_1062
L_main_kernel_spin_1066:
    s_mov_b32 s32, 262143
L_main_kernel_sl_1067:
    buffer_load_dwordx2 v[240:241], v235, s[16:19], s35 offen sc1
    s_waitcnt vmcnt(0)
    v_cmp_ne_u64 vcc, s[74:75], v[240:241]
    s_cmp_lg_u64 vcc, 0
    s_cbranch_scc0 L_main_kernel_ok_1065
    s_sub_u32 s32, s32, 1
    s_cmp_lg_u32 s32, 0
    s_cbranch_scc1 L_main_kernel_sl_1067
    s_branch L_main_kernel_ok_1065
L_main_kernel_spin_1069:
    s_mov_b32 s32, 262143
    s_mov_b32 s33, s35
L_main_kernel_sl_1070:
    s_and_b32 s59, s32, 15
    s_cselect_b32 s35, s33, 1888256
    buffer_load_dwordx2 v[240:241], v251, s[16:19], s35 offen sc1
    s_waitcnt vmcnt(0)
    v_cmp_ne_u64 vcc, s[74:75], v[240:241]
    s_cmp_lg_u64 vcc, 0
    s_cbranch_scc0 L_main_kernel_ok_1068
    s_sub_u32 s32, s32, 1
    s_cmp_lg_u32 s32, 0
    s_cbranch_scc1 L_main_kernel_sl_1070
    s_branch L_main_kernel_ok_1068
L_main_kernel_spin_1072:
    s_mov_b32 s32, 262144
L_main_kernel_sl_1073:
    buffer_load_dwordx4 v[104:107], v243, s[20:23], s90 offen offset:0 sc1
    buffer_load_dwordx4 v[108:111], v243, s[20:23], s90 offen offset:256 sc1
    buffer_load_dwordx4 v[112:115], v243, s[20:23], s90 offen offset:2048 sc1
    buffer_load_dwordx4 v[116:119], v243, s[20:23], s90 offen offset:2304 sc1
    buffer_load_dwordx4 v[120:123], v243, s[20:23], s91 offen offset:0 sc1
    buffer_load_dwordx4 v[124:127], v243, s[20:23], s91 offen offset:256 sc1
    buffer_load_dwordx4 v[128:131], v243, s[20:23], s91 offen offset:2048 sc1
    buffer_load_dwordx4 v[132:135], v243, s[20:23], s91 offen offset:2304 sc1
    s_waitcnt vmcnt(0)
    v_max3_u32 v5, v104, v105, v106
    v_max3_u32 v5, v5, v107, v108
    v_max3_u32 v5, v5, v109, v110
    v_max3_u32 v5, v5, v111, v112
    v_max3_u32 v5, v5, v113, v114
    v_max3_u32 v5, v5, v115, v116
    v_max3_u32 v5, v5, v117, v118
    v_max3_u32 v5, v5, v119, v120
    v_max3_u32 v5, v5, v121, v122
    v_max3_u32 v5, v5, v123, v124
    v_max3_u32 v5, v5, v125, v126
    v_max3_u32 v5, v5, v127, v128
    v_max3_u32 v5, v5, v129, v130
    v_max3_u32 v5, v5, v131, v132
    v_max3_u32 v5, v5, v133, v134
    v_max_u32 v5, v5, v135
    v_cmp_eq_u32 vcc, -1, v5
    s_cmp_lg_u64 vcc, 0
    s_cbranch_scc0 L_main_kernel_ok_1071
L_main_kernel_nx_1074:
    s_sub_u32 s32, s32, 1
    s_cmp_lg_u32 s32, 0
    s_cbranch_scc1 L_main_kernel_sl_1073
    buffer_load_dwordx4 v[104:107], v243, s[20:23], s90 offen offset:0 sc1
    buffer_load_dwordx4 v[108:111], v243, s[20:23], s90 offen offset:256 sc1
    buffer_load_dwordx4 v[112:115], v243, s[20:23], s90 offen offset:2048 sc1
    buffer_load_dwordx4 v[116:119], v243, s[20:23], s90 offen offset:2304 sc1
    buffer_load_dwordx4 v[120:123], v243, s[20:23], s91 offen offset:0 sc1
    buffer_load_dwordx4 v[124:127], v243, s[20:23], s91 offen offset:256 sc1
    buffer_load_dwordx4 v[128:131], v243, s[20:23], s91 offen offset:2048 sc1
    buffer_load_dwordx4 v[132:135], v243, s[20:23], s91 offen offset:2304 sc1
    s_waitcnt vmcnt(0)
    s_branch L_main_kernel_ok_1071
L_main_kernel_spin_1076:
    s_mov_b32 s32, 262143
    s_mov_b32 s33, s35
L_main_kernel_sl_1077:
    s_and_b32 s59, s32, 15
    s_cselect_b32 s35, s33, 1888256
    s_cbranch_scc1 L_main_kernel_sk_1078
    s_mov_b64 exec, 1
    s_add_u32 s59, s83, 1888256
    buffer_store_dwordx4 v[244:247], off, s[16:19], s59 sc1
    s_mov_b64 exec, -1
L_main_kernel_sk_1078:
    buffer_load_dwordx2 v[240:241], v251, s[16:19], s35 offen sc1
    s_waitcnt vmcnt(0)
    v_cmp_ne_u64 vcc, s[74:75], v[240:241]
    s_cmp_lg_u64 vcc, 0
    s_cbranch_scc0 L_main_kernel_ok_1075
    s_sub_u32 s32, s32, 1
    s_cmp_lg_u32 s32, 0
    s_cbranch_scc1 L_main_kernel_sl_1077
    s_branch L_main_kernel_ok_1075
Lcode_end:
    s_endpgm
    s_endpgm
    s_endpgm
    s_endpgm
    s_endpgm
    s_endpgm
    s_endpgm
    s_endpgm
    s_endpgm
    s_endpgm
    s_endpgm
    s_endpgm
    s_endpgm
    s_endpgm
    s_endpgm
    s_endpgm
    s_endpgm
    s_endpgm
    s_endpgm
    s_endpgm
    s_endpgm
    s_endpgm
    s_endpgm
    s_endpgm
    s_endpgm
    s_endpgm
    s_endpgm
    s_endpgm
    s_endpgm
    s_endpgm
    s_endpgm
    s_endpgm
    s_endpgm
    s_endpgm
    s_endpgm
    s_endpgm
    s_endpgm
    s_endpgm
    s_endpgm
    s_endpgm
    s_endpgm
    s_endpgm
    s_endpgm
    s_endpgm
    s_endpgm
    s_endpgm
    s_endpgm
    s_endpgm
    s_endpgm
    s_endpgm
    s_endpgm
    s_endpgm
    s_endpgm
    s_endpgm
    s_endpgm
    s_endpgm
    s_endpgm
    s_endpgm
    s_endpgm
    s_endpgm
    s_endpgm
    s_endpgm
    s_endpgm
    s_endpgm
.section .rodata,"a"
.p2align 6
.amdhsa_kernel interleave_layers__grouped_kv_mqa__dense_activation_silu__prompt_kernel
  .amdhsa_next_free_vgpr 512
  .amdhsa_next_free_sgpr 102
  .amdhsa_accum_offset 256
  .amdhsa_group_segment_fixed_size 0
  .amdhsa_kernarg_size 88
  .amdhsa_user_sgpr_count 2
  .amdhsa_user_sgpr_kernarg_segment_ptr 1
  .amdhsa_system_sgpr_workgroup_id_x 1
.end_amdhsa_kernel
```
